```python
import torch

def _softmax(x, axis=-1):
    return torch.softmax(x, dim=axis)
def _gelu(x):
    return torch.nn.functional.gelu(x, approximate="tanh")
def _silu(x):
    return torch.nn.functional.silu(x)
def _sigmoid(x):
    return torch.sigmoid(x)
def _layernorm(x, axis=-1, eps=1e-5):
    m = x.mean(dim=axis, keepdim=True)
    v = x.var(dim=axis, keepdim=True, unbiased=False)
    return (x - m) / torch.sqrt(v + eps)
def _scatter_add(tgt, idx, src, axis=0):
    return tgt.clone().index_add_(axis, idx, src)
def _segment_sum(src, seg, n):
    out = torch.zeros((n,) + src.shape[1:], dtype=src.dtype)
    return out.index_add_(0, seg, src)
def _pad(x, pw):
    flat = tuple(v for pair in reversed(pw) for v in pair)
    return torch.nn.functional.pad(x, flat)

kernel_name = 'standalone__gqa_block_cached__near_ridge'

def setup_inputs():

    _w = (lambda a: (lambda t: t.to(torch.bfloat16) if t.is_floating_point() else t)(torch.as_tensor(a)))
    B, Sq, D = 8, 256, 640
    Hq, Hkv, Sk, Dh = 32, 32, 1024, 192
    assert Hq % Hkv == 0, (Hq, Hkv)
    return {
        "x": _w((lambda *s: torch.randn(*s, dtype=torch.bfloat16) * 0.8)(B, Sq, D)),
        "k_cache": _w((lambda *s: torch.randn(*s, dtype=torch.bfloat16) * 0.8)(B, Hkv, Sk, Dh)),
        "v_cache": _w((lambda *s: torch.randn(*s, dtype=torch.bfloat16) * 0.05)(B, Hkv, Sk, Dh)),
        "wq": _w((lambda *s: torch.randn(*s, dtype=torch.bfloat16) * 0.8)(D, Hq * Dh) * (D ** -0.5)),
        "wo": _w((lambda *s: torch.randn(*s, dtype=torch.bfloat16) * 0.05)(Hq * Dh, D) * ((Hq * Dh) ** -0.5)),
    }

def reference(x, k_cache, v_cache, wq, wo):
    B, Sq, D = x.shape
    Hq, Dh = 32, 192
    Hkv = k_cache.shape[1]
    rep = Hq // Hkv
    q = (lambda x, *d: x.permute(*d))((x @ wq).reshape(B, Sq, Hq, Dh), 0, 2, 1, 3)
    k = (lambda x, n, axis: torch.repeat_interleave(x, n, dim=axis))(k_cache, rep, axis=1)
    v = (lambda x, n, axis: torch.repeat_interleave(x, n, dim=axis))(v_cache, rep, axis=1)
    scores = torch.einsum("bhqd,bhkd->bhqk", q, k) * (Dh ** -0.5)
    p = _softmax(scores, axis=-1)
    o = torch.einsum("bhqk,bhkd->bhqd", p, v)
    return (lambda x, *d: x.permute(*d))(o, 0, 2, 1, 3).reshape(B, Sq, Hq * Dh) @ wo
```

```asm
; @launch grid=(256,1,1) block=(256,1,1) lds=163840
.amdgcn_target "amdgcn-amd-amdhsa--gfx950"
.text
.globl standalone__gqa_block_cached__near_ridge_kernel
.p2align 8
.type standalone__gqa_block_cached__near_ridge_kernel,@function
standalone__gqa_block_cached__near_ridge_kernel:
 s_cmp_ge_u32 s2, 256
 s_cbranch_scc1 L_END
 s_load_dwordx16 s[4:19], s[0:1], 0
 s_memrealtime s[82:83]
 v_lshrrev_b32 v1, 6, v0
 v_and_b32 v0, 63, v0
 v_readfirstlane_b32 s3, v1
 s_and_b32 s60, s2, 1
 s_lshl_b32 s60, s60, 2
 s_bfe_u32 s75, s2, 0x20003
 s_add_u32 s60, s60, s75
 s_bfe_u32 s61, s2, 0x20001
 s_lshl_b32 s61, s61, 3
 s_lshr_b32 s75, s2, 5
 s_add_u32 s61, s61, s75
 s_mul_i32 s80, s3, 3072
 s_lshl_b32 s78, s3, 14
 s_add_u32 s78, s78, 98304
 v_lshrrev_b32 v128, 3, v0
 s_lshl_b32 s75, s3, 6
 v_add_u32 v128, s75, v128
 v_mul_u32_u24 v128, 1280, v128
 v_and_b32 v129, 7, v0
 v_lshrrev_b32 v130, 4, v0
 v_xor_b32 v129, v129, v130
 v_lshl_add_u32 v10, v129, 4, v128
 v_xor_b32 v11, 64, v10
 s_mul_i32 s75, s3, 192
 s_add_u32 s76, s75, 0
 v_add_u32 v128, s76, v0
 v_mul_u32_u24 v136, 2731, v128
 v_lshrrev_b32 v136, 16, v136
 v_mul_u32_u24 v137, 24, v136
 v_sub_u32 v137, v128, v137
 v_bfe_u32 v138, v136, 1, 1
 v_lshlrev_b32 v138, 2, v138
 v_xor_b32 v138, v138, v137
 v_mul_u32_u24 v133, 12288, v136
 v_subrev_u32 v133, 0, v133
 v_lshl_add_u32 v7, v138, 4, v133
 s_add_u32 s76, s75, 64
 v_add_u32 v128, s76, v0
 v_mul_u32_u24 v140, 2731, v128
 v_lshrrev_b32 v140, 16, v140
 v_mul_u32_u24 v141, 24, v140
 v_sub_u32 v141, v128, v141
 v_bfe_u32 v142, v140, 1, 1
 v_lshlrev_b32 v142, 2, v142
 v_xor_b32 v142, v142, v141
 v_mul_u32_u24 v133, 12288, v140
 v_subrev_u32 v133, 1024, v133
 v_lshl_add_u32 v8, v142, 4, v133
 s_add_u32 s76, s75, 128
 v_add_u32 v128, s76, v0
 v_mul_u32_u24 v144, 2731, v128
 v_lshrrev_b32 v144, 16, v144
 v_mul_u32_u24 v145, 24, v144
 v_sub_u32 v145, v128, v145
 v_bfe_u32 v146, v144, 1, 1
 v_lshlrev_b32 v146, 2, v146
 v_xor_b32 v146, v146, v145
 v_mul_u32_u24 v133, 12288, v144
 v_subrev_u32 v133, 2048, v133
 v_lshl_add_u32 v9, v146, 4, v133
 s_mul_i32 s75, s60, 327680
 s_mul_i32 s76, s61, 384
 s_waitcnt lgkmcnt(0)
 s_add_u32 s24, s10, s76
 s_addc_u32 s25, s11, 0
 s_and_b32 s25, s25, 0xffff
 s_mov_b32 s26, 7852416
 s_mov_b32 s27, 0x20000
 s_add_u32 s20, s4, s75
 s_addc_u32 s21, s5, 0
 s_and_b32 s21, s21, 0xffff
 s_mov_b32 s22, 327680
 s_mov_b32 s23, 0x20000
 s_add_u32 m0, s80, 0
 s_mov_b32 s76, 0
 buffer_load_dwordx4 v7, s[24:27], s76 offen offset:0 lds
 buffer_load_dwordx4 v8, s[24:27], s76 offen offset:1024 lds
 buffer_load_dwordx4 v9, s[24:27], s76 offen offset:2048 lds
 s_add_u32 m0, s80, 12288
 s_mov_b32 s76, 393216
 buffer_load_dwordx4 v7, s[24:27], s76 offen offset:0 lds
 buffer_load_dwordx4 v8, s[24:27], s76 offen offset:1024 lds
 buffer_load_dwordx4 v9, s[24:27], s76 offen offset:2048 lds
 s_add_u32 m0, s78, 0
 s_mov_b32 s75, 0
 buffer_load_dwordx4 v10, s[20:23], s75 offen offset:0 lds
 s_mov_b32 s75, 9216
 buffer_load_dwordx4 v11, s[20:23], s75 offen offset:1024 lds
 s_mov_b32 s75, 18432
 buffer_load_dwordx4 v10, s[20:23], s75 offen offset:2048 lds
 s_mov_b32 s75, 27648
 buffer_load_dwordx4 v11, s[20:23], s75 offen offset:3072 lds
 s_add_u32 m0, s78, 4096
 s_mov_b32 s75, 40960
 buffer_load_dwordx4 v10, s[20:23], s75 offen offset:0 lds
 s_mov_b32 s75, 50176
 buffer_load_dwordx4 v11, s[20:23], s75 offen offset:1024 lds
 s_mov_b32 s75, 59392
 buffer_load_dwordx4 v10, s[20:23], s75 offen offset:2048 lds
 s_mov_b32 s75, 68608
 buffer_load_dwordx4 v11, s[20:23], s75 offen offset:3072 lds
 v_bfe_u32 v139, v136, 1, 3
 v_xor_b32 v139, v139, v137
 v_and_b32 v138, 6, v136
 v_xor_b32 v138, v138, v137
 v_mul_u32_u24 v133, 384, v136
 v_subrev_u32 v133, 0, v133
 v_lshl_add_u32 v1, v139, 4, v133
 v_lshl_add_u32 v4, v138, 4, v133
 v_bfe_u32 v143, v140, 1, 3
 v_xor_b32 v143, v143, v141
 v_and_b32 v142, 6, v140
 v_xor_b32 v142, v142, v141
 v_mul_u32_u24 v133, 384, v140
 v_subrev_u32 v133, 1024, v133
 v_lshl_add_u32 v2, v143, 4, v133
 v_lshl_add_u32 v5, v142, 4, v133
 v_bfe_u32 v147, v144, 1, 3
 v_xor_b32 v147, v147, v145
 v_and_b32 v146, 6, v144
 v_xor_b32 v146, v146, v145
 v_mul_u32_u24 v133, 384, v144
 v_subrev_u32 v133, 2048, v133
 v_lshl_add_u32 v3, v147, 4, v133
 v_lshl_add_u32 v6, v146, 4, v133
 s_add_u32 m0, s80, 24576
 s_mov_b32 s76, 786432
 buffer_load_dwordx4 v7, s[24:27], s76 offen offset:0 lds
 buffer_load_dwordx4 v8, s[24:27], s76 offen offset:1024 lds
 buffer_load_dwordx4 v9, s[24:27], s76 offen offset:2048 lds
 s_add_u32 m0, s80, 36864
 s_mov_b32 s76, 1179648
 buffer_load_dwordx4 v7, s[24:27], s76 offen offset:0 lds
 buffer_load_dwordx4 v8, s[24:27], s76 offen offset:1024 lds
 buffer_load_dwordx4 v9, s[24:27], s76 offen offset:2048 lds
 s_add_u32 m0, s78, 8192
 s_mov_b32 s75, 128
 buffer_load_dwordx4 v10, s[20:23], s75 offen offset:0 lds
 s_mov_b32 s75, 9344
 buffer_load_dwordx4 v11, s[20:23], s75 offen offset:1024 lds
 s_mov_b32 s75, 18560
 buffer_load_dwordx4 v10, s[20:23], s75 offen offset:2048 lds
 s_mov_b32 s75, 27776
 buffer_load_dwordx4 v11, s[20:23], s75 offen offset:3072 lds
 s_add_u32 m0, s78, 12288
 s_mov_b32 s75, 41088
 buffer_load_dwordx4 v10, s[20:23], s75 offen offset:0 lds
 s_mov_b32 s75, 50304
 buffer_load_dwordx4 v11, s[20:23], s75 offen offset:1024 lds
 s_mov_b32 s75, 59520
 buffer_load_dwordx4 v10, s[20:23], s75 offen offset:2048 lds
 s_mov_b32 s75, 68736
 buffer_load_dwordx4 v11, s[20:23], s75 offen offset:3072 lds
 s_add_u32 s56, s16, 0
 s_addc_u32 s57, s17, 0
 s_and_b32 s57, s57, 0xffff
 s_mov_b32 s58, 256
 s_mov_b32 s59, 0x20000
 s_cmp_lg_u32 s3, 0
 s_cbranch_scc1 L_NONON
 v_mov_b32 v23, 0
 s_or_b32 s82, s82, 1
 v_mov_b32 v22, s82
 s_lshl_b32 s75, s60, 5
 s_mov_b64 exec, 1
 buffer_atomic_cmpswap v[22:23], v23, s[56:59], s75 offen sc0
 s_mov_b64 exec, -1
L_NONON:
 v_lshlrev_b32 v29, 7, v0
 s_getpc_b64 s[52:53]
L_PCREF:
 s_and_b32 s53, s53, 0xffff
 s_mov_b32 s54, L_END-L_PCREF
 s_mov_b32 s55, 0x20000
 v_and_b32 v128, 15, v0
 v_lshrrev_b32 v129, 4, v0
 v_bfe_u32 v130, v0, 1, 3
 v_xor_b32 v130, v130, v129
 v_mul_u32_u24 v131, 384, v128
 v_lshl_add_u32 v12, v130, 4, v131
 v_add_u32 v12, 36864, v12
 v_xor_b32 v13, 64, v12
 v_lshlrev_b32 v132, 7, v128
 v_add_u32 v132, s78, v132
 v_lshl_add_u32 v20, v130, 4, v132
 v_xor_b32 v21, 64, v20
 v_bfe_u32 v128, v0, 2, 2
 v_and_b32 v130, 3, v0
 v_lshl_add_u32 v131, v129, 3, v128
 v_mul_u32_u24 v131, 384, v131
 v_lshl_add_u32 v131, v130, 4, v131
 v_bfe_u32 v132, v0, 3, 1
 v_lshl_add_u32 v18, v132, 6, v131
 v_xor_b32 v19, 64, v18
 v_lshrrev_b32 v131, 2, v0
 v_bfe_u32 v132, v0, 3, 2
 v_lshlrev_b32 v132, 5, v132
 v_lshl_add_u32 v132, v130, 3, v132
 v_lshl_add_u32 v27, v131, 7, v132
 v_mul_u32_u24 v133, 384, v131
 v_add3_u32 v14, v133, v132, 0
 v_add_u32 v14, 73728, v14
 v_xor_b32 v15, 32, v14
 v_xor_b32 v16, 64, v14
 v_xor_b32 v17, 96, v14
 v_bfe_u32 v132, v0, 4, 1
 v_lshlrev_b32 v132, 5, v132
 v_lshl_add_u32 v132, v130, 3, v132
 v_lshl_add_u32 v28, v131, 6, v132
 s_waitcnt vmcnt(14)
 s_barrier
 ds_read_b128 v[224:227], v20 offset:0
 ds_read_b128 v[228:231], v20 offset:2048
 ds_read_b128 v[232:235], v20 offset:4096
 ds_read_b128 v[236:239], v20 offset:6144
 ds_read_b128 v[240:243], v21 offset:0
 ds_read_b128 v[244:247], v21 offset:2048
 ds_read_b128 v[248:251], v21 offset:4096
 ds_read_b128 v[252:255], v21 offset:6144
 ds_read_b64_tr_b16 a[192:193], v18 offset:0
 ds_read_b64_tr_b16 a[194:195], v18 offset:1536
 ds_read_b64_tr_b16 a[196:197], v18 offset:12288
 ds_read_b64_tr_b16 a[198:199], v18 offset:13824
 s_waitcnt lgkmcnt(4)
 ds_read_b64_tr_b16 a[200:201], v18 offset:8
 ds_read_b64_tr_b16 a[202:203], v18 offset:1544
 ds_read_b64_tr_b16 a[204:205], v18 offset:12296
 ds_read_b64_tr_b16 a[206:207], v18 offset:13832
 s_waitcnt lgkmcnt(4)
 v_mfma_f32_16x16x32_bf16 v[32:35], a[192:195], v[224:227], 0
 s_add_u32 m0, s80, 49152
 s_mov_b32 s76, 1572864
 v_mfma_f32_16x16x32_bf16 v[32:35], a[196:199], v[240:243], v[32:35]
 ds_read_b64_tr_b16 a[208:209], v19 offset:0
 ds_read_b64_tr_b16 a[210:211], v19 offset:1536
 v_mfma_f32_16x16x32_bf16 v[40:43], a[192:195], v[228:231], 0
 buffer_load_dwordx4 v7, s[24:27], s76 offen offset:0 lds
 v_mfma_f32_16x16x32_bf16 v[40:43], a[196:199], v[244:247], v[40:43]
 ds_read_b64_tr_b16 a[212:213], v19 offset:12288
 ds_read_b64_tr_b16 a[214:215], v19 offset:13824
 v_mfma_f32_16x16x32_bf16 v[48:51], a[192:195], v[232:235], 0
 buffer_load_dwordx4 v8, s[24:27], s76 offen offset:1024 lds
 v_mfma_f32_16x16x32_bf16 v[48:51], a[196:199], v[248:251], v[48:51]
 buffer_load_dwordx4 v9, s[24:27], s76 offen offset:2048 lds
 v_mfma_f32_16x16x32_bf16 v[56:59], a[192:195], v[236:239], 0
 s_lshl_b32 s89, s60, 5
 s_add_u32 s89, s89, s61
 v_mfma_f32_16x16x32_bf16 v[56:59], a[196:199], v[252:255], v[56:59]
 s_mul_i32 s89, s89, 393216
 s_waitcnt lgkmcnt(4)
 v_mfma_f32_16x16x32_bf16 v[36:39], a[200:203], v[224:227], 0
 s_add_u32 m0, s80, 61440
 s_mov_b32 s76, 1966080
 v_mfma_f32_16x16x32_bf16 v[36:39], a[204:207], v[240:243], v[36:39]
 ds_read_b64_tr_b16 a[216:217], v19 offset:8
 ds_read_b64_tr_b16 a[218:219], v19 offset:1544
 v_mfma_f32_16x16x32_bf16 v[44:47], a[200:203], v[228:231], 0
 buffer_load_dwordx4 v7, s[24:27], s76 offen offset:0 lds
 v_mfma_f32_16x16x32_bf16 v[44:47], a[204:207], v[244:247], v[44:47]
 ds_read_b64_tr_b16 a[220:221], v19 offset:12296
 ds_read_b64_tr_b16 a[222:223], v19 offset:13832
 v_mfma_f32_16x16x32_bf16 v[52:55], a[200:203], v[232:235], 0
 buffer_load_dwordx4 v8, s[24:27], s76 offen offset:1024 lds
 v_mfma_f32_16x16x32_bf16 v[52:55], a[204:207], v[248:251], v[52:55]
 s_waitcnt vmcnt(5)
 v_mfma_f32_16x16x32_bf16 v[60:63], a[200:203], v[236:239], 0
 buffer_load_dwordx4 v9, s[24:27], s76 offen offset:2048 lds
 v_mfma_f32_16x16x32_bf16 v[60:63], a[204:207], v[252:255], v[60:63]
 ds_read_b128 a[224:227], v20 offset:8192
 s_waitcnt lgkmcnt(5)
 v_mfma_f32_16x16x32_bf16 v[64:67], a[208:211], v[224:227], 0
 s_add_u32 m0, s78, 0
 s_mov_b32 s75, 256
 v_mfma_f32_16x16x32_bf16 v[64:67], a[212:215], v[240:243], v[64:67]
 buffer_load_dwordx4 v10, s[20:23], s75 offen offset:0 lds
 v_mfma_f32_16x16x32_bf16 v[72:75], a[208:211], v[228:231], 0
 ds_read_b64_tr_b16 a[192:193], v18 offset:128
 ds_read_b64_tr_b16 a[194:195], v18 offset:1664
 v_mfma_f32_16x16x32_bf16 v[72:75], a[212:215], v[244:247], v[72:75]
 s_mov_b32 s75, 9472
 ds_read_b64_tr_b16 a[196:197], v18 offset:12416
 v_mfma_f32_16x16x32_bf16 v[80:83], a[208:211], v[232:235], 0
 ds_read_b128 a[228:231], v20 offset:10240
 ds_read_b64_tr_b16 a[198:199], v18 offset:13952
 v_mfma_f32_16x16x32_bf16 v[80:83], a[212:215], v[248:251], v[80:83]
 buffer_load_dwordx4 v11, s[20:23], s75 offen offset:1024 lds
 v_mfma_f32_16x16x32_bf16 v[88:91], a[208:211], v[236:239], 0
 s_mov_b32 s75, 18688
 ds_read_b128 a[232:235], v20 offset:12288
 v_mfma_f32_16x16x32_bf16 v[88:91], a[212:215], v[252:255], v[88:91]
 ds_read_b128 a[236:239], v20 offset:14336
 s_waitcnt lgkmcnt(8)
 v_mfma_f32_16x16x32_bf16 v[68:71], a[216:219], v[224:227], 0
 buffer_load_dwordx4 v10, s[20:23], s75 offen offset:2048 lds
 v_mfma_f32_16x16x32_bf16 v[68:71], a[220:223], v[240:243], v[68:71]
 ds_read_b64_tr_b16 a[200:201], v18 offset:136
 s_mov_b32 s75, 27904
 v_mfma_f32_16x16x32_bf16 v[76:79], a[216:219], v[228:231], 0
 ds_read_b64_tr_b16 a[202:203], v18 offset:1672
 ds_read_b64_tr_b16 a[204:205], v18 offset:12424
 v_mfma_f32_16x16x32_bf16 v[76:79], a[220:223], v[244:247], v[76:79]
 buffer_load_dwordx4 v11, s[20:23], s75 offen offset:3072 lds
 v_mfma_f32_16x16x32_bf16 v[84:87], a[216:219], v[232:235], 0
 ds_read_b64_tr_b16 a[206:207], v18 offset:13960
 ds_read_b128 a[240:243], v21 offset:8192
 v_mfma_f32_16x16x32_bf16 v[84:87], a[220:223], v[248:251], v[84:87]
 s_add_u32 m0, s78, 4096
 s_mov_b32 s75, 41216
 v_mfma_f32_16x16x32_bf16 v[92:95], a[216:219], v[236:239], 0
 buffer_load_dwordx4 v10, s[20:23], s75 offen offset:0 lds
 v_mfma_f32_16x16x32_bf16 v[92:95], a[220:223], v[252:255], v[92:95]
 ds_read_b128 a[244:247], v21 offset:10240
 s_waitcnt lgkmcnt(8)
 v_mfma_f32_16x16x32_bf16 v[96:99], a[192:195], v[224:227], 0
 ds_read_b64_tr_b16 a[208:209], v19 offset:128
 s_mov_b32 s75, 50432
 v_mfma_f32_16x16x32_bf16 v[96:99], a[196:199], v[240:243], v[96:99]
 ds_read_b64_tr_b16 a[210:211], v19 offset:1664
 ds_read_b128 a[248:251], v21 offset:12288
 v_mfma_f32_16x16x32_bf16 v[104:107], a[192:195], v[228:231], 0
 buffer_load_dwordx4 v11, s[20:23], s75 offen offset:1024 lds
 v_mfma_f32_16x16x32_bf16 v[104:107], a[196:199], v[244:247], v[104:107]
 ds_read_b64_tr_b16 a[212:213], v19 offset:12416
 ds_read_b64_tr_b16 a[214:215], v19 offset:13952
 v_mfma_f32_16x16x32_bf16 v[112:115], a[192:195], v[232:235], 0
 s_mov_b32 s75, 59648
 ds_read_b128 a[252:255], v21 offset:14336
 v_mfma_f32_16x16x32_bf16 v[112:115], a[196:199], v[248:251], v[112:115]
 buffer_load_dwordx4 v10, s[20:23], s75 offen offset:2048 lds
 v_mfma_f32_16x16x32_bf16 v[120:123], a[192:195], v[236:239], 0
 s_add_u32 s28, s6, s89
 s_addc_u32 s29, s7, 0
 v_mfma_f32_16x16x32_bf16 v[120:123], a[196:199], v[252:255], v[120:123]
 s_mov_b32 s75, 68864
 s_waitcnt lgkmcnt(8)
 v_mfma_f32_16x16x32_bf16 v[100:103], a[200:203], v[224:227], 0
 ds_read_b64_tr_b16 a[216:217], v19 offset:136
 s_and_b32 s29, s29, 0xffff
 v_mfma_f32_16x16x32_bf16 v[100:103], a[204:207], v[240:243], v[100:103]
 buffer_load_dwordx4 v11, s[20:23], s75 offen offset:3072 lds
 v_mfma_f32_16x16x32_bf16 v[108:111], a[200:203], v[228:231], 0
 ds_read_b64_tr_b16 a[218:219], v19 offset:1672
 ds_read_b64_tr_b16 a[220:221], v19 offset:12424
 v_mfma_f32_16x16x32_bf16 v[108:111], a[204:207], v[244:247], v[108:111]
 ds_read_b64_tr_b16 a[222:223], v19 offset:13960
 s_mov_b32 s30, 393216
 v_mfma_f32_16x16x32_bf16 v[116:119], a[200:203], v[232:235], 0
 s_waitcnt lgkmcnt(4)
 s_mov_b32 s31, 0x20000
 v_mfma_f32_16x16x32_bf16 v[116:119], a[204:207], v[248:251], v[116:119]
 s_add_u32 m0, s78, 8192
 s_mov_b32 s75, 384
 v_mfma_f32_16x16x32_bf16 v[124:127], a[200:203], v[236:239], 0
 s_add_u32 s32, s8, s89
 s_addc_u32 s33, s9, 0
 v_mfma_f32_16x16x32_bf16 v[124:127], a[204:207], v[252:255], v[124:127]
 s_and_b32 s33, s33, 0xffff
 v_mfma_f32_16x16x32_bf16 v[128:131], a[208:211], v[224:227], 0
 buffer_load_dwordx4 v10, s[20:23], s75 offen offset:0 lds
 v_mfma_f32_16x16x32_bf16 v[128:131], a[212:215], v[240:243], v[128:131]
 ds_read_b64_tr_b16 a[192:193], v18 offset:256
 ds_read_b64_tr_b16 a[194:195], v18 offset:1792
 v_mfma_f32_16x16x32_bf16 v[136:139], a[208:211], v[228:231], 0
 s_mov_b32 s75, 9600
 ds_read_b64_tr_b16 a[196:197], v18 offset:12544
 v_mfma_f32_16x16x32_bf16 v[136:139], a[212:215], v[244:247], v[136:139]
 ds_read_b64_tr_b16 a[198:199], v18 offset:14080
 s_mov_b32 s34, 393216
 v_mfma_f32_16x16x32_bf16 v[144:147], a[208:211], v[232:235], 0
 buffer_load_dwordx4 v11, s[20:23], s75 offen offset:1024 lds
 v_mfma_f32_16x16x32_bf16 v[144:147], a[212:215], v[248:251], v[144:147]
 s_mov_b32 s75, 18816
 s_mov_b32 s35, 0x20000
 v_mfma_f32_16x16x32_bf16 v[152:155], a[208:211], v[236:239], 0
 s_lshr_b32 s62, s61, 2
 v_mfma_f32_16x16x32_bf16 v[152:155], a[212:215], v[252:255], v[152:155]
 s_waitcnt lgkmcnt(4)
 v_mfma_f32_16x16x32_bf16 v[132:135], a[216:219], v[224:227], 0
 buffer_load_dwordx4 v10, s[20:23], s75 offen offset:2048 lds
 v_mfma_f32_16x16x32_bf16 v[132:135], a[220:223], v[240:243], v[132:135]
 ds_read_b64_tr_b16 a[200:201], v18 offset:264
 ds_read_b64_tr_b16 a[202:203], v18 offset:1800
 v_mfma_f32_16x16x32_bf16 v[140:143], a[216:219], v[228:231], 0
 s_mov_b32 s75, 28032
 ds_read_b64_tr_b16 a[204:205], v18 offset:12552
 v_mfma_f32_16x16x32_bf16 v[140:143], a[220:223], v[244:247], v[140:143]
 ds_read_b64_tr_b16 a[206:207], v18 offset:14088
 v_mfma_f32_16x16x32_bf16 v[148:151], a[216:219], v[232:235], 0
 buffer_load_dwordx4 v11, s[20:23], s75 offen offset:3072 lds
 v_mfma_f32_16x16x32_bf16 v[148:151], a[220:223], v[248:251], v[148:151]
 s_add_u32 m0, s78, 12288
 s_mov_b32 s75, 41344
 v_mfma_f32_16x16x32_bf16 v[156:159], a[216:219], v[236:239], 0
 v_mfma_f32_16x16x32_bf16 v[156:159], a[220:223], v[252:255], v[156:159]
 s_waitcnt lgkmcnt(4)
 v_mfma_f32_16x16x32_bf16 v[160:163], a[192:195], v[224:227], 0
 buffer_load_dwordx4 v10, s[20:23], s75 offen offset:0 lds
 v_mfma_f32_16x16x32_bf16 v[160:163], a[196:199], v[240:243], v[160:163]
 ds_read_b64_tr_b16 a[208:209], v19 offset:256
 ds_read_b64_tr_b16 a[210:211], v19 offset:1792
 v_mfma_f32_16x16x32_bf16 v[168:171], a[192:195], v[228:231], 0
 s_mov_b32 s75, 50560
 ds_read_b64_tr_b16 a[212:213], v19 offset:12544
 v_mfma_f32_16x16x32_bf16 v[168:171], a[196:199], v[244:247], v[168:171]
 ds_read_b64_tr_b16 a[214:215], v19 offset:14080
 v_mfma_f32_16x16x32_bf16 v[176:179], a[192:195], v[232:235], 0
 buffer_load_dwordx4 v11, s[20:23], s75 offen offset:1024 lds
 v_mfma_f32_16x16x32_bf16 v[176:179], a[196:199], v[248:251], v[176:179]
 s_mov_b32 s75, 59776
 v_mfma_f32_16x16x32_bf16 v[184:187], a[192:195], v[236:239], 0
 v_mfma_f32_16x16x32_bf16 v[184:187], a[196:199], v[252:255], v[184:187]
 s_waitcnt lgkmcnt(4)
 v_mfma_f32_16x16x32_bf16 v[164:167], a[200:203], v[224:227], 0
 buffer_load_dwordx4 v10, s[20:23], s75 offen offset:2048 lds
 v_mfma_f32_16x16x32_bf16 v[164:167], a[204:207], v[240:243], v[164:167]
 ds_read_b64_tr_b16 a[216:217], v19 offset:264
 ds_read_b64_tr_b16 a[218:219], v19 offset:1800
 v_mfma_f32_16x16x32_bf16 v[172:175], a[200:203], v[228:231], 0
 s_mov_b32 s75, 68992
 ds_read_b64_tr_b16 a[220:221], v19 offset:12552
 v_mfma_f32_16x16x32_bf16 v[172:175], a[204:207], v[244:247], v[172:175]
 buffer_load_dwordx4 v11, s[20:23], s75 offen offset:3072 lds
 v_mfma_f32_16x16x32_bf16 v[180:183], a[200:203], v[232:235], 0
 ds_read_b64_tr_b16 a[222:223], v19 offset:14088
 v_mfma_f32_16x16x32_bf16 v[180:183], a[204:207], v[248:251], v[180:183]
 v_mfma_f32_16x16x32_bf16 v[188:191], a[200:203], v[236:239], 0
 s_barrier
 v_mfma_f32_16x16x32_bf16 v[188:191], a[204:207], v[252:255], v[188:191]
 s_waitcnt lgkmcnt(4)
 v_mfma_f32_16x16x32_bf16 v[192:195], a[208:211], v[224:227], 0
 s_add_u32 m0, s80, 73728
 s_mov_b32 s76, 2359296
 v_mfma_f32_16x16x32_bf16 v[192:195], a[212:215], v[240:243], v[192:195]
 ds_read_b64_tr_b16 a[192:193], v18 offset:24576
 ds_read_b64_tr_b16 a[194:195], v18 offset:26112
 v_mfma_f32_16x16x32_bf16 v[200:203], a[208:211], v[228:231], 0
 buffer_load_dwordx4 v7, s[24:27], s76 offen offset:0 lds
 v_mfma_f32_16x16x32_bf16 v[200:203], a[212:215], v[244:247], v[200:203]
 ds_read_b64_tr_b16 a[196:197], v18 offset:36864
 ds_read_b64_tr_b16 a[198:199], v18 offset:38400
 v_mfma_f32_16x16x32_bf16 v[208:211], a[208:211], v[232:235], 0
 buffer_load_dwordx4 v8, s[24:27], s76 offen offset:1024 lds
 v_mfma_f32_16x16x32_bf16 v[208:211], a[212:215], v[248:251], v[208:211]
 buffer_load_dwordx4 v9, s[24:27], s76 offen offset:2048 lds
 v_mfma_f32_16x16x32_bf16 v[216:219], a[208:211], v[236:239], 0
 v_mfma_f32_16x16x32_bf16 v[216:219], a[212:215], v[252:255], v[216:219]
 s_waitcnt lgkmcnt(4)
 v_mfma_f32_16x16x32_bf16 v[196:199], a[216:219], v[224:227], 0
 s_add_u32 m0, s80, 86016
 s_mov_b32 s76, 2752512
 v_mfma_f32_16x16x32_bf16 v[196:199], a[220:223], v[240:243], v[196:199]
 ds_read_b64_tr_b16 a[200:201], v18 offset:24584
 ds_read_b64_tr_b16 a[202:203], v18 offset:26120
 v_mfma_f32_16x16x32_bf16 v[204:207], a[216:219], v[228:231], 0
 buffer_load_dwordx4 v7, s[24:27], s76 offen offset:0 lds
 v_mfma_f32_16x16x32_bf16 v[204:207], a[220:223], v[244:247], v[204:207]
 ds_read_b64_tr_b16 a[204:205], v18 offset:36872
 ds_read_b64_tr_b16 a[206:207], v18 offset:38408
 v_mfma_f32_16x16x32_bf16 v[212:215], a[216:219], v[232:235], 0
 buffer_load_dwordx4 v8, s[24:27], s76 offen offset:1024 lds
 v_mfma_f32_16x16x32_bf16 v[212:215], a[220:223], v[248:251], v[212:215]
 buffer_load_dwordx4 v9, s[24:27], s76 offen offset:2048 lds
 v_mfma_f32_16x16x32_bf16 v[220:223], a[216:219], v[236:239], 0
 v_mfma_f32_16x16x32_bf16 v[220:223], a[220:223], v[252:255], v[220:223]
 s_waitcnt lgkmcnt(4)
 v_mfma_f32_16x16x32_bf16 v[32:35], a[192:195], a[224:227], v[32:35]
 s_waitcnt vmcnt(14)
 ds_read_b64_tr_b16 a[208:209], v19 offset:24576
 v_mfma_f32_16x16x32_bf16 v[32:35], a[196:199], a[240:243], v[32:35]
 ds_read_b64_tr_b16 a[210:211], v19 offset:26112
 s_bfe_u32 s71, s2, 0x20003
 v_mfma_f32_16x16x32_bf16 v[40:43], a[192:195], a[228:231], v[40:43]
 ds_read_b64_tr_b16 a[212:213], v19 offset:36864
 ds_read_b128 v[224:227], v20 offset:0
 v_mfma_f32_16x16x32_bf16 v[40:43], a[196:199], a[244:247], v[40:43]
 ds_read_b64_tr_b16 a[214:215], v19 offset:38400
 s_mov_b32 s74, 0
 v_mfma_f32_16x16x32_bf16 v[48:51], a[192:195], a[232:235], v[48:51]
 v_mfma_f32_16x16x32_bf16 v[48:51], a[196:199], a[248:251], v[48:51]
 v_mfma_f32_16x16x32_bf16 v[56:59], a[192:195], a[236:239], v[56:59]
 ds_read_b128 v[228:231], v20 offset:2048
 v_mfma_f32_16x16x32_bf16 v[56:59], a[196:199], a[252:255], v[56:59]
 s_waitcnt lgkmcnt(6)
 v_mfma_f32_16x16x32_bf16 v[36:39], a[200:203], a[224:227], v[36:39]
 ds_read_b64_tr_b16 a[216:217], v19 offset:24584
 s_lshl_b32 s71, s71, 2
 v_mfma_f32_16x16x32_bf16 v[36:39], a[204:207], a[240:243], v[36:39]
 ds_read_b64_tr_b16 a[218:219], v19 offset:26120
 v_mfma_f32_16x16x32_bf16 v[44:47], a[200:203], a[228:231], v[44:47]
 ds_read_b64_tr_b16 a[220:221], v19 offset:36872
 v_mfma_f32_16x16x32_bf16 v[44:47], a[204:207], a[244:247], v[44:47]
 ds_read_b64_tr_b16 a[222:223], v19 offset:38408
 ds_read_b128 v[232:235], v20 offset:4096
 v_mfma_f32_16x16x32_bf16 v[52:55], a[200:203], a[232:235], v[52:55]
 buffer_load_dwordx4 a[0:3], v1, s[28:31], s74 offen offset:0 nt
 v_mfma_f32_16x16x32_bf16 v[52:55], a[204:207], a[248:251], v[52:55]
 v_mfma_f32_16x16x32_bf16 v[60:63], a[200:203], a[236:239], v[60:63]
 v_mfma_f32_16x16x32_bf16 v[60:63], a[204:207], a[252:255], v[60:63]
 ds_read_b128 v[236:239], v20 offset:6144
 s_waitcnt lgkmcnt(7)
 v_mfma_f32_16x16x32_bf16 v[64:67], a[208:211], a[224:227], v[64:67]
 ds_read_b64_tr_b16 a[192:193], v18 offset:24704
 s_add_u32 s71, s71, s3
 v_mfma_f32_16x16x32_bf16 v[64:67], a[212:215], a[240:243], v[64:67]
 ds_read_b64_tr_b16 a[194:195], v18 offset:26240
 v_mfma_f32_16x16x32_bf16 v[72:75], a[208:211], a[228:231], v[72:75]
 ds_read_b64_tr_b16 a[196:197], v18 offset:36992
 v_mfma_f32_16x16x32_bf16 v[72:75], a[212:215], a[244:247], v[72:75]
 ds_read_b64_tr_b16 a[198:199], v18 offset:38528
 v_mfma_f32_16x16x32_bf16 v[80:83], a[208:211], a[232:235], v[80:83]
 ds_read_b128 v[240:243], v21 offset:0
 v_mfma_f32_16x16x32_bf16 v[80:83], a[212:215], a[248:251], v[80:83]
 v_mfma_f32_16x16x32_bf16 v[88:91], a[208:211], a[236:239], v[88:91]
 buffer_load_dwordx4 a[4:7], v2, s[28:31], s74 offen offset:1024 nt
 v_mfma_f32_16x16x32_bf16 v[88:91], a[212:215], a[252:255], v[88:91]
 s_waitcnt lgkmcnt(7)
 v_mfma_f32_16x16x32_bf16 v[68:71], a[216:219], a[224:227], v[68:71]
 ds_read_b64_tr_b16 a[200:201], v18 offset:24712
 s_lshl_b32 s71, s71, 13
 v_mfma_f32_16x16x32_bf16 v[68:71], a[220:223], a[240:243], v[68:71]
 ds_read_b64_tr_b16 a[202:203], v18 offset:26248
 ds_read_b128 v[244:247], v21 offset:2048
 v_mfma_f32_16x16x32_bf16 v[76:79], a[216:219], a[228:231], v[76:79]
 ds_read_b64_tr_b16 a[204:205], v18 offset:37000
 v_mfma_f32_16x16x32_bf16 v[76:79], a[220:223], a[244:247], v[76:79]
 ds_read_b64_tr_b16 a[206:207], v18 offset:38536
 v_mfma_f32_16x16x32_bf16 v[84:87], a[216:219], a[232:235], v[84:87]
 v_mfma_f32_16x16x32_bf16 v[84:87], a[220:223], a[248:251], v[84:87]
 ds_read_b128 v[248:251], v21 offset:4096
 v_mfma_f32_16x16x32_bf16 v[92:95], a[216:219], a[236:239], v[92:95]
 v_mfma_f32_16x16x32_bf16 v[92:95], a[220:223], a[252:255], v[92:95]
 s_waitcnt lgkmcnt(7)
 v_mfma_f32_16x16x32_bf16 v[96:99], a[192:195], a[224:227], v[96:99]
 ds_read_b64_tr_b16 a[208:209], v19 offset:24704
 v_mfma_f32_16x16x32_bf16 v[96:99], a[196:199], a[240:243], v[96:99]
 ds_read_b64_tr_b16 a[210:211], v19 offset:26240
 v_mfma_f32_16x16x32_bf16 v[104:107], a[192:195], a[228:231], v[104:107]
 ds_read_b64_tr_b16 a[212:213], v19 offset:36992
 ds_read_b128 v[252:255], v21 offset:6144
 v_mfma_f32_16x16x32_bf16 v[104:107], a[196:199], a[244:247], v[104:107]
 ds_read_b64_tr_b16 a[214:215], v19 offset:38528
 v_mfma_f32_16x16x32_bf16 v[112:115], a[192:195], a[232:235], v[112:115]
 buffer_load_dword v24, v29, s[52:55], s71 offen
 v_mfma_f32_16x16x32_bf16 v[112:115], a[196:199], a[248:251], v[112:115]
 buffer_load_dwordx4 a[8:11], v3, s[28:31], s74 offen offset:2048 nt
 v_mfma_f32_16x16x32_bf16 v[120:123], a[192:195], a[236:239], v[120:123]
 v_mfma_f32_16x16x32_bf16 v[120:123], a[196:199], a[252:255], v[120:123]
 s_waitcnt lgkmcnt(6)
 v_mfma_f32_16x16x32_bf16 v[100:103], a[200:203], a[224:227], v[100:103]
 ds_read_b64_tr_b16 a[216:217], v19 offset:24712
 v_mfma_f32_16x16x32_bf16 v[100:103], a[204:207], a[240:243], v[100:103]
 ds_read_b64_tr_b16 a[218:219], v19 offset:26248
 v_mfma_f32_16x16x32_bf16 v[108:111], a[200:203], a[228:231], v[108:111]
 ds_read_b64_tr_b16 a[220:221], v19 offset:37000
 v_mfma_f32_16x16x32_bf16 v[108:111], a[204:207], a[244:247], v[108:111]
 ds_read_b64_tr_b16 a[222:223], v19 offset:38536
 v_mfma_f32_16x16x32_bf16 v[116:119], a[200:203], a[232:235], v[116:119]
 s_waitcnt lgkmcnt(5)
 v_mfma_f32_16x16x32_bf16 v[116:119], a[204:207], a[248:251], v[116:119]
 s_add_u32 m0, s78, 0
 s_mov_b32 s75, 512
 v_mfma_f32_16x16x32_bf16 v[124:127], a[200:203], a[236:239], v[124:127]
 v_mfma_f32_16x16x32_bf16 v[124:127], a[204:207], a[252:255], v[124:127]
 s_waitcnt lgkmcnt(4)
 v_mfma_f32_16x16x32_bf16 v[128:131], a[208:211], a[224:227], v[128:131]
 buffer_load_dwordx4 v10, s[20:23], s75 offen offset:0 lds
 v_mfma_f32_16x16x32_bf16 v[128:131], a[212:215], a[240:243], v[128:131]
 ds_read_b64_tr_b16 a[192:193], v18 offset:24832
 ds_read_b64_tr_b16 a[194:195], v18 offset:26368
 v_mfma_f32_16x16x32_bf16 v[136:139], a[208:211], a[228:231], v[136:139]
 s_mov_b32 s75, 9728
 ds_read_b64_tr_b16 a[196:197], v18 offset:37120
 v_mfma_f32_16x16x32_bf16 v[136:139], a[212:215], a[244:247], v[136:139]
 ds_read_b64_tr_b16 a[198:199], v18 offset:38656
 v_mfma_f32_16x16x32_bf16 v[144:147], a[208:211], a[232:235], v[144:147]
 buffer_load_dwordx4 v11, s[20:23], s75 offen offset:1024 lds
 v_mfma_f32_16x16x32_bf16 v[144:147], a[212:215], a[248:251], v[144:147]
 s_mov_b32 s75, 18944
 v_mfma_f32_16x16x32_bf16 v[152:155], a[208:211], a[236:239], v[152:155]
 v_mfma_f32_16x16x32_bf16 v[152:155], a[212:215], a[252:255], v[152:155]
 s_waitcnt lgkmcnt(4)
 v_mfma_f32_16x16x32_bf16 v[132:135], a[216:219], a[224:227], v[132:135]
 buffer_load_dwordx4 v10, s[20:23], s75 offen offset:2048 lds
 v_mfma_f32_16x16x32_bf16 v[132:135], a[220:223], a[240:243], v[132:135]
 ds_read_b64_tr_b16 a[200:201], v18 offset:24840
 ds_read_b64_tr_b16 a[202:203], v18 offset:26376
 v_mfma_f32_16x16x32_bf16 v[140:143], a[216:219], a[228:231], v[140:143]
 s_mov_b32 s75, 28160
 ds_read_b64_tr_b16 a[204:205], v18 offset:37128
 v_mfma_f32_16x16x32_bf16 v[140:143], a[220:223], a[244:247], v[140:143]
 ds_read_b64_tr_b16 a[206:207], v18 offset:38664
 v_mfma_f32_16x16x32_bf16 v[148:151], a[216:219], a[232:235], v[148:151]
 buffer_load_dwordx4 v11, s[20:23], s75 offen offset:3072 lds
 v_mfma_f32_16x16x32_bf16 v[148:151], a[220:223], a[248:251], v[148:151]
 s_add_u32 m0, s78, 4096
 s_mov_b32 s75, 41472
 v_mfma_f32_16x16x32_bf16 v[156:159], a[216:219], a[236:239], v[156:159]
 v_mfma_f32_16x16x32_bf16 v[156:159], a[220:223], a[252:255], v[156:159]
 s_waitcnt lgkmcnt(4)
 v_mfma_f32_16x16x32_bf16 v[160:163], a[192:195], a[224:227], v[160:163]
 buffer_load_dwordx4 v10, s[20:23], s75 offen offset:0 lds
 v_mfma_f32_16x16x32_bf16 v[160:163], a[196:199], a[240:243], v[160:163]
 ds_read_b64_tr_b16 a[208:209], v19 offset:24832
 ds_read_b64_tr_b16 a[210:211], v19 offset:26368
 v_mfma_f32_16x16x32_bf16 v[168:171], a[192:195], a[228:231], v[168:171]
 s_mov_b32 s75, 50688
 ds_read_b64_tr_b16 a[212:213], v19 offset:37120
 v_mfma_f32_16x16x32_bf16 v[168:171], a[196:199], a[244:247], v[168:171]
 ds_read_b64_tr_b16 a[214:215], v19 offset:38656
 v_mfma_f32_16x16x32_bf16 v[176:179], a[192:195], a[232:235], v[176:179]
 buffer_load_dwordx4 v11, s[20:23], s75 offen offset:1024 lds
 v_mfma_f32_16x16x32_bf16 v[176:179], a[196:199], a[248:251], v[176:179]
 s_mov_b32 s75, 59904
 v_mfma_f32_16x16x32_bf16 v[184:187], a[192:195], a[236:239], v[184:187]
 v_mfma_f32_16x16x32_bf16 v[184:187], a[196:199], a[252:255], v[184:187]
 s_waitcnt lgkmcnt(4)
 v_mfma_f32_16x16x32_bf16 v[164:167], a[200:203], a[224:227], v[164:167]
 buffer_load_dwordx4 v10, s[20:23], s75 offen offset:2048 lds
 v_mfma_f32_16x16x32_bf16 v[164:167], a[204:207], a[240:243], v[164:167]
 ds_read_b64_tr_b16 a[216:217], v19 offset:24840
 ds_read_b64_tr_b16 a[218:219], v19 offset:26376
 v_mfma_f32_16x16x32_bf16 v[172:175], a[200:203], a[228:231], v[172:175]
 s_mov_b32 s75, 69120
 ds_read_b64_tr_b16 a[220:221], v19 offset:37128
 v_mfma_f32_16x16x32_bf16 v[172:175], a[204:207], a[244:247], v[172:175]
 buffer_load_dwordx4 v11, s[20:23], s75 offen offset:3072 lds
 v_mfma_f32_16x16x32_bf16 v[180:183], a[200:203], a[232:235], v[180:183]
 ds_read_b64_tr_b16 a[222:223], v19 offset:38664
 v_mfma_f32_16x16x32_bf16 v[180:183], a[204:207], a[248:251], v[180:183]
 v_add_u32 v18, 49152, v18
 v_add_u32 v19, 49152, v19
 v_mfma_f32_16x16x32_bf16 v[188:191], a[200:203], a[236:239], v[188:191]
 s_barrier
 v_mfma_f32_16x16x32_bf16 v[188:191], a[204:207], a[252:255], v[188:191]
 s_waitcnt lgkmcnt(4)
 v_mfma_f32_16x16x32_bf16 v[192:195], a[208:211], a[224:227], v[192:195]
 s_add_u32 m0, s80, 0
 s_mov_b32 s76, 3145728
 v_mfma_f32_16x16x32_bf16 v[192:195], a[212:215], a[240:243], v[192:195]
 ds_read_b64_tr_b16 a[192:193], v18 offset:0
 ds_read_b64_tr_b16 a[194:195], v18 offset:1536
 v_mfma_f32_16x16x32_bf16 v[200:203], a[208:211], a[228:231], v[200:203]
 buffer_load_dwordx4 v7, s[24:27], s76 offen offset:0 lds
 v_mfma_f32_16x16x32_bf16 v[200:203], a[212:215], a[244:247], v[200:203]
 ds_read_b64_tr_b16 a[196:197], v18 offset:12288
 ds_read_b64_tr_b16 a[198:199], v18 offset:13824
 v_mfma_f32_16x16x32_bf16 v[208:211], a[208:211], a[232:235], v[208:211]
 buffer_load_dwordx4 v8, s[24:27], s76 offen offset:1024 lds
 v_mfma_f32_16x16x32_bf16 v[208:211], a[212:215], a[248:251], v[208:211]
 buffer_load_dwordx4 v9, s[24:27], s76 offen offset:2048 lds
 v_mfma_f32_16x16x32_bf16 v[216:219], a[208:211], a[236:239], v[216:219]
 v_mfma_f32_16x16x32_bf16 v[216:219], a[212:215], a[252:255], v[216:219]
 s_waitcnt lgkmcnt(4)
 v_mfma_f32_16x16x32_bf16 v[196:199], a[216:219], a[224:227], v[196:199]
 s_add_u32 m0, s80, 12288
 s_mov_b32 s76, 3538944
 v_mfma_f32_16x16x32_bf16 v[196:199], a[220:223], a[240:243], v[196:199]
 ds_read_b64_tr_b16 a[200:201], v18 offset:8
 ds_read_b64_tr_b16 a[202:203], v18 offset:1544
 v_mfma_f32_16x16x32_bf16 v[204:207], a[216:219], a[228:231], v[204:207]
 buffer_load_dwordx4 v7, s[24:27], s76 offen offset:0 lds
 v_mfma_f32_16x16x32_bf16 v[204:207], a[220:223], a[244:247], v[204:207]
 ds_read_b64_tr_b16 a[204:205], v18 offset:12296
 ds_read_b64_tr_b16 a[206:207], v18 offset:13832
 v_mfma_f32_16x16x32_bf16 v[212:215], a[216:219], a[232:235], v[212:215]
 buffer_load_dwordx4 v8, s[24:27], s76 offen offset:1024 lds
 v_mfma_f32_16x16x32_bf16 v[212:215], a[220:223], a[248:251], v[212:215]
 buffer_load_dwordx4 v9, s[24:27], s76 offen offset:2048 lds
 v_mfma_f32_16x16x32_bf16 v[220:223], a[216:219], a[236:239], v[220:223]
 v_mfma_f32_16x16x32_bf16 v[220:223], a[220:223], a[252:255], v[220:223]
 s_waitcnt lgkmcnt(4)
 v_mfma_f32_16x16x32_bf16 v[32:35], a[192:195], v[224:227], v[32:35]
 s_waitcnt vmcnt(24)
 ds_read_b64_tr_b16 a[208:209], v19 offset:0
 v_mfma_f32_16x16x32_bf16 v[32:35], a[196:199], v[240:243], v[32:35]
 ds_read_b64_tr_b16 a[210:211], v19 offset:1536
 s_and_b32 s63, s61, 3
 v_mfma_f32_16x16x32_bf16 v[40:43], a[192:195], v[228:231], v[40:43]
 ds_read_b64_tr_b16 a[212:213], v19 offset:12288
 ds_read_b128 a[224:227], v20 offset:8192
 v_mfma_f32_16x16x32_bf16 v[40:43], a[196:199], v[244:247], v[40:43]
 ds_read_b64_tr_b16 a[214:215], v19 offset:13824
 s_mov_b32 s74, 12288
 v_mfma_f32_16x16x32_bf16 v[48:51], a[192:195], v[232:235], v[48:51]
 s_add_u32 s89, s63, 0
 s_and_b32 s89, s89, 3
 v_mfma_f32_16x16x32_bf16 v[48:51], a[196:199], v[248:251], v[48:51]
 s_lshl_b32 s86, s62, 2
 s_add_u32 s89, s89, s86
 v_mfma_f32_16x16x32_bf16 v[56:59], a[192:195], v[236:239], v[56:59]
 ds_read_b128 a[228:231], v20 offset:10240
 s_mul_i32 s90, s89, 245760
 v_mfma_f32_16x16x32_bf16 v[56:59], a[196:199], v[252:255], v[56:59]
 s_add_u32 s89, s63, 1
 s_waitcnt lgkmcnt(6)
 v_mfma_f32_16x16x32_bf16 v[36:39], a[200:203], v[224:227], v[36:39]
 ds_read_b64_tr_b16 a[216:217], v19 offset:8
 s_and_b32 s89, s89, 3
 v_mfma_f32_16x16x32_bf16 v[36:39], a[204:207], v[240:243], v[36:39]
 ds_read_b64_tr_b16 a[218:219], v19 offset:1544
 s_lshl_b32 s86, s62, 2
 v_mfma_f32_16x16x32_bf16 v[44:47], a[200:203], v[228:231], v[44:47]
 ds_read_b64_tr_b16 a[220:221], v19 offset:12296
 s_add_u32 s89, s89, s86
 v_mfma_f32_16x16x32_bf16 v[44:47], a[204:207], v[244:247], v[44:47]
 ds_read_b64_tr_b16 a[222:223], v19 offset:13832
 ds_read_b128 a[232:235], v20 offset:12288
 v_mfma_f32_16x16x32_bf16 v[52:55], a[200:203], v[232:235], v[52:55]
 buffer_load_dwordx4 a[12:15], v1, s[28:31], s74 offen offset:0 nt
 v_mfma_f32_16x16x32_bf16 v[52:55], a[204:207], v[248:251], v[52:55]
 s_mul_i32 s91, s89, 245760
 s_add_u32 s89, s63, 2
 v_mfma_f32_16x16x32_bf16 v[60:63], a[200:203], v[236:239], v[60:63]
 s_and_b32 s89, s89, 3
 s_lshl_b32 s86, s62, 2
 v_mfma_f32_16x16x32_bf16 v[60:63], a[204:207], v[252:255], v[60:63]
 ds_read_b128 a[236:239], v20 offset:14336
 s_waitcnt lgkmcnt(7)
 v_mfma_f32_16x16x32_bf16 v[64:67], a[208:211], v[224:227], v[64:67]
 ds_read_b64_tr_b16 a[192:193], v18 offset:128
 s_add_u32 s89, s89, s86
 v_mfma_f32_16x16x32_bf16 v[64:67], a[212:215], v[240:243], v[64:67]
 ds_read_b64_tr_b16 a[194:195], v18 offset:1664
 s_mul_i32 s92, s89, 245760
 v_mfma_f32_16x16x32_bf16 v[72:75], a[208:211], v[228:231], v[72:75]
 ds_read_b64_tr_b16 a[196:197], v18 offset:12416
 s_add_u32 s89, s63, 3
 v_mfma_f32_16x16x32_bf16 v[72:75], a[212:215], v[244:247], v[72:75]
 ds_read_b64_tr_b16 a[198:199], v18 offset:13952
 s_and_b32 s89, s89, 3
 v_mfma_f32_16x16x32_bf16 v[80:83], a[208:211], v[232:235], v[80:83]
 ds_read_b128 a[240:243], v21 offset:8192
 s_lshl_b32 s86, s62, 2
 v_mfma_f32_16x16x32_bf16 v[80:83], a[212:215], v[248:251], v[80:83]
 s_add_u32 s89, s89, s86
 s_mul_i32 s93, s89, 245760
 v_mfma_f32_16x16x32_bf16 v[88:91], a[208:211], v[236:239], v[88:91]
 buffer_load_dwordx4 a[16:19], v2, s[28:31], s74 offen offset:1024 nt
 v_mfma_f32_16x16x32_bf16 v[88:91], a[212:215], v[252:255], v[88:91]
 s_mul_i32 s85, s63, 320
 s_waitcnt lgkmcnt(7)
 v_mfma_f32_16x16x32_bf16 v[68:71], a[216:219], v[224:227], v[68:71]
 ds_read_b64_tr_b16 a[200:201], v18 offset:136
 s_and_b32 s89, s63, 1
 v_mfma_f32_16x16x32_bf16 v[68:71], a[220:223], v[240:243], v[68:71]
 ds_read_b64_tr_b16 a[202:203], v18 offset:1672
 ds_read_b128 a[244:247], v21 offset:10240
 v_mfma_f32_16x16x32_bf16 v[76:79], a[216:219], v[228:231], v[76:79]
 ds_read_b64_tr_b16 a[204:205], v18 offset:12424
 s_lshl_b32 s86, s89, 6
 v_mfma_f32_16x16x32_bf16 v[76:79], a[220:223], v[244:247], v[76:79]
 ds_read_b64_tr_b16 a[206:207], v18 offset:13960
 s_add_u32 s84, s85, s86
 v_mfma_f32_16x16x32_bf16 v[84:87], a[216:219], v[232:235], v[84:87]
 s_xor_b32 s89, s89, 1
 s_lshl_b32 s89, s89, 8
 v_mfma_f32_16x16x32_bf16 v[84:87], a[220:223], v[248:251], v[84:87]
 ds_read_b128 a[248:251], v21 offset:12288
 s_add_u32 s85, s85, s89
 v_mfma_f32_16x16x32_bf16 v[92:95], a[216:219], v[236:239], v[92:95]
 s_add_u32 s40, s12, 0
 s_addc_u32 s41, s13, 0
 v_mfma_f32_16x16x32_bf16 v[92:95], a[220:223], v[252:255], v[92:95]
 s_and_b32 s41, s41, 0xffff
 s_waitcnt lgkmcnt(7)
 v_mfma_f32_16x16x32_bf16 v[96:99], a[192:195], v[224:227], v[96:99]
 ds_read_b64_tr_b16 a[208:209], v19 offset:128
 s_mov_b32 s42, 7864320
 v_mfma_f32_16x16x32_bf16 v[96:99], a[196:199], v[240:243], v[96:99]
 ds_read_b64_tr_b16 a[210:211], v19 offset:1664
 s_mov_b32 s43, 0x20000
 v_mfma_f32_16x16x32_bf16 v[104:107], a[192:195], v[228:231], v[104:107]
 ds_read_b64_tr_b16 a[212:213], v19 offset:12416
 ds_read_b128 a[252:255], v21 offset:14336
 v_mfma_f32_16x16x32_bf16 v[104:107], a[196:199], v[244:247], v[104:107]
 ds_read_b64_tr_b16 a[214:215], v19 offset:13952
 s_lshl_b32 s89, s60, 3
 v_mfma_f32_16x16x32_bf16 v[112:115], a[192:195], v[232:235], v[112:115]
 buffer_load_dwordx4 a[20:23], v3, s[28:31], s74 offen offset:2048 nt
 v_mfma_f32_16x16x32_bf16 v[112:115], a[196:199], v[248:251], v[112:115]
 s_add_u32 s89, s89, s62
 s_lshl_b32 s87, s89, 2
 v_mfma_f32_16x16x32_bf16 v[120:123], a[192:195], v[236:239], v[120:123]
 s_add_u32 s87, s87, s3
 s_lshl_b32 s87, s87, 7
 v_mfma_f32_16x16x32_bf16 v[120:123], a[196:199], v[252:255], v[120:123]
 s_mul_i32 s89, s89, 393216
 s_waitcnt lgkmcnt(6)
 v_mfma_f32_16x16x32_bf16 v[100:103], a[200:203], v[224:227], v[100:103]
 ds_read_b64_tr_b16 a[216:217], v19 offset:136
 s_mul_i32 s86, s3, 24576
 v_mfma_f32_16x16x32_bf16 v[100:103], a[204:207], v[240:243], v[100:103]
 ds_read_b64_tr_b16 a[218:219], v19 offset:1672
 s_add_u32 s89, s89, s86
 v_mfma_f32_16x16x32_bf16 v[108:111], a[200:203], v[228:231], v[108:111]
 ds_read_b64_tr_b16 a[220:221], v19 offset:12424
 v_mfma_f32_16x16x32_bf16 v[108:111], a[204:207], v[244:247], v[108:111]
 ds_read_b64_tr_b16 a[222:223], v19 offset:13960
 v_mfma_f32_16x16x32_bf16 v[116:119], a[200:203], v[232:235], v[116:119]
 s_waitcnt lgkmcnt(5)
 v_mfma_f32_16x16x32_bf16 v[116:119], a[204:207], v[248:251], v[116:119]
 s_add_u32 m0, s78, 8192
 s_mov_b32 s75, 640
 v_mfma_f32_16x16x32_bf16 v[124:127], a[200:203], v[236:239], v[124:127]
 v_mfma_f32_16x16x32_bf16 v[124:127], a[204:207], v[252:255], v[124:127]
 s_waitcnt lgkmcnt(4)
 v_mfma_f32_16x16x32_bf16 v[128:131], a[208:211], v[224:227], v[128:131]
 buffer_load_dwordx4 v10, s[20:23], s75 offen offset:0 lds
 v_mfma_f32_16x16x32_bf16 v[128:131], a[212:215], v[240:243], v[128:131]
 ds_read_b64_tr_b16 a[192:193], v18 offset:256
 ds_read_b64_tr_b16 a[194:195], v18 offset:1792
 v_mfma_f32_16x16x32_bf16 v[136:139], a[208:211], v[228:231], v[136:139]
 s_mov_b32 s75, 9856
 ds_read_b64_tr_b16 a[196:197], v18 offset:12544
 v_mfma_f32_16x16x32_bf16 v[136:139], a[212:215], v[244:247], v[136:139]
 ds_read_b64_tr_b16 a[198:199], v18 offset:14080
 v_mfma_f32_16x16x32_bf16 v[144:147], a[208:211], v[232:235], v[144:147]
 buffer_load_dwordx4 v11, s[20:23], s75 offen offset:1024 lds
 v_mfma_f32_16x16x32_bf16 v[144:147], a[212:215], v[248:251], v[144:147]
 s_mov_b32 s75, 19072
 v_mfma_f32_16x16x32_bf16 v[152:155], a[208:211], v[236:239], v[152:155]
 v_mfma_f32_16x16x32_bf16 v[152:155], a[212:215], v[252:255], v[152:155]
 s_waitcnt lgkmcnt(4)
 v_mfma_f32_16x16x32_bf16 v[132:135], a[216:219], v[224:227], v[132:135]
 buffer_load_dwordx4 v10, s[20:23], s75 offen offset:2048 lds
 v_mfma_f32_16x16x32_bf16 v[132:135], a[220:223], v[240:243], v[132:135]
 ds_read_b64_tr_b16 a[200:201], v18 offset:264
 ds_read_b64_tr_b16 a[202:203], v18 offset:1800
 v_mfma_f32_16x16x32_bf16 v[140:143], a[216:219], v[228:231], v[140:143]
 s_mov_b32 s75, 28288
 ds_read_b64_tr_b16 a[204:205], v18 offset:12552
 v_mfma_f32_16x16x32_bf16 v[140:143], a[220:223], v[244:247], v[140:143]
 ds_read_b64_tr_b16 a[206:207], v18 offset:14088
 v_mfma_f32_16x16x32_bf16 v[148:151], a[216:219], v[232:235], v[148:151]
 buffer_load_dwordx4 v11, s[20:23], s75 offen offset:3072 lds
 v_mfma_f32_16x16x32_bf16 v[148:151], a[220:223], v[248:251], v[148:151]
 s_add_u32 m0, s78, 12288
 s_mov_b32 s75, 41600
 v_mfma_f32_16x16x32_bf16 v[156:159], a[216:219], v[236:239], v[156:159]
 v_mfma_f32_16x16x32_bf16 v[156:159], a[220:223], v[252:255], v[156:159]
 s_waitcnt lgkmcnt(4)
 v_mfma_f32_16x16x32_bf16 v[160:163], a[192:195], v[224:227], v[160:163]
 buffer_load_dwordx4 v10, s[20:23], s75 offen offset:0 lds
 v_mfma_f32_16x16x32_bf16 v[160:163], a[196:199], v[240:243], v[160:163]
 ds_read_b64_tr_b16 a[208:209], v19 offset:256
 ds_read_b64_tr_b16 a[210:211], v19 offset:1792
 v_mfma_f32_16x16x32_bf16 v[168:171], a[192:195], v[228:231], v[168:171]
 s_mov_b32 s75, 50816
 ds_read_b64_tr_b16 a[212:213], v19 offset:12544
 v_mfma_f32_16x16x32_bf16 v[168:171], a[196:199], v[244:247], v[168:171]
 ds_read_b64_tr_b16 a[214:215], v19 offset:14080
 v_mfma_f32_16x16x32_bf16 v[176:179], a[192:195], v[232:235], v[176:179]
 buffer_load_dwordx4 v11, s[20:23], s75 offen offset:1024 lds
 v_mfma_f32_16x16x32_bf16 v[176:179], a[196:199], v[248:251], v[176:179]
 s_mov_b32 s75, 60032
 v_mfma_f32_16x16x32_bf16 v[184:187], a[192:195], v[236:239], v[184:187]
 v_mfma_f32_16x16x32_bf16 v[184:187], a[196:199], v[252:255], v[184:187]
 s_waitcnt lgkmcnt(4)
 v_mfma_f32_16x16x32_bf16 v[164:167], a[200:203], v[224:227], v[164:167]
 buffer_load_dwordx4 v10, s[20:23], s75 offen offset:2048 lds
 v_mfma_f32_16x16x32_bf16 v[164:167], a[204:207], v[240:243], v[164:167]
 ds_read_b64_tr_b16 a[216:217], v19 offset:264
 ds_read_b64_tr_b16 a[218:219], v19 offset:1800
 v_mfma_f32_16x16x32_bf16 v[172:175], a[200:203], v[228:231], v[172:175]
 s_mov_b32 s75, 69248
 ds_read_b64_tr_b16 a[220:221], v19 offset:12552
 v_mfma_f32_16x16x32_bf16 v[172:175], a[204:207], v[244:247], v[172:175]
 buffer_load_dwordx4 v11, s[20:23], s75 offen offset:3072 lds
 v_mfma_f32_16x16x32_bf16 v[180:183], a[200:203], v[232:235], v[180:183]
 ds_read_b64_tr_b16 a[222:223], v19 offset:14088
 v_mfma_f32_16x16x32_bf16 v[180:183], a[204:207], v[248:251], v[180:183]
 v_mfma_f32_16x16x32_bf16 v[188:191], a[200:203], v[236:239], v[188:191]
 s_waitcnt vmcnt(29)
 s_barrier
 v_mfma_f32_16x16x32_bf16 v[188:191], a[204:207], v[252:255], v[188:191]
 s_waitcnt lgkmcnt(4)
 v_mfma_f32_16x16x32_bf16 v[192:195], a[208:211], v[224:227], v[192:195]
 s_add_u32 m0, s80, 24576
 s_mov_b32 s76, 3932160
 v_mfma_f32_16x16x32_bf16 v[192:195], a[212:215], v[240:243], v[192:195]
 ds_read_b64_tr_b16 a[192:193], v18 offset:24576
 ds_read_b64_tr_b16 a[194:195], v18 offset:26112
 v_mfma_f32_16x16x32_bf16 v[200:203], a[208:211], v[228:231], v[200:203]
 buffer_load_dwordx4 v7, s[24:27], s76 offen offset:0 lds
 v_mfma_f32_16x16x32_bf16 v[200:203], a[212:215], v[244:247], v[200:203]
 ds_read_b64_tr_b16 a[196:197], v18 offset:36864
 ds_read_b64_tr_b16 a[198:199], v18 offset:38400
 v_mfma_f32_16x16x32_bf16 v[208:211], a[208:211], v[232:235], v[208:211]
 buffer_load_dwordx4 v8, s[24:27], s76 offen offset:1024 lds
 v_mfma_f32_16x16x32_bf16 v[208:211], a[212:215], v[248:251], v[208:211]
 buffer_load_dwordx4 v9, s[24:27], s76 offen offset:2048 lds
 v_mfma_f32_16x16x32_bf16 v[216:219], a[208:211], v[236:239], v[216:219]
 v_mfma_f32_16x16x32_bf16 v[216:219], a[212:215], v[252:255], v[216:219]
 s_waitcnt lgkmcnt(4)
 v_mfma_f32_16x16x32_bf16 v[196:199], a[216:219], v[224:227], v[196:199]
 s_add_u32 m0, s80, 36864
 s_mov_b32 s76, 4325376
 v_mfma_f32_16x16x32_bf16 v[196:199], a[220:223], v[240:243], v[196:199]
 ds_read_b64_tr_b16 a[200:201], v18 offset:24584
 ds_read_b64_tr_b16 a[202:203], v18 offset:26120
 v_mfma_f32_16x16x32_bf16 v[204:207], a[216:219], v[228:231], v[204:207]
 buffer_load_dwordx4 v7, s[24:27], s76 offen offset:0 lds
 v_mfma_f32_16x16x32_bf16 v[204:207], a[220:223], v[244:247], v[204:207]
 ds_read_b64_tr_b16 a[204:205], v18 offset:36872
 ds_read_b64_tr_b16 a[206:207], v18 offset:38408
 v_mfma_f32_16x16x32_bf16 v[212:215], a[216:219], v[232:235], v[212:215]
 buffer_load_dwordx4 v8, s[24:27], s76 offen offset:1024 lds
 v_mfma_f32_16x16x32_bf16 v[212:215], a[220:223], v[248:251], v[212:215]
 buffer_load_dwordx4 v9, s[24:27], s76 offen offset:2048 lds
 v_mfma_f32_16x16x32_bf16 v[220:223], a[216:219], v[236:239], v[220:223]
 v_mfma_f32_16x16x32_bf16 v[220:223], a[220:223], v[252:255], v[220:223]
 s_waitcnt lgkmcnt(4)
 v_mfma_f32_16x16x32_bf16 v[32:35], a[192:195], a[224:227], v[32:35]
 s_waitcnt vmcnt(23)
 ds_read_b64_tr_b16 a[208:209], v19 offset:24576
 v_mfma_f32_16x16x32_bf16 v[32:35], a[196:199], a[240:243], v[32:35]
 ds_read_b64_tr_b16 a[210:211], v19 offset:26112
 v_mfma_f32_16x16x32_bf16 v[40:43], a[192:195], a[228:231], v[40:43]
 ds_read_b64_tr_b16 a[212:213], v19 offset:36864
 ds_read_b128 v[224:227], v20 offset:0
 v_mfma_f32_16x16x32_bf16 v[40:43], a[196:199], a[244:247], v[40:43]
 ds_read_b64_tr_b16 a[214:215], v19 offset:38400
 s_mov_b32 s74, 0
 v_mfma_f32_16x16x32_bf16 v[48:51], a[192:195], a[232:235], v[48:51]
 s_add_u32 s36, s18, s89
 s_addc_u32 s37, s19, 0
 v_mfma_f32_16x16x32_bf16 v[48:51], a[196:199], a[248:251], v[48:51]
 s_and_b32 s37, s37, 0xffff
 s_mov_b32 s38, 319488
 v_mfma_f32_16x16x32_bf16 v[56:59], a[192:195], a[236:239], v[56:59]
 ds_read_b128 v[228:231], v20 offset:2048
 s_mov_b32 s39, 0x20000
 v_mfma_f32_16x16x32_bf16 v[56:59], a[196:199], a[252:255], v[56:59]
 s_lshl_b32 s89, s60, 2
 s_waitcnt lgkmcnt(6)
 v_mfma_f32_16x16x32_bf16 v[36:39], a[200:203], a[224:227], v[36:39]
 ds_read_b64_tr_b16 a[216:217], v19 offset:24584
 s_add_u32 s89, s89, s63
 v_mfma_f32_16x16x32_bf16 v[36:39], a[204:207], a[240:243], v[36:39]
 ds_read_b64_tr_b16 a[218:219], v19 offset:26120
 s_lshl_b32 s88, s89, 2
 v_mfma_f32_16x16x32_bf16 v[44:47], a[200:203], a[228:231], v[44:47]
 ds_read_b64_tr_b16 a[220:221], v19 offset:36872
 s_add_u32 s88, s88, s3
 v_mfma_f32_16x16x32_bf16 v[44:47], a[204:207], a[244:247], v[44:47]
 ds_read_b64_tr_b16 a[222:223], v19 offset:38408
 ds_read_b128 v[232:235], v20 offset:4096
 v_mfma_f32_16x16x32_bf16 v[52:55], a[200:203], a[232:235], v[52:55]
 buffer_load_dwordx4 a[24:27], v4, s[32:35], s74 offen offset:0 nt
 v_mfma_f32_16x16x32_bf16 v[52:55], a[204:207], a[248:251], v[52:55]
 s_lshl_b32 s88, s88, 7
 s_add_u32 s88, s88, 32768
 v_mfma_f32_16x16x32_bf16 v[60:63], a[200:203], a[236:239], v[60:63]
 s_mul_i32 s89, s89, 655360
 s_mul_i32 s86, s3, 2560
 v_mfma_f32_16x16x32_bf16 v[60:63], a[204:207], a[252:255], v[60:63]
 ds_read_b128 v[236:239], v20 offset:6144
 s_waitcnt lgkmcnt(7)
 v_mfma_f32_16x16x32_bf16 v[64:67], a[208:211], a[224:227], v[64:67]
 ds_read_b64_tr_b16 a[192:193], v18 offset:24704
 s_add_u32 s89, s89, s86
 v_mfma_f32_16x16x32_bf16 v[64:67], a[212:215], a[240:243], v[64:67]
 ds_read_b64_tr_b16 a[194:195], v18 offset:26240
 s_add_u32 s89, s89, 33554432
 v_mfma_f32_16x16x32_bf16 v[72:75], a[208:211], a[228:231], v[72:75]
 ds_read_b64_tr_b16 a[196:197], v18 offset:36992
 v_mfma_f32_16x16x32_bf16 v[72:75], a[212:215], a[244:247], v[72:75]
 ds_read_b64_tr_b16 a[198:199], v18 offset:38528
 v_mfma_f32_16x16x32_bf16 v[80:83], a[208:211], a[232:235], v[80:83]
 ds_read_b128 v[240:243], v21 offset:0
 v_mfma_f32_16x16x32_bf16 v[80:83], a[212:215], a[248:251], v[80:83]
 s_add_u32 s44, s18, s89
 s_addc_u32 s45, s19, 0
 v_mfma_f32_16x16x32_bf16 v[88:91], a[208:211], a[236:239], v[88:91]
 buffer_load_dwordx4 a[28:31], v5, s[32:35], s74 offen offset:1024 nt
 v_mfma_f32_16x16x32_bf16 v[88:91], a[212:215], a[252:255], v[88:91]
 s_and_b32 s45, s45, 0xffff
 s_waitcnt lgkmcnt(7)
 v_mfma_f32_16x16x32_bf16 v[68:71], a[216:219], a[224:227], v[68:71]
 ds_read_b64_tr_b16 a[200:201], v18 offset:24712
 s_mov_b32 s46, 647680
 v_mfma_f32_16x16x32_bf16 v[68:71], a[220:223], a[240:243], v[68:71]
 ds_read_b64_tr_b16 a[202:203], v18 offset:26248
 ds_read_b128 v[244:247], v21 offset:2048
 v_mfma_f32_16x16x32_bf16 v[76:79], a[216:219], a[228:231], v[76:79]
 ds_read_b64_tr_b16 a[204:205], v18 offset:37000
 s_mov_b32 s47, 0x20000
 v_mfma_f32_16x16x32_bf16 v[76:79], a[220:223], a[244:247], v[76:79]
 ds_read_b64_tr_b16 a[206:207], v18 offset:38536
 v_mfma_f32_16x16x32_bf16 v[84:87], a[216:219], a[232:235], v[84:87]
 s_add_u32 s48, s18, 100663296
 s_addc_u32 s49, s19, 0
 v_mfma_f32_16x16x32_bf16 v[84:87], a[220:223], a[248:251], v[84:87]
 ds_read_b128 v[248:251], v21 offset:4096
 s_and_b32 s49, s49, 0xffff
 v_mfma_f32_16x16x32_bf16 v[92:95], a[216:219], a[236:239], v[92:95]
 s_mov_b32 s50, 65536
 s_mov_b32 s51, 0x20000
 v_mfma_f32_16x16x32_bf16 v[92:95], a[220:223], a[252:255], v[92:95]
 s_waitcnt lgkmcnt(7)
 v_mfma_f32_16x16x32_bf16 v[96:99], a[192:195], a[224:227], v[96:99]
 ds_read_b64_tr_b16 a[208:209], v19 offset:24704
 v_mfma_f32_16x16x32_bf16 v[96:99], a[196:199], a[240:243], v[96:99]
 ds_read_b64_tr_b16 a[210:211], v19 offset:26240
 v_mfma_f32_16x16x32_bf16 v[104:107], a[192:195], a[228:231], v[104:107]
 ds_read_b64_tr_b16 a[212:213], v19 offset:36992
 ds_read_b128 v[252:255], v21 offset:6144
 v_mfma_f32_16x16x32_bf16 v[104:107], a[196:199], a[244:247], v[104:107]
 ds_read_b64_tr_b16 a[214:215], v19 offset:38528
 v_mfma_f32_16x16x32_bf16 v[112:115], a[192:195], a[232:235], v[112:115]
 buffer_load_dwordx4 a[32:35], v6, s[32:35], s74 offen offset:2048 nt
 v_mfma_f32_16x16x32_bf16 v[112:115], a[196:199], a[248:251], v[112:115]
 s_add_u32 s52, s14, 0
 s_addc_u32 s53, s15, 0
 v_mfma_f32_16x16x32_bf16 v[120:123], a[192:195], a[236:239], v[120:123]
 s_and_b32 s53, s53, 0xffff
 s_mov_b32 s54, 2621440
 v_mfma_f32_16x16x32_bf16 v[120:123], a[196:199], a[252:255], v[120:123]
 s_mov_b32 s55, 0x20000
 s_waitcnt lgkmcnt(6)
 v_mfma_f32_16x16x32_bf16 v[100:103], a[200:203], a[224:227], v[100:103]
 ds_read_b64_tr_b16 a[216:217], v19 offset:24712
 s_mov_b32 s70, 0x3dd53b95
 v_mfma_f32_16x16x32_bf16 v[100:103], a[204:207], a[240:243], v[100:103]
 ds_read_b64_tr_b16 a[218:219], v19 offset:26248
 s_mov_b32 s72, 0x45000000
 v_mfma_f32_16x16x32_bf16 v[108:111], a[200:203], a[228:231], v[108:111]
 ds_read_b64_tr_b16 a[220:221], v19 offset:37000
 v_mfma_f32_16x16x32_bf16 v[108:111], a[204:207], a[244:247], v[108:111]
 ds_read_b64_tr_b16 a[222:223], v19 offset:38536
 v_mfma_f32_16x16x32_bf16 v[116:119], a[200:203], a[232:235], v[116:119]
 s_waitcnt lgkmcnt(5)
 v_mfma_f32_16x16x32_bf16 v[116:119], a[204:207], a[248:251], v[116:119]
 s_add_u32 m0, s78, 0
 s_mov_b32 s75, 768
 v_mfma_f32_16x16x32_bf16 v[124:127], a[200:203], a[236:239], v[124:127]
 v_mfma_f32_16x16x32_bf16 v[124:127], a[204:207], a[252:255], v[124:127]
 s_waitcnt lgkmcnt(4)
 v_mfma_f32_16x16x32_bf16 v[128:131], a[208:211], a[224:227], v[128:131]
 buffer_load_dwordx4 v10, s[20:23], s75 offen offset:0 lds
 v_mfma_f32_16x16x32_bf16 v[128:131], a[212:215], a[240:243], v[128:131]
 ds_read_b64_tr_b16 a[192:193], v18 offset:24832
 ds_read_b64_tr_b16 a[194:195], v18 offset:26368
 v_mfma_f32_16x16x32_bf16 v[136:139], a[208:211], a[228:231], v[136:139]
 s_mov_b32 s75, 9984
 ds_read_b64_tr_b16 a[196:197], v18 offset:37120
 v_mfma_f32_16x16x32_bf16 v[136:139], a[212:215], a[244:247], v[136:139]
 ds_read_b64_tr_b16 a[198:199], v18 offset:38656
 v_mfma_f32_16x16x32_bf16 v[144:147], a[208:211], a[232:235], v[144:147]
 buffer_load_dwordx4 v11, s[20:23], s75 offen offset:1024 lds
 v_mfma_f32_16x16x32_bf16 v[144:147], a[212:215], a[248:251], v[144:147]
 s_mov_b32 s75, 19200
 v_mfma_f32_16x16x32_bf16 v[152:155], a[208:211], a[236:239], v[152:155]
 v_mfma_f32_16x16x32_bf16 v[152:155], a[212:215], a[252:255], v[152:155]
 s_waitcnt lgkmcnt(4)
 v_mfma_f32_16x16x32_bf16 v[132:135], a[216:219], a[224:227], v[132:135]
 buffer_load_dwordx4 v10, s[20:23], s75 offen offset:2048 lds
 v_mfma_f32_16x16x32_bf16 v[132:135], a[220:223], a[240:243], v[132:135]
 ds_read_b64_tr_b16 a[200:201], v18 offset:24840
 ds_read_b64_tr_b16 a[202:203], v18 offset:26376
 v_mfma_f32_16x16x32_bf16 v[140:143], a[216:219], a[228:231], v[140:143]
 s_mov_b32 s75, 28416
 ds_read_b64_tr_b16 a[204:205], v18 offset:37128
 v_mfma_f32_16x16x32_bf16 v[140:143], a[220:223], a[244:247], v[140:143]
 ds_read_b64_tr_b16 a[206:207], v18 offset:38664
 v_mfma_f32_16x16x32_bf16 v[148:151], a[216:219], a[232:235], v[148:151]
 buffer_load_dwordx4 v11, s[20:23], s75 offen offset:3072 lds
 v_mfma_f32_16x16x32_bf16 v[148:151], a[220:223], a[248:251], v[148:151]
 s_add_u32 m0, s78, 4096
 s_mov_b32 s75, 41728
 v_mfma_f32_16x16x32_bf16 v[156:159], a[216:219], a[236:239], v[156:159]
 v_mfma_f32_16x16x32_bf16 v[156:159], a[220:223], a[252:255], v[156:159]
 s_waitcnt lgkmcnt(4)
 v_mfma_f32_16x16x32_bf16 v[160:163], a[192:195], a[224:227], v[160:163]
 buffer_load_dwordx4 v10, s[20:23], s75 offen offset:0 lds
 v_mfma_f32_16x16x32_bf16 v[160:163], a[196:199], a[240:243], v[160:163]
 ds_read_b64_tr_b16 a[208:209], v19 offset:24832
 ds_read_b64_tr_b16 a[210:211], v19 offset:26368
 v_mfma_f32_16x16x32_bf16 v[168:171], a[192:195], a[228:231], v[168:171]
 s_mov_b32 s75, 50944
 ds_read_b64_tr_b16 a[212:213], v19 offset:37120
 v_mfma_f32_16x16x32_bf16 v[168:171], a[196:199], a[244:247], v[168:171]
 ds_read_b64_tr_b16 a[214:215], v19 offset:38656
 v_mfma_f32_16x16x32_bf16 v[176:179], a[192:195], a[232:235], v[176:179]
 buffer_load_dwordx4 v11, s[20:23], s75 offen offset:1024 lds
 v_mfma_f32_16x16x32_bf16 v[176:179], a[196:199], a[248:251], v[176:179]
 s_mov_b32 s75, 60160
 v_mfma_f32_16x16x32_bf16 v[184:187], a[192:195], a[236:239], v[184:187]
 v_mfma_f32_16x16x32_bf16 v[184:187], a[196:199], a[252:255], v[184:187]
 s_waitcnt lgkmcnt(4)
 v_mfma_f32_16x16x32_bf16 v[164:167], a[200:203], a[224:227], v[164:167]
 buffer_load_dwordx4 v10, s[20:23], s75 offen offset:2048 lds
 v_mfma_f32_16x16x32_bf16 v[164:167], a[204:207], a[240:243], v[164:167]
 ds_read_b64_tr_b16 a[216:217], v19 offset:24840
 ds_read_b64_tr_b16 a[218:219], v19 offset:26376
 v_mfma_f32_16x16x32_bf16 v[172:175], a[200:203], a[228:231], v[172:175]
 s_mov_b32 s75, 69376
 ds_read_b64_tr_b16 a[220:221], v19 offset:37128
 v_mfma_f32_16x16x32_bf16 v[172:175], a[204:207], a[244:247], v[172:175]
 buffer_load_dwordx4 v11, s[20:23], s75 offen offset:3072 lds
 v_mfma_f32_16x16x32_bf16 v[180:183], a[200:203], a[232:235], v[180:183]
 ds_read_b64_tr_b16 a[222:223], v19 offset:38664
 v_mfma_f32_16x16x32_bf16 v[180:183], a[204:207], a[248:251], v[180:183]
 v_subrev_u32 v18, 49152, v18
 v_subrev_u32 v19, 49152, v19
 v_mfma_f32_16x16x32_bf16 v[188:191], a[200:203], a[236:239], v[188:191]
 s_waitcnt vmcnt(28)
 s_barrier
 v_mfma_f32_16x16x32_bf16 v[188:191], a[204:207], a[252:255], v[188:191]
 s_waitcnt lgkmcnt(4)
 v_mfma_f32_16x16x32_bf16 v[192:195], a[208:211], a[224:227], v[192:195]
 s_add_u32 m0, s80, 49152
 s_mov_b32 s76, 4718592
 v_mfma_f32_16x16x32_bf16 v[192:195], a[212:215], a[240:243], v[192:195]
 ds_read_b64_tr_b16 a[192:193], v18 offset:0
 ds_read_b64_tr_b16 a[194:195], v18 offset:1536
 v_mfma_f32_16x16x32_bf16 v[200:203], a[208:211], a[228:231], v[200:203]
 buffer_load_dwordx4 v7, s[24:27], s76 offen offset:0 lds
 v_mfma_f32_16x16x32_bf16 v[200:203], a[212:215], a[244:247], v[200:203]
 ds_read_b64_tr_b16 a[196:197], v18 offset:12288
 ds_read_b64_tr_b16 a[198:199], v18 offset:13824
 v_mfma_f32_16x16x32_bf16 v[208:211], a[208:211], a[232:235], v[208:211]
 buffer_load_dwordx4 v8, s[24:27], s76 offen offset:1024 lds
 v_mfma_f32_16x16x32_bf16 v[208:211], a[212:215], a[248:251], v[208:211]
 buffer_load_dwordx4 v9, s[24:27], s76 offen offset:2048 lds
 v_mfma_f32_16x16x32_bf16 v[216:219], a[208:211], a[236:239], v[216:219]
 v_mfma_f32_16x16x32_bf16 v[216:219], a[212:215], a[252:255], v[216:219]
 s_waitcnt lgkmcnt(4)
 v_mfma_f32_16x16x32_bf16 v[196:199], a[216:219], a[224:227], v[196:199]
 s_add_u32 m0, s80, 61440
 s_mov_b32 s76, 5111808
 v_mfma_f32_16x16x32_bf16 v[196:199], a[220:223], a[240:243], v[196:199]
 ds_read_b64_tr_b16 a[200:201], v18 offset:8
 ds_read_b64_tr_b16 a[202:203], v18 offset:1544
 v_mfma_f32_16x16x32_bf16 v[204:207], a[216:219], a[228:231], v[204:207]
 buffer_load_dwordx4 v7, s[24:27], s76 offen offset:0 lds
 v_mfma_f32_16x16x32_bf16 v[204:207], a[220:223], a[244:247], v[204:207]
 ds_read_b64_tr_b16 a[204:205], v18 offset:12296
 ds_read_b64_tr_b16 a[206:207], v18 offset:13832
 v_mfma_f32_16x16x32_bf16 v[212:215], a[216:219], a[232:235], v[212:215]
 buffer_load_dwordx4 v8, s[24:27], s76 offen offset:1024 lds
 v_mfma_f32_16x16x32_bf16 v[212:215], a[220:223], a[248:251], v[212:215]
 buffer_load_dwordx4 v9, s[24:27], s76 offen offset:2048 lds
 v_mfma_f32_16x16x32_bf16 v[220:223], a[216:219], a[236:239], v[220:223]
 v_mfma_f32_16x16x32_bf16 v[220:223], a[220:223], a[252:255], v[220:223]
 s_waitcnt lgkmcnt(4)
 v_mfma_f32_16x16x32_bf16 v[32:35], a[192:195], v[224:227], v[32:35]
 s_waitcnt vmcnt(23)
 ds_read_b64_tr_b16 a[208:209], v19 offset:0
 v_mfma_f32_16x16x32_bf16 v[32:35], a[196:199], v[240:243], v[32:35]
 ds_read_b64_tr_b16 a[210:211], v19 offset:1536
 s_lshr_b32 s68, s2, 3
 v_mfma_f32_16x16x32_bf16 v[40:43], a[192:195], v[228:231], v[40:43]
 ds_read_b64_tr_b16 a[212:213], v19 offset:12288
 ds_read_b128 a[224:227], v20 offset:8192
 v_mfma_f32_16x16x32_bf16 v[40:43], a[196:199], v[244:247], v[40:43]
 ds_read_b64_tr_b16 a[214:215], v19 offset:13824
 s_mov_b32 s74, 24576
 v_mfma_f32_16x16x32_bf16 v[48:51], a[192:195], v[232:235], v[48:51]
 v_mfma_f32_16x16x32_bf16 v[48:51], a[196:199], v[248:251], v[48:51]
 v_mfma_f32_16x16x32_bf16 v[56:59], a[192:195], v[236:239], v[56:59]
 ds_read_b128 a[228:231], v20 offset:10240
 v_mfma_f32_16x16x32_bf16 v[56:59], a[196:199], v[252:255], v[56:59]
 s_waitcnt lgkmcnt(6)
 v_mfma_f32_16x16x32_bf16 v[36:39], a[200:203], v[224:227], v[36:39]
 ds_read_b64_tr_b16 a[216:217], v19 offset:8
 s_lshl_b32 s68, s68, 2
 v_mfma_f32_16x16x32_bf16 v[36:39], a[204:207], v[240:243], v[36:39]
 ds_read_b64_tr_b16 a[218:219], v19 offset:1544
 v_mfma_f32_16x16x32_bf16 v[44:47], a[200:203], v[228:231], v[44:47]
 ds_read_b64_tr_b16 a[220:221], v19 offset:12296
 v_mfma_f32_16x16x32_bf16 v[44:47], a[204:207], v[244:247], v[44:47]
 ds_read_b64_tr_b16 a[222:223], v19 offset:13832
 ds_read_b128 a[232:235], v20 offset:12288
 v_mfma_f32_16x16x32_bf16 v[52:55], a[200:203], v[232:235], v[52:55]
 buffer_load_dwordx4 a[36:39], v1, s[28:31], s74 offen offset:0 nt
 v_mfma_f32_16x16x32_bf16 v[52:55], a[204:207], v[248:251], v[52:55]
 v_mfma_f32_16x16x32_bf16 v[60:63], a[200:203], v[236:239], v[60:63]
 v_mfma_f32_16x16x32_bf16 v[60:63], a[204:207], v[252:255], v[60:63]
 ds_read_b128 a[236:239], v20 offset:14336
 s_waitcnt lgkmcnt(7)
 v_mfma_f32_16x16x32_bf16 v[64:67], a[208:211], v[224:227], v[64:67]
 ds_read_b64_tr_b16 a[192:193], v18 offset:128
 v_mfma_f32_16x16x32_bf16 v[64:67], a[212:215], v[240:243], v[64:67]
 ds_read_b64_tr_b16 a[194:195], v18 offset:1664
 s_add_u32 s68, s68, s3
 v_mfma_f32_16x16x32_bf16 v[72:75], a[208:211], v[228:231], v[72:75]
 ds_read_b64_tr_b16 a[196:197], v18 offset:12416
 v_mfma_f32_16x16x32_bf16 v[72:75], a[212:215], v[244:247], v[72:75]
 ds_read_b64_tr_b16 a[198:199], v18 offset:13952
 v_mfma_f32_16x16x32_bf16 v[80:83], a[208:211], v[232:235], v[80:83]
 ds_read_b128 a[240:243], v21 offset:8192
 v_mfma_f32_16x16x32_bf16 v[80:83], a[212:215], v[248:251], v[80:83]
 v_mfma_f32_16x16x32_bf16 v[88:91], a[208:211], v[236:239], v[88:91]
 buffer_load_dwordx4 a[40:43], v2, s[28:31], s74 offen offset:1024 nt
 v_mfma_f32_16x16x32_bf16 v[88:91], a[212:215], v[252:255], v[88:91]
 s_waitcnt lgkmcnt(7)
 v_mfma_f32_16x16x32_bf16 v[68:71], a[216:219], v[224:227], v[68:71]
 ds_read_b64_tr_b16 a[200:201], v18 offset:136
 v_mfma_f32_16x16x32_bf16 v[68:71], a[220:223], v[240:243], v[68:71]
 ds_read_b64_tr_b16 a[202:203], v18 offset:1672
 ds_read_b128 a[244:247], v21 offset:10240
 v_mfma_f32_16x16x32_bf16 v[76:79], a[216:219], v[228:231], v[76:79]
 ds_read_b64_tr_b16 a[204:205], v18 offset:12424
 s_and_b32 s68, s68, 15
 v_mfma_f32_16x16x32_bf16 v[76:79], a[220:223], v[244:247], v[76:79]
 ds_read_b64_tr_b16 a[206:207], v18 offset:13960
 v_mfma_f32_16x16x32_bf16 v[84:87], a[216:219], v[232:235], v[84:87]
 v_mfma_f32_16x16x32_bf16 v[84:87], a[220:223], v[248:251], v[84:87]
 ds_read_b128 a[248:251], v21 offset:12288
 v_mfma_f32_16x16x32_bf16 v[92:95], a[216:219], v[236:239], v[92:95]
 v_mfma_f32_16x16x32_bf16 v[92:95], a[220:223], v[252:255], v[92:95]
 s_waitcnt lgkmcnt(7)
 v_mfma_f32_16x16x32_bf16 v[96:99], a[192:195], v[224:227], v[96:99]
 ds_read_b64_tr_b16 a[208:209], v19 offset:128
 v_mfma_f32_16x16x32_bf16 v[96:99], a[196:199], v[240:243], v[96:99]
 ds_read_b64_tr_b16 a[210:211], v19 offset:1664
 v_mfma_f32_16x16x32_bf16 v[104:107], a[192:195], v[228:231], v[104:107]
 ds_read_b64_tr_b16 a[212:213], v19 offset:12416
 ds_read_b128 a[252:255], v21 offset:14336
 v_mfma_f32_16x16x32_bf16 v[104:107], a[196:199], v[244:247], v[104:107]
 ds_read_b64_tr_b16 a[214:215], v19 offset:13952
 s_mul_i32 s68, s68, 7680
 v_mfma_f32_16x16x32_bf16 v[112:115], a[192:195], v[232:235], v[112:115]
 buffer_load_dwordx4 a[44:47], v3, s[28:31], s74 offen offset:2048 nt
 v_mfma_f32_16x16x32_bf16 v[112:115], a[196:199], v[248:251], v[112:115]
 v_mfma_f32_16x16x32_bf16 v[120:123], a[192:195], v[236:239], v[120:123]
 v_mfma_f32_16x16x32_bf16 v[120:123], a[196:199], v[252:255], v[120:123]
 s_waitcnt lgkmcnt(6)
 v_mfma_f32_16x16x32_bf16 v[100:103], a[200:203], v[224:227], v[100:103]
 ds_read_b64_tr_b16 a[216:217], v19 offset:136
 v_mfma_f32_16x16x32_bf16 v[100:103], a[204:207], v[240:243], v[100:103]
 ds_read_b64_tr_b16 a[218:219], v19 offset:1672
 v_mfma_f32_16x16x32_bf16 v[108:111], a[200:203], v[228:231], v[108:111]
 ds_read_b64_tr_b16 a[220:221], v19 offset:12424
 v_mfma_f32_16x16x32_bf16 v[108:111], a[204:207], v[244:247], v[108:111]
 ds_read_b64_tr_b16 a[222:223], v19 offset:13960
 s_add_u32 s68, s68, 122880
 v_mfma_f32_16x16x32_bf16 v[116:119], a[200:203], v[232:235], v[116:119]
 s_waitcnt lgkmcnt(5)
 v_mfma_f32_16x16x32_bf16 v[116:119], a[204:207], v[248:251], v[116:119]
 s_add_u32 m0, s78, 8192
 s_mov_b32 s75, 896
 v_mfma_f32_16x16x32_bf16 v[124:127], a[200:203], v[236:239], v[124:127]
 v_mfma_f32_16x16x32_bf16 v[124:127], a[204:207], v[252:255], v[124:127]
 s_waitcnt lgkmcnt(4)
 v_mfma_f32_16x16x32_bf16 v[128:131], a[208:211], v[224:227], v[128:131]
 buffer_load_dwordx4 v10, s[20:23], s75 offen offset:0 lds
 v_mfma_f32_16x16x32_bf16 v[128:131], a[212:215], v[240:243], v[128:131]
 ds_read_b64_tr_b16 a[192:193], v18 offset:256
 ds_read_b64_tr_b16 a[194:195], v18 offset:1792
 v_mfma_f32_16x16x32_bf16 v[136:139], a[208:211], v[228:231], v[136:139]
 s_mov_b32 s75, 10112
 ds_read_b64_tr_b16 a[196:197], v18 offset:12544
 v_mfma_f32_16x16x32_bf16 v[136:139], a[212:215], v[244:247], v[136:139]
 ds_read_b64_tr_b16 a[198:199], v18 offset:14080
 v_mfma_f32_16x16x32_bf16 v[144:147], a[208:211], v[232:235], v[144:147]
 buffer_load_dwordx4 v11, s[20:23], s75 offen offset:1024 lds
 v_mfma_f32_16x16x32_bf16 v[144:147], a[212:215], v[248:251], v[144:147]
 s_mov_b32 s75, 19328
 s_add_u32 s68, s68, s90
 v_mfma_f32_16x16x32_bf16 v[152:155], a[208:211], v[236:239], v[152:155]
 v_mfma_f32_16x16x32_bf16 v[152:155], a[212:215], v[252:255], v[152:155]
 s_waitcnt lgkmcnt(4)
 v_mfma_f32_16x16x32_bf16 v[132:135], a[216:219], v[224:227], v[132:135]
 buffer_load_dwordx4 v10, s[20:23], s75 offen offset:2048 lds
 v_mfma_f32_16x16x32_bf16 v[132:135], a[220:223], v[240:243], v[132:135]
 ds_read_b64_tr_b16 a[200:201], v18 offset:264
 ds_read_b64_tr_b16 a[202:203], v18 offset:1800
 v_mfma_f32_16x16x32_bf16 v[140:143], a[216:219], v[228:231], v[140:143]
 s_mov_b32 s75, 28544
 ds_read_b64_tr_b16 a[204:205], v18 offset:12552
 v_mfma_f32_16x16x32_bf16 v[140:143], a[220:223], v[244:247], v[140:143]
 ds_read_b64_tr_b16 a[206:207], v18 offset:14088
 v_mfma_f32_16x16x32_bf16 v[148:151], a[216:219], v[232:235], v[148:151]
 buffer_load_dwordx4 v11, s[20:23], s75 offen offset:3072 lds
 v_mfma_f32_16x16x32_bf16 v[148:151], a[220:223], v[248:251], v[148:151]
 s_add_u32 m0, s78, 12288
 s_mov_b32 s75, 41856
 v_mfma_f32_16x16x32_bf16 v[156:159], a[216:219], v[236:239], v[156:159]
 v_mfma_f32_16x16x32_bf16 v[156:159], a[220:223], v[252:255], v[156:159]
 s_waitcnt lgkmcnt(4)
 v_mfma_f32_16x16x32_bf16 v[160:163], a[192:195], v[224:227], v[160:163]
 buffer_load_dwordx4 v10, s[20:23], s75 offen offset:0 lds
 v_mfma_f32_16x16x32_bf16 v[160:163], a[196:199], v[240:243], v[160:163]
 ds_read_b64_tr_b16 a[208:209], v19 offset:256
 ds_read_b64_tr_b16 a[210:211], v19 offset:1792
 v_mfma_f32_16x16x32_bf16 v[168:171], a[192:195], v[228:231], v[168:171]
 s_mov_b32 s75, 51072
 ds_read_b64_tr_b16 a[212:213], v19 offset:12544
 v_mfma_f32_16x16x32_bf16 v[168:171], a[196:199], v[244:247], v[168:171]
 ds_read_b64_tr_b16 a[214:215], v19 offset:14080
 v_mfma_f32_16x16x32_bf16 v[176:179], a[192:195], v[232:235], v[176:179]
 buffer_load_dwordx4 v11, s[20:23], s75 offen offset:1024 lds
 v_mfma_f32_16x16x32_bf16 v[176:179], a[196:199], v[248:251], v[176:179]
 s_mov_b32 s75, 60288
 v_mfma_f32_16x16x32_bf16 v[184:187], a[192:195], v[236:239], v[184:187]
 v_mfma_f32_16x16x32_bf16 v[184:187], a[196:199], v[252:255], v[184:187]
 s_waitcnt lgkmcnt(4)
 v_mfma_f32_16x16x32_bf16 v[164:167], a[200:203], v[224:227], v[164:167]
 buffer_load_dwordx4 v10, s[20:23], s75 offen offset:2048 lds
 v_mfma_f32_16x16x32_bf16 v[164:167], a[204:207], v[240:243], v[164:167]
 ds_read_b64_tr_b16 a[216:217], v19 offset:264
 ds_read_b64_tr_b16 a[218:219], v19 offset:1800
 v_mfma_f32_16x16x32_bf16 v[172:175], a[200:203], v[228:231], v[172:175]
 s_mov_b32 s75, 69504
 ds_read_b64_tr_b16 a[220:221], v19 offset:12552
 v_mfma_f32_16x16x32_bf16 v[172:175], a[204:207], v[244:247], v[172:175]
 buffer_load_dwordx4 v11, s[20:23], s75 offen offset:3072 lds
 v_mfma_f32_16x16x32_bf16 v[180:183], a[200:203], v[232:235], v[180:183]
 ds_read_b64_tr_b16 a[222:223], v19 offset:14088
 v_mfma_f32_16x16x32_bf16 v[180:183], a[204:207], v[248:251], v[180:183]
 v_mfma_f32_16x16x32_bf16 v[188:191], a[200:203], v[236:239], v[188:191]
 s_waitcnt vmcnt(28)
 s_barrier
 v_mfma_f32_16x16x32_bf16 v[188:191], a[204:207], v[252:255], v[188:191]
 s_waitcnt lgkmcnt(4)
 v_mfma_f32_16x16x32_bf16 v[192:195], a[208:211], v[224:227], v[192:195]
 s_add_u32 m0, s80, 73728
 s_mov_b32 s76, 5505024
 v_mfma_f32_16x16x32_bf16 v[192:195], a[212:215], v[240:243], v[192:195]
 ds_read_b64_tr_b16 a[192:193], v18 offset:24576
 ds_read_b64_tr_b16 a[194:195], v18 offset:26112
 v_mfma_f32_16x16x32_bf16 v[200:203], a[208:211], v[228:231], v[200:203]
 buffer_load_dwordx4 v7, s[24:27], s76 offen offset:0 lds
 v_mfma_f32_16x16x32_bf16 v[200:203], a[212:215], v[244:247], v[200:203]
 ds_read_b64_tr_b16 a[196:197], v18 offset:36864
 ds_read_b64_tr_b16 a[198:199], v18 offset:38400
 v_mfma_f32_16x16x32_bf16 v[208:211], a[208:211], v[232:235], v[208:211]
 buffer_load_dwordx4 v8, s[24:27], s76 offen offset:1024 lds
 v_mfma_f32_16x16x32_bf16 v[208:211], a[212:215], v[248:251], v[208:211]
 buffer_load_dwordx4 v9, s[24:27], s76 offen offset:2048 lds
 v_mfma_f32_16x16x32_bf16 v[216:219], a[208:211], v[236:239], v[216:219]
 v_mfma_f32_16x16x32_bf16 v[216:219], a[212:215], v[252:255], v[216:219]
 s_waitcnt lgkmcnt(4)
 v_mfma_f32_16x16x32_bf16 v[196:199], a[216:219], v[224:227], v[196:199]
 s_add_u32 m0, s80, 86016
 s_mov_b32 s76, 5898240
 v_mfma_f32_16x16x32_bf16 v[196:199], a[220:223], v[240:243], v[196:199]
 ds_read_b64_tr_b16 a[200:201], v18 offset:24584
 ds_read_b64_tr_b16 a[202:203], v18 offset:26120
 v_mfma_f32_16x16x32_bf16 v[204:207], a[216:219], v[228:231], v[204:207]
 buffer_load_dwordx4 v7, s[24:27], s76 offen offset:0 lds
 v_mfma_f32_16x16x32_bf16 v[204:207], a[220:223], v[244:247], v[204:207]
 ds_read_b64_tr_b16 a[204:205], v18 offset:36872
 ds_read_b64_tr_b16 a[206:207], v18 offset:38408
 v_mfma_f32_16x16x32_bf16 v[212:215], a[216:219], v[232:235], v[212:215]
 buffer_load_dwordx4 v8, s[24:27], s76 offen offset:1024 lds
 v_mfma_f32_16x16x32_bf16 v[212:215], a[220:223], v[248:251], v[212:215]
 buffer_load_dwordx4 v9, s[24:27], s76 offen offset:2048 lds
 v_mfma_f32_16x16x32_bf16 v[220:223], a[216:219], v[236:239], v[220:223]
 v_mfma_f32_16x16x32_bf16 v[220:223], a[220:223], v[252:255], v[220:223]
 s_waitcnt lgkmcnt(4)
 v_mfma_f32_16x16x32_bf16 v[32:35], a[192:195], a[224:227], v[32:35]
 s_waitcnt vmcnt(23)
 ds_read_b64_tr_b16 a[208:209], v19 offset:24576
 v_mfma_f32_16x16x32_bf16 v[32:35], a[196:199], a[240:243], v[32:35]
 ds_read_b64_tr_b16 a[210:211], v19 offset:26112
 v_mfma_f32_16x16x32_bf16 v[40:43], a[192:195], a[228:231], v[40:43]
 ds_read_b64_tr_b16 a[212:213], v19 offset:36864
 ds_read_b128 v[224:227], v20 offset:0
 v_mfma_f32_16x16x32_bf16 v[40:43], a[196:199], a[244:247], v[40:43]
 ds_read_b64_tr_b16 a[214:215], v19 offset:38400
 s_mov_b32 s74, 12288
 v_mfma_f32_16x16x32_bf16 v[48:51], a[192:195], a[232:235], v[48:51]
 v_mfma_f32_16x16x32_bf16 v[48:51], a[196:199], a[248:251], v[48:51]
 v_mfma_f32_16x16x32_bf16 v[56:59], a[192:195], a[236:239], v[56:59]
 ds_read_b128 v[228:231], v20 offset:2048
 v_mfma_f32_16x16x32_bf16 v[56:59], a[196:199], a[252:255], v[56:59]
 s_waitcnt lgkmcnt(6)
 v_mfma_f32_16x16x32_bf16 v[36:39], a[200:203], a[224:227], v[36:39]
 ds_read_b64_tr_b16 a[216:217], v19 offset:24584
 v_mfma_f32_16x16x32_bf16 v[36:39], a[204:207], a[240:243], v[36:39]
 ds_read_b64_tr_b16 a[218:219], v19 offset:26120
 v_mfma_f32_16x16x32_bf16 v[44:47], a[200:203], a[228:231], v[44:47]
 ds_read_b64_tr_b16 a[220:221], v19 offset:36872
 v_mfma_f32_16x16x32_bf16 v[44:47], a[204:207], a[244:247], v[44:47]
 ds_read_b64_tr_b16 a[222:223], v19 offset:38408
 ds_read_b128 v[232:235], v20 offset:4096
 v_mfma_f32_16x16x32_bf16 v[52:55], a[200:203], a[232:235], v[52:55]
 buffer_load_dwordx4 a[48:51], v4, s[32:35], s74 offen offset:0 nt
 v_mfma_f32_16x16x32_bf16 v[52:55], a[204:207], a[248:251], v[52:55]
 v_mfma_f32_16x16x32_bf16 v[60:63], a[200:203], a[236:239], v[60:63]
 v_mfma_f32_16x16x32_bf16 v[60:63], a[204:207], a[252:255], v[60:63]
 ds_read_b128 v[236:239], v20 offset:6144
 s_waitcnt lgkmcnt(7)
 v_mfma_f32_16x16x32_bf16 v[64:67], a[208:211], a[224:227], v[64:67]
 ds_read_b64_tr_b16 a[192:193], v18 offset:24704
 v_mfma_f32_16x16x32_bf16 v[64:67], a[212:215], a[240:243], v[64:67]
 ds_read_b64_tr_b16 a[194:195], v18 offset:26240
 v_mfma_f32_16x16x32_bf16 v[72:75], a[208:211], a[228:231], v[72:75]
 ds_read_b64_tr_b16 a[196:197], v18 offset:36992
 v_mfma_f32_16x16x32_bf16 v[72:75], a[212:215], a[244:247], v[72:75]
 ds_read_b64_tr_b16 a[198:199], v18 offset:38528
 v_mfma_f32_16x16x32_bf16 v[80:83], a[208:211], a[232:235], v[80:83]
 ds_read_b128 v[240:243], v21 offset:0
 v_mfma_f32_16x16x32_bf16 v[80:83], a[212:215], a[248:251], v[80:83]
 v_mfma_f32_16x16x32_bf16 v[88:91], a[208:211], a[236:239], v[88:91]
 buffer_load_dwordx4 a[52:55], v5, s[32:35], s74 offen offset:1024 nt
 v_mfma_f32_16x16x32_bf16 v[88:91], a[212:215], a[252:255], v[88:91]
 s_waitcnt lgkmcnt(7)
 v_mfma_f32_16x16x32_bf16 v[68:71], a[216:219], a[224:227], v[68:71]
 ds_read_b64_tr_b16 a[200:201], v18 offset:24712
 v_mfma_f32_16x16x32_bf16 v[68:71], a[220:223], a[240:243], v[68:71]
 ds_read_b64_tr_b16 a[202:203], v18 offset:26248
 ds_read_b128 v[244:247], v21 offset:2048
 v_mfma_f32_16x16x32_bf16 v[76:79], a[216:219], a[228:231], v[76:79]
 ds_read_b64_tr_b16 a[204:205], v18 offset:37000
 v_mfma_f32_16x16x32_bf16 v[76:79], a[220:223], a[244:247], v[76:79]
 ds_read_b64_tr_b16 a[206:207], v18 offset:38536
 v_mfma_f32_16x16x32_bf16 v[84:87], a[216:219], a[232:235], v[84:87]
 v_mfma_f32_16x16x32_bf16 v[84:87], a[220:223], a[248:251], v[84:87]
 ds_read_b128 v[248:251], v21 offset:4096
 v_mfma_f32_16x16x32_bf16 v[92:95], a[216:219], a[236:239], v[92:95]
 v_mfma_f32_16x16x32_bf16 v[92:95], a[220:223], a[252:255], v[92:95]
 s_waitcnt lgkmcnt(7)
 v_mfma_f32_16x16x32_bf16 v[96:99], a[192:195], a[224:227], v[96:99]
 ds_read_b64_tr_b16 a[208:209], v19 offset:24704
 v_mfma_f32_16x16x32_bf16 v[96:99], a[196:199], a[240:243], v[96:99]
 ds_read_b64_tr_b16 a[210:211], v19 offset:26240
 v_mfma_f32_16x16x32_bf16 v[104:107], a[192:195], a[228:231], v[104:107]
 ds_read_b64_tr_b16 a[212:213], v19 offset:36992
 ds_read_b128 v[252:255], v21 offset:6144
 v_mfma_f32_16x16x32_bf16 v[104:107], a[196:199], a[244:247], v[104:107]
 ds_read_b64_tr_b16 a[214:215], v19 offset:38528
 v_mfma_f32_16x16x32_bf16 v[112:115], a[192:195], a[232:235], v[112:115]
 buffer_load_dwordx4 a[56:59], v6, s[32:35], s74 offen offset:2048 nt
 v_mfma_f32_16x16x32_bf16 v[112:115], a[196:199], a[248:251], v[112:115]
 v_mfma_f32_16x16x32_bf16 v[120:123], a[192:195], a[236:239], v[120:123]
 v_mfma_f32_16x16x32_bf16 v[120:123], a[196:199], a[252:255], v[120:123]
 s_waitcnt lgkmcnt(6)
 v_mfma_f32_16x16x32_bf16 v[100:103], a[200:203], a[224:227], v[100:103]
 ds_read_b64_tr_b16 a[216:217], v19 offset:24712
 v_mfma_f32_16x16x32_bf16 v[100:103], a[204:207], a[240:243], v[100:103]
 ds_read_b64_tr_b16 a[218:219], v19 offset:26248
 v_mfma_f32_16x16x32_bf16 v[108:111], a[200:203], a[228:231], v[108:111]
 ds_read_b64_tr_b16 a[220:221], v19 offset:37000
 v_mfma_f32_16x16x32_bf16 v[108:111], a[204:207], a[244:247], v[108:111]
 ds_read_b64_tr_b16 a[222:223], v19 offset:38536
 v_mfma_f32_16x16x32_bf16 v[116:119], a[200:203], a[232:235], v[116:119]
 s_waitcnt lgkmcnt(5)
 v_mfma_f32_16x16x32_bf16 v[116:119], a[204:207], a[248:251], v[116:119]
 s_add_u32 m0, s78, 0
 s_mov_b32 s75, 1024
 v_mfma_f32_16x16x32_bf16 v[124:127], a[200:203], a[236:239], v[124:127]
 v_mfma_f32_16x16x32_bf16 v[124:127], a[204:207], a[252:255], v[124:127]
 s_waitcnt lgkmcnt(4)
 v_mfma_f32_16x16x32_bf16 v[128:131], a[208:211], a[224:227], v[128:131]
 buffer_load_dwordx4 v10, s[20:23], s75 offen offset:0 lds
 v_mfma_f32_16x16x32_bf16 v[128:131], a[212:215], a[240:243], v[128:131]
 ds_read_b64_tr_b16 a[192:193], v18 offset:24832
 ds_read_b64_tr_b16 a[194:195], v18 offset:26368
 v_mfma_f32_16x16x32_bf16 v[136:139], a[208:211], a[228:231], v[136:139]
 s_mov_b32 s75, 10240
 ds_read_b64_tr_b16 a[196:197], v18 offset:37120
 v_mfma_f32_16x16x32_bf16 v[136:139], a[212:215], a[244:247], v[136:139]
 ds_read_b64_tr_b16 a[198:199], v18 offset:38656
 v_readfirstlane_b32 s89, v22
 v_mfma_f32_16x16x32_bf16 v[144:147], a[208:211], a[232:235], v[144:147]
 buffer_load_dwordx4 v11, s[20:23], s75 offen offset:1024 lds
 v_mfma_f32_16x16x32_bf16 v[144:147], a[212:215], a[248:251], v[144:147]
 s_mov_b32 s75, 19456
 v_mfma_f32_16x16x32_bf16 v[152:155], a[208:211], a[236:239], v[152:155]
 v_mfma_f32_16x16x32_bf16 v[152:155], a[212:215], a[252:255], v[152:155]
 s_waitcnt lgkmcnt(4)
 v_mfma_f32_16x16x32_bf16 v[132:135], a[216:219], a[224:227], v[132:135]
 buffer_load_dwordx4 v10, s[20:23], s75 offen offset:2048 lds
 v_mfma_f32_16x16x32_bf16 v[132:135], a[220:223], a[240:243], v[132:135]
 ds_read_b64_tr_b16 a[200:201], v18 offset:24840
 ds_read_b64_tr_b16 a[202:203], v18 offset:26376
 v_mfma_f32_16x16x32_bf16 v[140:143], a[216:219], a[228:231], v[140:143]
 s_mov_b32 s75, 28672
 ds_read_b64_tr_b16 a[204:205], v18 offset:37128
 v_mfma_f32_16x16x32_bf16 v[140:143], a[220:223], a[244:247], v[140:143]
 ds_read_b64_tr_b16 a[206:207], v18 offset:38664
 v_mfma_f32_16x16x32_bf16 v[148:151], a[216:219], a[232:235], v[148:151]
 buffer_load_dwordx4 v11, s[20:23], s75 offen offset:3072 lds
 v_mfma_f32_16x16x32_bf16 v[148:151], a[220:223], a[248:251], v[148:151]
 s_add_u32 m0, s78, 4096
 s_mov_b32 s75, 41984
 v_mfma_f32_16x16x32_bf16 v[156:159], a[216:219], a[236:239], v[156:159]
 s_cmp_eq_u32 s89, 0
 s_cselect_b32 s82, s82, s89
 v_mfma_f32_16x16x32_bf16 v[156:159], a[220:223], a[252:255], v[156:159]
 s_waitcnt lgkmcnt(4)
 v_mfma_f32_16x16x32_bf16 v[160:163], a[192:195], a[224:227], v[160:163]
 buffer_load_dwordx4 v10, s[20:23], s75 offen offset:0 lds
 v_mfma_f32_16x16x32_bf16 v[160:163], a[196:199], a[240:243], v[160:163]
 ds_read_b64_tr_b16 a[208:209], v19 offset:24832
 ds_read_b64_tr_b16 a[210:211], v19 offset:26368
 v_mfma_f32_16x16x32_bf16 v[168:171], a[192:195], a[228:231], v[168:171]
 s_mov_b32 s75, 51200
 ds_read_b64_tr_b16 a[212:213], v19 offset:37120
 v_mfma_f32_16x16x32_bf16 v[168:171], a[196:199], a[244:247], v[168:171]
 ds_read_b64_tr_b16 a[214:215], v19 offset:38656
 v_mfma_f32_16x16x32_bf16 v[176:179], a[192:195], a[232:235], v[176:179]
 buffer_load_dwordx4 v11, s[20:23], s75 offen offset:1024 lds
 v_mfma_f32_16x16x32_bf16 v[176:179], a[196:199], a[248:251], v[176:179]
 s_mov_b32 s75, 60416
 v_mfma_f32_16x16x32_bf16 v[184:187], a[192:195], a[236:239], v[184:187]
 v_mfma_f32_16x16x32_bf16 v[184:187], a[196:199], a[252:255], v[184:187]
 s_waitcnt lgkmcnt(4)
 v_mfma_f32_16x16x32_bf16 v[164:167], a[200:203], a[224:227], v[164:167]
 buffer_load_dwordx4 v10, s[20:23], s75 offen offset:2048 lds
 v_mfma_f32_16x16x32_bf16 v[164:167], a[204:207], a[240:243], v[164:167]
 ds_read_b64_tr_b16 a[216:217], v19 offset:24840
 ds_read_b64_tr_b16 a[218:219], v19 offset:26376
 v_mfma_f32_16x16x32_bf16 v[172:175], a[200:203], a[228:231], v[172:175]
 s_mov_b32 s75, 69632
 ds_read_b64_tr_b16 a[220:221], v19 offset:37128
 v_mfma_f32_16x16x32_bf16 v[172:175], a[204:207], a[244:247], v[172:175]
 buffer_load_dwordx4 v11, s[20:23], s75 offen offset:3072 lds
 v_mfma_f32_16x16x32_bf16 v[180:183], a[200:203], a[232:235], v[180:183]
 ds_read_b64_tr_b16 a[222:223], v19 offset:38664
 v_mfma_f32_16x16x32_bf16 v[180:183], a[204:207], a[248:251], v[180:183]
 v_add_u32 v18, 49152, v18
 v_add_u32 v19, 49152, v19
 v_mfma_f32_16x16x32_bf16 v[188:191], a[200:203], a[236:239], v[188:191]
 s_waitcnt vmcnt(28)
 s_barrier
 v_mfma_f32_16x16x32_bf16 v[188:191], a[204:207], a[252:255], v[188:191]
 s_waitcnt lgkmcnt(4)
 v_mfma_f32_16x16x32_bf16 v[192:195], a[208:211], a[224:227], v[192:195]
 s_add_u32 m0, s80, 0
 s_mov_b32 s76, 6291456
 v_mfma_f32_16x16x32_bf16 v[192:195], a[212:215], a[240:243], v[192:195]
 ds_read_b64_tr_b16 a[192:193], v18 offset:0
 ds_read_b64_tr_b16 a[194:195], v18 offset:1536
 v_mfma_f32_16x16x32_bf16 v[200:203], a[208:211], a[228:231], v[200:203]
 buffer_load_dwordx4 v7, s[24:27], s76 offen offset:0 lds
 v_mfma_f32_16x16x32_bf16 v[200:203], a[212:215], a[244:247], v[200:203]
 ds_read_b64_tr_b16 a[196:197], v18 offset:12288
 ds_read_b64_tr_b16 a[198:199], v18 offset:13824
 v_mfma_f32_16x16x32_bf16 v[208:211], a[208:211], a[232:235], v[208:211]
 buffer_load_dwordx4 v8, s[24:27], s76 offen offset:1024 lds
 v_mfma_f32_16x16x32_bf16 v[208:211], a[212:215], a[248:251], v[208:211]
 buffer_load_dwordx4 v9, s[24:27], s76 offen offset:2048 lds
 v_mfma_f32_16x16x32_bf16 v[216:219], a[208:211], a[236:239], v[216:219]
 v_mfma_f32_16x16x32_bf16 v[216:219], a[212:215], a[252:255], v[216:219]
 s_waitcnt lgkmcnt(4)
 v_mfma_f32_16x16x32_bf16 v[196:199], a[216:219], a[224:227], v[196:199]
 s_add_u32 m0, s80, 12288
 s_mov_b32 s76, 6684672
 v_mfma_f32_16x16x32_bf16 v[196:199], a[220:223], a[240:243], v[196:199]
 ds_read_b64_tr_b16 a[200:201], v18 offset:8
 ds_read_b64_tr_b16 a[202:203], v18 offset:1544
 v_mfma_f32_16x16x32_bf16 v[204:207], a[216:219], a[228:231], v[204:207]
 buffer_load_dwordx4 v7, s[24:27], s76 offen offset:0 lds
 v_mfma_f32_16x16x32_bf16 v[204:207], a[220:223], a[244:247], v[204:207]
 ds_read_b64_tr_b16 a[204:205], v18 offset:12296
 ds_read_b64_tr_b16 a[206:207], v18 offset:13832
 v_mfma_f32_16x16x32_bf16 v[212:215], a[216:219], a[232:235], v[212:215]
 buffer_load_dwordx4 v8, s[24:27], s76 offen offset:1024 lds
 v_mfma_f32_16x16x32_bf16 v[212:215], a[220:223], a[248:251], v[212:215]
 buffer_load_dwordx4 v9, s[24:27], s76 offen offset:2048 lds
 v_mfma_f32_16x16x32_bf16 v[220:223], a[216:219], a[236:239], v[220:223]
 v_mfma_f32_16x16x32_bf16 v[220:223], a[220:223], a[252:255], v[220:223]
 s_waitcnt lgkmcnt(4)
 v_mfma_f32_16x16x32_bf16 v[32:35], a[192:195], v[224:227], v[32:35]
 s_waitcnt vmcnt(23)
 ds_read_b64_tr_b16 a[208:209], v19 offset:0
 v_mfma_f32_16x16x32_bf16 v[32:35], a[196:199], v[240:243], v[32:35]
 ds_read_b64_tr_b16 a[210:211], v19 offset:1536
 v_mfma_f32_16x16x32_bf16 v[40:43], a[192:195], v[228:231], v[40:43]
 ds_read_b64_tr_b16 a[212:213], v19 offset:12288
 ds_read_b128 a[224:227], v20 offset:8192
 v_mfma_f32_16x16x32_bf16 v[40:43], a[196:199], v[244:247], v[40:43]
 ds_read_b64_tr_b16 a[214:215], v19 offset:13824
 s_mov_b32 s74, 36864
 v_mfma_f32_16x16x32_bf16 v[48:51], a[192:195], v[232:235], v[48:51]
 v_mfma_f32_16x16x32_bf16 v[48:51], a[196:199], v[248:251], v[48:51]
 v_mfma_f32_16x16x32_bf16 v[56:59], a[192:195], v[236:239], v[56:59]
 ds_read_b128 a[228:231], v20 offset:10240
 v_mfma_f32_16x16x32_bf16 v[56:59], a[196:199], v[252:255], v[56:59]
 s_waitcnt lgkmcnt(6)
 v_mfma_f32_16x16x32_bf16 v[36:39], a[200:203], v[224:227], v[36:39]
 ds_read_b64_tr_b16 a[216:217], v19 offset:8
 v_mfma_f32_16x16x32_bf16 v[36:39], a[204:207], v[240:243], v[36:39]
 ds_read_b64_tr_b16 a[218:219], v19 offset:1544
 v_mfma_f32_16x16x32_bf16 v[44:47], a[200:203], v[228:231], v[44:47]
 ds_read_b64_tr_b16 a[220:221], v19 offset:12296
 v_mfma_f32_16x16x32_bf16 v[44:47], a[204:207], v[244:247], v[44:47]
 ds_read_b64_tr_b16 a[222:223], v19 offset:13832
 ds_read_b128 a[232:235], v20 offset:12288
 v_mfma_f32_16x16x32_bf16 v[52:55], a[200:203], v[232:235], v[52:55]
 buffer_load_dwordx4 a[60:63], v1, s[28:31], s74 offen offset:0 nt
 v_mfma_f32_16x16x32_bf16 v[52:55], a[204:207], v[248:251], v[52:55]
 v_mfma_f32_16x16x32_bf16 v[60:63], a[200:203], v[236:239], v[60:63]
 v_mfma_f32_16x16x32_bf16 v[60:63], a[204:207], v[252:255], v[60:63]
 ds_read_b128 a[236:239], v20 offset:14336
 s_waitcnt lgkmcnt(7)
 v_mfma_f32_16x16x32_bf16 v[64:67], a[208:211], v[224:227], v[64:67]
 ds_read_b64_tr_b16 a[192:193], v18 offset:128
 v_mfma_f32_16x16x32_bf16 v[64:67], a[212:215], v[240:243], v[64:67]
 ds_read_b64_tr_b16 a[194:195], v18 offset:1664
 v_mfma_f32_16x16x32_bf16 v[72:75], a[208:211], v[228:231], v[72:75]
 ds_read_b64_tr_b16 a[196:197], v18 offset:12416
 v_mfma_f32_16x16x32_bf16 v[72:75], a[212:215], v[244:247], v[72:75]
 ds_read_b64_tr_b16 a[198:199], v18 offset:13952
 v_mfma_f32_16x16x32_bf16 v[80:83], a[208:211], v[232:235], v[80:83]
 ds_read_b128 a[240:243], v21 offset:8192
 v_mfma_f32_16x16x32_bf16 v[80:83], a[212:215], v[248:251], v[80:83]
 v_mfma_f32_16x16x32_bf16 v[88:91], a[208:211], v[236:239], v[88:91]
 buffer_load_dwordx4 a[64:67], v2, s[28:31], s74 offen offset:1024 nt
 v_mfma_f32_16x16x32_bf16 v[88:91], a[212:215], v[252:255], v[88:91]
 s_waitcnt lgkmcnt(7)
 v_mfma_f32_16x16x32_bf16 v[68:71], a[216:219], v[224:227], v[68:71]
 ds_read_b64_tr_b16 a[200:201], v18 offset:136
 v_mfma_f32_16x16x32_bf16 v[68:71], a[220:223], v[240:243], v[68:71]
 ds_read_b64_tr_b16 a[202:203], v18 offset:1672
 ds_read_b128 a[244:247], v21 offset:10240
 v_mfma_f32_16x16x32_bf16 v[76:79], a[216:219], v[228:231], v[76:79]
 ds_read_b64_tr_b16 a[204:205], v18 offset:12424
 v_mfma_f32_16x16x32_bf16 v[76:79], a[220:223], v[244:247], v[76:79]
 ds_read_b64_tr_b16 a[206:207], v18 offset:13960
 v_mfma_f32_16x16x32_bf16 v[84:87], a[216:219], v[232:235], v[84:87]
 v_mfma_f32_16x16x32_bf16 v[84:87], a[220:223], v[248:251], v[84:87]
 ds_read_b128 a[248:251], v21 offset:12288
 v_mfma_f32_16x16x32_bf16 v[92:95], a[216:219], v[236:239], v[92:95]
 v_mfma_f32_16x16x32_bf16 v[92:95], a[220:223], v[252:255], v[92:95]
 s_waitcnt lgkmcnt(7)
 v_mfma_f32_16x16x32_bf16 v[96:99], a[192:195], v[224:227], v[96:99]
 ds_read_b64_tr_b16 a[208:209], v19 offset:128
 v_mfma_f32_16x16x32_bf16 v[96:99], a[196:199], v[240:243], v[96:99]
 ds_read_b64_tr_b16 a[210:211], v19 offset:1664
 v_mfma_f32_16x16x32_bf16 v[104:107], a[192:195], v[228:231], v[104:107]
 ds_read_b64_tr_b16 a[212:213], v19 offset:12416
 ds_read_b128 a[252:255], v21 offset:14336
 v_mfma_f32_16x16x32_bf16 v[104:107], a[196:199], v[244:247], v[104:107]
 ds_read_b64_tr_b16 a[214:215], v19 offset:13952
 v_mfma_f32_16x16x32_bf16 v[112:115], a[192:195], v[232:235], v[112:115]
 buffer_load_dwordx4 a[68:71], v3, s[28:31], s74 offen offset:2048 nt
 v_mfma_f32_16x16x32_bf16 v[112:115], a[196:199], v[248:251], v[112:115]
 v_mfma_f32_16x16x32_bf16 v[120:123], a[192:195], v[236:239], v[120:123]
 v_mfma_f32_16x16x32_bf16 v[120:123], a[196:199], v[252:255], v[120:123]
 s_waitcnt lgkmcnt(6)
 v_mfma_f32_16x16x32_bf16 v[100:103], a[200:203], v[224:227], v[100:103]
 ds_read_b64_tr_b16 a[216:217], v19 offset:136
 v_mfma_f32_16x16x32_bf16 v[100:103], a[204:207], v[240:243], v[100:103]
 ds_read_b64_tr_b16 a[218:219], v19 offset:1672
 v_mfma_f32_16x16x32_bf16 v[108:111], a[200:203], v[228:231], v[108:111]
 ds_read_b64_tr_b16 a[220:221], v19 offset:12424
 v_mfma_f32_16x16x32_bf16 v[108:111], a[204:207], v[244:247], v[108:111]
 ds_read_b64_tr_b16 a[222:223], v19 offset:13960
 v_mfma_f32_16x16x32_bf16 v[116:119], a[200:203], v[232:235], v[116:119]
 s_waitcnt lgkmcnt(5)
 v_mfma_f32_16x16x32_bf16 v[116:119], a[204:207], v[248:251], v[116:119]
 s_add_u32 m0, s78, 8192
 s_mov_b32 s75, 1152
 v_mfma_f32_16x16x32_bf16 v[124:127], a[200:203], v[236:239], v[124:127]
 v_mfma_f32_16x16x32_bf16 v[124:127], a[204:207], v[252:255], v[124:127]
 s_waitcnt lgkmcnt(4)
 v_mfma_f32_16x16x32_bf16 v[128:131], a[208:211], v[224:227], v[128:131]
 buffer_load_dwordx4 v10, s[20:23], s75 offen offset:0 lds
 v_mfma_f32_16x16x32_bf16 v[128:131], a[212:215], v[240:243], v[128:131]
 ds_read_b64_tr_b16 a[192:193], v18 offset:256
 ds_read_b64_tr_b16 a[194:195], v18 offset:1792
 v_mfma_f32_16x16x32_bf16 v[136:139], a[208:211], v[228:231], v[136:139]
 s_mov_b32 s75, 10368
 ds_read_b64_tr_b16 a[196:197], v18 offset:12544
 v_mfma_f32_16x16x32_bf16 v[136:139], a[212:215], v[244:247], v[136:139]
 ds_read_b64_tr_b16 a[198:199], v18 offset:14080
 v_mfma_f32_16x16x32_bf16 v[144:147], a[208:211], v[232:235], v[144:147]
 buffer_load_dwordx4 v11, s[20:23], s75 offen offset:1024 lds
 v_mfma_f32_16x16x32_bf16 v[144:147], a[212:215], v[248:251], v[144:147]
 s_mov_b32 s75, 19584
 v_mfma_f32_16x16x32_bf16 v[152:155], a[208:211], v[236:239], v[152:155]
 v_mfma_f32_16x16x32_bf16 v[152:155], a[212:215], v[252:255], v[152:155]
 s_waitcnt lgkmcnt(4)
 v_mfma_f32_16x16x32_bf16 v[132:135], a[216:219], v[224:227], v[132:135]
 buffer_load_dwordx4 v10, s[20:23], s75 offen offset:2048 lds
 v_mfma_f32_16x16x32_bf16 v[132:135], a[220:223], v[240:243], v[132:135]
 ds_read_b64_tr_b16 a[200:201], v18 offset:264
 ds_read_b64_tr_b16 a[202:203], v18 offset:1800
 v_mfma_f32_16x16x32_bf16 v[140:143], a[216:219], v[228:231], v[140:143]
 s_mov_b32 s75, 28800
 ds_read_b64_tr_b16 a[204:205], v18 offset:12552
 v_mfma_f32_16x16x32_bf16 v[140:143], a[220:223], v[244:247], v[140:143]
 ds_read_b64_tr_b16 a[206:207], v18 offset:14088
 v_mfma_f32_16x16x32_bf16 v[148:151], a[216:219], v[232:235], v[148:151]
 buffer_load_dwordx4 v11, s[20:23], s75 offen offset:3072 lds
 v_mfma_f32_16x16x32_bf16 v[148:151], a[220:223], v[248:251], v[148:151]
 s_add_u32 m0, s78, 12288
 s_mov_b32 s75, 42112
 v_mfma_f32_16x16x32_bf16 v[156:159], a[216:219], v[236:239], v[156:159]
 v_mfma_f32_16x16x32_bf16 v[156:159], a[220:223], v[252:255], v[156:159]
 s_waitcnt lgkmcnt(4)
 v_mfma_f32_16x16x32_bf16 v[160:163], a[192:195], v[224:227], v[160:163]
 buffer_load_dwordx4 v10, s[20:23], s75 offen offset:0 lds
 v_mfma_f32_16x16x32_bf16 v[160:163], a[196:199], v[240:243], v[160:163]
 ds_read_b64_tr_b16 a[208:209], v19 offset:256
 ds_read_b64_tr_b16 a[210:211], v19 offset:1792
 v_mfma_f32_16x16x32_bf16 v[168:171], a[192:195], v[228:231], v[168:171]
 s_mov_b32 s75, 51328
 ds_read_b64_tr_b16 a[212:213], v19 offset:12544
 v_mfma_f32_16x16x32_bf16 v[168:171], a[196:199], v[244:247], v[168:171]
 ds_read_b64_tr_b16 a[214:215], v19 offset:14080
 v_mfma_f32_16x16x32_bf16 v[176:179], a[192:195], v[232:235], v[176:179]
 buffer_load_dwordx4 v11, s[20:23], s75 offen offset:1024 lds
 v_mfma_f32_16x16x32_bf16 v[176:179], a[196:199], v[248:251], v[176:179]
 s_mov_b32 s75, 60544
 v_mfma_f32_16x16x32_bf16 v[184:187], a[192:195], v[236:239], v[184:187]
 v_mfma_f32_16x16x32_bf16 v[184:187], a[196:199], v[252:255], v[184:187]
 s_waitcnt lgkmcnt(4)
 v_mfma_f32_16x16x32_bf16 v[164:167], a[200:203], v[224:227], v[164:167]
 buffer_load_dwordx4 v10, s[20:23], s75 offen offset:2048 lds
 v_mfma_f32_16x16x32_bf16 v[164:167], a[204:207], v[240:243], v[164:167]
 ds_read_b64_tr_b16 a[216:217], v19 offset:264
 ds_read_b64_tr_b16 a[218:219], v19 offset:1800
 v_mfma_f32_16x16x32_bf16 v[172:175], a[200:203], v[228:231], v[172:175]
 s_mov_b32 s75, 69760
 ds_read_b64_tr_b16 a[220:221], v19 offset:12552
 v_mfma_f32_16x16x32_bf16 v[172:175], a[204:207], v[244:247], v[172:175]
 buffer_load_dwordx4 v11, s[20:23], s75 offen offset:3072 lds
 v_mfma_f32_16x16x32_bf16 v[180:183], a[200:203], v[232:235], v[180:183]
 ds_read_b64_tr_b16 a[222:223], v19 offset:14088
 v_mfma_f32_16x16x32_bf16 v[180:183], a[204:207], v[248:251], v[180:183]
 v_mfma_f32_16x16x32_bf16 v[188:191], a[200:203], v[236:239], v[188:191]
 s_waitcnt vmcnt(28)
 s_barrier
 v_mfma_f32_16x16x32_bf16 v[188:191], a[204:207], v[252:255], v[188:191]
 s_waitcnt lgkmcnt(4)
 v_mfma_f32_16x16x32_bf16 v[192:195], a[208:211], v[224:227], v[192:195]
 s_add_u32 m0, s80, 24576
 s_mov_b32 s76, 7077888
 v_mfma_f32_16x16x32_bf16 v[192:195], a[212:215], v[240:243], v[192:195]
 ds_read_b64_tr_b16 a[192:193], v18 offset:24576
 ds_read_b64_tr_b16 a[194:195], v18 offset:26112
 v_mfma_f32_16x16x32_bf16 v[200:203], a[208:211], v[228:231], v[200:203]
 buffer_load_dwordx4 v7, s[24:27], s76 offen offset:0 lds
 v_mfma_f32_16x16x32_bf16 v[200:203], a[212:215], v[244:247], v[200:203]
 ds_read_b64_tr_b16 a[196:197], v18 offset:36864
 ds_read_b64_tr_b16 a[198:199], v18 offset:38400
 v_mfma_f32_16x16x32_bf16 v[208:211], a[208:211], v[232:235], v[208:211]
 buffer_load_dwordx4 v8, s[24:27], s76 offen offset:1024 lds
 v_mfma_f32_16x16x32_bf16 v[208:211], a[212:215], v[248:251], v[208:211]
 buffer_load_dwordx4 v9, s[24:27], s76 offen offset:2048 lds
 v_mfma_f32_16x16x32_bf16 v[216:219], a[208:211], v[236:239], v[216:219]
 v_mfma_f32_16x16x32_bf16 v[216:219], a[212:215], v[252:255], v[216:219]
 s_waitcnt lgkmcnt(4)
 v_mfma_f32_16x16x32_bf16 v[196:199], a[216:219], v[224:227], v[196:199]
 s_add_u32 m0, s80, 36864
 s_mov_b32 s76, 7471104
 v_mfma_f32_16x16x32_bf16 v[196:199], a[220:223], v[240:243], v[196:199]
 ds_read_b64_tr_b16 a[200:201], v18 offset:24584
 ds_read_b64_tr_b16 a[202:203], v18 offset:26120
 v_mfma_f32_16x16x32_bf16 v[204:207], a[216:219], v[228:231], v[204:207]
 buffer_load_dwordx4 v7, s[24:27], s76 offen offset:0 lds
 v_mfma_f32_16x16x32_bf16 v[204:207], a[220:223], v[244:247], v[204:207]
 ds_read_b64_tr_b16 a[204:205], v18 offset:36872
 ds_read_b64_tr_b16 a[206:207], v18 offset:38408
 v_mfma_f32_16x16x32_bf16 v[212:215], a[216:219], v[232:235], v[212:215]
 buffer_load_dwordx4 v8, s[24:27], s76 offen offset:1024 lds
 v_mfma_f32_16x16x32_bf16 v[212:215], a[220:223], v[248:251], v[212:215]
 buffer_load_dwordx4 v9, s[24:27], s76 offen offset:2048 lds
 v_mfma_f32_16x16x32_bf16 v[220:223], a[216:219], v[236:239], v[220:223]
 v_mfma_f32_16x16x32_bf16 v[220:223], a[220:223], v[252:255], v[220:223]
 s_waitcnt lgkmcnt(4)
 v_mfma_f32_16x16x32_bf16 v[32:35], a[192:195], a[224:227], v[32:35]
 s_waitcnt vmcnt(23)
 ds_read_b64_tr_b16 a[208:209], v19 offset:24576
 v_mfma_f32_16x16x32_bf16 v[32:35], a[196:199], a[240:243], v[32:35]
 ds_read_b64_tr_b16 a[210:211], v19 offset:26112
 s_mul_i32 s89, s3, 192
 v_mfma_f32_16x16x32_bf16 v[40:43], a[192:195], a[228:231], v[40:43]
 ds_read_b64_tr_b16 a[212:213], v19 offset:36864
 ds_read_b128 v[224:227], v20 offset:0
 v_mfma_f32_16x16x32_bf16 v[40:43], a[196:199], a[244:247], v[40:43]
 ds_read_b64_tr_b16 a[214:215], v19 offset:38400
 s_mov_b32 s74, 24576
 v_mfma_f32_16x16x32_bf16 v[48:51], a[192:195], a[232:235], v[48:51]
 s_add_u32 s86, s89, 0
 v_add_u32 v10, s86, v0
 v_mfma_f32_16x16x32_bf16 v[48:51], a[196:199], a[248:251], v[48:51]
 v_lshrrev_b32 v11, 3, v10
 v_mul_u32_u24 v22, 1280, v11
 v_mfma_f32_16x16x32_bf16 v[56:59], a[192:195], a[236:239], v[56:59]
 ds_read_b128 v[228:231], v20 offset:2048
 v_and_b32 v11, 6, v11
 v_mfma_f32_16x16x32_bf16 v[56:59], a[196:199], a[252:255], v[56:59]
 v_and_b32 v23, 7, v10
 s_waitcnt lgkmcnt(6)
 v_mfma_f32_16x16x32_bf16 v[36:39], a[200:203], a[224:227], v[36:39]
 ds_read_b64_tr_b16 a[216:217], v19 offset:24584
 v_xor_b32 v11, v11, v23
 v_mfma_f32_16x16x32_bf16 v[36:39], a[204:207], a[240:243], v[36:39]
 ds_read_b64_tr_b16 a[218:219], v19 offset:26120
 v_lshl_add_u32 v22, v11, 4, v22
 v_mfma_f32_16x16x32_bf16 v[44:47], a[200:203], a[228:231], v[44:47]
 ds_read_b64_tr_b16 a[220:221], v19 offset:36872
 v_subrev_u32 v7, 0, v22
 v_mfma_f32_16x16x32_bf16 v[44:47], a[204:207], a[244:247], v[44:47]
 ds_read_b64_tr_b16 a[222:223], v19 offset:38408
 ds_read_b128 v[232:235], v20 offset:4096
 v_mfma_f32_16x16x32_bf16 v[52:55], a[200:203], a[232:235], v[52:55]
 v_lshrrev_b32 v11, 2, v10
 v_mul_u32_u24 v22, 1280, v11
 v_mfma_f32_16x16x32_bf16 v[52:55], a[204:207], a[248:251], v[52:55]
 v_bfe_u32 v11, v11, 2, 1
 v_lshlrev_b32 v11, 1, v11
 v_mfma_f32_16x16x32_bf16 v[60:63], a[200:203], a[236:239], v[60:63]
 v_and_b32 v23, 3, v10
 v_xor_b32 v11, v11, v23
 v_mfma_f32_16x16x32_bf16 v[60:63], a[204:207], a[252:255], v[60:63]
 ds_read_b128 v[236:239], v20 offset:6144
 s_waitcnt lgkmcnt(7)
 v_mfma_f32_16x16x32_bf16 v[64:67], a[208:211], a[224:227], v[64:67]
 ds_read_b64_tr_b16 a[192:193], v18 offset:24704
 v_lshl_add_u32 v22, v11, 4, v22
 v_mfma_f32_16x16x32_bf16 v[64:67], a[212:215], a[240:243], v[64:67]
 ds_read_b64_tr_b16 a[194:195], v18 offset:26240
 v_subrev_u32 v24, 0, v22
 v_mfma_f32_16x16x32_bf16 v[72:75], a[208:211], a[228:231], v[72:75]
 ds_read_b64_tr_b16 a[196:197], v18 offset:36992
 s_add_u32 s86, s89, 64
 v_mfma_f32_16x16x32_bf16 v[72:75], a[212:215], a[244:247], v[72:75]
 ds_read_b64_tr_b16 a[198:199], v18 offset:38528
 v_add_u32 v10, s86, v0
 v_mfma_f32_16x16x32_bf16 v[80:83], a[208:211], a[232:235], v[80:83]
 ds_read_b128 v[240:243], v21 offset:0
 v_lshrrev_b32 v11, 3, v10
 v_mfma_f32_16x16x32_bf16 v[80:83], a[212:215], a[248:251], v[80:83]
 buffer_load_dwordx4 a[72:75], v4, s[32:35], s74 offen offset:0 nt
 v_mfma_f32_16x16x32_bf16 v[88:91], a[208:211], a[236:239], v[88:91]
 v_mul_u32_u24 v22, 1280, v11
 v_and_b32 v11, 6, v11
 v_mfma_f32_16x16x32_bf16 v[88:91], a[212:215], a[252:255], v[88:91]
 v_and_b32 v23, 7, v10
 s_waitcnt lgkmcnt(7)
 v_mfma_f32_16x16x32_bf16 v[68:71], a[216:219], a[224:227], v[68:71]
 ds_read_b64_tr_b16 a[200:201], v18 offset:24712
 v_xor_b32 v11, v11, v23
 v_mfma_f32_16x16x32_bf16 v[68:71], a[220:223], a[240:243], v[68:71]
 ds_read_b64_tr_b16 a[202:203], v18 offset:26248
 ds_read_b128 v[244:247], v21 offset:2048
 v_mfma_f32_16x16x32_bf16 v[76:79], a[216:219], a[228:231], v[76:79]
 ds_read_b64_tr_b16 a[204:205], v18 offset:37000
 v_lshl_add_u32 v22, v11, 4, v22
 v_mfma_f32_16x16x32_bf16 v[76:79], a[220:223], a[244:247], v[76:79]
 ds_read_b64_tr_b16 a[206:207], v18 offset:38536
 v_subrev_u32 v8, 1024, v22
 v_mfma_f32_16x16x32_bf16 v[84:87], a[216:219], a[232:235], v[84:87]
 v_lshrrev_b32 v11, 2, v10
 v_mul_u32_u24 v22, 1280, v11
 v_mfma_f32_16x16x32_bf16 v[84:87], a[220:223], a[248:251], v[84:87]
 ds_read_b128 v[248:251], v21 offset:4096
 v_bfe_u32 v11, v11, 2, 1
 v_mfma_f32_16x16x32_bf16 v[92:95], a[216:219], a[236:239], v[92:95]
 v_lshlrev_b32 v11, 1, v11
 v_and_b32 v23, 3, v10
 v_mfma_f32_16x16x32_bf16 v[92:95], a[220:223], a[252:255], v[92:95]
 v_xor_b32 v11, v11, v23
 s_waitcnt lgkmcnt(7)
 v_mfma_f32_16x16x32_bf16 v[96:99], a[192:195], a[224:227], v[96:99]
 ds_read_b64_tr_b16 a[208:209], v19 offset:24704
 v_lshl_add_u32 v22, v11, 4, v22
 v_mfma_f32_16x16x32_bf16 v[96:99], a[196:199], a[240:243], v[96:99]
 ds_read_b64_tr_b16 a[210:211], v19 offset:26240
 v_subrev_u32 v25, 1024, v22
 v_mfma_f32_16x16x32_bf16 v[104:107], a[192:195], a[228:231], v[104:107]
 ds_read_b64_tr_b16 a[212:213], v19 offset:36992
 ds_read_b128 v[252:255], v21 offset:6144
 v_mfma_f32_16x16x32_bf16 v[104:107], a[196:199], a[244:247], v[104:107]
 ds_read_b64_tr_b16 a[214:215], v19 offset:38528
 s_add_u32 s86, s89, 128
 v_mfma_f32_16x16x32_bf16 v[112:115], a[192:195], a[232:235], v[112:115]
 buffer_load_dwordx4 a[76:79], v5, s[32:35], s74 offen offset:1024 nt
 v_mfma_f32_16x16x32_bf16 v[112:115], a[196:199], a[248:251], v[112:115]
 v_add_u32 v10, s86, v0
 v_lshrrev_b32 v11, 3, v10
 v_mfma_f32_16x16x32_bf16 v[120:123], a[192:195], a[236:239], v[120:123]
 v_mul_u32_u24 v22, 1280, v11
 v_and_b32 v11, 6, v11
 v_mfma_f32_16x16x32_bf16 v[120:123], a[196:199], a[252:255], v[120:123]
 v_and_b32 v23, 7, v10
 s_waitcnt lgkmcnt(6)
 v_mfma_f32_16x16x32_bf16 v[100:103], a[200:203], a[224:227], v[100:103]
 ds_read_b64_tr_b16 a[216:217], v19 offset:24712
 v_xor_b32 v11, v11, v23
 v_mfma_f32_16x16x32_bf16 v[100:103], a[204:207], a[240:243], v[100:103]
 ds_read_b64_tr_b16 a[218:219], v19 offset:26248
 v_lshl_add_u32 v22, v11, 4, v22
 v_mfma_f32_16x16x32_bf16 v[108:111], a[200:203], a[228:231], v[108:111]
 ds_read_b64_tr_b16 a[220:221], v19 offset:37000
 v_subrev_u32 v9, 2048, v22
 v_mfma_f32_16x16x32_bf16 v[108:111], a[204:207], a[244:247], v[108:111]
 ds_read_b64_tr_b16 a[222:223], v19 offset:38536
 v_lshrrev_b32 v11, 2, v10
 v_mfma_f32_16x16x32_bf16 v[116:119], a[200:203], a[232:235], v[116:119]
 v_mul_u32_u24 v22, 1280, v11
 v_bfe_u32 v11, v11, 2, 1
 v_mfma_f32_16x16x32_bf16 v[116:119], a[204:207], a[248:251], v[116:119]
 v_lshlrev_b32 v11, 1, v11
 v_and_b32 v23, 3, v10
 v_mfma_f32_16x16x32_bf16 v[124:127], a[200:203], a[236:239], v[124:127]
 v_xor_b32 v11, v11, v23
 v_lshl_add_u32 v22, v11, 4, v22
 v_mfma_f32_16x16x32_bf16 v[124:127], a[204:207], a[252:255], v[124:127]
 v_subrev_u32 v26, 2048, v22
 s_waitcnt lgkmcnt(4)
 v_mfma_f32_16x16x32_bf16 v[128:131], a[208:211], a[224:227], v[128:131]
 ds_read_b64_tr_b16 a[192:193], v18 offset:24832
 v_lshlrev_b32 v29, 4, v0
 v_mfma_f32_16x16x32_bf16 v[128:131], a[212:215], a[240:243], v[128:131]
 ds_read_b64_tr_b16 a[194:195], v18 offset:26368
 v_add_u32 v29, s80, v29
 v_mfma_f32_16x16x32_bf16 v[136:139], a[208:211], a[228:231], v[136:139]
 ds_read_b64_tr_b16 a[196:197], v18 offset:37120
 v_add_u32 v23, 61440, v29
 v_mfma_f32_16x16x32_bf16 v[136:139], a[212:215], a[244:247], v[136:139]
 ds_read_b64_tr_b16 a[198:199], v18 offset:38656
 v_mfma_f32_16x16x32_bf16 v[144:147], a[208:211], a[232:235], v[144:147]
 buffer_load_dwordx4 a[80:83], v6, s[32:35], s74 offen offset:2048 nt
 v_mfma_f32_16x16x32_bf16 v[144:147], a[212:215], a[248:251], v[144:147]
 v_mfma_f32_16x16x32_bf16 v[152:155], a[208:211], a[236:239], v[152:155]
 v_mfma_f32_16x16x32_bf16 v[152:155], a[212:215], a[252:255], v[152:155]
 s_waitcnt lgkmcnt(4)
 v_mfma_f32_16x16x32_bf16 v[132:135], a[216:219], a[224:227], v[132:135]
 ds_read_b64_tr_b16 a[200:201], v18 offset:24840
 v_mfma_f32_16x16x32_bf16 v[132:135], a[220:223], a[240:243], v[132:135]
 ds_read_b64_tr_b16 a[202:203], v18 offset:26376
 v_mfma_f32_16x16x32_bf16 v[140:143], a[216:219], a[228:231], v[140:143]
 ds_read_b64_tr_b16 a[204:205], v18 offset:37128
 v_mfma_f32_16x16x32_bf16 v[140:143], a[220:223], a[244:247], v[140:143]
 ds_read_b64_tr_b16 a[206:207], v18 offset:38664
 v_mfma_f32_16x16x32_bf16 v[148:151], a[216:219], a[232:235], v[148:151]
 v_mfma_f32_16x16x32_bf16 v[148:151], a[220:223], a[248:251], v[148:151]
 v_mfma_f32_16x16x32_bf16 v[156:159], a[216:219], a[236:239], v[156:159]
 v_mfma_f32_16x16x32_bf16 v[156:159], a[220:223], a[252:255], v[156:159]
 s_waitcnt lgkmcnt(4)
 v_mfma_f32_16x16x32_bf16 v[160:163], a[192:195], a[224:227], v[160:163]
 ds_read_b64_tr_b16 a[208:209], v19 offset:24832
 s_mov_b32 s74, 49152
 v_mfma_f32_16x16x32_bf16 v[160:163], a[196:199], a[240:243], v[160:163]
 ds_read_b64_tr_b16 a[210:211], v19 offset:26368
 v_mfma_f32_16x16x32_bf16 v[168:171], a[192:195], a[228:231], v[168:171]
 ds_read_b64_tr_b16 a[212:213], v19 offset:37120
 v_mfma_f32_16x16x32_bf16 v[168:171], a[196:199], a[244:247], v[168:171]
 ds_read_b64_tr_b16 a[214:215], v19 offset:38656
 v_mfma_f32_16x16x32_bf16 v[176:179], a[192:195], a[232:235], v[176:179]
 v_mfma_f32_16x16x32_bf16 v[176:179], a[196:199], a[248:251], v[176:179]
 v_mfma_f32_16x16x32_bf16 v[184:187], a[192:195], a[236:239], v[184:187]
 v_mfma_f32_16x16x32_bf16 v[184:187], a[196:199], a[252:255], v[184:187]
 s_waitcnt lgkmcnt(4)
 v_mfma_f32_16x16x32_bf16 v[164:167], a[200:203], a[224:227], v[164:167]
 ds_read_b64_tr_b16 a[216:217], v19 offset:24840
 v_mfma_f32_16x16x32_bf16 v[164:167], a[204:207], a[240:243], v[164:167]
 ds_read_b64_tr_b16 a[218:219], v19 offset:26376
 v_mfma_f32_16x16x32_bf16 v[172:175], a[200:203], a[228:231], v[172:175]
 ds_read_b64_tr_b16 a[220:221], v19 offset:37128
 v_mfma_f32_16x16x32_bf16 v[172:175], a[204:207], a[244:247], v[172:175]
 ds_read_b64_tr_b16 a[222:223], v19 offset:38664
 v_mfma_f32_16x16x32_bf16 v[180:183], a[200:203], a[232:235], v[180:183]
 v_mfma_f32_16x16x32_bf16 v[180:183], a[204:207], a[248:251], v[180:183]
 v_subrev_u32 v18, 49152, v18
 v_subrev_u32 v19, 49152, v19
 v_mfma_f32_16x16x32_bf16 v[188:191], a[200:203], a[236:239], v[188:191]
 s_waitcnt vmcnt(20)
 s_barrier
 v_mfma_f32_16x16x32_bf16 v[188:191], a[204:207], a[252:255], v[188:191]
 s_waitcnt lgkmcnt(4)
 v_mfma_f32_16x16x32_bf16 v[192:195], a[208:211], a[224:227], v[192:195]
 ds_read_b64_tr_b16 a[192:193], v18 offset:0
 v_mfma_f32_16x16x32_bf16 v[192:195], a[212:215], a[240:243], v[192:195]
 ds_read_b64_tr_b16 a[194:195], v18 offset:1536
 v_mfma_f32_16x16x32_bf16 v[200:203], a[208:211], a[228:231], v[200:203]
 ds_read_b64_tr_b16 a[196:197], v18 offset:12288
 v_mfma_f32_16x16x32_bf16 v[200:203], a[212:215], a[244:247], v[200:203]
 ds_read_b64_tr_b16 a[198:199], v18 offset:13824
 v_mfma_f32_16x16x32_bf16 v[208:211], a[208:211], a[232:235], v[208:211]
 buffer_load_dwordx4 a[84:87], v1, s[28:31], s74 offen offset:0 nt
 v_mfma_f32_16x16x32_bf16 v[208:211], a[212:215], a[248:251], v[208:211]
 v_mfma_f32_16x16x32_bf16 v[216:219], a[208:211], a[236:239], v[216:219]
 v_mfma_f32_16x16x32_bf16 v[216:219], a[212:215], a[252:255], v[216:219]
 s_waitcnt lgkmcnt(4)
 v_mfma_f32_16x16x32_bf16 v[196:199], a[216:219], a[224:227], v[196:199]
 ds_read_b64_tr_b16 a[200:201], v18 offset:8
 v_mfma_f32_16x16x32_bf16 v[196:199], a[220:223], a[240:243], v[196:199]
 ds_read_b64_tr_b16 a[202:203], v18 offset:1544
 v_mfma_f32_16x16x32_bf16 v[204:207], a[216:219], a[228:231], v[204:207]
 ds_read_b64_tr_b16 a[204:205], v18 offset:12296
 v_mfma_f32_16x16x32_bf16 v[204:207], a[220:223], a[244:247], v[204:207]
 ds_read_b64_tr_b16 a[206:207], v18 offset:13832
 v_mfma_f32_16x16x32_bf16 v[212:215], a[216:219], a[232:235], v[212:215]
 v_mfma_f32_16x16x32_bf16 v[212:215], a[220:223], a[248:251], v[212:215]
 v_mfma_f32_16x16x32_bf16 v[220:223], a[216:219], a[236:239], v[220:223]
 v_mfma_f32_16x16x32_bf16 v[220:223], a[220:223], a[252:255], v[220:223]
 s_waitcnt lgkmcnt(4)
 v_mfma_f32_16x16x32_bf16 v[32:35], a[192:195], v[224:227], v[32:35]
 s_waitcnt vmcnt(10)
 ds_read_b64_tr_b16 a[208:209], v19 offset:0
 v_mfma_f32_16x16x32_bf16 v[32:35], a[196:199], v[240:243], v[32:35]
 ds_read_b64_tr_b16 a[210:211], v19 offset:1536
 v_mfma_f32_16x16x32_bf16 v[40:43], a[192:195], v[228:231], v[40:43]
 ds_read_b64_tr_b16 a[212:213], v19 offset:12288
 ds_read_b128 a[224:227], v20 offset:8192
 v_mfma_f32_16x16x32_bf16 v[40:43], a[196:199], v[244:247], v[40:43]
 ds_read_b64_tr_b16 a[214:215], v19 offset:13824
 v_mfma_f32_16x16x32_bf16 v[48:51], a[192:195], v[232:235], v[48:51]
 buffer_load_dwordx4 a[88:91], v2, s[28:31], s74 offen offset:1024 nt
 v_mfma_f32_16x16x32_bf16 v[48:51], a[196:199], v[248:251], v[48:51]
 v_mfma_f32_16x16x32_bf16 v[56:59], a[192:195], v[236:239], v[56:59]
 ds_read_b128 a[228:231], v20 offset:10240
 v_mfma_f32_16x16x32_bf16 v[56:59], a[196:199], v[252:255], v[56:59]
 s_waitcnt lgkmcnt(6)
 v_mfma_f32_16x16x32_bf16 v[36:39], a[200:203], v[224:227], v[36:39]
 ds_read_b64_tr_b16 a[216:217], v19 offset:8
 v_mfma_f32_16x16x32_bf16 v[36:39], a[204:207], v[240:243], v[36:39]
 ds_read_b64_tr_b16 a[218:219], v19 offset:1544
 v_mfma_f32_16x16x32_bf16 v[44:47], a[200:203], v[228:231], v[44:47]
 ds_read_b64_tr_b16 a[220:221], v19 offset:12296
 ds_write_b128 v29, a[0:3] offset:49152
 v_mfma_f32_16x16x32_bf16 v[44:47], a[204:207], v[244:247], v[44:47]
 ds_read_b64_tr_b16 a[222:223], v19 offset:13832
 ds_read_b128 a[232:235], v20 offset:12288
 v_mfma_f32_16x16x32_bf16 v[52:55], a[200:203], v[232:235], v[52:55]
 v_mfma_f32_16x16x32_bf16 v[52:55], a[204:207], v[248:251], v[52:55]
 v_mfma_f32_16x16x32_bf16 v[60:63], a[200:203], v[236:239], v[60:63]
 v_mfma_f32_16x16x32_bf16 v[60:63], a[204:207], v[252:255], v[60:63]
 ds_read_b128 a[236:239], v20 offset:14336
 s_waitcnt lgkmcnt(8)
 v_mfma_f32_16x16x32_bf16 v[64:67], a[208:211], v[224:227], v[64:67]
 ds_read_b64_tr_b16 a[192:193], v18 offset:128
 v_mfma_f32_16x16x32_bf16 v[64:67], a[212:215], v[240:243], v[64:67]
 ds_read_b64_tr_b16 a[194:195], v18 offset:1664
 v_mfma_f32_16x16x32_bf16 v[72:75], a[208:211], v[228:231], v[72:75]
 ds_read_b64_tr_b16 a[196:197], v18 offset:12416
 v_mfma_f32_16x16x32_bf16 v[72:75], a[212:215], v[244:247], v[72:75]
 ds_read_b64_tr_b16 a[198:199], v18 offset:13952
 ds_write_b128 v29, a[4:7] offset:50176
 v_mfma_f32_16x16x32_bf16 v[80:83], a[208:211], v[232:235], v[80:83]
 ds_read_b128 a[240:243], v21 offset:8192
 v_mfma_f32_16x16x32_bf16 v[80:83], a[212:215], v[248:251], v[80:83]
 buffer_load_dwordx4 a[92:95], v3, s[28:31], s74 offen offset:2048 nt
 v_mfma_f32_16x16x32_bf16 v[88:91], a[208:211], v[236:239], v[88:91]
 v_mfma_f32_16x16x32_bf16 v[88:91], a[212:215], v[252:255], v[88:91]
 s_waitcnt lgkmcnt(8)
 v_mfma_f32_16x16x32_bf16 v[68:71], a[216:219], v[224:227], v[68:71]
 ds_read_b64_tr_b16 a[200:201], v18 offset:136
 v_mfma_f32_16x16x32_bf16 v[68:71], a[220:223], v[240:243], v[68:71]
 ds_read_b64_tr_b16 a[202:203], v18 offset:1672
 ds_read_b128 a[244:247], v21 offset:10240
 v_mfma_f32_16x16x32_bf16 v[76:79], a[216:219], v[228:231], v[76:79]
 ds_read_b64_tr_b16 a[204:205], v18 offset:12424
 v_mfma_f32_16x16x32_bf16 v[76:79], a[220:223], v[244:247], v[76:79]
 ds_read_b64_tr_b16 a[206:207], v18 offset:13960
 ds_write_b128 v29, a[8:11] offset:51200
 v_mfma_f32_16x16x32_bf16 v[84:87], a[216:219], v[232:235], v[84:87]
 v_mfma_f32_16x16x32_bf16 v[84:87], a[220:223], v[248:251], v[84:87]
 ds_read_b128 a[248:251], v21 offset:12288
 v_mfma_f32_16x16x32_bf16 v[92:95], a[216:219], v[236:239], v[92:95]
 v_mfma_f32_16x16x32_bf16 v[92:95], a[220:223], v[252:255], v[92:95]
 s_waitcnt lgkmcnt(9)
 v_mfma_f32_16x16x32_bf16 v[96:99], a[192:195], v[224:227], v[96:99]
 ds_read_b64_tr_b16 a[208:209], v19 offset:128
 v_mfma_f32_16x16x32_bf16 v[96:99], a[196:199], v[240:243], v[96:99]
 ds_read_b64_tr_b16 a[210:211], v19 offset:1664
 s_mov_b32 s74, 61440
 v_mfma_f32_16x16x32_bf16 v[104:107], a[192:195], v[228:231], v[104:107]
 ds_read_b64_tr_b16 a[212:213], v19 offset:12416
 ds_read_b128 a[252:255], v21 offset:14336
 v_mfma_f32_16x16x32_bf16 v[104:107], a[196:199], v[244:247], v[104:107]
 ds_read_b64_tr_b16 a[214:215], v19 offset:13952
 v_mfma_f32_16x16x32_bf16 v[112:115], a[192:195], v[232:235], v[112:115]
 v_mfma_f32_16x16x32_bf16 v[112:115], a[196:199], v[248:251], v[112:115]
 v_mfma_f32_16x16x32_bf16 v[120:123], a[192:195], v[236:239], v[120:123]
 v_mfma_f32_16x16x32_bf16 v[120:123], a[196:199], v[252:255], v[120:123]
 s_waitcnt lgkmcnt(7)
 v_mfma_f32_16x16x32_bf16 v[100:103], a[200:203], v[224:227], v[100:103]
 ds_read_b64_tr_b16 a[216:217], v19 offset:136
 v_mfma_f32_16x16x32_bf16 v[100:103], a[204:207], v[240:243], v[100:103]
 ds_read_b64_tr_b16 a[218:219], v19 offset:1672
 v_mfma_f32_16x16x32_bf16 v[108:111], a[200:203], v[228:231], v[108:111]
 ds_read_b64_tr_b16 a[220:221], v19 offset:12424
 v_mfma_f32_16x16x32_bf16 v[108:111], a[204:207], v[244:247], v[108:111]
 ds_read_b64_tr_b16 a[222:223], v19 offset:13960
 v_mfma_f32_16x16x32_bf16 v[116:119], a[200:203], v[232:235], v[116:119]
 v_mfma_f32_16x16x32_bf16 v[116:119], a[204:207], v[248:251], v[116:119]
 ds_write_b128 v23, a[12:15] offset:0
 v_mfma_f32_16x16x32_bf16 v[124:127], a[200:203], v[236:239], v[124:127]
 v_mfma_f32_16x16x32_bf16 v[124:127], a[204:207], v[252:255], v[124:127]
 s_waitcnt lgkmcnt(5)
 v_mfma_f32_16x16x32_bf16 v[128:131], a[208:211], v[224:227], v[128:131]
 ds_read_b64_tr_b16 a[192:193], v18 offset:256
 v_mfma_f32_16x16x32_bf16 v[128:131], a[212:215], v[240:243], v[128:131]
 ds_read_b64_tr_b16 a[194:195], v18 offset:1792
 v_mfma_f32_16x16x32_bf16 v[136:139], a[208:211], v[228:231], v[136:139]
 ds_read_b64_tr_b16 a[196:197], v18 offset:12544
 v_mfma_f32_16x16x32_bf16 v[136:139], a[212:215], v[244:247], v[136:139]
 ds_read_b64_tr_b16 a[198:199], v18 offset:14080
 v_mfma_f32_16x16x32_bf16 v[144:147], a[208:211], v[232:235], v[144:147]
 buffer_load_dwordx4 a[96:99], v1, s[28:31], s74 offen offset:0 nt
 v_mfma_f32_16x16x32_bf16 v[144:147], a[212:215], v[248:251], v[144:147]
 ds_write_b128 v23, a[16:19] offset:1024
 v_mfma_f32_16x16x32_bf16 v[152:155], a[208:211], v[236:239], v[152:155]
 v_mfma_f32_16x16x32_bf16 v[152:155], a[212:215], v[252:255], v[152:155]
 s_waitcnt lgkmcnt(6)
 v_mfma_f32_16x16x32_bf16 v[132:135], a[216:219], v[224:227], v[132:135]
 ds_read_b64_tr_b16 a[200:201], v18 offset:264
 v_mfma_f32_16x16x32_bf16 v[132:135], a[220:223], v[240:243], v[132:135]
 ds_read_b64_tr_b16 a[202:203], v18 offset:1800
 v_mfma_f32_16x16x32_bf16 v[140:143], a[216:219], v[228:231], v[140:143]
 ds_read_b64_tr_b16 a[204:205], v18 offset:12552
 v_mfma_f32_16x16x32_bf16 v[140:143], a[220:223], v[244:247], v[140:143]
 ds_read_b64_tr_b16 a[206:207], v18 offset:14088
 v_mfma_f32_16x16x32_bf16 v[148:151], a[216:219], v[232:235], v[148:151]
 v_mfma_f32_16x16x32_bf16 v[148:151], a[220:223], v[248:251], v[148:151]
 v_mfma_f32_16x16x32_bf16 v[156:159], a[216:219], v[236:239], v[156:159]
 ds_write_b128 v23, a[20:23] offset:2048
 v_mfma_f32_16x16x32_bf16 v[156:159], a[220:223], v[252:255], v[156:159]
 s_waitcnt lgkmcnt(6)
 v_mfma_f32_16x16x32_bf16 v[160:163], a[192:195], v[224:227], v[160:163]
 ds_read_b64_tr_b16 a[208:209], v19 offset:256
 v_mfma_f32_16x16x32_bf16 v[160:163], a[196:199], v[240:243], v[160:163]
 ds_read_b64_tr_b16 a[210:211], v19 offset:1792
 v_mfma_f32_16x16x32_bf16 v[168:171], a[192:195], v[228:231], v[168:171]
 ds_read_b64_tr_b16 a[212:213], v19 offset:12544
 v_mfma_f32_16x16x32_bf16 v[168:171], a[196:199], v[244:247], v[168:171]
 ds_read_b64_tr_b16 a[214:215], v19 offset:14080
 v_mfma_f32_16x16x32_bf16 v[176:179], a[192:195], v[232:235], v[176:179]
 buffer_load_dwordx4 a[100:103], v2, s[28:31], s74 offen offset:1024 nt
 v_mfma_f32_16x16x32_bf16 v[176:179], a[196:199], v[248:251], v[176:179]
 v_mfma_f32_16x16x32_bf16 v[184:187], a[192:195], v[236:239], v[184:187]
 v_mfma_f32_16x16x32_bf16 v[184:187], a[196:199], v[252:255], v[184:187]
 s_waitcnt lgkmcnt(5)
 v_mfma_f32_16x16x32_bf16 v[164:167], a[200:203], v[224:227], v[164:167]
 ds_read_b64_tr_b16 a[216:217], v19 offset:264
 v_mfma_f32_16x16x32_bf16 v[164:167], a[204:207], v[240:243], v[164:167]
 ds_read_b64_tr_b16 a[218:219], v19 offset:1800
 v_mfma_f32_16x16x32_bf16 v[172:175], a[200:203], v[228:231], v[172:175]
 ds_read_b64_tr_b16 a[220:221], v19 offset:12552
 v_mfma_f32_16x16x32_bf16 v[172:175], a[204:207], v[244:247], v[172:175]
 ds_read_b64_tr_b16 a[222:223], v19 offset:14088
 v_mfma_f32_16x16x32_bf16 v[180:183], a[200:203], v[232:235], v[180:183]
 v_mfma_f32_16x16x32_bf16 v[180:183], a[204:207], v[248:251], v[180:183]
 v_mfma_f32_16x16x32_bf16 v[188:191], a[200:203], v[236:239], v[188:191]
 s_waitcnt vmcnt(8)
 s_barrier
 v_mfma_f32_16x16x32_bf16 v[188:191], a[204:207], v[252:255], v[188:191]
 s_waitcnt lgkmcnt(4)
 v_mfma_f32_16x16x32_bf16 v[192:195], a[208:211], v[224:227], v[192:195]
 ds_read_b64_tr_b16 a[192:193], v18 offset:24576
 v_mfma_f32_16x16x32_bf16 v[192:195], a[212:215], v[240:243], v[192:195]
 ds_read_b64_tr_b16 a[194:195], v18 offset:26112
 ds_write_b128 v23, a[24:27] offset:12288
 v_mfma_f32_16x16x32_bf16 v[200:203], a[208:211], v[228:231], v[200:203]
 ds_read_b64_tr_b16 a[196:197], v18 offset:36864
 v_mfma_f32_16x16x32_bf16 v[200:203], a[212:215], v[244:247], v[200:203]
 ds_read_b64_tr_b16 a[198:199], v18 offset:38400
 v_mfma_f32_16x16x32_bf16 v[208:211], a[208:211], v[232:235], v[208:211]
 buffer_load_dwordx4 a[104:107], v3, s[28:31], s74 offen offset:2048 nt
 v_mfma_f32_16x16x32_bf16 v[208:211], a[212:215], v[248:251], v[208:211]
 v_mfma_f32_16x16x32_bf16 v[216:219], a[208:211], v[236:239], v[216:219]
 ds_write_b128 v23, a[28:31] offset:13312
 v_mfma_f32_16x16x32_bf16 v[216:219], a[212:215], v[252:255], v[216:219]
 s_waitcnt lgkmcnt(6)
 v_mfma_f32_16x16x32_bf16 v[196:199], a[216:219], v[224:227], v[196:199]
 ds_read_b64_tr_b16 a[200:201], v18 offset:24584
 v_mfma_f32_16x16x32_bf16 v[196:199], a[220:223], v[240:243], v[196:199]
 ds_read_b64_tr_b16 a[202:203], v18 offset:26120
 v_mfma_f32_16x16x32_bf16 v[204:207], a[216:219], v[228:231], v[204:207]
 ds_read_b64_tr_b16 a[204:205], v18 offset:36872
 v_mfma_f32_16x16x32_bf16 v[204:207], a[220:223], v[244:247], v[204:207]
 ds_read_b64_tr_b16 a[206:207], v18 offset:38408
 ds_write_b128 v23, a[32:35] offset:14336
 v_mfma_f32_16x16x32_bf16 v[212:215], a[216:219], v[232:235], v[212:215]
 v_mfma_f32_16x16x32_bf16 v[212:215], a[220:223], v[248:251], v[212:215]
 v_mfma_f32_16x16x32_bf16 v[220:223], a[216:219], v[236:239], v[220:223]
 v_mfma_f32_16x16x32_bf16 v[220:223], a[220:223], v[252:255], v[220:223]
 s_waitcnt lgkmcnt(6)
 v_mfma_f32_16x16x32_bf16 v[32:35], a[192:195], a[224:227], v[32:35]
 ds_read_b64_tr_b16 a[208:209], v19 offset:24576
 v_mfma_f32_16x16x32_bf16 v[32:35], a[196:199], a[240:243], v[32:35]
 ds_read_b64_tr_b16 a[210:211], v19 offset:26112
 v_mfma_f32_16x16x32_bf16 v[40:43], a[192:195], a[228:231], v[40:43]
 ds_read_b64_tr_b16 a[212:213], v19 offset:36864
 v_mfma_f32_16x16x32_bf16 v[40:43], a[196:199], a[244:247], v[40:43]
 ds_read_b64_tr_b16 a[214:215], v19 offset:38400
 v_mfma_f32_16x16x32_bf16 v[48:51], a[192:195], a[232:235], v[48:51]
 ds_write_b128 v23, a[48:51] offset:24576
 v_mfma_f32_16x16x32_bf16 v[48:51], a[196:199], a[248:251], v[48:51]
 s_add_u32 m0, s80, 110592
 s_mov_b32 s76, 36864
 v_mfma_f32_16x16x32_bf16 v[56:59], a[192:195], a[236:239], v[56:59]
 v_mfma_f32_16x16x32_bf16 v[56:59], a[196:199], a[252:255], v[56:59]
 s_waitcnt lgkmcnt(6)
 v_mfma_f32_16x16x32_bf16 v[36:39], a[200:203], a[224:227], v[36:39]
 ds_read_b64_tr_b16 a[216:217], v19 offset:24584
 v_mfma_f32_16x16x32_bf16 v[36:39], a[204:207], a[240:243], v[36:39]
 ds_read_b64_tr_b16 a[218:219], v19 offset:26120
 ds_write_b128 v23, a[52:55] offset:25600
 v_mfma_f32_16x16x32_bf16 v[44:47], a[200:203], a[228:231], v[44:47]
 ds_read_b64_tr_b16 a[220:221], v19 offset:36872
 v_mfma_f32_16x16x32_bf16 v[44:47], a[204:207], a[244:247], v[44:47]
 ds_read_b64_tr_b16 a[222:223], v19 offset:38408
 v_mfma_f32_16x16x32_bf16 v[52:55], a[200:203], a[232:235], v[52:55]
 v_mfma_f32_16x16x32_bf16 v[52:55], a[204:207], a[248:251], v[52:55]
 v_mfma_f32_16x16x32_bf16 v[60:63], a[200:203], a[236:239], v[60:63]
 ds_write_b128 v23, a[56:59] offset:26624
 v_mfma_f32_16x16x32_bf16 v[60:63], a[204:207], a[252:255], v[60:63]
 s_waitcnt lgkmcnt(7)
 v_mfma_f32_16x16x32_bf16 v[64:67], a[208:211], a[224:227], v[64:67]
 ds_read_b64_tr_b16 a[192:193], v18 offset:24704
 v_mfma_f32_16x16x32_bf16 v[64:67], a[212:215], a[240:243], v[64:67]
 ds_read_b64_tr_b16 a[194:195], v18 offset:26240
 v_mfma_f32_16x16x32_bf16 v[72:75], a[208:211], a[228:231], v[72:75]
 ds_read_b64_tr_b16 a[196:197], v18 offset:36992
 v_mfma_f32_16x16x32_bf16 v[72:75], a[212:215], a[244:247], v[72:75]
 ds_read_b64_tr_b16 a[198:199], v18 offset:38528
 s_waitcnt vmcnt(6)
 v_mfma_f32_16x16x32_bf16 v[80:83], a[208:211], a[232:235], v[80:83]
 buffer_load_dwordx4 v4, s[32:35], s76 offen offset:0 nt lds
 v_mfma_f32_16x16x32_bf16 v[80:83], a[212:215], a[248:251], v[80:83]
 v_mul_f32 v32, s70, v32
 v_mul_f32 v33, s70, v33
 v_mfma_f32_16x16x32_bf16 v[88:91], a[208:211], a[236:239], v[88:91]
 v_mul_f32 v34, s70, v34
 v_mul_f32 v35, s70, v35
 v_mfma_f32_16x16x32_bf16 v[88:91], a[212:215], a[252:255], v[88:91]
 v_mul_f32 v36, s70, v36
 s_waitcnt lgkmcnt(5)
 v_mfma_f32_16x16x32_bf16 v[68:71], a[216:219], a[224:227], v[68:71]
 ds_read_b64_tr_b16 a[200:201], v18 offset:24712
 ds_write_b128 v23, a[72:75] offset:36864
 v_mfma_f32_16x16x32_bf16 v[68:71], a[220:223], a[240:243], v[68:71]
 ds_read_b64_tr_b16 a[202:203], v18 offset:26248
 v_mul_f32 v37, s70, v37
 v_mfma_f32_16x16x32_bf16 v[76:79], a[216:219], a[228:231], v[76:79]
 ds_read_b64_tr_b16 a[204:205], v18 offset:37000
 v_mul_f32 v38, s70, v38
 v_mfma_f32_16x16x32_bf16 v[76:79], a[220:223], a[244:247], v[76:79]
 ds_read_b64_tr_b16 a[206:207], v18 offset:38536
 v_mul_f32 v39, s70, v39
 v_mfma_f32_16x16x32_bf16 v[84:87], a[216:219], a[232:235], v[84:87]
 v_cvt_pk_bf16_f32 v32, v32, v33
 v_cvt_pk_bf16_f32 v33, v34, v35
 v_mfma_f32_16x16x32_bf16 v[84:87], a[220:223], a[248:251], v[84:87]
 ds_write_b128 v23, a[76:79] offset:37888
 v_cvt_pk_bf16_f32 v34, v36, v37
 v_mfma_f32_16x16x32_bf16 v[92:95], a[216:219], a[236:239], v[92:95]
 buffer_load_dwordx4 v5, s[32:35], s76 offen offset:1024 nt lds
 v_mfma_f32_16x16x32_bf16 v[92:95], a[220:223], a[252:255], v[92:95]
 v_cvt_pk_bf16_f32 v35, v38, v39
 s_waitcnt lgkmcnt(6)
 v_mfma_f32_16x16x32_bf16 v[96:99], a[192:195], a[224:227], v[96:99]
 ds_read_b64_tr_b16 a[208:209], v19 offset:24704
 v_mul_f32 v40, s70, v40
 v_mfma_f32_16x16x32_bf16 v[96:99], a[196:199], a[240:243], v[96:99]
 ds_read_b64_tr_b16 a[210:211], v19 offset:26240
 v_mul_f32 v41, s70, v41
 v_mfma_f32_16x16x32_bf16 v[104:107], a[192:195], a[228:231], v[104:107]
 ds_read_b64_tr_b16 a[212:213], v19 offset:36992
 ds_write_b128 v23, a[80:83] offset:38912
 v_mfma_f32_16x16x32_bf16 v[104:107], a[196:199], a[244:247], v[104:107]
 ds_read_b64_tr_b16 a[214:215], v19 offset:38528
 v_mul_f32 v42, s70, v42
 v_mfma_f32_16x16x32_bf16 v[112:115], a[192:195], a[232:235], v[112:115]
 v_mul_f32 v43, s70, v43
 v_mul_f32 v44, s70, v44
 v_mfma_f32_16x16x32_bf16 v[112:115], a[196:199], a[248:251], v[112:115]
 v_mul_f32 v45, s70, v45
 v_mul_f32 v46, s70, v46
 v_mfma_f32_16x16x32_bf16 v[120:123], a[192:195], a[236:239], v[120:123]
 v_mul_f32 v47, s70, v47
 v_cvt_pk_bf16_f32 v36, v40, v41
 v_mfma_f32_16x16x32_bf16 v[120:123], a[196:199], a[252:255], v[120:123]
 v_cvt_pk_bf16_f32 v37, v42, v43
 s_waitcnt lgkmcnt(6)
 v_mfma_f32_16x16x32_bf16 v[100:103], a[200:203], a[224:227], v[100:103]
 s_barrier
 v_mfma_f32_16x16x32_bf16 v[100:103], a[204:207], a[240:243], v[100:103]
 ds_read_b64_tr_b16 a[216:217], v19 offset:24712
 ds_read_b64_tr_b16 a[218:219], v19 offset:26248
 v_mfma_f32_16x16x32_bf16 v[108:111], a[200:203], a[228:231], v[108:111]
 ds_read_b64_tr_b16 a[220:221], v19 offset:37000
 v_mfma_f32_16x16x32_bf16 v[108:111], a[204:207], a[244:247], v[108:111]
 ds_read_b64_tr_b16 a[222:223], v19 offset:38536
 ds_write_b128 v29, a[36:39] offset:0
 v_mfma_f32_16x16x32_bf16 v[116:119], a[200:203], a[232:235], v[116:119]
 buffer_load_dwordx4 v6, s[32:35], s76 offen offset:2048 nt lds
 v_mfma_f32_16x16x32_bf16 v[116:119], a[204:207], a[248:251], v[116:119]
 v_cvt_pk_bf16_f32 v38, v44, v45
 v_cvt_pk_bf16_f32 v39, v46, v47
 v_mfma_f32_16x16x32_bf16 v[124:127], a[200:203], a[236:239], v[124:127]
 v_mul_f32 v48, s70, v48
 v_mul_f32 v49, s70, v49
 v_mfma_f32_16x16x32_bf16 v[124:127], a[204:207], a[252:255], v[124:127]
 v_mul_f32 v50, s70, v50
 s_waitcnt lgkmcnt(5)
 v_mfma_f32_16x16x32_bf16 v[128:131], a[208:211], a[224:227], v[128:131]
 ds_read_b64_tr_b16 a[192:193], v18 offset:24832
 v_mul_f32 v51, s70, v51
 v_mfma_f32_16x16x32_bf16 v[128:131], a[212:215], a[240:243], v[128:131]
 ds_read_b64_tr_b16 a[194:195], v18 offset:26368
 ds_write_b128 v29, a[40:43] offset:1024
 v_mfma_f32_16x16x32_bf16 v[136:139], a[208:211], a[228:231], v[136:139]
 ds_read_b64_tr_b16 a[196:197], v18 offset:37120
 v_mul_f32 v52, s70, v52
 v_mfma_f32_16x16x32_bf16 v[136:139], a[212:215], a[244:247], v[136:139]
 ds_read_b64_tr_b16 a[198:199], v18 offset:38656
 v_mul_f32 v53, s70, v53
 v_mfma_f32_16x16x32_bf16 v[144:147], a[208:211], a[232:235], v[144:147]
 v_mul_f32 v54, s70, v54
 v_mul_f32 v55, s70, v55
 v_mfma_f32_16x16x32_bf16 v[144:147], a[212:215], a[248:251], v[144:147]
 v_cvt_pk_bf16_f32 v40, v48, v49
 v_cvt_pk_bf16_f32 v41, v50, v51
 v_mfma_f32_16x16x32_bf16 v[152:155], a[208:211], a[236:239], v[152:155]
 s_add_u32 m0, s80, 122880
 s_mov_b32 s76, 49152
 v_mfma_f32_16x16x32_bf16 v[152:155], a[212:215], a[252:255], v[152:155]
 v_cvt_pk_bf16_f32 v42, v52, v53
 s_waitcnt lgkmcnt(6)
 v_mfma_f32_16x16x32_bf16 v[132:135], a[216:219], a[224:227], v[132:135]
 ds_read_b64_tr_b16 a[200:201], v18 offset:24840
 ds_write_b128 v29, a[44:47] offset:2048
 v_mfma_f32_16x16x32_bf16 v[132:135], a[220:223], a[240:243], v[132:135]
 ds_read_b64_tr_b16 a[202:203], v18 offset:26376
 v_cvt_pk_bf16_f32 v43, v54, v55
 v_mfma_f32_16x16x32_bf16 v[140:143], a[216:219], a[228:231], v[140:143]
 ds_read_b64_tr_b16 a[204:205], v18 offset:37128
 v_mul_f32 v56, s70, v56
 v_mfma_f32_16x16x32_bf16 v[140:143], a[220:223], a[244:247], v[140:143]
 ds_read_b64_tr_b16 a[206:207], v18 offset:38664
 v_mul_f32 v57, s70, v57
 v_mfma_f32_16x16x32_bf16 v[148:151], a[216:219], a[232:235], v[148:151]
 v_mul_f32 v58, s70, v58
 v_mul_f32 v59, s70, v59
 v_mfma_f32_16x16x32_bf16 v[148:151], a[220:223], a[248:251], v[148:151]
 v_mul_f32 v60, s70, v60
 v_mul_f32 v61, s70, v61
 v_mfma_f32_16x16x32_bf16 v[156:159], a[216:219], a[236:239], v[156:159]
 v_mul_f32 v62, s70, v62
 v_mul_f32 v63, s70, v63
 v_mfma_f32_16x16x32_bf16 v[156:159], a[220:223], a[252:255], v[156:159]
 s_waitcnt lgkmcnt(5)
 v_mfma_f32_16x16x32_bf16 v[160:163], a[192:195], a[224:227], v[160:163]
 ds_read_b64_tr_b16 a[208:209], v19 offset:24832
 v_cvt_pk_bf16_f32 v44, v56, v57
 v_mfma_f32_16x16x32_bf16 v[160:163], a[196:199], a[240:243], v[160:163]
 ds_read_b64_tr_b16 a[210:211], v19 offset:26368
 v_cvt_pk_bf16_f32 v45, v58, v59
 v_mfma_f32_16x16x32_bf16 v[168:171], a[192:195], a[228:231], v[168:171]
 ds_read_b64_tr_b16 a[212:213], v19 offset:37120
 v_cvt_pk_bf16_f32 v46, v60, v61
 v_mfma_f32_16x16x32_bf16 v[168:171], a[196:199], a[244:247], v[168:171]
 ds_read_b64_tr_b16 a[214:215], v19 offset:38656
 v_cvt_pk_bf16_f32 v47, v62, v63
 v_mfma_f32_16x16x32_bf16 v[176:179], a[192:195], a[232:235], v[176:179]
 buffer_load_dwordx4 v4, s[32:35], s76 offen offset:0 nt lds
 v_mfma_f32_16x16x32_bf16 v[176:179], a[196:199], a[248:251], v[176:179]
 v_mul_f32 v64, s70, v64
 v_mul_f32 v65, s70, v65
 v_mfma_f32_16x16x32_bf16 v[184:187], a[192:195], a[236:239], v[184:187]
 ds_write_b128 v29, a[60:63] offset:12288
 v_mul_f32 v66, s70, v66
 v_mfma_f32_16x16x32_bf16 v[184:187], a[196:199], a[252:255], v[184:187]
 v_mul_f32 v67, s70, v67
 s_waitcnt lgkmcnt(5)
 v_mfma_f32_16x16x32_bf16 v[164:167], a[200:203], a[224:227], v[164:167]
 ds_read_b64_tr_b16 a[216:217], v19 offset:24840
 v_mul_f32 v68, s70, v68
 v_mfma_f32_16x16x32_bf16 v[164:167], a[204:207], a[240:243], v[164:167]
 ds_read_b64_tr_b16 a[218:219], v19 offset:26376
 v_mul_f32 v69, s70, v69
 v_mfma_f32_16x16x32_bf16 v[172:175], a[200:203], a[228:231], v[172:175]
 ds_read_b64_tr_b16 a[220:221], v19 offset:37128
 v_mul_f32 v70, s70, v70
 v_mfma_f32_16x16x32_bf16 v[172:175], a[204:207], a[244:247], v[172:175]
 ds_read_b64_tr_b16 a[222:223], v19 offset:38664
 v_mul_f32 v71, s70, v71
 v_mfma_f32_16x16x32_bf16 v[180:183], a[200:203], a[232:235], v[180:183]
 v_cvt_pk_bf16_f32 v48, v64, v65
 v_cvt_pk_bf16_f32 v49, v66, v67
 v_mfma_f32_16x16x32_bf16 v[180:183], a[204:207], a[248:251], v[180:183]
 ds_write_b128 v29, a[64:67] offset:13312
 v_cvt_pk_bf16_f32 v50, v68, v69
 v_mfma_f32_16x16x32_bf16 v[188:191], a[200:203], a[236:239], v[188:191]
 v_cvt_pk_bf16_f32 v51, v70, v71
 v_mul_f32 v72, s70, v72
 v_mfma_f32_16x16x32_bf16 v[188:191], a[204:207], a[252:255], v[188:191]
 v_mul_f32 v73, s70, v73
 s_waitcnt lgkmcnt(6)
 v_mfma_f32_16x16x32_bf16 v[192:195], a[208:211], a[224:227], v[192:195]
 buffer_load_dwordx4 v5, s[32:35], s76 offen offset:1024 nt lds
 v_mfma_f32_16x16x32_bf16 v[192:195], a[212:215], a[240:243], v[192:195]
 v_mul_f32 v74, s70, v74
 v_mul_f32 v75, s70, v75
 v_mfma_f32_16x16x32_bf16 v[200:203], a[208:211], a[228:231], v[200:203]
 v_mul_f32 v76, s70, v76
 v_mul_f32 v77, s70, v77
 v_mfma_f32_16x16x32_bf16 v[200:203], a[212:215], a[244:247], v[200:203]
 v_mul_f32 v78, s70, v78
 v_mul_f32 v79, s70, v79
 v_mfma_f32_16x16x32_bf16 v[208:211], a[208:211], a[232:235], v[208:211]
 ds_write_b128 v29, a[68:71] offset:14336
 v_cvt_pk_bf16_f32 v52, v72, v73
 v_mfma_f32_16x16x32_bf16 v[208:211], a[212:215], a[248:251], v[208:211]
 v_cvt_pk_bf16_f32 v53, v74, v75
 v_cvt_pk_bf16_f32 v54, v76, v77
 v_mfma_f32_16x16x32_bf16 v[216:219], a[208:211], a[236:239], v[216:219]
 v_cvt_pk_bf16_f32 v55, v78, v79
 v_mul_f32 v80, s70, v80
 v_mfma_f32_16x16x32_bf16 v[216:219], a[212:215], a[252:255], v[216:219]
 v_mul_f32 v81, s70, v81
 s_waitcnt lgkmcnt(2)
 v_mfma_f32_16x16x32_bf16 v[196:199], a[216:219], a[224:227], v[196:199]
 v_mul_f32 v82, s70, v82
 v_mul_f32 v83, s70, v83
 v_mfma_f32_16x16x32_bf16 v[196:199], a[220:223], a[240:243], v[196:199]
 v_mul_f32 v84, s70, v84
 v_mul_f32 v85, s70, v85
 v_mfma_f32_16x16x32_bf16 v[204:207], a[216:219], a[228:231], v[204:207]
 v_mul_f32 v86, s70, v86
 v_mul_f32 v87, s70, v87
 v_mfma_f32_16x16x32_bf16 v[204:207], a[220:223], a[244:247], v[204:207]
 v_cvt_pk_bf16_f32 v56, v80, v81
 v_cvt_pk_bf16_f32 v57, v82, v83
 v_mfma_f32_16x16x32_bf16 v[212:215], a[216:219], a[232:235], v[212:215]
 v_cvt_pk_bf16_f32 v58, v84, v85
 v_cvt_pk_bf16_f32 v59, v86, v87
 v_mfma_f32_16x16x32_bf16 v[212:215], a[220:223], a[248:251], v[212:215]
 v_mul_f32 v88, s70, v88
 v_mul_f32 v89, s70, v89
 v_mfma_f32_16x16x32_bf16 v[220:223], a[216:219], a[236:239], v[220:223]
 v_mul_f32 v90, s70, v90
 v_mul_f32 v91, s70, v91
 v_mfma_f32_16x16x32_bf16 v[220:223], a[220:223], a[252:255], v[220:223]
 v_mul_f32 v92, s70, v92
 v_mul_f32 v93, s70, v93
 v_mul_f32 v94, s70, v94
 v_mul_f32 v95, s70, v95
 v_cvt_pk_bf16_f32 v60, v88, v89
 v_cvt_pk_bf16_f32 v61, v90, v91
 v_cvt_pk_bf16_f32 v62, v92, v93
 v_cvt_pk_bf16_f32 v63, v94, v95
 v_mul_f32 v96, s70, v96
 v_mul_f32 v97, s70, v97
 v_mul_f32 v98, s70, v98
 v_mul_f32 v99, s70, v99
 v_mul_f32 v100, s70, v100
 v_mul_f32 v101, s70, v101
 v_mul_f32 v102, s70, v102
 v_mul_f32 v103, s70, v103
 v_cvt_pk_bf16_f32 v64, v96, v97
 v_cvt_pk_bf16_f32 v65, v98, v99
 v_cvt_pk_bf16_f32 v66, v100, v101
 v_cvt_pk_bf16_f32 v67, v102, v103
 v_mul_f32 v104, s70, v104
 v_mul_f32 v105, s70, v105
 v_mul_f32 v106, s70, v106
 v_mul_f32 v107, s70, v107
 v_mul_f32 v108, s70, v108
 v_mul_f32 v109, s70, v109
 v_mul_f32 v110, s70, v110
 v_mul_f32 v111, s70, v111
 v_cvt_pk_bf16_f32 v68, v104, v105
 v_cvt_pk_bf16_f32 v69, v106, v107
 v_cvt_pk_bf16_f32 v70, v108, v109
 v_cvt_pk_bf16_f32 v71, v110, v111
 v_mul_f32 v112, s70, v112
 v_mul_f32 v113, s70, v113
 v_mul_f32 v114, s70, v114
 v_mul_f32 v115, s70, v115
 v_mul_f32 v116, s70, v116
 v_mul_f32 v117, s70, v117
 v_mul_f32 v118, s70, v118
 v_mul_f32 v119, s70, v119
 v_cvt_pk_bf16_f32 v72, v112, v113
 v_cvt_pk_bf16_f32 v73, v114, v115
 v_cvt_pk_bf16_f32 v74, v116, v117
 v_cvt_pk_bf16_f32 v75, v118, v119
 v_mul_f32 v120, s70, v120
 v_mul_f32 v121, s70, v121
 v_mul_f32 v122, s70, v122
 v_mul_f32 v123, s70, v123
 v_mul_f32 v124, s70, v124
 v_mul_f32 v125, s70, v125
 v_mul_f32 v126, s70, v126
 v_mul_f32 v127, s70, v127
 v_cvt_pk_bf16_f32 v76, v120, v121
 v_cvt_pk_bf16_f32 v77, v122, v123
 v_cvt_pk_bf16_f32 v78, v124, v125
 v_cvt_pk_bf16_f32 v79, v126, v127
 ds_read_b128 a[224:227], v12 offset:12288
 ds_read_b128 a[228:231], v12 offset:18432
 ds_read_b128 a[232:235], v13 offset:12288
 ds_read_b128 a[236:239], v13 offset:18432
 s_mov_b32 s96, s70
 s_mov_b32 s97, s70
 s_waitcnt lgkmcnt(4)
 s_barrier
 v_pk_mul_f32 v[128:129], v[128:129], s[96:97]
 v_pk_mul_f32 v[130:131], v[130:131], s[96:97]
 v_pk_mul_f32 v[132:133], v[132:133], s[96:97]
 v_pk_mul_f32 v[134:135], v[134:135], s[96:97]
 v_cvt_pk_bf16_f32 v80, v128, v129
 v_cvt_pk_bf16_f32 v81, v130, v131
 v_cvt_pk_bf16_f32 v82, v132, v133
 v_cvt_pk_bf16_f32 v83, v134, v135
 v_pk_mul_f32 v[136:137], v[136:137], s[96:97]
 v_pk_mul_f32 v[138:139], v[138:139], s[96:97]
 v_pk_mul_f32 v[140:141], v[140:141], s[96:97]
 v_pk_mul_f32 v[142:143], v[142:143], s[96:97]
 v_cvt_pk_bf16_f32 v84, v136, v137
 v_cvt_pk_bf16_f32 v85, v138, v139
 v_cvt_pk_bf16_f32 v86, v140, v141
 v_cvt_pk_bf16_f32 v87, v142, v143
 v_pk_mul_f32 v[144:145], v[144:145], s[96:97]
 v_pk_mul_f32 v[146:147], v[146:147], s[96:97]
 v_pk_mul_f32 v[148:149], v[148:149], s[96:97]
 v_pk_mul_f32 v[150:151], v[150:151], s[96:97]
 v_cvt_pk_bf16_f32 v88, v144, v145
 v_cvt_pk_bf16_f32 v89, v146, v147
 v_cvt_pk_bf16_f32 v90, v148, v149
 v_cvt_pk_bf16_f32 v91, v150, v151
 v_pk_mul_f32 v[152:153], v[152:153], s[96:97]
 v_pk_mul_f32 v[154:155], v[154:155], s[96:97]
 v_pk_mul_f32 v[156:157], v[156:157], s[96:97]
 v_pk_mul_f32 v[158:159], v[158:159], s[96:97]
 v_cvt_pk_bf16_f32 v92, v152, v153
 v_cvt_pk_bf16_f32 v93, v154, v155
 v_cvt_pk_bf16_f32 v94, v156, v157
 v_cvt_pk_bf16_f32 v95, v158, v159
 s_waitcnt lgkmcnt(2)
 v_mfma_f32_16x16x32_bf16 v[224:227], a[224:227], v[32:35], 0
 ds_read_b128 a[240:243], v12 offset:12416
 v_mul_f32 v160, s70, v160
 v_mfma_f32_16x16x32_bf16 v[232:235], a[224:227], v[36:39], 0
 v_mul_f32 v161, s70, v161
 v_mul_f32 v162, s70, v162
 v_mfma_f32_16x16x32_bf16 v[240:243], a[224:227], v[40:43], 0
 buffer_load_dwordx4 v6, s[32:35], s76 offen offset:2048 nt lds
 v_mfma_f32_16x16x32_bf16 v[248:251], a[224:227], v[44:47], 0
 v_mul_f32 v163, s70, v163
 v_mul_f32 v164, s70, v164
 v_mfma_f32_16x16x32_bf16 v[228:231], a[228:231], v[32:35], 0
 ds_read_b128 a[244:247], v12 offset:18560
 v_mul_f32 v165, s70, v165
 v_mfma_f32_16x16x32_bf16 v[236:239], a[228:231], v[36:39], 0
 v_mul_f32 v166, s70, v166
 v_mul_f32 v167, s70, v167
 v_mfma_f32_16x16x32_bf16 v[244:247], a[228:231], v[40:43], 0
 v_cvt_pk_bf16_f32 v96, v160, v161
 v_cvt_pk_bf16_f32 v97, v162, v163
 v_mfma_f32_16x16x32_bf16 v[252:255], a[228:231], v[44:47], 0
 v_cvt_pk_bf16_f32 v98, v164, v165
 v_cvt_pk_bf16_f32 v99, v166, v167
 s_waitcnt lgkmcnt(2)
 v_mfma_f32_16x16x32_bf16 v[224:227], a[232:235], v[48:51], v[224:227]
 ds_read_b128 a[248:251], v13 offset:12416
 v_mul_f32 v168, s70, v168
 v_mfma_f32_16x16x32_bf16 v[232:235], a[232:235], v[52:55], v[232:235]
 v_mul_f32 v169, s70, v169
 v_mul_f32 v170, s70, v170
 v_mfma_f32_16x16x32_bf16 v[240:243], a[232:235], v[56:59], v[240:243]
 v_mul_f32 v171, s70, v171
 v_mul_f32 v172, s70, v172
 v_mfma_f32_16x16x32_bf16 v[248:251], a[232:235], v[60:63], v[248:251]
 s_add_u32 m0, s80, 135168
 s_mov_b32 s76, 61440
 v_mfma_f32_16x16x32_bf16 v[228:231], a[236:239], v[48:51], v[228:231]
 ds_read_b128 a[252:255], v13 offset:18560
 v_mul_f32 v173, s70, v173
 v_mfma_f32_16x16x32_bf16 v[236:239], a[236:239], v[52:55], v[236:239]
 v_mul_f32 v174, s70, v174
 v_mul_f32 v175, s70, v175
 v_mfma_f32_16x16x32_bf16 v[244:247], a[236:239], v[56:59], v[244:247]
 v_cvt_pk_bf16_f32 v100, v168, v169
 v_cvt_pk_bf16_f32 v101, v170, v171
 v_mfma_f32_16x16x32_bf16 v[252:255], a[236:239], v[60:63], v[252:255]
 v_cvt_pk_bf16_f32 v102, v172, v173
 v_cvt_pk_bf16_f32 v103, v174, v175
 s_waitcnt lgkmcnt(2)
 v_mfma_f32_16x16x32_bf16 v[224:227], a[240:243], v[64:67], v[224:227]
 ds_read_b128 a[192:195], v12 offset:12544
 v_mul_f32 v176, s70, v176
 v_mfma_f32_16x16x32_bf16 v[232:235], a[240:243], v[68:71], v[232:235]
 v_mul_f32 v177, s70, v177
 v_mul_f32 v178, s70, v178
 v_mfma_f32_16x16x32_bf16 v[240:243], a[240:243], v[72:75], v[240:243]
 v_mul_f32 v179, s70, v179
 v_mul_f32 v180, s70, v180
 v_mfma_f32_16x16x32_bf16 v[248:251], a[240:243], v[76:79], v[248:251]
 v_mul_f32 v181, s70, v181
 v_mul_f32 v182, s70, v182
 v_mfma_f32_16x16x32_bf16 v[228:231], a[244:247], v[64:67], v[228:231]
 ds_read_b128 a[196:199], v12 offset:18688
 v_mul_f32 v183, s70, v183
 v_mfma_f32_16x16x32_bf16 v[236:239], a[244:247], v[68:71], v[236:239]
 v_cvt_pk_bf16_f32 v104, v176, v177
 v_cvt_pk_bf16_f32 v105, v178, v179
 v_mfma_f32_16x16x32_bf16 v[244:247], a[244:247], v[72:75], v[244:247]
 v_cvt_pk_bf16_f32 v106, v180, v181
 v_cvt_pk_bf16_f32 v107, v182, v183
 v_mfma_f32_16x16x32_bf16 v[252:255], a[244:247], v[76:79], v[252:255]
 v_mul_f32 v184, s70, v184
 v_mul_f32 v185, s70, v185
 s_waitcnt lgkmcnt(2)
 v_mfma_f32_16x16x32_bf16 v[224:227], a[248:251], v[80:83], v[224:227]
 ds_read_b128 a[200:203], v13 offset:12544
 v_mul_f32 v186, s70, v186
 v_mfma_f32_16x16x32_bf16 v[232:235], a[248:251], v[84:87], v[232:235]
 v_mul_f32 v187, s70, v187
 v_mul_f32 v188, s70, v188
 v_mfma_f32_16x16x32_bf16 v[240:243], a[248:251], v[88:91], v[240:243]
 v_mul_f32 v189, s70, v189
 v_mul_f32 v190, s70, v190
 v_mfma_f32_16x16x32_bf16 v[248:251], a[248:251], v[92:95], v[248:251]
 v_mul_f32 v191, s70, v191
 v_cvt_pk_bf16_f32 v108, v184, v185
 v_mfma_f32_16x16x32_bf16 v[228:231], a[252:255], v[80:83], v[228:231]
 ds_read_b128 a[204:207], v13 offset:18688
 v_cvt_pk_bf16_f32 v109, v186, v187
 v_mfma_f32_16x16x32_bf16 v[236:239], a[252:255], v[84:87], v[236:239]
 v_cvt_pk_bf16_f32 v110, v188, v189
 v_cvt_pk_bf16_f32 v111, v190, v191
 v_mfma_f32_16x16x32_bf16 v[244:247], a[252:255], v[88:91], v[244:247]
 buffer_load_dwordx4 v4, s[32:35], s76 offen offset:0 nt lds
 v_mfma_f32_16x16x32_bf16 v[252:255], a[252:255], v[92:95], v[252:255]
 v_mul_f32 v192, s70, v192
 v_mul_f32 v193, s70, v193
 s_waitcnt lgkmcnt(2)
 v_mfma_f32_16x16x32_bf16 v[224:227], a[192:195], v[96:99], v[224:227]
 v_mul_f32 v194, s70, v194
 v_mul_f32 v195, s70, v195
 v_mfma_f32_16x16x32_bf16 v[232:235], a[192:195], v[100:103], v[232:235]
 v_mul_f32 v196, s70, v196
 v_mul_f32 v197, s70, v197
 v_mfma_f32_16x16x32_bf16 v[240:243], a[192:195], v[104:107], v[240:243]
 s_waitcnt vmcnt(10)
 v_mul_f32 v198, s70, v198
 v_mfma_f32_16x16x32_bf16 v[248:251], a[192:195], v[108:111], v[248:251]
 v_mul_f32 v199, s70, v199
 v_cvt_pk_bf16_f32 v112, v192, v193
 v_mfma_f32_16x16x32_bf16 v[228:231], a[196:199], v[96:99], v[228:231]
 v_cvt_pk_bf16_f32 v113, v194, v195
 v_cvt_pk_bf16_f32 v114, v196, v197
 v_mfma_f32_16x16x32_bf16 v[236:239], a[196:199], v[100:103], v[236:239]
 v_cvt_pk_bf16_f32 v115, v198, v199
 v_mul_f32 v200, s70, v200
 v_mfma_f32_16x16x32_bf16 v[244:247], a[196:199], v[104:107], v[244:247]
 v_mul_f32 v201, s70, v201
 v_mul_f32 v202, s70, v202
 v_mul_f32 v203, s70, v203
 v_mul_f32 v204, s70, v204
 v_mul_f32 v205, s70, v205
 v_mul_f32 v206, s70, v206
 v_mul_f32 v207, s70, v207
 v_cvt_pk_bf16_f32 v116, v200, v201
 v_cvt_pk_bf16_f32 v117, v202, v203
 v_cvt_pk_bf16_f32 v118, v204, v205
 v_cvt_pk_bf16_f32 v119, v206, v207
 v_mul_f32 v208, s70, v208
 v_mul_f32 v209, s70, v209
 v_mul_f32 v210, s70, v210
 v_mul_f32 v211, s70, v211
 v_mul_f32 v212, s70, v212
 v_mul_f32 v213, s70, v213
 v_mul_f32 v214, s70, v214
 v_mul_f32 v215, s70, v215
 v_cvt_pk_bf16_f32 v120, v208, v209
 v_cvt_pk_bf16_f32 v121, v210, v211
 v_cvt_pk_bf16_f32 v122, v212, v213
 v_cvt_pk_bf16_f32 v123, v214, v215
 v_mul_f32 v216, s70, v216
 v_mul_f32 v217, s70, v217
 v_mul_f32 v218, s70, v218
 v_mul_f32 v219, s70, v219
 v_mul_f32 v220, s70, v220
 v_mul_f32 v221, s70, v221
 v_mul_f32 v222, s70, v222
 v_mul_f32 v223, s70, v223
 v_cvt_pk_bf16_f32 v124, v216, v217
 v_cvt_pk_bf16_f32 v125, v218, v219
 v_cvt_pk_bf16_f32 v126, v220, v221
 v_cvt_pk_bf16_f32 v127, v222, v223
 ds_write_b128 v29, a[84:87] offset:24576
 v_mfma_f32_16x16x32_bf16 v[252:255], a[196:199], v[108:111], v[252:255]
 ds_read_b128 a[208:211], v12 offset:24576
 buffer_load_dwordx4 v5, s[32:35], s76 offen offset:1024 nt lds
 s_waitcnt lgkmcnt(2)
 v_mfma_f32_16x16x32_bf16 v[224:227], a[200:203], v[112:115], v[224:227]
 ds_write_b128 v29, a[88:91] offset:25600
 ds_read_b128 a[212:215], v13 offset:24576
 v_mfma_f32_16x16x32_bf16 v[232:235], a[200:203], v[116:119], v[232:235]
 ds_write_b128 v29, a[92:95] offset:26624
 ds_read_b128 a[216:219], v12 offset:24704
 v_mfma_f32_16x16x32_bf16 v[240:243], a[200:203], v[120:123], v[240:243]
 s_waitcnt vmcnt(8)
 ds_read_b128 a[220:223], v13 offset:24704
 v_mfma_f32_16x16x32_bf16 v[248:251], a[200:203], v[124:127], v[248:251]
 ds_write_b128 v29, a[96:99] offset:36864
 v_mfma_f32_16x16x32_bf16 v[228:231], a[204:207], v[112:115], v[228:231]
 ds_read_b128 a[224:227], v12 offset:24832
 ds_write_b128 v29, a[100:103] offset:37888
 v_mfma_f32_16x16x32_bf16 v[236:239], a[204:207], v[116:119], v[236:239]
 buffer_load_dwordx4 v6, s[32:35], s76 offen offset:2048 nt lds
 v_mfma_f32_16x16x32_bf16 v[244:247], a[204:207], v[120:123], v[244:247]
 ds_read_b128 a[228:231], v13 offset:24832
 ds_write_b128 v29, a[104:107] offset:38912
 v_mfma_f32_16x16x32_bf16 v[252:255], a[204:207], v[124:127], v[252:255]
 v_mov_b32 v144, 0
 v_mov_b32 v145, 0
 v_mov_b32 v146, 0
 v_mov_b32 v147, 0
 v_max3_f32 v148, v224, v225, v226
 v_max3_f32 v149, v232, v233, v234
 v_max3_f32 v150, v240, v241, v242
 v_max3_f32 v151, v248, v249, v250
 v_max3_f32 v148, v148, v227, v228
 v_max3_f32 v149, v149, v235, v236
 v_max3_f32 v150, v150, v243, v244
 v_max3_f32 v151, v151, v251, v252
 v_max3_f32 v148, v148, v229, v230
 v_max3_f32 v149, v149, v237, v238
 v_max3_f32 v150, v150, v245, v246
 v_max3_f32 v151, v151, v253, v254
 v_max_f32 v148, v148, v231
 v_max_f32 v149, v149, v239
 v_max_f32 v150, v150, v247
 v_max_f32 v151, v151, v255
 v_mov_b32 v152, v148
 v_mov_b32 v153, v149
 v_mov_b32 v154, v150
 v_mov_b32 v155, v151
 v_permlane32_swap_b32 v152, v148
 v_permlane32_swap_b32 v153, v149
 v_permlane32_swap_b32 v154, v150
 v_permlane32_swap_b32 v155, v151
 v_max_f32 v148, v148, v152
 v_max_f32 v149, v149, v153
 v_max_f32 v150, v150, v154
 v_max_f32 v151, v151, v155
 v_mov_b32 v152, v148
 v_mov_b32 v153, v149
 v_mov_b32 v154, v150
 v_mov_b32 v155, v151
 v_permlane16_swap_b32 v152, v148
 v_permlane16_swap_b32 v153, v149
 v_permlane16_swap_b32 v154, v150
 v_permlane16_swap_b32 v155, v151
 v_max_f32 v148, v148, v152
 v_max_f32 v149, v149, v153
 v_max_f32 v150, v150, v154
 v_max_f32 v151, v151, v155
 v_sub_f32 v128, 0, v148
 v_sub_f32 v129, 0, v148
 v_sub_f32 v130, 0, v148
 v_sub_f32 v131, 0, v148
 v_sub_f32 v132, 0, v149
 v_sub_f32 v133, 0, v149
 v_sub_f32 v134, 0, v149
 v_sub_f32 v135, 0, v149
 v_sub_f32 v136, 0, v150
 v_sub_f32 v137, 0, v150
 v_sub_f32 v138, 0, v150
 v_sub_f32 v139, 0, v150
 v_sub_f32 v140, 0, v151
 v_sub_f32 v141, 0, v151
 v_sub_f32 v142, 0, v151
 v_sub_f32 v143, 0, v151
 s_waitcnt lgkmcnt(6)
 v_mfma_f32_16x16x32_bf16 v[160:163], a[208:211], v[32:35], v[128:131]
 v_add_f32 v224, v224, v128
 v_add_f32 v225, v225, v128
 v_mfma_f32_16x16x32_bf16 v[160:163], a[212:215], v[48:51], v[160:163]
 v_exp_f32 v152, v224
 v_mfma_f32_16x16x32_bf16 v[160:163], a[216:219], v[64:67], v[160:163]
 ds_read_b128 a[232:235], v12 offset:30720
 s_waitcnt lgkmcnt(2)
 v_mfma_f32_16x16x32_bf16 v[160:163], a[220:223], v[80:83], v[160:163]
 v_exp_f32 v153, v225
 v_add_f32 v226, v226, v128
 v_mfma_f32_16x16x32_bf16 v[160:163], a[224:227], v[96:99], v[160:163]
 s_add_u32 m0, s80, 147456
 s_mov_b32 s76, 73728
 v_exp_f32 v154, v226
 v_mfma_f32_16x16x32_bf16 v[160:163], a[228:231], v[112:115], v[160:163]
 ds_read_b128 a[236:239], v13 offset:30720
 v_add_f32 v227, v227, v128
 v_mfma_f32_16x16x32_bf16 v[168:171], a[208:211], v[36:39], v[132:135]
 v_exp_f32 v155, v227
 v_add_f32 v228, v228, v128
 v_mfma_f32_16x16x32_bf16 v[168:171], a[212:215], v[52:55], v[168:171]
 ds_read_b128 a[240:243], v12 offset:30848
 buffer_load_dwordx4 v4, s[32:35], s76 offen offset:0 nt lds
 v_exp_f32 v156, v228
 v_mfma_f32_16x16x32_bf16 v[168:171], a[216:219], v[68:71], v[168:171]
 v_add_f32 v229, v229, v128
 ds_read_b128 a[244:247], v13 offset:30848
 v_mfma_f32_16x16x32_bf16 v[168:171], a[220:223], v[84:87], v[168:171]
 v_add_f32 v148, v152, v153
 v_cvt_pk_bf16_f32 v192, v152, v153
 v_exp_f32 v157, v229
 v_add_f32 v230, v230, v128
 v_mfma_f32_16x16x32_bf16 v[168:171], a[224:227], v[100:103], v[168:171]
 v_add_f32 v148, v148, v154
 v_exp_f32 v152, v230
 v_add_f32 v231, v231, v128
 v_mfma_f32_16x16x32_bf16 v[168:171], a[228:231], v[116:119], v[168:171]
 ds_read_b128 a[248:251], v12 offset:30976
 v_exp_f32 v153, v231
 v_mfma_f32_16x16x32_bf16 v[176:179], a[208:211], v[40:43], v[136:139]
 ds_read_b128 a[252:255], v13 offset:30976
 v_add_f32 v148, v148, v155
 v_cvt_pk_bf16_f32 v193, v154, v155
 v_add_f32 v232, v232, v132
 v_mfma_f32_16x16x32_bf16 v[176:179], a[212:215], v[56:59], v[176:179]
 v_add_f32 v148, v148, v156
 v_exp_f32 v154, v232
 v_add_f32 v233, v233, v132
 v_mfma_f32_16x16x32_bf16 v[176:179], a[216:219], v[72:75], v[176:179]
 v_exp_f32 v155, v233
 v_mfma_f32_16x16x32_bf16 v[176:179], a[220:223], v[88:91], v[176:179]
 v_add_f32 v148, v148, v157
 v_cvt_pk_bf16_f32 v194, v156, v157
 v_add_f32 v234, v234, v132
 v_mfma_f32_16x16x32_bf16 v[176:179], a[224:227], v[104:107], v[176:179]
 v_add_f32 v148, v148, v152
 v_exp_f32 v156, v234
 v_add_f32 v235, v235, v132
 v_mfma_f32_16x16x32_bf16 v[176:179], a[228:231], v[120:123], v[176:179]
 v_add_f32 v148, v148, v153
 v_cvt_pk_bf16_f32 v195, v152, v153
 v_exp_f32 v157, v235
 v_add_f32 v236, v236, v132
 v_mfma_f32_16x16x32_bf16 v[184:187], a[208:211], v[44:47], v[140:143]
 v_exp_f32 v152, v236
 v_mfma_f32_16x16x32_bf16 v[184:187], a[212:215], v[60:63], v[184:187]
 v_add_f32 v237, v237, v132
 v_add_f32 v149, v154, v155
 v_mfma_f32_16x16x32_bf16 v[184:187], a[216:219], v[76:79], v[184:187]
 v_cvt_pk_bf16_f32 v196, v154, v155
 v_exp_f32 v153, v237
 v_add_f32 v238, v238, v132
 v_mfma_f32_16x16x32_bf16 v[184:187], a[220:223], v[92:95], v[184:187]
 v_exp_f32 v154, v238
 v_mfma_f32_16x16x32_bf16 v[184:187], a[224:227], v[108:111], v[184:187]
 buffer_load_dwordx4 v5, s[32:35], s76 offen offset:1024 nt lds
 v_add_f32 v149, v149, v156
 v_add_f32 v239, v239, v132
 v_mfma_f32_16x16x32_bf16 v[184:187], a[228:231], v[124:127], v[184:187]
 v_subrev_u32 v12, 36864, v12
 v_add_f32 v149, v149, v157
 v_cvt_pk_bf16_f32 v197, v156, v157
 v_exp_f32 v155, v239
 v_add_f32 v240, v240, v136
 s_waitcnt lgkmcnt(3)
 v_mfma_f32_16x16x32_bf16 v[164:167], a[232:235], v[32:35], v[128:131]
 v_add_f32 v149, v149, v152
 v_exp_f32 v156, v240
 v_add_f32 v241, v241, v136
 v_mfma_f32_16x16x32_bf16 v[164:167], a[236:239], v[48:51], v[164:167]
 v_exp_f32 v157, v241
 v_mfma_f32_16x16x32_bf16 v[164:167], a[240:243], v[64:67], v[164:167]
 v_add_f32 v149, v149, v153
 v_cvt_pk_bf16_f32 v198, v152, v153
 v_add_f32 v242, v242, v136
 s_waitcnt lgkmcnt(0)
 v_mfma_f32_16x16x32_bf16 v[164:167], a[244:247], v[80:83], v[164:167]
 v_add_f32 v149, v149, v154
 v_exp_f32 v152, v242
 v_add_f32 v243, v243, v136
 v_mfma_f32_16x16x32_bf16 v[164:167], a[248:251], v[96:99], v[164:167]
 v_exp_f32 v153, v243
 v_mfma_f32_16x16x32_bf16 v[164:167], a[252:255], v[112:115], v[164:167]
 s_barrier
 v_add_f32 v149, v149, v155
 v_cvt_pk_bf16_f32 v199, v154, v155
 v_add_f32 v244, v244, v136
 v_mfma_f32_16x16x32_bf16 v[172:175], a[232:235], v[36:39], v[132:135]
 v_subrev_u32 v13, 36864, v13
 v_exp_f32 v154, v244
 v_add_f32 v245, v245, v136
 v_mfma_f32_16x16x32_bf16 v[172:175], a[236:239], v[52:55], v[172:175]
 ds_read_b64_tr_b16 a[192:193], v14 offset:0
 v_add_f32 v150, v156, v157
 v_cvt_pk_bf16_f32 v200, v156, v157
 v_exp_f32 v155, v245
 v_add_f32 v246, v246, v136
 v_mfma_f32_16x16x32_bf16 v[172:175], a[240:243], v[68:71], v[172:175]
 v_exp_f32 v156, v246
 v_mfma_f32_16x16x32_bf16 v[172:175], a[244:247], v[84:87], v[172:175]
 v_add_f32 v150, v150, v152
 v_add_f32 v247, v247, v136
 v_mfma_f32_16x16x32_bf16 v[172:175], a[248:251], v[100:103], v[172:175]
 ds_read_b64_tr_b16 a[194:195], v14 offset:6144
 v_add_f32 v150, v150, v153
 v_cvt_pk_bf16_f32 v201, v152, v153
 v_exp_f32 v157, v247
 v_add_f32 v248, v248, v140
 v_mfma_f32_16x16x32_bf16 v[172:175], a[252:255], v[116:119], v[172:175]
 v_exp_f32 v152, v248
 v_mfma_f32_16x16x32_bf16 v[180:183], a[232:235], v[40:43], v[136:139]
 ds_read_b64_tr_b16 a[196:197], v15 offset:0
 v_add_f32 v150, v150, v154
 v_add_f32 v249, v249, v140
 v_mfma_f32_16x16x32_bf16 v[180:183], a[236:239], v[56:59], v[180:183]
 buffer_load_dwordx4 v6, s[32:35], s76 offen offset:2048 nt lds
 v_add_f32 v150, v150, v155
 v_cvt_pk_bf16_f32 v202, v154, v155
 v_exp_f32 v153, v249
 v_add_f32 v250, v250, v140
 v_mfma_f32_16x16x32_bf16 v[180:183], a[240:243], v[72:75], v[180:183]
 ds_read_b64_tr_b16 a[198:199], v15 offset:6144
 v_add_f32 v150, v150, v156
 v_exp_f32 v154, v250
 v_add_f32 v251, v251, v140
 v_mfma_f32_16x16x32_bf16 v[180:183], a[244:247], v[88:91], v[180:183]
 v_exp_f32 v155, v251
 v_mfma_f32_16x16x32_bf16 v[180:183], a[248:251], v[104:107], v[180:183]
 v_add_f32 v150, v150, v157
 v_cvt_pk_bf16_f32 v203, v156, v157
 v_add_f32 v252, v252, v140
 v_mfma_f32_16x16x32_bf16 v[180:183], a[252:255], v[120:123], v[180:183]
 ds_read_b64_tr_b16 a[200:201], v16 offset:0
 v_exp_f32 v156, v252
 v_add_f32 v253, v253, v140
 v_mfma_f32_16x16x32_bf16 v[188:191], a[232:235], v[44:47], v[140:143]
 v_exp_f32 v157, v253
 v_mfma_f32_16x16x32_bf16 v[188:191], a[236:239], v[60:63], v[188:191]
 ds_read_b64_tr_b16 a[202:203], v16 offset:6144
 v_add_f32 v151, v152, v153
 v_cvt_pk_bf16_f32 v204, v152, v153
 v_add_f32 v254, v254, v140
 v_mfma_f32_16x16x32_bf16 v[188:191], a[240:243], v[76:79], v[188:191]
 v_add_f32 v151, v151, v154
 v_exp_f32 v152, v254
 v_add_f32 v255, v255, v140
 v_mfma_f32_16x16x32_bf16 v[188:191], a[244:247], v[92:95], v[188:191]
 ds_read_b64_tr_b16 a[204:205], v17 offset:0
 v_add_f32 v151, v151, v155
 v_cvt_pk_bf16_f32 v205, v154, v155
 v_exp_f32 v153, v255
 v_mfma_f32_16x16x32_bf16 v[188:191], a[248:251], v[108:111], v[188:191]
 ds_read_b64_tr_b16 a[206:207], v17 offset:6144
 v_add_f32 v151, v151, v156
 v_mfma_f32_16x16x32_bf16 v[188:191], a[252:255], v[124:127], v[188:191]
 v_add_f32 v151, v151, v157
 v_cvt_pk_bf16_f32 v206, v156, v157
 v_add_f32 v151, v151, v152
 v_add_f32 v151, v151, v153
 v_cvt_pk_bf16_f32 v207, v152, v153
 s_waitcnt lgkmcnt(4)
 v_mfma_f32_16x16x32_bf16 a[0:3], a[192:195], v[192:195], 0
 s_add_u32 m0, s80, 49152
 s_mov_b32 s76, 73728
 v_mfma_f32_16x16x32_bf16 a[4:7], a[192:195], v[196:199], 0
 v_exp_f32 v152, v160
 v_mfma_f32_16x16x32_bf16 a[8:11], a[192:195], v[200:203], 0
 ds_read_b64_tr_b16 a[208:209], v14 offset:128
 v_add_f32 v144, v144, v148
 v_mfma_f32_16x16x32_bf16 a[12:15], a[192:195], v[204:207], 0
 v_exp_f32 v153, v161
 v_mfma_f32_16x16x32_bf16 a[16:19], a[196:199], v[192:195], 0
 ds_read_b64_tr_b16 a[210:211], v14 offset:6272
 buffer_load_dwordx4 v1, s[28:31], s76 offen offset:0 nt lds
 v_mfma_f32_16x16x32_bf16 a[20:23], a[196:199], v[196:199], 0
 v_exp_f32 v154, v162
 v_mfma_f32_16x16x32_bf16 a[24:27], a[196:199], v[200:203], 0
 ds_read_b64_tr_b16 a[212:213], v15 offset:128
 ds_read_b64_tr_b16 a[214:215], v15 offset:6272
 v_mfma_f32_16x16x32_bf16 a[28:31], a[196:199], v[204:207], 0
 v_add_f32 v148, v152, v153
 s_waitcnt lgkmcnt(4)
 v_mfma_f32_16x16x32_bf16 a[32:35], a[200:203], v[192:195], 0
 v_cvt_pk_bf16_f32 v208, v152, v153
 ds_read_b64_tr_b16 a[216:217], v16 offset:128
 v_mfma_f32_16x16x32_bf16 a[36:39], a[200:203], v[196:199], 0
 v_exp_f32 v155, v163
 v_mfma_f32_16x16x32_bf16 a[40:43], a[200:203], v[200:203], 0
 ds_read_b64_tr_b16 a[218:219], v16 offset:6272
 v_add_f32 v148, v148, v154
 v_mfma_f32_16x16x32_bf16 a[44:47], a[200:203], v[204:207], 0
 v_exp_f32 v156, v164
 v_mfma_f32_16x16x32_bf16 a[48:51], a[204:207], v[192:195], 0
 ds_read_b64_tr_b16 a[220:221], v17 offset:128
 v_add_f32 v148, v148, v155
 v_mfma_f32_16x16x32_bf16 a[52:55], a[204:207], v[196:199], 0
 v_cvt_pk_bf16_f32 v209, v154, v155
 ds_read_b64_tr_b16 a[222:223], v17 offset:6272
 v_mfma_f32_16x16x32_bf16 a[56:59], a[204:207], v[200:203], 0
 v_exp_f32 v157, v165
 v_mfma_f32_16x16x32_bf16 a[60:63], a[204:207], v[204:207], 0
 v_add_f32 v148, v148, v156
 s_waitcnt lgkmcnt(4)
 v_mfma_f32_16x16x32_bf16 a[64:67], a[208:211], v[192:195], 0
 ds_read_b64_tr_b16 a[224:225], v14 offset:256
 v_add_f32 v148, v148, v157
 v_mfma_f32_16x16x32_bf16 a[68:71], a[208:211], v[196:199], 0
 v_exp_f32 v152, v166
 v_mfma_f32_16x16x32_bf16 a[72:75], a[208:211], v[200:203], 0
 ds_read_b64_tr_b16 a[226:227], v14 offset:6400
 v_cvt_pk_bf16_f32 v210, v156, v157
 v_mfma_f32_16x16x32_bf16 a[76:79], a[208:211], v[204:207], 0
 v_exp_f32 v153, v167
 v_mfma_f32_16x16x32_bf16 a[80:83], a[212:215], v[192:195], 0
 ds_read_b64_tr_b16 a[228:229], v15 offset:256
 v_add_f32 v148, v148, v152
 v_mfma_f32_16x16x32_bf16 a[84:87], a[212:215], v[196:199], 0
 ds_read_b64_tr_b16 a[230:231], v15 offset:6400
 v_add_f32 v148, v148, v153
 v_mfma_f32_16x16x32_bf16 a[88:91], a[212:215], v[200:203], 0
 v_exp_f32 v154, v168
 v_mfma_f32_16x16x32_bf16 a[92:95], a[212:215], v[204:207], 0
 v_cvt_pk_bf16_f32 v211, v152, v153
 s_waitcnt lgkmcnt(4)
 v_mfma_f32_16x16x32_bf16 a[96:99], a[216:219], v[192:195], 0
 buffer_load_dwordx4 v2, s[28:31], s76 offen offset:1024 nt lds
 v_mfma_f32_16x16x32_bf16 a[100:103], a[216:219], v[196:199], 0
 v_exp_f32 v155, v169
 v_mfma_f32_16x16x32_bf16 a[104:107], a[216:219], v[200:203], 0
 v_add_f32 v145, v145, v149
 ds_read_b64_tr_b16 a[232:233], v16 offset:256
 v_mfma_f32_16x16x32_bf16 a[108:111], a[216:219], v[204:207], 0
 ds_read_b64_tr_b16 a[234:235], v16 offset:6400
 v_add_f32 v149, v154, v155
 v_mfma_f32_16x16x32_bf16 a[112:115], a[220:223], v[192:195], 0
 v_exp_f32 v156, v170
 v_mfma_f32_16x16x32_bf16 a[116:119], a[220:223], v[196:199], 0
 ds_read_b64_tr_b16 a[236:237], v17 offset:256
 ds_read_b64_tr_b16 a[238:239], v17 offset:6400
 v_mfma_f32_16x16x32_bf16 a[120:123], a[220:223], v[200:203], 0
 v_cvt_pk_bf16_f32 v212, v154, v155
 ds_read_b128 a[240:243], v12 offset:0
 v_mfma_f32_16x16x32_bf16 a[124:127], a[220:223], v[204:207], 0
 v_add_f32 v149, v149, v156
 s_waitcnt lgkmcnt(5)
 v_mfma_f32_16x16x32_bf16 a[128:131], a[224:227], v[192:195], 0
 v_exp_f32 v157, v171
 v_mfma_f32_16x16x32_bf16 a[132:135], a[224:227], v[196:199], 0
 ds_read_b128 a[244:247], v13 offset:0
 v_add_f32 v149, v149, v157
 v_mfma_f32_16x16x32_bf16 a[136:139], a[224:227], v[200:203], 0
 v_exp_f32 v152, v172
 v_mfma_f32_16x16x32_bf16 a[140:143], a[224:227], v[204:207], 0
 ds_read_b128 a[248:251], v12 offset:128
 v_cvt_pk_bf16_f32 v213, v156, v157
 v_mfma_f32_16x16x32_bf16 a[144:147], a[228:231], v[192:195], 0
 v_exp_f32 v153, v173
 v_mfma_f32_16x16x32_bf16 a[148:151], a[228:231], v[196:199], 0
 ds_read_b128 a[252:255], v13 offset:128
 v_add_f32 v149, v149, v152
 v_mfma_f32_16x16x32_bf16 a[152:155], a[228:231], v[200:203], 0
 ds_read_b128 a[192:195], v12 offset:256
 v_add_f32 v149, v149, v153
 v_mfma_f32_16x16x32_bf16 a[156:159], a[228:231], v[204:207], 0
 v_cvt_pk_bf16_f32 v214, v152, v153
 s_waitcnt lgkmcnt(5)
 v_mfma_f32_16x16x32_bf16 a[160:163], a[232:235], v[192:195], 0
 v_exp_f32 v154, v174
 v_mfma_f32_16x16x32_bf16 a[164:167], a[232:235], v[196:199], 0
 ds_read_b128 a[196:199], v13 offset:256
 v_add_f32 v149, v149, v154
 v_mfma_f32_16x16x32_bf16 a[168:171], a[232:235], v[200:203], 0
 v_exp_f32 v155, v175
 v_mfma_f32_16x16x32_bf16 a[172:175], a[232:235], v[204:207], 0
 v_add_f32 v149, v149, v155
 v_cvt_pk_bf16_f32 v215, v154, v155
 v_mfma_f32_16x16x32_bf16 a[176:179], a[236:239], v[192:195], 0
 v_add_f32 v146, v146, v150
 v_add_f32 v147, v147, v151
 v_mfma_f32_16x16x32_bf16 a[180:183], a[236:239], v[196:199], 0
 v_exp_f32 v156, v176
 v_mfma_f32_16x16x32_bf16 a[184:187], a[236:239], v[200:203], 0
 buffer_load_dwordx4 v3, s[28:31], s76 offen offset:2048 nt lds
 v_mfma_f32_16x16x32_bf16 a[188:191], a[236:239], v[204:207], 0
 s_waitcnt lgkmcnt(3)
 v_mfma_f32_16x16x32_bf16 v[224:227], a[240:243], v[32:35], v[128:131]
 v_exp_f32 v157, v177
 v_mfma_f32_16x16x32_bf16 v[224:227], a[244:247], v[48:51], v[224:227]
 ds_read_b128 a[200:203], v12 offset:6144
 v_add_f32 v150, v156, v157
 v_mfma_f32_16x16x32_bf16 v[224:227], a[248:251], v[64:67], v[224:227]
 ds_read_b128 a[204:207], v13 offset:6144
 s_waitcnt lgkmcnt(2)
 v_mfma_f32_16x16x32_bf16 v[224:227], a[252:255], v[80:83], v[224:227]
 v_exp_f32 v152, v178
 v_mfma_f32_16x16x32_bf16 v[224:227], a[192:195], v[96:99], v[224:227]
 v_cvt_pk_bf16_f32 v216, v156, v157
 v_add_f32 v150, v150, v152
 v_mfma_f32_16x16x32_bf16 v[224:227], a[196:199], v[112:115], v[224:227]
 ds_read_b128 a[208:211], v12 offset:6272
 v_mfma_f32_16x16x32_bf16 v[232:235], a[240:243], v[36:39], v[132:135]
 v_exp_f32 v153, v179
 v_mfma_f32_16x16x32_bf16 v[232:235], a[244:247], v[52:55], v[232:235]
 v_add_f32 v150, v150, v153
 v_cvt_pk_bf16_f32 v217, v152, v153
 v_mfma_f32_16x16x32_bf16 v[232:235], a[248:251], v[68:71], v[232:235]
 v_exp_f32 v154, v180
 v_mfma_f32_16x16x32_bf16 v[232:235], a[252:255], v[84:87], v[232:235]
 ds_read_b128 a[212:215], v13 offset:6272
 v_add_f32 v150, v150, v154
 v_mfma_f32_16x16x32_bf16 v[232:235], a[192:195], v[100:103], v[232:235]
 v_mfma_f32_16x16x32_bf16 v[232:235], a[196:199], v[116:119], v[232:235]
 v_exp_f32 v155, v181
 v_mfma_f32_16x16x32_bf16 v[240:243], a[240:243], v[40:43], v[136:139]
 ds_read_b128 a[216:219], v12 offset:6400
 v_add_f32 v150, v150, v155
 v_mfma_f32_16x16x32_bf16 v[240:243], a[244:247], v[56:59], v[240:243]
 v_cvt_pk_bf16_f32 v218, v154, v155
 v_mfma_f32_16x16x32_bf16 v[240:243], a[248:251], v[72:75], v[240:243]
 v_exp_f32 v156, v182
 v_mfma_f32_16x16x32_bf16 v[240:243], a[252:255], v[88:91], v[240:243]
 ds_read_b128 a[220:223], v13 offset:6400
 v_add_f32 v150, v150, v156
 v_mfma_f32_16x16x32_bf16 v[240:243], a[192:195], v[104:107], v[240:243]
 s_add_u32 m0, s80, 61440
 s_mov_b32 s76, 86016
 v_mfma_f32_16x16x32_bf16 v[240:243], a[196:199], v[120:123], v[240:243]
 v_exp_f32 v157, v183
 v_mfma_f32_16x16x32_bf16 v[248:251], a[240:243], v[44:47], v[140:143]
 v_add_f32 v150, v150, v157
 v_cvt_pk_bf16_f32 v219, v156, v157
 v_mfma_f32_16x16x32_bf16 v[248:251], a[244:247], v[60:63], v[248:251]
 v_max3_f32 v158, v148, v149, v150
 v_mfma_f32_16x16x32_bf16 v[248:251], a[248:251], v[76:79], v[248:251]
 v_exp_f32 v152, v184
 v_mfma_f32_16x16x32_bf16 v[248:251], a[252:255], v[92:95], v[248:251]
 buffer_load_dwordx4 v1, s[28:31], s76 offen offset:0 nt lds
 v_mfma_f32_16x16x32_bf16 v[248:251], a[192:195], v[108:111], v[248:251]
 v_mfma_f32_16x16x32_bf16 v[248:251], a[196:199], v[124:127], v[248:251]
 s_waitcnt lgkmcnt(3)
 v_mfma_f32_16x16x32_bf16 v[228:231], a[200:203], v[32:35], v[128:131]
 v_exp_f32 v153, v185
 v_mfma_f32_16x16x32_bf16 v[228:231], a[204:207], v[48:51], v[228:231]
 v_exp_f32 v154, v186
 v_mfma_f32_16x16x32_bf16 v[228:231], a[208:211], v[64:67], v[228:231]
 v_add_f32 v151, v152, v153
 s_waitcnt lgkmcnt(0)
 v_mfma_f32_16x16x32_bf16 v[228:231], a[212:215], v[80:83], v[228:231]
 v_cvt_pk_bf16_f32 v220, v152, v153
 v_add_f32 v151, v151, v154
 v_mfma_f32_16x16x32_bf16 v[228:231], a[216:219], v[96:99], v[228:231]
 s_barrier
 v_mfma_f32_16x16x32_bf16 v[228:231], a[220:223], v[112:115], v[228:231]
 v_exp_f32 v155, v187
 v_mfma_f32_16x16x32_bf16 v[236:239], a[200:203], v[36:39], v[132:135]
 ds_read_b64_tr_b16 a[224:225], v14 offset:12288
 v_add_f32 v151, v151, v155
 v_mfma_f32_16x16x32_bf16 v[236:239], a[204:207], v[52:55], v[236:239]
 v_exp_f32 v156, v188
 v_mfma_f32_16x16x32_bf16 v[236:239], a[208:211], v[68:71], v[236:239]
 ds_read_b64_tr_b16 a[226:227], v14 offset:18432
 v_cvt_pk_bf16_f32 v221, v154, v155
 v_mfma_f32_16x16x32_bf16 v[236:239], a[212:215], v[84:87], v[236:239]
 ds_read_b64_tr_b16 a[228:229], v15 offset:12288
 v_add_f32 v151, v151, v156
 v_mfma_f32_16x16x32_bf16 v[236:239], a[216:219], v[100:103], v[236:239]
 v_exp_f32 v157, v189
 v_mfma_f32_16x16x32_bf16 v[236:239], a[220:223], v[116:119], v[236:239]
 ds_read_b64_tr_b16 a[230:231], v15 offset:18432
 v_add_f32 v151, v151, v157
 v_mfma_f32_16x16x32_bf16 v[244:247], a[200:203], v[40:43], v[136:139]
 v_cvt_pk_bf16_f32 v222, v156, v157
 v_mfma_f32_16x16x32_bf16 v[244:247], a[204:207], v[56:59], v[244:247]
 v_exp_f32 v152, v190
 v_mfma_f32_16x16x32_bf16 v[244:247], a[208:211], v[72:75], v[244:247]
 ds_read_b64_tr_b16 a[232:233], v16 offset:12288
 v_add_f32 v151, v151, v152
 v_mfma_f32_16x16x32_bf16 v[244:247], a[212:215], v[88:91], v[244:247]
 v_mfma_f32_16x16x32_bf16 v[244:247], a[216:219], v[104:107], v[244:247]
 v_exp_f32 v153, v191
 v_mfma_f32_16x16x32_bf16 v[244:247], a[220:223], v[120:123], v[244:247]
 ds_read_b64_tr_b16 a[234:235], v16 offset:18432
 v_add_f32 v151, v151, v153
 v_mfma_f32_16x16x32_bf16 v[252:255], a[200:203], v[44:47], v[140:143]
 ds_read_b64_tr_b16 a[236:237], v17 offset:12288
 v_cvt_pk_bf16_f32 v223, v152, v153
 v_mfma_f32_16x16x32_bf16 v[252:255], a[204:207], v[60:63], v[252:255]
 buffer_load_dwordx4 v2, s[28:31], s76 offen offset:1024 nt lds
 v_mfma_f32_16x16x32_bf16 v[252:255], a[208:211], v[76:79], v[252:255]
 ds_read_b64_tr_b16 a[238:239], v17 offset:18432
 v_max_f32 v158, v158, v151
 v_mfma_f32_16x16x32_bf16 v[252:255], a[212:215], v[92:95], v[252:255]
 v_cmp_lt_f32 vcc, s72, v158
 v_mfma_f32_16x16x32_bf16 v[252:255], a[216:219], v[108:111], v[252:255]
 v_mfma_f32_16x16x32_bf16 v[252:255], a[220:223], v[124:127], v[252:255]
 s_cbranch_vccnz L_S_0
L_R_0:
 s_waitcnt lgkmcnt(4)
 v_mfma_f32_16x16x32_bf16 a[0:3], a[224:227], v[208:211], a[0:3]
 v_exp_f32 v152, v224
 v_mfma_f32_16x16x32_bf16 a[4:7], a[224:227], v[212:215], a[4:7]
 ds_read_b64_tr_b16 a[240:241], v14 offset:12416
 v_add_f32 v144, v144, v148
 v_mfma_f32_16x16x32_bf16 a[8:11], a[224:227], v[216:219], a[8:11]
 v_exp_f32 v153, v225
 v_mfma_f32_16x16x32_bf16 a[12:15], a[224:227], v[220:223], a[12:15]
 ds_read_b64_tr_b16 a[242:243], v14 offset:18560
 v_add_f32 v148, v152, v153
 v_mfma_f32_16x16x32_bf16 a[16:19], a[228:231], v[208:211], a[16:19]
 ds_read_b64_tr_b16 a[244:245], v15 offset:12416
 v_cvt_pk_bf16_f32 v192, v152, v153
 v_mfma_f32_16x16x32_bf16 a[20:23], a[228:231], v[212:215], a[20:23]
 v_exp_f32 v154, v226
 v_mfma_f32_16x16x32_bf16 a[24:27], a[228:231], v[216:219], a[24:27]
 ds_read_b64_tr_b16 a[246:247], v15 offset:18560
 v_add_f32 v148, v148, v154
 v_mfma_f32_16x16x32_bf16 a[28:31], a[228:231], v[220:223], a[28:31]
 v_add_f32 v145, v145, v149
 s_waitcnt lgkmcnt(4)
 v_mfma_f32_16x16x32_bf16 a[32:35], a[232:235], v[208:211], a[32:35]
 v_exp_f32 v155, v227
 v_mfma_f32_16x16x32_bf16 a[36:39], a[232:235], v[212:215], a[36:39]
 ds_read_b64_tr_b16 a[248:249], v16 offset:12416
 ds_read_b64_tr_b16 a[250:251], v16 offset:18560
 v_mfma_f32_16x16x32_bf16 a[40:43], a[232:235], v[216:219], a[40:43]
 v_add_f32 v148, v148, v155
 v_cvt_pk_bf16_f32 v193, v154, v155
 v_mfma_f32_16x16x32_bf16 a[44:47], a[232:235], v[220:223], a[44:47]
 v_exp_f32 v156, v228
 v_mfma_f32_16x16x32_bf16 a[48:51], a[236:239], v[208:211], a[48:51]
 ds_read_b64_tr_b16 a[252:253], v17 offset:12416
 v_add_f32 v148, v148, v156
 v_mfma_f32_16x16x32_bf16 a[52:55], a[236:239], v[212:215], a[52:55]
 ds_read_b64_tr_b16 a[254:255], v17 offset:18560
 v_add_f32 v146, v146, v150
 v_mfma_f32_16x16x32_bf16 a[56:59], a[236:239], v[216:219], a[56:59]
 v_exp_f32 v157, v229
 v_mfma_f32_16x16x32_bf16 a[60:63], a[236:239], v[220:223], a[60:63]
 v_add_f32 v148, v148, v157
 s_waitcnt lgkmcnt(4)
 v_mfma_f32_16x16x32_bf16 a[64:67], a[240:243], v[208:211], a[64:67]
 ds_read_b64_tr_b16 a[192:193], v14 offset:12544
 v_cvt_pk_bf16_f32 v194, v156, v157
 v_mfma_f32_16x16x32_bf16 a[68:71], a[240:243], v[212:215], a[68:71]
 v_exp_f32 v152, v230
 v_mfma_f32_16x16x32_bf16 a[72:75], a[240:243], v[216:219], a[72:75]
 ds_read_b64_tr_b16 a[194:195], v14 offset:18688
 v_add_f32 v148, v148, v152
 v_mfma_f32_16x16x32_bf16 a[76:79], a[240:243], v[220:223], a[76:79]
 v_exp_f32 v153, v231
 v_mfma_f32_16x16x32_bf16 a[80:83], a[244:247], v[208:211], a[80:83]
 buffer_load_dwordx4 v3, s[28:31], s76 offen offset:2048 nt lds
 v_mfma_f32_16x16x32_bf16 a[84:87], a[244:247], v[212:215], a[84:87]
 ds_read_b64_tr_b16 a[196:197], v15 offset:12544
 ds_read_b64_tr_b16 a[198:199], v15 offset:18688
 v_mfma_f32_16x16x32_bf16 a[88:91], a[244:247], v[216:219], a[88:91]
 v_exp_f32 v154, v232
 v_mfma_f32_16x16x32_bf16 a[92:95], a[244:247], v[220:223], a[92:95]
 v_add_f32 v148, v148, v153
 s_waitcnt lgkmcnt(4)
 v_mfma_f32_16x16x32_bf16 a[96:99], a[248:251], v[208:211], a[96:99]
 v_cvt_pk_bf16_f32 v195, v152, v153
 ds_read_b64_tr_b16 a[200:201], v16 offset:12544
 v_mfma_f32_16x16x32_bf16 a[100:103], a[248:251], v[212:215], a[100:103]
 v_exp_f32 v155, v233
 v_mfma_f32_16x16x32_bf16 a[104:107], a[248:251], v[216:219], a[104:107]
 ds_read_b64_tr_b16 a[202:203], v16 offset:18688
 v_add_f32 v149, v154, v155
 v_mfma_f32_16x16x32_bf16 a[108:111], a[248:251], v[220:223], a[108:111]
 v_cvt_pk_bf16_f32 v196, v154, v155
 v_add_f32 v147, v147, v151
 v_mfma_f32_16x16x32_bf16 a[112:115], a[252:255], v[208:211], a[112:115]
 v_exp_f32 v156, v234
 v_mfma_f32_16x16x32_bf16 a[116:119], a[252:255], v[212:215], a[116:119]
 ds_read_b64_tr_b16 a[204:205], v17 offset:12544
 ds_read_b64_tr_b16 a[206:207], v17 offset:18688
 v_mfma_f32_16x16x32_bf16 a[120:123], a[252:255], v[216:219], a[120:123]
 ds_read_b128 a[208:211], v12 offset:12288
 v_add_f32 v149, v149, v156
 v_mfma_f32_16x16x32_bf16 a[124:127], a[252:255], v[220:223], a[124:127]
 s_waitcnt lgkmcnt(5)
 v_mfma_f32_16x16x32_bf16 a[128:131], a[192:195], v[208:211], a[128:131]
 v_exp_f32 v157, v235
 v_mfma_f32_16x16x32_bf16 a[132:135], a[192:195], v[212:215], a[132:135]
 ds_read_b128 a[212:215], v13 offset:12288
 v_add_f32 v149, v149, v157
 v_mfma_f32_16x16x32_bf16 a[136:139], a[192:195], v[216:219], a[136:139]
 v_exp_f32 v152, v236
 v_mfma_f32_16x16x32_bf16 a[140:143], a[192:195], v[220:223], a[140:143]
 ds_read_b128 a[216:219], v12 offset:12416
 v_cvt_pk_bf16_f32 v197, v156, v157
 v_mfma_f32_16x16x32_bf16 a[144:147], a[196:199], v[208:211], a[144:147]
 v_exp_f32 v153, v237
 v_mfma_f32_16x16x32_bf16 a[148:151], a[196:199], v[212:215], a[148:151]
 ds_read_b128 a[220:223], v13 offset:12416
 v_add_f32 v149, v149, v152
 v_mfma_f32_16x16x32_bf16 a[152:155], a[196:199], v[216:219], a[152:155]
 s_add_u32 m0, s80, 0
 s_mov_b32 s76, 98304
 v_mfma_f32_16x16x32_bf16 a[156:159], a[196:199], v[220:223], a[156:159]
 ds_read_b128 a[224:227], v12 offset:12544
 s_waitcnt lgkmcnt(5)
 v_mfma_f32_16x16x32_bf16 a[160:163], a[200:203], v[208:211], a[160:163]
 v_exp_f32 v154, v238
 v_mfma_f32_16x16x32_bf16 a[164:167], a[200:203], v[212:215], a[164:167]
 ds_read_b128 a[228:231], v13 offset:12544
 v_add_f32 v149, v149, v153
 v_mfma_f32_16x16x32_bf16 a[168:171], a[200:203], v[216:219], a[168:171]
 buffer_load_dwordx4 v1, s[28:31], s76 offen offset:0 nt lds
 v_mfma_f32_16x16x32_bf16 a[172:175], a[200:203], v[220:223], a[172:175]
 v_cvt_pk_bf16_f32 v198, v152, v153
 v_exp_f32 v155, v239
 v_mfma_f32_16x16x32_bf16 a[176:179], a[204:207], v[208:211], a[176:179]
 v_add_f32 v149, v149, v154
 v_add_f32 v149, v149, v155
 v_mfma_f32_16x16x32_bf16 a[180:183], a[204:207], v[212:215], a[180:183]
 v_exp_f32 v156, v240
 v_mfma_f32_16x16x32_bf16 a[184:187], a[204:207], v[216:219], a[184:187]
 v_cvt_pk_bf16_f32 v199, v154, v155
 v_mfma_f32_16x16x32_bf16 a[188:191], a[204:207], v[220:223], a[188:191]
 s_waitcnt lgkmcnt(3)
 v_mfma_f32_16x16x32_bf16 v[160:163], a[208:211], v[32:35], v[128:131]
 v_exp_f32 v157, v241
 v_mfma_f32_16x16x32_bf16 v[160:163], a[212:215], v[48:51], v[160:163]
 ds_read_b128 a[232:235], v12 offset:18432
 v_add_f32 v150, v156, v157
 v_mfma_f32_16x16x32_bf16 v[160:163], a[216:219], v[64:67], v[160:163]
 ds_read_b128 a[236:239], v13 offset:18432
 s_waitcnt lgkmcnt(2)
 v_mfma_f32_16x16x32_bf16 v[160:163], a[220:223], v[80:83], v[160:163]
 v_exp_f32 v152, v242
 v_mfma_f32_16x16x32_bf16 v[160:163], a[224:227], v[96:99], v[160:163]
 v_cvt_pk_bf16_f32 v200, v156, v157
 v_add_f32 v150, v150, v152
 v_mfma_f32_16x16x32_bf16 v[160:163], a[228:231], v[112:115], v[160:163]
 ds_read_b128 a[240:243], v12 offset:18560
 v_mfma_f32_16x16x32_bf16 v[168:171], a[208:211], v[36:39], v[132:135]
 v_exp_f32 v153, v243
 v_mfma_f32_16x16x32_bf16 v[168:171], a[212:215], v[52:55], v[168:171]
 v_add_f32 v150, v150, v153
 v_cvt_pk_bf16_f32 v201, v152, v153
 v_mfma_f32_16x16x32_bf16 v[168:171], a[216:219], v[68:71], v[168:171]
 v_exp_f32 v154, v244
 v_mfma_f32_16x16x32_bf16 v[168:171], a[220:223], v[84:87], v[168:171]
 ds_read_b128 a[244:247], v13 offset:18560
 v_add_f32 v150, v150, v154
 v_mfma_f32_16x16x32_bf16 v[168:171], a[224:227], v[100:103], v[168:171]
 v_mfma_f32_16x16x32_bf16 v[168:171], a[228:231], v[116:119], v[168:171]
 v_exp_f32 v155, v245
 v_mfma_f32_16x16x32_bf16 v[176:179], a[208:211], v[40:43], v[136:139]
 ds_read_b128 a[248:251], v12 offset:18688
 v_add_f32 v150, v150, v155
 v_mfma_f32_16x16x32_bf16 v[176:179], a[212:215], v[56:59], v[176:179]
 v_cvt_pk_bf16_f32 v202, v154, v155
 v_mfma_f32_16x16x32_bf16 v[176:179], a[216:219], v[72:75], v[176:179]
 v_exp_f32 v156, v246
 v_mfma_f32_16x16x32_bf16 v[176:179], a[220:223], v[88:91], v[176:179]
 ds_read_b128 a[252:255], v13 offset:18688
 v_add_f32 v150, v150, v156
 v_mfma_f32_16x16x32_bf16 v[176:179], a[224:227], v[104:107], v[176:179]
 buffer_load_dwordx4 v2, s[28:31], s76 offen offset:1024 nt lds
 v_mfma_f32_16x16x32_bf16 v[176:179], a[228:231], v[120:123], v[176:179]
 v_exp_f32 v157, v247
 v_mfma_f32_16x16x32_bf16 v[184:187], a[208:211], v[44:47], v[140:143]
 v_add_f32 v150, v150, v157
 v_cvt_pk_bf16_f32 v203, v156, v157
 v_mfma_f32_16x16x32_bf16 v[184:187], a[212:215], v[60:63], v[184:187]
 v_max3_f32 v158, v148, v149, v150
 v_mfma_f32_16x16x32_bf16 v[184:187], a[216:219], v[76:79], v[184:187]
 v_exp_f32 v152, v248
 v_mfma_f32_16x16x32_bf16 v[184:187], a[220:223], v[92:95], v[184:187]
 v_mfma_f32_16x16x32_bf16 v[184:187], a[224:227], v[108:111], v[184:187]
 v_mfma_f32_16x16x32_bf16 v[184:187], a[228:231], v[124:127], v[184:187]
 s_waitcnt lgkmcnt(3)
 v_mfma_f32_16x16x32_bf16 v[164:167], a[232:235], v[32:35], v[128:131]
 v_exp_f32 v153, v249
 v_mfma_f32_16x16x32_bf16 v[164:167], a[236:239], v[48:51], v[164:167]
 v_exp_f32 v154, v250
 v_mfma_f32_16x16x32_bf16 v[164:167], a[240:243], v[64:67], v[164:167]
 v_add_f32 v151, v152, v153
 s_waitcnt lgkmcnt(0)
 v_mfma_f32_16x16x32_bf16 v[164:167], a[244:247], v[80:83], v[164:167]
 v_cvt_pk_bf16_f32 v204, v152, v153
 v_add_f32 v151, v151, v154
 v_mfma_f32_16x16x32_bf16 v[164:167], a[248:251], v[96:99], v[164:167]
 s_waitcnt vmcnt(17)
 s_barrier
 v_mfma_f32_16x16x32_bf16 v[164:167], a[252:255], v[112:115], v[164:167]
 v_exp_f32 v155, v251
 v_mfma_f32_16x16x32_bf16 v[172:175], a[232:235], v[36:39], v[132:135]
 ds_read_b64_tr_b16 a[192:193], v14 offset:24576
 v_add_f32 v151, v151, v155
 v_mfma_f32_16x16x32_bf16 v[172:175], a[236:239], v[52:55], v[172:175]
 v_exp_f32 v156, v252
 v_mfma_f32_16x16x32_bf16 v[172:175], a[240:243], v[68:71], v[172:175]
 ds_read_b64_tr_b16 a[194:195], v14 offset:30720
 v_cvt_pk_bf16_f32 v205, v154, v155
 v_mfma_f32_16x16x32_bf16 v[172:175], a[244:247], v[84:87], v[172:175]
 ds_read_b64_tr_b16 a[196:197], v15 offset:24576
 v_add_f32 v151, v151, v156
 v_mfma_f32_16x16x32_bf16 v[172:175], a[248:251], v[100:103], v[172:175]
 v_exp_f32 v157, v253
 v_mfma_f32_16x16x32_bf16 v[172:175], a[252:255], v[116:119], v[172:175]
 ds_read_b64_tr_b16 a[198:199], v15 offset:30720
 v_add_f32 v151, v151, v157
 v_mfma_f32_16x16x32_bf16 v[180:183], a[232:235], v[40:43], v[136:139]
 v_cvt_pk_bf16_f32 v206, v156, v157
 v_mfma_f32_16x16x32_bf16 v[180:183], a[236:239], v[56:59], v[180:183]
 v_exp_f32 v152, v254
 v_mfma_f32_16x16x32_bf16 v[180:183], a[240:243], v[72:75], v[180:183]
 buffer_load_dwordx4 v3, s[28:31], s76 offen offset:2048 nt lds
 v_mfma_f32_16x16x32_bf16 v[180:183], a[244:247], v[88:91], v[180:183]
 ds_read_b64_tr_b16 a[200:201], v16 offset:24576
 v_add_f32 v151, v151, v152
 v_mfma_f32_16x16x32_bf16 v[180:183], a[248:251], v[104:107], v[180:183]
 v_exp_f32 v153, v255
 v_mfma_f32_16x16x32_bf16 v[180:183], a[252:255], v[120:123], v[180:183]
 ds_read_b64_tr_b16 a[202:203], v16 offset:30720
 v_add_f32 v151, v151, v153
 v_mfma_f32_16x16x32_bf16 v[188:191], a[232:235], v[44:47], v[140:143]
 ds_read_b64_tr_b16 a[204:205], v17 offset:24576
 v_cvt_pk_bf16_f32 v207, v152, v153
 v_mfma_f32_16x16x32_bf16 v[188:191], a[236:239], v[60:63], v[188:191]
 v_mfma_f32_16x16x32_bf16 v[188:191], a[240:243], v[76:79], v[188:191]
 ds_read_b64_tr_b16 a[206:207], v17 offset:30720
 v_max_f32 v158, v158, v151
 v_mfma_f32_16x16x32_bf16 v[188:191], a[244:247], v[92:95], v[188:191]
 v_cmp_lt_f32 vcc, s72, v158
 v_mfma_f32_16x16x32_bf16 v[188:191], a[248:251], v[108:111], v[188:191]
 v_mfma_f32_16x16x32_bf16 v[188:191], a[252:255], v[124:127], v[188:191]
 s_cbranch_vccnz L_S_1
L_R_1:
 s_waitcnt lgkmcnt(4)
 v_mfma_f32_16x16x32_bf16 a[0:3], a[192:195], v[192:195], a[0:3]
 v_exp_f32 v152, v160
 v_mfma_f32_16x16x32_bf16 a[4:7], a[192:195], v[196:199], a[4:7]
 ds_read_b64_tr_b16 a[208:209], v14 offset:24704
 v_add_f32 v144, v144, v148
 v_mfma_f32_16x16x32_bf16 a[8:11], a[192:195], v[200:203], a[8:11]
 v_exp_f32 v153, v161
 v_mfma_f32_16x16x32_bf16 a[12:15], a[192:195], v[204:207], a[12:15]
 ds_read_b64_tr_b16 a[210:211], v14 offset:30848
 v_add_f32 v148, v152, v153
 v_mfma_f32_16x16x32_bf16 a[16:19], a[196:199], v[192:195], a[16:19]
 ds_read_b64_tr_b16 a[212:213], v15 offset:24704
 v_cvt_pk_bf16_f32 v208, v152, v153
 v_mfma_f32_16x16x32_bf16 a[20:23], a[196:199], v[196:199], a[20:23]
 v_exp_f32 v154, v162
 v_mfma_f32_16x16x32_bf16 a[24:27], a[196:199], v[200:203], a[24:27]
 ds_read_b64_tr_b16 a[214:215], v15 offset:30848
 v_add_f32 v148, v148, v154
 v_mfma_f32_16x16x32_bf16 a[28:31], a[196:199], v[204:207], a[28:31]
 v_add_f32 v145, v145, v149
 s_waitcnt lgkmcnt(4)
 v_mfma_f32_16x16x32_bf16 a[32:35], a[200:203], v[192:195], a[32:35]
 v_exp_f32 v155, v163
 v_mfma_f32_16x16x32_bf16 a[36:39], a[200:203], v[196:199], a[36:39]
 ds_read_b64_tr_b16 a[216:217], v16 offset:24704
 ds_read_b64_tr_b16 a[218:219], v16 offset:30848
 v_mfma_f32_16x16x32_bf16 a[40:43], a[200:203], v[200:203], a[40:43]
 s_add_u32 m0, s80, 73728
 s_mov_b32 s76, 86016
 v_mfma_f32_16x16x32_bf16 a[44:47], a[200:203], v[204:207], a[44:47]
 v_exp_f32 v156, v164
 v_mfma_f32_16x16x32_bf16 a[48:51], a[204:207], v[192:195], a[48:51]
 buffer_load_dwordx4 v4, s[32:35], s76 offen offset:0 nt lds
 v_mfma_f32_16x16x32_bf16 a[52:55], a[204:207], v[196:199], a[52:55]
 ds_read_b64_tr_b16 a[220:221], v17 offset:24704
 v_add_f32 v148, v148, v155
 v_mfma_f32_16x16x32_bf16 a[56:59], a[204:207], v[200:203], a[56:59]
 v_cvt_pk_bf16_f32 v209, v154, v155
 ds_read_b64_tr_b16 a[222:223], v17 offset:30848
 v_mfma_f32_16x16x32_bf16 a[60:63], a[204:207], v[204:207], a[60:63]
 v_exp_f32 v157, v165
 s_waitcnt lgkmcnt(4)
 v_mfma_f32_16x16x32_bf16 a[64:67], a[208:211], v[192:195], a[64:67]
 v_add_f32 v148, v148, v156
 ds_read_b64_tr_b16 a[224:225], v14 offset:24832
 v_mfma_f32_16x16x32_bf16 a[68:71], a[208:211], v[196:199], a[68:71]
 v_exp_f32 v152, v166
 v_mfma_f32_16x16x32_bf16 a[72:75], a[208:211], v[200:203], a[72:75]
 ds_read_b64_tr_b16 a[226:227], v14 offset:30976
 v_add_f32 v148, v148, v157
 v_mfma_f32_16x16x32_bf16 a[76:79], a[208:211], v[204:207], a[76:79]
 v_exp_f32 v153, v167
 v_mfma_f32_16x16x32_bf16 a[80:83], a[212:215], v[192:195], a[80:83]
 v_cvt_pk_bf16_f32 v210, v156, v157
 ds_read_b64_tr_b16 a[228:229], v15 offset:24832
 v_mfma_f32_16x16x32_bf16 a[84:87], a[212:215], v[196:199], a[84:87]
 ds_read_b64_tr_b16 a[230:231], v15 offset:30976
 v_add_f32 v148, v148, v152
 v_mfma_f32_16x16x32_bf16 a[88:91], a[212:215], v[200:203], a[88:91]
 v_exp_f32 v154, v168
 v_mfma_f32_16x16x32_bf16 a[92:95], a[212:215], v[204:207], a[92:95]
 v_add_f32 v148, v148, v153
 s_waitcnt lgkmcnt(4)
 v_mfma_f32_16x16x32_bf16 a[96:99], a[216:219], v[192:195], a[96:99]
 v_cvt_pk_bf16_f32 v211, v152, v153
 ds_read_b64_tr_b16 a[232:233], v16 offset:24832
 v_mfma_f32_16x16x32_bf16 a[100:103], a[216:219], v[196:199], a[100:103]
 v_exp_f32 v155, v169
 v_mfma_f32_16x16x32_bf16 a[104:107], a[216:219], v[200:203], a[104:107]
 ds_read_b64_tr_b16 a[234:235], v16 offset:30976
 v_add_f32 v149, v154, v155
 v_mfma_f32_16x16x32_bf16 a[108:111], a[216:219], v[204:207], a[108:111]
 v_cvt_pk_bf16_f32 v212, v154, v155
 v_add_f32 v146, v146, v150
 v_mfma_f32_16x16x32_bf16 a[112:115], a[220:223], v[192:195], a[112:115]
 v_exp_f32 v156, v170
 v_mfma_f32_16x16x32_bf16 a[116:119], a[220:223], v[196:199], a[116:119]
 ds_read_b64_tr_b16 a[236:237], v17 offset:24832
 ds_read_b64_tr_b16 a[238:239], v17 offset:30976
 v_mfma_f32_16x16x32_bf16 a[120:123], a[220:223], v[200:203], a[120:123]
 ds_read_b128 a[240:243], v12 offset:24576
 v_add_f32 v149, v149, v156
 v_mfma_f32_16x16x32_bf16 a[124:127], a[220:223], v[204:207], a[124:127]
 v_add_f32 v147, v147, v151
 s_waitcnt lgkmcnt(5)
 v_mfma_f32_16x16x32_bf16 a[128:131], a[224:227], v[192:195], a[128:131]
 v_exp_f32 v157, v171
 v_mfma_f32_16x16x32_bf16 a[132:135], a[224:227], v[196:199], a[132:135]
 ds_read_b128 a[244:247], v13 offset:24576
 v_add_f32 v149, v149, v157
 v_mfma_f32_16x16x32_bf16 a[136:139], a[224:227], v[200:203], a[136:139]
 v_exp_f32 v152, v172
 v_mfma_f32_16x16x32_bf16 a[140:143], a[224:227], v[204:207], a[140:143]
 buffer_load_dwordx4 v5, s[32:35], s76 offen offset:1024 nt lds
 v_mfma_f32_16x16x32_bf16 a[144:147], a[228:231], v[192:195], a[144:147]
 ds_read_b128 a[248:251], v12 offset:24704
 v_cvt_pk_bf16_f32 v213, v156, v157
 v_mfma_f32_16x16x32_bf16 a[148:151], a[228:231], v[196:199], a[148:151]
 v_exp_f32 v153, v173
 v_mfma_f32_16x16x32_bf16 a[152:155], a[228:231], v[200:203], a[152:155]
 ds_read_b128 a[252:255], v13 offset:24704
 ds_read_b128 a[192:195], v12 offset:24832
 v_mfma_f32_16x16x32_bf16 a[156:159], a[228:231], v[204:207], a[156:159]
 v_add_f32 v149, v149, v152
 s_waitcnt lgkmcnt(5)
 v_mfma_f32_16x16x32_bf16 a[160:163], a[232:235], v[192:195], a[160:163]
 v_exp_f32 v154, v174
 v_mfma_f32_16x16x32_bf16 a[164:167], a[232:235], v[196:199], a[164:167]
 ds_read_b128 a[196:199], v13 offset:24832
 v_add_f32 v149, v149, v153
 v_mfma_f32_16x16x32_bf16 a[168:171], a[232:235], v[200:203], a[168:171]
 v_cvt_pk_bf16_f32 v214, v152, v153
 v_add_f32 v149, v149, v154
 v_mfma_f32_16x16x32_bf16 a[172:175], a[232:235], v[204:207], a[172:175]
 v_exp_f32 v155, v175
 v_mfma_f32_16x16x32_bf16 a[176:179], a[236:239], v[192:195], a[176:179]
 v_add_f32 v149, v149, v155
 v_cvt_pk_bf16_f32 v215, v154, v155
 v_mfma_f32_16x16x32_bf16 a[180:183], a[236:239], v[196:199], a[180:183]
 v_exp_f32 v156, v176
 v_mfma_f32_16x16x32_bf16 a[184:187], a[236:239], v[200:203], a[184:187]
 v_mfma_f32_16x16x32_bf16 a[188:191], a[236:239], v[204:207], a[188:191]
 s_waitcnt lgkmcnt(3)
 v_mfma_f32_16x16x32_bf16 v[224:227], a[240:243], v[32:35], v[128:131]
 v_exp_f32 v157, v177
 v_mfma_f32_16x16x32_bf16 v[224:227], a[244:247], v[48:51], v[224:227]
 ds_read_b128 a[200:203], v12 offset:30720
 v_add_f32 v150, v156, v157
 v_mfma_f32_16x16x32_bf16 v[224:227], a[248:251], v[64:67], v[224:227]
 ds_read_b128 a[204:207], v13 offset:30720
 s_waitcnt lgkmcnt(2)
 v_mfma_f32_16x16x32_bf16 v[224:227], a[252:255], v[80:83], v[224:227]
 v_exp_f32 v152, v178
 v_mfma_f32_16x16x32_bf16 v[224:227], a[192:195], v[96:99], v[224:227]
 v_cvt_pk_bf16_f32 v216, v156, v157
 v_add_f32 v150, v150, v152
 v_mfma_f32_16x16x32_bf16 v[224:227], a[196:199], v[112:115], v[224:227]
 ds_read_b128 a[208:211], v12 offset:30848
 v_mfma_f32_16x16x32_bf16 v[232:235], a[240:243], v[36:39], v[132:135]
 v_exp_f32 v153, v179
 v_mfma_f32_16x16x32_bf16 v[232:235], a[244:247], v[52:55], v[232:235]
 buffer_load_dwordx4 v6, s[32:35], s76 offen offset:2048 nt lds
 v_mfma_f32_16x16x32_bf16 v[232:235], a[248:251], v[68:71], v[232:235]
 v_exp_f32 v154, v180
 v_mfma_f32_16x16x32_bf16 v[232:235], a[252:255], v[84:87], v[232:235]
 ds_read_b128 a[212:215], v13 offset:30848
 v_add_f32 v150, v150, v153
 v_mfma_f32_16x16x32_bf16 v[232:235], a[192:195], v[100:103], v[232:235]
 v_cvt_pk_bf16_f32 v217, v152, v153
 v_add_f32 v150, v150, v154
 v_mfma_f32_16x16x32_bf16 v[232:235], a[196:199], v[116:119], v[232:235]
 v_exp_f32 v155, v181
 v_mfma_f32_16x16x32_bf16 v[240:243], a[240:243], v[40:43], v[136:139]
 ds_read_b128 a[216:219], v12 offset:30976
 v_add_f32 v150, v150, v155
 v_mfma_f32_16x16x32_bf16 v[240:243], a[244:247], v[56:59], v[240:243]
 v_cvt_pk_bf16_f32 v218, v154, v155
 v_mfma_f32_16x16x32_bf16 v[240:243], a[248:251], v[72:75], v[240:243]
 v_exp_f32 v156, v182
 v_mfma_f32_16x16x32_bf16 v[240:243], a[252:255], v[88:91], v[240:243]
 ds_read_b128 a[220:223], v13 offset:30976
 v_add_f32 v150, v150, v156
 v_mfma_f32_16x16x32_bf16 v[240:243], a[192:195], v[104:107], v[240:243]
 v_mfma_f32_16x16x32_bf16 v[240:243], a[196:199], v[120:123], v[240:243]
 v_exp_f32 v157, v183
 v_mfma_f32_16x16x32_bf16 v[248:251], a[240:243], v[44:47], v[140:143]
 v_add_f32 v150, v150, v157
 v_cvt_pk_bf16_f32 v219, v156, v157
 v_mfma_f32_16x16x32_bf16 v[248:251], a[244:247], v[60:63], v[248:251]
 v_add_u32 v12, 36864, v12
 v_add_u32 v13, 36864, v13
 v_mfma_f32_16x16x32_bf16 v[248:251], a[248:251], v[76:79], v[248:251]
 v_exp_f32 v152, v184
 v_mfma_f32_16x16x32_bf16 v[248:251], a[252:255], v[92:95], v[248:251]
 s_add_u32 m0, s80, 12288
 s_mov_b32 s76, 110592
 v_mfma_f32_16x16x32_bf16 v[248:251], a[192:195], v[108:111], v[248:251]
 v_max3_f32 v158, v148, v149, v150
 v_mfma_f32_16x16x32_bf16 v[248:251], a[196:199], v[124:127], v[248:251]
 s_waitcnt lgkmcnt(3)
 v_mfma_f32_16x16x32_bf16 v[228:231], a[200:203], v[32:35], v[128:131]
 v_exp_f32 v153, v185
 v_mfma_f32_16x16x32_bf16 v[228:231], a[204:207], v[48:51], v[228:231]
 v_exp_f32 v154, v186
 v_mfma_f32_16x16x32_bf16 v[228:231], a[208:211], v[64:67], v[228:231]
 v_add_f32 v151, v152, v153
 s_waitcnt lgkmcnt(0)
 v_mfma_f32_16x16x32_bf16 v[228:231], a[212:215], v[80:83], v[228:231]
 v_cvt_pk_bf16_f32 v220, v152, v153
 v_add_f32 v151, v151, v154
 v_mfma_f32_16x16x32_bf16 v[228:231], a[216:219], v[96:99], v[228:231]
 v_exp_f32 v155, v187
 v_mfma_f32_16x16x32_bf16 v[228:231], a[220:223], v[112:115], v[228:231]
 buffer_load_dwordx4 v1, s[28:31], s76 offen offset:0 nt lds
 v_mfma_f32_16x16x32_bf16 v[236:239], a[200:203], v[36:39], v[132:135]
 ds_read_b64_tr_b16 a[224:225], v14 offset:36864
 v_add_f32 v151, v151, v155
 v_mfma_f32_16x16x32_bf16 v[236:239], a[204:207], v[52:55], v[236:239]
 v_exp_f32 v156, v188
 v_mfma_f32_16x16x32_bf16 v[236:239], a[208:211], v[68:71], v[236:239]
 ds_read_b64_tr_b16 a[226:227], v14 offset:43008
 v_cvt_pk_bf16_f32 v221, v154, v155
 v_mfma_f32_16x16x32_bf16 v[236:239], a[212:215], v[84:87], v[236:239]
 ds_read_b64_tr_b16 a[228:229], v15 offset:36864
 v_add_f32 v151, v151, v156
 v_mfma_f32_16x16x32_bf16 v[236:239], a[216:219], v[100:103], v[236:239]
 v_exp_f32 v157, v189
 v_mfma_f32_16x16x32_bf16 v[236:239], a[220:223], v[116:119], v[236:239]
 ds_read_b64_tr_b16 a[230:231], v15 offset:43008
 v_add_f32 v151, v151, v157
 v_mfma_f32_16x16x32_bf16 v[244:247], a[200:203], v[40:43], v[136:139]
 v_cvt_pk_bf16_f32 v222, v156, v157
 v_mfma_f32_16x16x32_bf16 v[244:247], a[204:207], v[56:59], v[244:247]
 v_exp_f32 v152, v190
 v_mfma_f32_16x16x32_bf16 v[244:247], a[208:211], v[72:75], v[244:247]
 ds_read_b64_tr_b16 a[232:233], v16 offset:36864
 v_add_f32 v151, v151, v152
 v_mfma_f32_16x16x32_bf16 v[244:247], a[212:215], v[88:91], v[244:247]
 v_mfma_f32_16x16x32_bf16 v[244:247], a[216:219], v[104:107], v[244:247]
 v_exp_f32 v153, v191
 v_mfma_f32_16x16x32_bf16 v[244:247], a[220:223], v[120:123], v[244:247]
 ds_read_b64_tr_b16 a[234:235], v16 offset:43008
 v_add_f32 v151, v151, v153
 v_mfma_f32_16x16x32_bf16 v[252:255], a[200:203], v[44:47], v[140:143]
 ds_read_b64_tr_b16 a[236:237], v17 offset:36864
 v_cvt_pk_bf16_f32 v223, v152, v153
 v_mfma_f32_16x16x32_bf16 v[252:255], a[204:207], v[60:63], v[252:255]
 v_mfma_f32_16x16x32_bf16 v[252:255], a[208:211], v[76:79], v[252:255]
 ds_read_b64_tr_b16 a[238:239], v17 offset:43008
 v_max_f32 v158, v158, v151
 v_mfma_f32_16x16x32_bf16 v[252:255], a[212:215], v[92:95], v[252:255]
 v_cmp_lt_f32 vcc, s72, v158
 v_mfma_f32_16x16x32_bf16 v[252:255], a[216:219], v[108:111], v[252:255]
 v_mfma_f32_16x16x32_bf16 v[252:255], a[220:223], v[124:127], v[252:255]
 s_cbranch_vccnz L_S_2
L_R_2:
 s_waitcnt lgkmcnt(4)
 v_mfma_f32_16x16x32_bf16 a[0:3], a[224:227], v[208:211], a[0:3]
 v_exp_f32 v152, v224
 v_mfma_f32_16x16x32_bf16 a[4:7], a[224:227], v[212:215], a[4:7]
 ds_read_b64_tr_b16 a[240:241], v14 offset:36992
 v_add_f32 v144, v144, v148
 v_mfma_f32_16x16x32_bf16 a[8:11], a[224:227], v[216:219], a[8:11]
 v_exp_f32 v153, v225
 v_mfma_f32_16x16x32_bf16 a[12:15], a[224:227], v[220:223], a[12:15]
 ds_read_b64_tr_b16 a[242:243], v14 offset:43136
 v_add_f32 v148, v152, v153
 v_mfma_f32_16x16x32_bf16 a[16:19], a[228:231], v[208:211], a[16:19]
 buffer_load_dwordx4 v2, s[28:31], s76 offen offset:1024 nt lds
 v_mfma_f32_16x16x32_bf16 a[20:23], a[228:231], v[212:215], a[20:23]
 v_exp_f32 v154, v226
 v_mfma_f32_16x16x32_bf16 a[24:27], a[228:231], v[216:219], a[24:27]
 ds_read_b64_tr_b16 a[244:245], v15 offset:36992
 ds_read_b64_tr_b16 a[246:247], v15 offset:43136
 v_mfma_f32_16x16x32_bf16 a[28:31], a[228:231], v[220:223], a[28:31]
 v_cvt_pk_bf16_f32 v192, v152, v153
 s_waitcnt lgkmcnt(4)
 v_mfma_f32_16x16x32_bf16 a[32:35], a[232:235], v[208:211], a[32:35]
 v_exp_f32 v155, v227
 v_mfma_f32_16x16x32_bf16 a[36:39], a[232:235], v[212:215], a[36:39]
 ds_read_b64_tr_b16 a[248:249], v16 offset:36992
 ds_read_b64_tr_b16 a[250:251], v16 offset:43136
 v_mfma_f32_16x16x32_bf16 a[40:43], a[232:235], v[216:219], a[40:43]
 v_add_f32 v148, v148, v154
 v_add_f32 v148, v148, v155
 v_mfma_f32_16x16x32_bf16 a[44:47], a[232:235], v[220:223], a[44:47]
 v_exp_f32 v156, v228
 v_mfma_f32_16x16x32_bf16 a[48:51], a[236:239], v[208:211], a[48:51]
 ds_read_b64_tr_b16 a[252:253], v17 offset:36992
 v_cvt_pk_bf16_f32 v193, v154, v155
 v_mfma_f32_16x16x32_bf16 a[52:55], a[236:239], v[212:215], a[52:55]
 ds_read_b64_tr_b16 a[254:255], v17 offset:43136
 v_add_f32 v148, v148, v156
 v_mfma_f32_16x16x32_bf16 a[56:59], a[236:239], v[216:219], a[56:59]
 v_exp_f32 v157, v229
 v_mfma_f32_16x16x32_bf16 a[60:63], a[236:239], v[220:223], a[60:63]
 v_add_f32 v148, v148, v157
 s_waitcnt lgkmcnt(4)
 v_mfma_f32_16x16x32_bf16 a[64:67], a[240:243], v[208:211], a[64:67]
 ds_read_b64_tr_b16 a[192:193], v14 offset:37120
 v_cvt_pk_bf16_f32 v194, v156, v157
 v_mfma_f32_16x16x32_bf16 a[68:71], a[240:243], v[212:215], a[68:71]
 v_exp_f32 v152, v230
 v_mfma_f32_16x16x32_bf16 a[72:75], a[240:243], v[216:219], a[72:75]
 ds_read_b64_tr_b16 a[194:195], v14 offset:43264
 v_add_f32 v148, v148, v152
 v_mfma_f32_16x16x32_bf16 a[76:79], a[240:243], v[220:223], a[76:79]
 v_exp_f32 v153, v231
 v_mfma_f32_16x16x32_bf16 a[80:83], a[244:247], v[208:211], a[80:83]
 ds_read_b64_tr_b16 a[196:197], v15 offset:37120
 v_add_f32 v148, v148, v153
 v_mfma_f32_16x16x32_bf16 a[84:87], a[244:247], v[212:215], a[84:87]
 ds_read_b64_tr_b16 a[198:199], v15 offset:43264
 v_cvt_pk_bf16_f32 v195, v152, v153
 v_mfma_f32_16x16x32_bf16 a[88:91], a[244:247], v[216:219], a[88:91]
 v_exp_f32 v154, v232
 v_mfma_f32_16x16x32_bf16 a[92:95], a[244:247], v[220:223], a[92:95]
 v_add_f32 v145, v145, v149
 s_waitcnt lgkmcnt(4)
 v_mfma_f32_16x16x32_bf16 a[96:99], a[248:251], v[208:211], a[96:99]
 ds_read_b64_tr_b16 a[200:201], v16 offset:37120
 v_add_f32 v146, v146, v150
 v_mfma_f32_16x16x32_bf16 a[100:103], a[248:251], v[212:215], a[100:103]
 v_exp_f32 v155, v233
 v_mfma_f32_16x16x32_bf16 a[104:107], a[248:251], v[216:219], a[104:107]
 buffer_load_dwordx4 v3, s[28:31], s76 offen offset:2048 nt lds
 v_mfma_f32_16x16x32_bf16 a[108:111], a[248:251], v[220:223], a[108:111]
 ds_read_b64_tr_b16 a[202:203], v16 offset:43264
 v_add_f32 v149, v154, v155
 v_mfma_f32_16x16x32_bf16 a[112:115], a[252:255], v[208:211], a[112:115]
 v_exp_f32 v156, v234
 v_mfma_f32_16x16x32_bf16 a[116:119], a[252:255], v[212:215], a[116:119]
 ds_read_b64_tr_b16 a[204:205], v17 offset:37120
 ds_read_b64_tr_b16 a[206:207], v17 offset:43264
 v_mfma_f32_16x16x32_bf16 a[120:123], a[252:255], v[216:219], a[120:123]
 v_cvt_pk_bf16_f32 v196, v154, v155
 ds_read_b128 a[208:211], v12 offset:0
 v_mfma_f32_16x16x32_bf16 a[124:127], a[252:255], v[220:223], a[124:127]
 v_add_f32 v149, v149, v156
 s_waitcnt lgkmcnt(5)
 v_mfma_f32_16x16x32_bf16 a[128:131], a[192:195], v[208:211], a[128:131]
 v_exp_f32 v157, v235
 v_mfma_f32_16x16x32_bf16 a[132:135], a[192:195], v[212:215], a[132:135]
 ds_read_b128 a[212:215], v13 offset:0
 v_add_f32 v149, v149, v157
 v_mfma_f32_16x16x32_bf16 a[136:139], a[192:195], v[216:219], a[136:139]
 v_exp_f32 v152, v236
 v_mfma_f32_16x16x32_bf16 a[140:143], a[192:195], v[220:223], a[140:143]
 ds_read_b128 a[216:219], v12 offset:128
 v_cvt_pk_bf16_f32 v197, v156, v157
 v_mfma_f32_16x16x32_bf16 a[144:147], a[196:199], v[208:211], a[144:147]
 v_exp_f32 v153, v237
 v_mfma_f32_16x16x32_bf16 a[148:151], a[196:199], v[212:215], a[148:151]
 ds_read_b128 a[220:223], v13 offset:128
 v_add_f32 v149, v149, v152
 v_mfma_f32_16x16x32_bf16 a[152:155], a[196:199], v[216:219], a[152:155]
 ds_read_b128 a[224:227], v12 offset:256
 v_add_f32 v149, v149, v153
 v_mfma_f32_16x16x32_bf16 a[156:159], a[196:199], v[220:223], a[156:159]
 v_cvt_pk_bf16_f32 v198, v152, v153
 s_waitcnt lgkmcnt(5)
 v_mfma_f32_16x16x32_bf16 a[160:163], a[200:203], v[208:211], a[160:163]
 v_exp_f32 v154, v238
 v_mfma_f32_16x16x32_bf16 a[164:167], a[200:203], v[212:215], a[164:167]
 ds_read_b128 a[228:231], v13 offset:256
 v_add_f32 v149, v149, v154
 v_mfma_f32_16x16x32_bf16 a[168:171], a[200:203], v[216:219], a[168:171]
 v_exp_f32 v155, v239
 v_mfma_f32_16x16x32_bf16 a[172:175], a[200:203], v[220:223], a[172:175]
 s_add_u32 m0, s80, 86016
 s_mov_b32 s76, 98304
 v_mfma_f32_16x16x32_bf16 a[176:179], a[204:207], v[208:211], a[176:179]
 v_add_f32 v149, v149, v155
 v_cvt_pk_bf16_f32 v199, v154, v155
 v_mfma_f32_16x16x32_bf16 a[180:183], a[204:207], v[212:215], a[180:183]
 v_exp_f32 v156, v240
 v_mfma_f32_16x16x32_bf16 a[184:187], a[204:207], v[216:219], a[184:187]
 buffer_load_dwordx4 v4, s[32:35], s76 offen offset:0 nt lds
 v_mfma_f32_16x16x32_bf16 a[188:191], a[204:207], v[220:223], a[188:191]
 v_add_f32 v147, v147, v151
 s_waitcnt lgkmcnt(3)
 v_mfma_f32_16x16x32_bf16 v[160:163], a[208:211], v[32:35], v[128:131]
 v_exp_f32 v157, v241
 v_mfma_f32_16x16x32_bf16 v[160:163], a[212:215], v[48:51], v[160:163]
 ds_read_b128 a[232:235], v12 offset:6144
 v_add_f32 v150, v156, v157
 v_mfma_f32_16x16x32_bf16 v[160:163], a[216:219], v[64:67], v[160:163]
 ds_read_b128 a[236:239], v13 offset:6144
 s_waitcnt lgkmcnt(2)
 v_mfma_f32_16x16x32_bf16 v[160:163], a[220:223], v[80:83], v[160:163]
 v_exp_f32 v152, v242
 v_mfma_f32_16x16x32_bf16 v[160:163], a[224:227], v[96:99], v[160:163]
 v_cvt_pk_bf16_f32 v200, v156, v157
 v_add_f32 v150, v150, v152
 v_mfma_f32_16x16x32_bf16 v[160:163], a[228:231], v[112:115], v[160:163]
 ds_read_b128 a[240:243], v12 offset:6272
 v_add_u32 v14, 49152, v14
 v_mfma_f32_16x16x32_bf16 v[168:171], a[208:211], v[36:39], v[132:135]
 v_exp_f32 v153, v243
 v_mfma_f32_16x16x32_bf16 v[168:171], a[212:215], v[52:55], v[168:171]
 v_add_f32 v150, v150, v153
 v_cvt_pk_bf16_f32 v201, v152, v153
 v_mfma_f32_16x16x32_bf16 v[168:171], a[216:219], v[68:71], v[168:171]
 v_exp_f32 v154, v244
 v_mfma_f32_16x16x32_bf16 v[168:171], a[220:223], v[84:87], v[168:171]
 ds_read_b128 a[244:247], v13 offset:6272
 v_add_f32 v150, v150, v154
 v_mfma_f32_16x16x32_bf16 v[168:171], a[224:227], v[100:103], v[168:171]
 v_add_u32 v15, 49152, v15
 v_add_u32 v16, 49152, v16
 v_mfma_f32_16x16x32_bf16 v[168:171], a[228:231], v[116:119], v[168:171]
 v_exp_f32 v155, v245
 v_mfma_f32_16x16x32_bf16 v[176:179], a[208:211], v[40:43], v[136:139]
 ds_read_b128 a[248:251], v12 offset:6400
 v_add_f32 v150, v150, v155
 v_mfma_f32_16x16x32_bf16 v[176:179], a[212:215], v[56:59], v[176:179]
 v_cvt_pk_bf16_f32 v202, v154, v155
 v_add_u32 v17, 49152, v17
 v_mfma_f32_16x16x32_bf16 v[176:179], a[216:219], v[72:75], v[176:179]
 v_exp_f32 v156, v246
 v_mfma_f32_16x16x32_bf16 v[176:179], a[220:223], v[88:91], v[176:179]
 ds_read_b128 a[252:255], v13 offset:6400
 v_add_f32 v150, v150, v156
 v_mfma_f32_16x16x32_bf16 v[176:179], a[224:227], v[104:107], v[176:179]
 v_mfma_f32_16x16x32_bf16 v[176:179], a[228:231], v[120:123], v[176:179]
 v_exp_f32 v157, v247
 v_mfma_f32_16x16x32_bf16 v[184:187], a[208:211], v[44:47], v[140:143]
 v_add_f32 v150, v150, v157
 v_cvt_pk_bf16_f32 v203, v156, v157
 v_mfma_f32_16x16x32_bf16 v[184:187], a[212:215], v[60:63], v[184:187]
 v_max3_f32 v158, v148, v149, v150
 v_mfma_f32_16x16x32_bf16 v[184:187], a[216:219], v[76:79], v[184:187]
 v_exp_f32 v152, v248
 v_mfma_f32_16x16x32_bf16 v[184:187], a[220:223], v[92:95], v[184:187]
 buffer_load_dwordx4 v5, s[32:35], s76 offen offset:1024 nt lds
 v_mfma_f32_16x16x32_bf16 v[184:187], a[224:227], v[108:111], v[184:187]
 v_mfma_f32_16x16x32_bf16 v[184:187], a[228:231], v[124:127], v[184:187]
 s_waitcnt lgkmcnt(3)
 v_mfma_f32_16x16x32_bf16 v[164:167], a[232:235], v[32:35], v[128:131]
 v_exp_f32 v153, v249
 v_mfma_f32_16x16x32_bf16 v[164:167], a[236:239], v[48:51], v[164:167]
 v_exp_f32 v154, v250
 v_mfma_f32_16x16x32_bf16 v[164:167], a[240:243], v[64:67], v[164:167]
 v_add_f32 v151, v152, v153
 s_waitcnt lgkmcnt(0)
 v_mfma_f32_16x16x32_bf16 v[164:167], a[244:247], v[80:83], v[164:167]
 v_cvt_pk_bf16_f32 v204, v152, v153
 v_add_f32 v151, v151, v154
 v_mfma_f32_16x16x32_bf16 v[164:167], a[248:251], v[96:99], v[164:167]
 s_waitcnt vmcnt(11)
 s_barrier
 v_mfma_f32_16x16x32_bf16 v[164:167], a[252:255], v[112:115], v[164:167]
 v_exp_f32 v155, v251
 v_mfma_f32_16x16x32_bf16 v[172:175], a[232:235], v[36:39], v[132:135]
 ds_read_b64_tr_b16 a[192:193], v14 offset:0
 v_add_f32 v151, v151, v155
 v_mfma_f32_16x16x32_bf16 v[172:175], a[236:239], v[52:55], v[172:175]
 v_exp_f32 v156, v252
 v_mfma_f32_16x16x32_bf16 v[172:175], a[240:243], v[68:71], v[172:175]
 ds_read_b64_tr_b16 a[194:195], v14 offset:6144
 v_cvt_pk_bf16_f32 v205, v154, v155
 v_mfma_f32_16x16x32_bf16 v[172:175], a[244:247], v[84:87], v[172:175]
 ds_read_b64_tr_b16 a[196:197], v15 offset:0
 v_add_f32 v151, v151, v156
 v_mfma_f32_16x16x32_bf16 v[172:175], a[248:251], v[100:103], v[172:175]
 v_exp_f32 v157, v253
 v_mfma_f32_16x16x32_bf16 v[172:175], a[252:255], v[116:119], v[172:175]
 ds_read_b64_tr_b16 a[198:199], v15 offset:6144
 v_add_f32 v151, v151, v157
 v_mfma_f32_16x16x32_bf16 v[180:183], a[232:235], v[40:43], v[136:139]
 v_cvt_pk_bf16_f32 v206, v156, v157
 v_mfma_f32_16x16x32_bf16 v[180:183], a[236:239], v[56:59], v[180:183]
 v_exp_f32 v152, v254
 v_mfma_f32_16x16x32_bf16 v[180:183], a[240:243], v[72:75], v[180:183]
 ds_read_b64_tr_b16 a[200:201], v16 offset:0
 v_add_f32 v151, v151, v152
 v_mfma_f32_16x16x32_bf16 v[180:183], a[244:247], v[88:91], v[180:183]
 v_mfma_f32_16x16x32_bf16 v[180:183], a[248:251], v[104:107], v[180:183]
 v_exp_f32 v153, v255
 v_mfma_f32_16x16x32_bf16 v[180:183], a[252:255], v[120:123], v[180:183]
 ds_read_b64_tr_b16 a[202:203], v16 offset:6144
 v_add_f32 v151, v151, v153
 v_mfma_f32_16x16x32_bf16 v[188:191], a[232:235], v[44:47], v[140:143]
 buffer_load_dwordx4 v6, s[32:35], s76 offen offset:2048 nt lds
 v_mfma_f32_16x16x32_bf16 v[188:191], a[236:239], v[60:63], v[188:191]
 ds_read_b64_tr_b16 a[204:205], v17 offset:0
 v_cvt_pk_bf16_f32 v207, v152, v153
 v_mfma_f32_16x16x32_bf16 v[188:191], a[240:243], v[76:79], v[188:191]
 ds_read_b64_tr_b16 a[206:207], v17 offset:6144
 v_max_f32 v158, v158, v151
 v_mfma_f32_16x16x32_bf16 v[188:191], a[244:247], v[92:95], v[188:191]
 v_cmp_lt_f32 vcc, s72, v158
 v_mfma_f32_16x16x32_bf16 v[188:191], a[248:251], v[108:111], v[188:191]
 v_mfma_f32_16x16x32_bf16 v[188:191], a[252:255], v[124:127], v[188:191]
 s_cbranch_vccnz L_S_3
L_R_3:
 s_waitcnt lgkmcnt(4)
 v_mfma_f32_16x16x32_bf16 a[0:3], a[192:195], v[192:195], a[0:3]
 v_exp_f32 v152, v160
 v_mfma_f32_16x16x32_bf16 a[4:7], a[192:195], v[196:199], a[4:7]
 ds_read_b64_tr_b16 a[208:209], v14 offset:128
 v_add_f32 v144, v144, v148
 v_mfma_f32_16x16x32_bf16 a[8:11], a[192:195], v[200:203], a[8:11]
 v_exp_f32 v153, v161
 v_mfma_f32_16x16x32_bf16 a[12:15], a[192:195], v[204:207], a[12:15]
 ds_read_b64_tr_b16 a[210:211], v14 offset:6272
 v_add_f32 v148, v152, v153
 v_mfma_f32_16x16x32_bf16 a[16:19], a[196:199], v[192:195], a[16:19]
 ds_read_b64_tr_b16 a[212:213], v15 offset:128
 v_cvt_pk_bf16_f32 v208, v152, v153
 v_mfma_f32_16x16x32_bf16 a[20:23], a[196:199], v[196:199], a[20:23]
 v_exp_f32 v154, v162
 v_mfma_f32_16x16x32_bf16 a[24:27], a[196:199], v[200:203], a[24:27]
 ds_read_b64_tr_b16 a[214:215], v15 offset:6272
 v_add_f32 v148, v148, v154
 v_mfma_f32_16x16x32_bf16 a[28:31], a[196:199], v[204:207], a[28:31]
 v_add_f32 v145, v145, v149
 s_waitcnt lgkmcnt(4)
 v_mfma_f32_16x16x32_bf16 a[32:35], a[200:203], v[192:195], a[32:35]
 v_exp_f32 v155, v163
 v_mfma_f32_16x16x32_bf16 a[36:39], a[200:203], v[196:199], a[36:39]
 ds_read_b64_tr_b16 a[216:217], v16 offset:128
 ds_read_b64_tr_b16 a[218:219], v16 offset:6272
 v_mfma_f32_16x16x32_bf16 a[40:43], a[200:203], v[200:203], a[40:43]
 s_add_u32 m0, s80, 24576
 s_mov_b32 s76, 122880
 v_mfma_f32_16x16x32_bf16 a[44:47], a[200:203], v[204:207], a[44:47]
 v_exp_f32 v156, v164
 v_mfma_f32_16x16x32_bf16 a[48:51], a[204:207], v[192:195], a[48:51]
 ds_read_b64_tr_b16 a[220:221], v17 offset:128
 v_add_f32 v148, v148, v155
 v_mfma_f32_16x16x32_bf16 a[52:55], a[204:207], v[196:199], a[52:55]
 v_cvt_pk_bf16_f32 v209, v154, v155
 ds_read_b64_tr_b16 a[222:223], v17 offset:6272
 v_mfma_f32_16x16x32_bf16 a[56:59], a[204:207], v[200:203], a[56:59]
 v_exp_f32 v157, v165
 v_mfma_f32_16x16x32_bf16 a[60:63], a[204:207], v[204:207], a[60:63]
 v_add_f32 v148, v148, v156
 s_waitcnt lgkmcnt(4)
 v_mfma_f32_16x16x32_bf16 a[64:67], a[208:211], v[192:195], a[64:67]
 buffer_load_dwordx4 v1, s[28:31], s76 offen offset:0 nt lds
 v_mfma_f32_16x16x32_bf16 a[68:71], a[208:211], v[196:199], a[68:71]
 v_exp_f32 v152, v166
 v_mfma_f32_16x16x32_bf16 a[72:75], a[208:211], v[200:203], a[72:75]
 ds_read_b64_tr_b16 a[224:225], v14 offset:256
 ds_read_b64_tr_b16 a[226:227], v14 offset:6400
 v_mfma_f32_16x16x32_bf16 a[76:79], a[208:211], v[204:207], a[76:79]
 v_exp_f32 v153, v167
 v_mfma_f32_16x16x32_bf16 a[80:83], a[212:215], v[192:195], a[80:83]
 v_add_f32 v148, v148, v157
 v_cvt_pk_bf16_f32 v210, v156, v157
 v_mfma_f32_16x16x32_bf16 a[84:87], a[212:215], v[196:199], a[84:87]
 ds_read_b64_tr_b16 a[228:229], v15 offset:256
 ds_read_b64_tr_b16 a[230:231], v15 offset:6400
 v_mfma_f32_16x16x32_bf16 a[88:91], a[212:215], v[200:203], a[88:91]
 v_exp_f32 v154, v168
 v_mfma_f32_16x16x32_bf16 a[92:95], a[212:215], v[204:207], a[92:95]
 v_add_f32 v148, v148, v152
 s_waitcnt lgkmcnt(4)
 v_mfma_f32_16x16x32_bf16 a[96:99], a[216:219], v[192:195], a[96:99]
 v_add_f32 v148, v148, v153
 v_cvt_pk_bf16_f32 v211, v152, v153
 v_mfma_f32_16x16x32_bf16 a[100:103], a[216:219], v[196:199], a[100:103]
 v_exp_f32 v155, v169
 v_mfma_f32_16x16x32_bf16 a[104:107], a[216:219], v[200:203], a[104:107]
 ds_read_b64_tr_b16 a[232:233], v16 offset:256
 ds_read_b64_tr_b16 a[234:235], v16 offset:6400
 v_mfma_f32_16x16x32_bf16 a[108:111], a[216:219], v[204:207], a[108:111]
 v_add_f32 v149, v154, v155
 v_cvt_pk_bf16_f32 v212, v154, v155
 v_mfma_f32_16x16x32_bf16 a[112:115], a[220:223], v[192:195], a[112:115]
 v_exp_f32 v156, v170
 v_mfma_f32_16x16x32_bf16 a[116:119], a[220:223], v[196:199], a[116:119]
 ds_read_b64_tr_b16 a[236:237], v17 offset:256
 ds_read_b64_tr_b16 a[238:239], v17 offset:6400
 v_mfma_f32_16x16x32_bf16 a[120:123], a[220:223], v[200:203], a[120:123]
 ds_read_b128 a[240:243], v12 offset:12288
 v_add_f32 v149, v149, v156
 v_mfma_f32_16x16x32_bf16 a[124:127], a[220:223], v[204:207], a[124:127]
 v_add_f32 v146, v146, v150
 s_waitcnt lgkmcnt(5)
 v_mfma_f32_16x16x32_bf16 a[128:131], a[224:227], v[192:195], a[128:131]
 v_exp_f32 v157, v171
 v_mfma_f32_16x16x32_bf16 a[132:135], a[224:227], v[196:199], a[132:135]
 ds_read_b128 a[244:247], v13 offset:12288
 v_add_f32 v149, v149, v157
 v_mfma_f32_16x16x32_bf16 a[136:139], a[224:227], v[200:203], a[136:139]
 v_exp_f32 v152, v172
 v_mfma_f32_16x16x32_bf16 a[140:143], a[224:227], v[204:207], a[140:143]
 ds_read_b128 a[248:251], v12 offset:12416
 v_cvt_pk_bf16_f32 v213, v156, v157
 v_mfma_f32_16x16x32_bf16 a[144:147], a[228:231], v[192:195], a[144:147]
 v_exp_f32 v153, v173
 v_mfma_f32_16x16x32_bf16 a[148:151], a[228:231], v[196:199], a[148:151]
 ds_read_b128 a[252:255], v13 offset:12416
 v_add_f32 v149, v149, v152
 v_mfma_f32_16x16x32_bf16 a[152:155], a[228:231], v[200:203], a[152:155]
 buffer_load_dwordx4 v2, s[28:31], s76 offen offset:1024 nt lds
 v_mfma_f32_16x16x32_bf16 a[156:159], a[228:231], v[204:207], a[156:159]
 ds_read_b128 a[192:195], v12 offset:12544
 s_waitcnt lgkmcnt(5)
 v_mfma_f32_16x16x32_bf16 a[160:163], a[232:235], v[192:195], a[160:163]
 v_exp_f32 v154, v174
 v_mfma_f32_16x16x32_bf16 a[164:167], a[232:235], v[196:199], a[164:167]
 ds_read_b128 a[196:199], v13 offset:12544
 v_add_f32 v149, v149, v153
 v_mfma_f32_16x16x32_bf16 a[168:171], a[232:235], v[200:203], a[168:171]
 v_cvt_pk_bf16_f32 v214, v152, v153
 v_add_f32 v149, v149, v154
 v_mfma_f32_16x16x32_bf16 a[172:175], a[232:235], v[204:207], a[172:175]
 v_exp_f32 v155, v175
 v_mfma_f32_16x16x32_bf16 a[176:179], a[236:239], v[192:195], a[176:179]
 v_add_f32 v149, v149, v155
 v_cvt_pk_bf16_f32 v215, v154, v155
 v_mfma_f32_16x16x32_bf16 a[180:183], a[236:239], v[196:199], a[180:183]
 v_exp_f32 v156, v176
 v_mfma_f32_16x16x32_bf16 a[184:187], a[236:239], v[200:203], a[184:187]
 v_add_f32 v147, v147, v151
 v_mfma_f32_16x16x32_bf16 a[188:191], a[236:239], v[204:207], a[188:191]
 s_waitcnt lgkmcnt(3)
 v_mfma_f32_16x16x32_bf16 v[224:227], a[240:243], v[32:35], v[128:131]
 v_exp_f32 v157, v177
 v_mfma_f32_16x16x32_bf16 v[224:227], a[244:247], v[48:51], v[224:227]
 ds_read_b128 a[200:203], v12 offset:18432
 v_add_f32 v150, v156, v157
 v_mfma_f32_16x16x32_bf16 v[224:227], a[248:251], v[64:67], v[224:227]
 ds_read_b128 a[204:207], v13 offset:18432
 s_waitcnt lgkmcnt(2)
 v_mfma_f32_16x16x32_bf16 v[224:227], a[252:255], v[80:83], v[224:227]
 v_exp_f32 v152, v178
 v_mfma_f32_16x16x32_bf16 v[224:227], a[192:195], v[96:99], v[224:227]
 v_cvt_pk_bf16_f32 v216, v156, v157
 v_add_f32 v150, v150, v152
 v_mfma_f32_16x16x32_bf16 v[224:227], a[196:199], v[112:115], v[224:227]
 ds_read_b128 a[208:211], v12 offset:18560
 v_mfma_f32_16x16x32_bf16 v[232:235], a[240:243], v[36:39], v[132:135]
 v_exp_f32 v153, v179
 v_mfma_f32_16x16x32_bf16 v[232:235], a[244:247], v[52:55], v[232:235]
 v_add_f32 v150, v150, v153
 v_cvt_pk_bf16_f32 v217, v152, v153
 v_mfma_f32_16x16x32_bf16 v[232:235], a[248:251], v[68:71], v[232:235]
 v_exp_f32 v154, v180
 v_mfma_f32_16x16x32_bf16 v[232:235], a[252:255], v[84:87], v[232:235]
 ds_read_b128 a[212:215], v13 offset:18560
 v_add_f32 v150, v150, v154
 v_mfma_f32_16x16x32_bf16 v[232:235], a[192:195], v[100:103], v[232:235]
 buffer_load_dwordx4 v3, s[28:31], s76 offen offset:2048 nt lds
 v_mfma_f32_16x16x32_bf16 v[232:235], a[196:199], v[116:119], v[232:235]
 v_exp_f32 v155, v181
 v_mfma_f32_16x16x32_bf16 v[240:243], a[240:243], v[40:43], v[136:139]
 ds_read_b128 a[216:219], v12 offset:18688
 v_add_f32 v150, v150, v155
 v_mfma_f32_16x16x32_bf16 v[240:243], a[244:247], v[56:59], v[240:243]
 v_cvt_pk_bf16_f32 v218, v154, v155
 v_mfma_f32_16x16x32_bf16 v[240:243], a[248:251], v[72:75], v[240:243]
 v_exp_f32 v156, v182
 v_mfma_f32_16x16x32_bf16 v[240:243], a[252:255], v[88:91], v[240:243]
 ds_read_b128 a[220:223], v13 offset:18688
 v_add_f32 v150, v150, v156
 v_mfma_f32_16x16x32_bf16 v[240:243], a[192:195], v[104:107], v[240:243]
 v_mfma_f32_16x16x32_bf16 v[240:243], a[196:199], v[120:123], v[240:243]
 v_exp_f32 v157, v183
 v_mfma_f32_16x16x32_bf16 v[248:251], a[240:243], v[44:47], v[140:143]
 v_add_f32 v150, v150, v157
 v_cvt_pk_bf16_f32 v219, v156, v157
 v_mfma_f32_16x16x32_bf16 v[248:251], a[244:247], v[60:63], v[248:251]
 v_max3_f32 v158, v148, v149, v150
 v_mfma_f32_16x16x32_bf16 v[248:251], a[248:251], v[76:79], v[248:251]
 v_exp_f32 v152, v184
 v_mfma_f32_16x16x32_bf16 v[248:251], a[252:255], v[92:95], v[248:251]
 v_mfma_f32_16x16x32_bf16 v[248:251], a[192:195], v[108:111], v[248:251]
 v_mfma_f32_16x16x32_bf16 v[248:251], a[196:199], v[124:127], v[248:251]
 s_waitcnt lgkmcnt(3)
 v_mfma_f32_16x16x32_bf16 v[228:231], a[200:203], v[32:35], v[128:131]
 v_exp_f32 v153, v185
 v_mfma_f32_16x16x32_bf16 v[228:231], a[204:207], v[48:51], v[228:231]
 v_exp_f32 v154, v186
 v_mfma_f32_16x16x32_bf16 v[228:231], a[208:211], v[64:67], v[228:231]
 v_add_f32 v151, v152, v153
 s_waitcnt lgkmcnt(0)
 v_mfma_f32_16x16x32_bf16 v[228:231], a[212:215], v[80:83], v[228:231]
 v_cvt_pk_bf16_f32 v220, v152, v153
 v_add_f32 v151, v151, v154
 v_mfma_f32_16x16x32_bf16 v[228:231], a[216:219], v[96:99], v[228:231]
 v_exp_f32 v155, v187
 v_mfma_f32_16x16x32_bf16 v[228:231], a[220:223], v[112:115], v[228:231]
 s_add_u32 m0, s80, 98304
 s_mov_b32 s76, 110592
 v_mfma_f32_16x16x32_bf16 v[236:239], a[200:203], v[36:39], v[132:135]
 ds_read_b64_tr_b16 a[224:225], v14 offset:12288
 v_add_f32 v151, v151, v155
 v_mfma_f32_16x16x32_bf16 v[236:239], a[204:207], v[52:55], v[236:239]
 v_exp_f32 v156, v188
 v_mfma_f32_16x16x32_bf16 v[236:239], a[208:211], v[68:71], v[236:239]
 ds_read_b64_tr_b16 a[226:227], v14 offset:18432
 v_cvt_pk_bf16_f32 v221, v154, v155
 v_mfma_f32_16x16x32_bf16 v[236:239], a[212:215], v[84:87], v[236:239]
 buffer_load_dwordx4 v4, s[32:35], s76 offen offset:0 nt lds
 v_mfma_f32_16x16x32_bf16 v[236:239], a[216:219], v[100:103], v[236:239]
 v_exp_f32 v157, v189
 v_mfma_f32_16x16x32_bf16 v[236:239], a[220:223], v[116:119], v[236:239]
 ds_read_b64_tr_b16 a[228:229], v15 offset:12288
 ds_read_b64_tr_b16 a[230:231], v15 offset:18432
 v_mfma_f32_16x16x32_bf16 v[244:247], a[200:203], v[40:43], v[136:139]
 v_add_f32 v151, v151, v156
 v_add_f32 v151, v151, v157
 v_mfma_f32_16x16x32_bf16 v[244:247], a[204:207], v[56:59], v[244:247]
 v_exp_f32 v152, v190
 v_mfma_f32_16x16x32_bf16 v[244:247], a[208:211], v[72:75], v[244:247]
 ds_read_b64_tr_b16 a[232:233], v16 offset:12288
 v_cvt_pk_bf16_f32 v222, v156, v157
 v_mfma_f32_16x16x32_bf16 v[244:247], a[212:215], v[88:91], v[244:247]
 v_add_f32 v151, v151, v152
 v_mfma_f32_16x16x32_bf16 v[244:247], a[216:219], v[104:107], v[244:247]
 v_exp_f32 v153, v191
 v_mfma_f32_16x16x32_bf16 v[244:247], a[220:223], v[120:123], v[244:247]
 ds_read_b64_tr_b16 a[234:235], v16 offset:18432
 v_add_f32 v151, v151, v153
 v_mfma_f32_16x16x32_bf16 v[252:255], a[200:203], v[44:47], v[140:143]
 ds_read_b64_tr_b16 a[236:237], v17 offset:12288
 v_cvt_pk_bf16_f32 v223, v152, v153
 v_mfma_f32_16x16x32_bf16 v[252:255], a[204:207], v[60:63], v[252:255]
 v_mfma_f32_16x16x32_bf16 v[252:255], a[208:211], v[76:79], v[252:255]
 ds_read_b64_tr_b16 a[238:239], v17 offset:18432
 v_max_f32 v158, v158, v151
 v_mfma_f32_16x16x32_bf16 v[252:255], a[212:215], v[92:95], v[252:255]
 v_cmp_lt_f32 vcc, s72, v158
 v_mfma_f32_16x16x32_bf16 v[252:255], a[216:219], v[108:111], v[252:255]
 v_mfma_f32_16x16x32_bf16 v[252:255], a[220:223], v[124:127], v[252:255]
 s_cbranch_vccnz L_S_4
L_R_4:
 s_waitcnt lgkmcnt(4)
 v_mfma_f32_16x16x32_bf16 a[0:3], a[224:227], v[208:211], a[0:3]
 v_exp_f32 v152, v224
 v_mfma_f32_16x16x32_bf16 a[4:7], a[224:227], v[212:215], a[4:7]
 ds_read_b64_tr_b16 a[240:241], v14 offset:12416
 v_add_f32 v144, v144, v148
 v_mfma_f32_16x16x32_bf16 a[8:11], a[224:227], v[216:219], a[8:11]
 v_exp_f32 v153, v225
 v_mfma_f32_16x16x32_bf16 a[12:15], a[224:227], v[220:223], a[12:15]
 ds_read_b64_tr_b16 a[242:243], v14 offset:18560
 v_add_f32 v148, v152, v153
 v_mfma_f32_16x16x32_bf16 a[16:19], a[228:231], v[208:211], a[16:19]
 ds_read_b64_tr_b16 a[244:245], v15 offset:12416
 v_cvt_pk_bf16_f32 v192, v152, v153
 v_mfma_f32_16x16x32_bf16 a[20:23], a[228:231], v[212:215], a[20:23]
 v_exp_f32 v154, v226
 v_mfma_f32_16x16x32_bf16 a[24:27], a[228:231], v[216:219], a[24:27]
 buffer_load_dwordx4 v5, s[32:35], s76 offen offset:1024 nt lds
 v_mfma_f32_16x16x32_bf16 a[28:31], a[228:231], v[220:223], a[28:31]
 ds_read_b64_tr_b16 a[246:247], v15 offset:18560
 s_waitcnt lgkmcnt(4)
 v_mfma_f32_16x16x32_bf16 a[32:35], a[232:235], v[208:211], a[32:35]
 v_exp_f32 v155, v227
 v_mfma_f32_16x16x32_bf16 a[36:39], a[232:235], v[212:215], a[36:39]
 ds_read_b64_tr_b16 a[248:249], v16 offset:12416
 ds_read_b64_tr_b16 a[250:251], v16 offset:18560
 v_mfma_f32_16x16x32_bf16 a[40:43], a[232:235], v[216:219], a[40:43]
 v_add_f32 v148, v148, v154
 v_add_f32 v148, v148, v155
 v_mfma_f32_16x16x32_bf16 a[44:47], a[232:235], v[220:223], a[44:47]
 v_exp_f32 v156, v228
 v_mfma_f32_16x16x32_bf16 a[48:51], a[236:239], v[208:211], a[48:51]
 ds_read_b64_tr_b16 a[252:253], v17 offset:12416
 v_cvt_pk_bf16_f32 v193, v154, v155
 v_mfma_f32_16x16x32_bf16 a[52:55], a[236:239], v[212:215], a[52:55]
 ds_read_b64_tr_b16 a[254:255], v17 offset:18560
 v_add_f32 v148, v148, v156
 v_mfma_f32_16x16x32_bf16 a[56:59], a[236:239], v[216:219], a[56:59]
 v_exp_f32 v157, v229
 v_mfma_f32_16x16x32_bf16 a[60:63], a[236:239], v[220:223], a[60:63]
 v_add_f32 v148, v148, v157
 s_waitcnt lgkmcnt(4)
 v_mfma_f32_16x16x32_bf16 a[64:67], a[240:243], v[208:211], a[64:67]
 ds_read_b64_tr_b16 a[192:193], v14 offset:12544
 v_cvt_pk_bf16_f32 v194, v156, v157
 v_mfma_f32_16x16x32_bf16 a[68:71], a[240:243], v[212:215], a[68:71]
 v_exp_f32 v152, v230
 v_mfma_f32_16x16x32_bf16 a[72:75], a[240:243], v[216:219], a[72:75]
 ds_read_b64_tr_b16 a[194:195], v14 offset:18688
 v_add_f32 v148, v148, v152
 v_mfma_f32_16x16x32_bf16 a[76:79], a[240:243], v[220:223], a[76:79]
 v_exp_f32 v153, v231
 v_mfma_f32_16x16x32_bf16 a[80:83], a[244:247], v[208:211], a[80:83]
 ds_read_b64_tr_b16 a[196:197], v15 offset:12544
 v_add_f32 v148, v148, v153
 v_mfma_f32_16x16x32_bf16 a[84:87], a[244:247], v[212:215], a[84:87]
 ds_read_b64_tr_b16 a[198:199], v15 offset:18688
 v_cvt_pk_bf16_f32 v195, v152, v153
 v_mfma_f32_16x16x32_bf16 a[88:91], a[244:247], v[216:219], a[88:91]
 v_exp_f32 v154, v232
 v_mfma_f32_16x16x32_bf16 a[92:95], a[244:247], v[220:223], a[92:95]
 v_add_f32 v145, v145, v149
 s_waitcnt lgkmcnt(4)
 v_mfma_f32_16x16x32_bf16 a[96:99], a[248:251], v[208:211], a[96:99]
 ds_read_b64_tr_b16 a[200:201], v16 offset:12544
 v_add_f32 v146, v146, v150
 v_mfma_f32_16x16x32_bf16 a[100:103], a[248:251], v[212:215], a[100:103]
 v_exp_f32 v155, v233
 v_mfma_f32_16x16x32_bf16 a[104:107], a[248:251], v[216:219], a[104:107]
 ds_read_b64_tr_b16 a[202:203], v16 offset:18688
 v_add_f32 v149, v154, v155
 v_mfma_f32_16x16x32_bf16 a[108:111], a[248:251], v[220:223], a[108:111]
 buffer_load_dwordx4 v6, s[32:35], s76 offen offset:2048 nt lds
 v_mfma_f32_16x16x32_bf16 a[112:115], a[252:255], v[208:211], a[112:115]
 v_exp_f32 v156, v234
 v_mfma_f32_16x16x32_bf16 a[116:119], a[252:255], v[212:215], a[116:119]
 ds_read_b64_tr_b16 a[204:205], v17 offset:12544
 ds_read_b64_tr_b16 a[206:207], v17 offset:18688
 v_mfma_f32_16x16x32_bf16 a[120:123], a[252:255], v[216:219], a[120:123]
 v_cvt_pk_bf16_f32 v196, v154, v155
 ds_read_b128 a[208:211], v12 offset:24576
 v_mfma_f32_16x16x32_bf16 a[124:127], a[252:255], v[220:223], a[124:127]
 v_add_f32 v149, v149, v156
 s_waitcnt lgkmcnt(5)
 v_mfma_f32_16x16x32_bf16 a[128:131], a[192:195], v[208:211], a[128:131]
 v_exp_f32 v157, v235
 v_mfma_f32_16x16x32_bf16 a[132:135], a[192:195], v[212:215], a[132:135]
 ds_read_b128 a[212:215], v13 offset:24576
 v_add_f32 v149, v149, v157
 v_mfma_f32_16x16x32_bf16 a[136:139], a[192:195], v[216:219], a[136:139]
 v_exp_f32 v152, v236
 v_mfma_f32_16x16x32_bf16 a[140:143], a[192:195], v[220:223], a[140:143]
 ds_read_b128 a[216:219], v12 offset:24704
 v_cvt_pk_bf16_f32 v197, v156, v157
 v_mfma_f32_16x16x32_bf16 a[144:147], a[196:199], v[208:211], a[144:147]
 v_exp_f32 v153, v237
 v_mfma_f32_16x16x32_bf16 a[148:151], a[196:199], v[212:215], a[148:151]
 ds_read_b128 a[220:223], v13 offset:24704
 v_add_f32 v149, v149, v152
 v_mfma_f32_16x16x32_bf16 a[152:155], a[196:199], v[216:219], a[152:155]
 ds_read_b128 a[224:227], v12 offset:24832
 v_add_f32 v149, v149, v153
 v_mfma_f32_16x16x32_bf16 a[156:159], a[196:199], v[220:223], a[156:159]
 v_cvt_pk_bf16_f32 v198, v152, v153
 s_waitcnt lgkmcnt(5)
 v_mfma_f32_16x16x32_bf16 a[160:163], a[200:203], v[208:211], a[160:163]
 v_exp_f32 v154, v238
 v_mfma_f32_16x16x32_bf16 a[164:167], a[200:203], v[212:215], a[164:167]
 ds_read_b128 a[228:231], v13 offset:24832
 v_add_f32 v149, v149, v154
 v_mfma_f32_16x16x32_bf16 a[168:171], a[200:203], v[216:219], a[168:171]
 v_exp_f32 v155, v239
 v_mfma_f32_16x16x32_bf16 a[172:175], a[200:203], v[220:223], a[172:175]
 s_add_u32 m0, s80, 36864
 s_mov_b32 s76, 135168
 v_mfma_f32_16x16x32_bf16 a[176:179], a[204:207], v[208:211], a[176:179]
 v_add_f32 v149, v149, v155
 v_cvt_pk_bf16_f32 v199, v154, v155
 v_mfma_f32_16x16x32_bf16 a[180:183], a[204:207], v[212:215], a[180:183]
 v_exp_f32 v156, v240
 v_mfma_f32_16x16x32_bf16 a[184:187], a[204:207], v[216:219], a[184:187]
 buffer_load_dwordx4 v1, s[28:31], s76 offen offset:0 nt lds
 v_mfma_f32_16x16x32_bf16 a[188:191], a[204:207], v[220:223], a[188:191]
 v_add_f32 v147, v147, v151
 s_waitcnt lgkmcnt(3)
 v_mfma_f32_16x16x32_bf16 v[160:163], a[208:211], v[32:35], v[128:131]
 v_exp_f32 v157, v241
 v_mfma_f32_16x16x32_bf16 v[160:163], a[212:215], v[48:51], v[160:163]
 ds_read_b128 a[232:235], v12 offset:30720
 v_add_f32 v150, v156, v157
 v_mfma_f32_16x16x32_bf16 v[160:163], a[216:219], v[64:67], v[160:163]
 ds_read_b128 a[236:239], v13 offset:30720
 s_waitcnt lgkmcnt(2)
 v_mfma_f32_16x16x32_bf16 v[160:163], a[220:223], v[80:83], v[160:163]
 v_exp_f32 v152, v242
 v_mfma_f32_16x16x32_bf16 v[160:163], a[224:227], v[96:99], v[160:163]
 v_cvt_pk_bf16_f32 v200, v156, v157
 v_add_f32 v150, v150, v152
 v_mfma_f32_16x16x32_bf16 v[160:163], a[228:231], v[112:115], v[160:163]
 ds_read_b128 a[240:243], v12 offset:30848
 v_mfma_f32_16x16x32_bf16 v[168:171], a[208:211], v[36:39], v[132:135]
 v_exp_f32 v153, v243
 v_mfma_f32_16x16x32_bf16 v[168:171], a[212:215], v[52:55], v[168:171]
 v_add_f32 v150, v150, v153
 v_cvt_pk_bf16_f32 v201, v152, v153
 v_mfma_f32_16x16x32_bf16 v[168:171], a[216:219], v[68:71], v[168:171]
 v_exp_f32 v154, v244
 v_mfma_f32_16x16x32_bf16 v[168:171], a[220:223], v[84:87], v[168:171]
 ds_read_b128 a[244:247], v13 offset:30848
 v_add_f32 v150, v150, v154
 v_mfma_f32_16x16x32_bf16 v[168:171], a[224:227], v[100:103], v[168:171]
 v_mfma_f32_16x16x32_bf16 v[168:171], a[228:231], v[116:119], v[168:171]
 v_exp_f32 v155, v245
 v_mfma_f32_16x16x32_bf16 v[176:179], a[208:211], v[40:43], v[136:139]
 ds_read_b128 a[248:251], v12 offset:30976
 v_add_f32 v150, v150, v155
 v_mfma_f32_16x16x32_bf16 v[176:179], a[212:215], v[56:59], v[176:179]
 v_cvt_pk_bf16_f32 v202, v154, v155
 v_mfma_f32_16x16x32_bf16 v[176:179], a[216:219], v[72:75], v[176:179]
 v_exp_f32 v156, v246
 v_mfma_f32_16x16x32_bf16 v[176:179], a[220:223], v[88:91], v[176:179]
 ds_read_b128 a[252:255], v13 offset:30976
 v_add_f32 v150, v150, v156
 v_mfma_f32_16x16x32_bf16 v[176:179], a[224:227], v[104:107], v[176:179]
 v_mfma_f32_16x16x32_bf16 v[176:179], a[228:231], v[120:123], v[176:179]
 v_exp_f32 v157, v247
 v_mfma_f32_16x16x32_bf16 v[184:187], a[208:211], v[44:47], v[140:143]
 v_add_f32 v150, v150, v157
 v_cvt_pk_bf16_f32 v203, v156, v157
 v_mfma_f32_16x16x32_bf16 v[184:187], a[212:215], v[60:63], v[184:187]
 buffer_load_dwordx4 v2, s[28:31], s76 offen offset:1024 nt lds
 v_mfma_f32_16x16x32_bf16 v[184:187], a[216:219], v[76:79], v[184:187]
 v_exp_f32 v152, v248
 v_mfma_f32_16x16x32_bf16 v[184:187], a[220:223], v[92:95], v[184:187]
 v_subrev_u32 v12, 36864, v12
 v_subrev_u32 v13, 36864, v13
 v_mfma_f32_16x16x32_bf16 v[184:187], a[224:227], v[108:111], v[184:187]
 v_max3_f32 v158, v148, v149, v150
 v_mfma_f32_16x16x32_bf16 v[184:187], a[228:231], v[124:127], v[184:187]
 s_waitcnt lgkmcnt(3)
 v_mfma_f32_16x16x32_bf16 v[164:167], a[232:235], v[32:35], v[128:131]
 v_exp_f32 v153, v249
 v_mfma_f32_16x16x32_bf16 v[164:167], a[236:239], v[48:51], v[164:167]
 v_exp_f32 v154, v250
 v_mfma_f32_16x16x32_bf16 v[164:167], a[240:243], v[64:67], v[164:167]
 v_add_f32 v151, v152, v153
 s_waitcnt lgkmcnt(0)
 v_mfma_f32_16x16x32_bf16 v[164:167], a[244:247], v[80:83], v[164:167]
 v_cvt_pk_bf16_f32 v204, v152, v153
 v_add_f32 v151, v151, v154
 v_mfma_f32_16x16x32_bf16 v[164:167], a[248:251], v[96:99], v[164:167]
 s_waitcnt vmcnt(11)
 s_barrier
 v_mfma_f32_16x16x32_bf16 v[164:167], a[252:255], v[112:115], v[164:167]
 v_exp_f32 v155, v251
 v_mfma_f32_16x16x32_bf16 v[172:175], a[232:235], v[36:39], v[132:135]
 ds_read_b64_tr_b16 a[192:193], v14 offset:24576
 v_add_f32 v151, v151, v155
 v_mfma_f32_16x16x32_bf16 v[172:175], a[236:239], v[52:55], v[172:175]
 v_exp_f32 v156, v252
 v_mfma_f32_16x16x32_bf16 v[172:175], a[240:243], v[68:71], v[172:175]
 ds_read_b64_tr_b16 a[194:195], v14 offset:30720
 v_cvt_pk_bf16_f32 v205, v154, v155
 v_mfma_f32_16x16x32_bf16 v[172:175], a[244:247], v[84:87], v[172:175]
 ds_read_b64_tr_b16 a[196:197], v15 offset:24576
 v_add_f32 v151, v151, v156
 v_mfma_f32_16x16x32_bf16 v[172:175], a[248:251], v[100:103], v[172:175]
 v_exp_f32 v157, v253
 v_mfma_f32_16x16x32_bf16 v[172:175], a[252:255], v[116:119], v[172:175]
 ds_read_b64_tr_b16 a[198:199], v15 offset:30720
 v_add_f32 v151, v151, v157
 v_mfma_f32_16x16x32_bf16 v[180:183], a[232:235], v[40:43], v[136:139]
 v_cvt_pk_bf16_f32 v206, v156, v157
 v_mfma_f32_16x16x32_bf16 v[180:183], a[236:239], v[56:59], v[180:183]
 v_exp_f32 v152, v254
 v_mfma_f32_16x16x32_bf16 v[180:183], a[240:243], v[72:75], v[180:183]
 ds_read_b64_tr_b16 a[200:201], v16 offset:24576
 v_add_f32 v151, v151, v152
 v_mfma_f32_16x16x32_bf16 v[180:183], a[244:247], v[88:91], v[180:183]
 v_mfma_f32_16x16x32_bf16 v[180:183], a[248:251], v[104:107], v[180:183]
 v_exp_f32 v153, v255
 v_mfma_f32_16x16x32_bf16 v[180:183], a[252:255], v[120:123], v[180:183]
 ds_read_b64_tr_b16 a[202:203], v16 offset:30720
 v_add_f32 v151, v151, v153
 v_mfma_f32_16x16x32_bf16 v[188:191], a[232:235], v[44:47], v[140:143]
 buffer_load_dwordx4 v3, s[28:31], s76 offen offset:2048 nt lds
 v_mfma_f32_16x16x32_bf16 v[188:191], a[236:239], v[60:63], v[188:191]
 ds_read_b64_tr_b16 a[204:205], v17 offset:24576
 v_cvt_pk_bf16_f32 v207, v152, v153
 v_mfma_f32_16x16x32_bf16 v[188:191], a[240:243], v[76:79], v[188:191]
 ds_read_b64_tr_b16 a[206:207], v17 offset:30720
 v_max_f32 v158, v158, v151
 v_mfma_f32_16x16x32_bf16 v[188:191], a[244:247], v[92:95], v[188:191]
 v_cmp_lt_f32 vcc, s72, v158
 v_mfma_f32_16x16x32_bf16 v[188:191], a[248:251], v[108:111], v[188:191]
 v_mfma_f32_16x16x32_bf16 v[188:191], a[252:255], v[124:127], v[188:191]
 s_cbranch_vccnz L_S_5
L_R_5:
 s_waitcnt lgkmcnt(4)
 v_mfma_f32_16x16x32_bf16 a[0:3], a[192:195], v[192:195], a[0:3]
 v_exp_f32 v152, v160
 v_mfma_f32_16x16x32_bf16 a[4:7], a[192:195], v[196:199], a[4:7]
 ds_read_b64_tr_b16 a[208:209], v14 offset:24704
 v_add_f32 v144, v144, v148
 v_mfma_f32_16x16x32_bf16 a[8:11], a[192:195], v[200:203], a[8:11]
 v_exp_f32 v153, v161
 v_mfma_f32_16x16x32_bf16 a[12:15], a[192:195], v[204:207], a[12:15]
 ds_read_b64_tr_b16 a[210:211], v14 offset:30848
 v_add_f32 v148, v152, v153
 v_mfma_f32_16x16x32_bf16 a[16:19], a[196:199], v[192:195], a[16:19]
 ds_read_b64_tr_b16 a[212:213], v15 offset:24704
 v_cvt_pk_bf16_f32 v208, v152, v153
 v_mfma_f32_16x16x32_bf16 a[20:23], a[196:199], v[196:199], a[20:23]
 v_exp_f32 v154, v162
 v_mfma_f32_16x16x32_bf16 a[24:27], a[196:199], v[200:203], a[24:27]
 ds_read_b64_tr_b16 a[214:215], v15 offset:30848
 v_add_f32 v148, v148, v154
 v_mfma_f32_16x16x32_bf16 a[28:31], a[196:199], v[204:207], a[28:31]
 v_add_f32 v145, v145, v149
 s_waitcnt lgkmcnt(4)
 v_mfma_f32_16x16x32_bf16 a[32:35], a[200:203], v[192:195], a[32:35]
 v_exp_f32 v155, v163
 v_mfma_f32_16x16x32_bf16 a[36:39], a[200:203], v[196:199], a[36:39]
 ds_read_b64_tr_b16 a[216:217], v16 offset:24704
 ds_read_b64_tr_b16 a[218:219], v16 offset:30848
 v_mfma_f32_16x16x32_bf16 a[40:43], a[200:203], v[200:203], a[40:43]
 s_add_u32 m0, s80, 110592
 s_mov_b32 s76, 122880
 v_mfma_f32_16x16x32_bf16 a[44:47], a[200:203], v[204:207], a[44:47]
 v_exp_f32 v156, v164
 v_mfma_f32_16x16x32_bf16 a[48:51], a[204:207], v[192:195], a[48:51]
 ds_read_b64_tr_b16 a[220:221], v17 offset:24704
 v_add_f32 v148, v148, v155
 v_mfma_f32_16x16x32_bf16 a[52:55], a[204:207], v[196:199], a[52:55]
 v_cvt_pk_bf16_f32 v209, v154, v155
 ds_read_b64_tr_b16 a[222:223], v17 offset:30848
 v_mfma_f32_16x16x32_bf16 a[56:59], a[204:207], v[200:203], a[56:59]
 v_exp_f32 v157, v165
 v_mfma_f32_16x16x32_bf16 a[60:63], a[204:207], v[204:207], a[60:63]
 v_add_f32 v148, v148, v156
 s_waitcnt lgkmcnt(4)
 v_mfma_f32_16x16x32_bf16 a[64:67], a[208:211], v[192:195], a[64:67]
 buffer_load_dwordx4 v4, s[32:35], s76 offen offset:0 nt lds
 v_mfma_f32_16x16x32_bf16 a[68:71], a[208:211], v[196:199], a[68:71]
 v_exp_f32 v152, v166
 v_mfma_f32_16x16x32_bf16 a[72:75], a[208:211], v[200:203], a[72:75]
 ds_read_b64_tr_b16 a[224:225], v14 offset:24832
 ds_read_b64_tr_b16 a[226:227], v14 offset:30976
 v_mfma_f32_16x16x32_bf16 a[76:79], a[208:211], v[204:207], a[76:79]
 v_exp_f32 v153, v167
 v_mfma_f32_16x16x32_bf16 a[80:83], a[212:215], v[192:195], a[80:83]
 v_add_f32 v148, v148, v157
 v_cvt_pk_bf16_f32 v210, v156, v157
 v_mfma_f32_16x16x32_bf16 a[84:87], a[212:215], v[196:199], a[84:87]
 ds_read_b64_tr_b16 a[228:229], v15 offset:24832
 ds_read_b64_tr_b16 a[230:231], v15 offset:30976
 v_mfma_f32_16x16x32_bf16 a[88:91], a[212:215], v[200:203], a[88:91]
 v_exp_f32 v154, v168
 v_mfma_f32_16x16x32_bf16 a[92:95], a[212:215], v[204:207], a[92:95]
 v_add_f32 v148, v148, v152
 s_waitcnt lgkmcnt(4)
 v_mfma_f32_16x16x32_bf16 a[96:99], a[216:219], v[192:195], a[96:99]
 v_add_f32 v148, v148, v153
 v_cvt_pk_bf16_f32 v211, v152, v153
 v_mfma_f32_16x16x32_bf16 a[100:103], a[216:219], v[196:199], a[100:103]
 v_exp_f32 v155, v169
 v_mfma_f32_16x16x32_bf16 a[104:107], a[216:219], v[200:203], a[104:107]
 ds_read_b64_tr_b16 a[232:233], v16 offset:24832
 ds_read_b64_tr_b16 a[234:235], v16 offset:30976
 v_mfma_f32_16x16x32_bf16 a[108:111], a[216:219], v[204:207], a[108:111]
 v_add_f32 v149, v154, v155
 v_cvt_pk_bf16_f32 v212, v154, v155
 v_mfma_f32_16x16x32_bf16 a[112:115], a[220:223], v[192:195], a[112:115]
 v_exp_f32 v156, v170
 v_mfma_f32_16x16x32_bf16 a[116:119], a[220:223], v[196:199], a[116:119]
 ds_read_b64_tr_b16 a[236:237], v17 offset:24832
 ds_read_b64_tr_b16 a[238:239], v17 offset:30976
 v_mfma_f32_16x16x32_bf16 a[120:123], a[220:223], v[200:203], a[120:123]
 ds_read_b128 a[240:243], v12 offset:0
 v_add_f32 v149, v149, v156
 v_mfma_f32_16x16x32_bf16 a[124:127], a[220:223], v[204:207], a[124:127]
 v_add_f32 v146, v146, v150
 s_waitcnt lgkmcnt(5)
 v_mfma_f32_16x16x32_bf16 a[128:131], a[224:227], v[192:195], a[128:131]
 v_exp_f32 v157, v171
 v_mfma_f32_16x16x32_bf16 a[132:135], a[224:227], v[196:199], a[132:135]
 ds_read_b128 a[244:247], v13 offset:0
 v_add_f32 v149, v149, v157
 v_mfma_f32_16x16x32_bf16 a[136:139], a[224:227], v[200:203], a[136:139]
 v_exp_f32 v152, v172
 v_mfma_f32_16x16x32_bf16 a[140:143], a[224:227], v[204:207], a[140:143]
 buffer_load_dwordx4 v5, s[32:35], s76 offen offset:1024 nt lds
 v_mfma_f32_16x16x32_bf16 a[144:147], a[228:231], v[192:195], a[144:147]
 ds_read_b128 a[248:251], v12 offset:128
 v_cvt_pk_bf16_f32 v213, v156, v157
 v_mfma_f32_16x16x32_bf16 a[148:151], a[228:231], v[196:199], a[148:151]
 v_exp_f32 v153, v173
 v_mfma_f32_16x16x32_bf16 a[152:155], a[228:231], v[200:203], a[152:155]
 ds_read_b128 a[252:255], v13 offset:128
 ds_read_b128 a[192:195], v12 offset:256
 v_mfma_f32_16x16x32_bf16 a[156:159], a[228:231], v[204:207], a[156:159]
 v_add_f32 v149, v149, v152
 s_waitcnt lgkmcnt(5)
 v_mfma_f32_16x16x32_bf16 a[160:163], a[232:235], v[192:195], a[160:163]
 v_exp_f32 v154, v174
 v_mfma_f32_16x16x32_bf16 a[164:167], a[232:235], v[196:199], a[164:167]
 ds_read_b128 a[196:199], v13 offset:256
 v_add_f32 v149, v149, v153
 v_mfma_f32_16x16x32_bf16 a[168:171], a[232:235], v[200:203], a[168:171]
 v_cvt_pk_bf16_f32 v214, v152, v153
 v_add_f32 v149, v149, v154
 v_mfma_f32_16x16x32_bf16 a[172:175], a[232:235], v[204:207], a[172:175]
 v_exp_f32 v155, v175
 v_mfma_f32_16x16x32_bf16 a[176:179], a[236:239], v[192:195], a[176:179]
 v_add_f32 v149, v149, v155
 v_cvt_pk_bf16_f32 v215, v154, v155
 v_mfma_f32_16x16x32_bf16 a[180:183], a[236:239], v[196:199], a[180:183]
 v_exp_f32 v156, v176
 v_mfma_f32_16x16x32_bf16 a[184:187], a[236:239], v[200:203], a[184:187]
 v_add_f32 v147, v147, v151
 v_subrev_u32 v14, 49152, v14
 v_mfma_f32_16x16x32_bf16 a[188:191], a[236:239], v[204:207], a[188:191]
 v_subrev_u32 v15, 49152, v15
 s_waitcnt lgkmcnt(3)
 v_mfma_f32_16x16x32_bf16 v[224:227], a[240:243], v[32:35], v[128:131]
 v_exp_f32 v157, v177
 v_mfma_f32_16x16x32_bf16 v[224:227], a[244:247], v[48:51], v[224:227]
 ds_read_b128 a[200:203], v12 offset:6144
 v_add_f32 v150, v156, v157
 v_mfma_f32_16x16x32_bf16 v[224:227], a[248:251], v[64:67], v[224:227]
 ds_read_b128 a[204:207], v13 offset:6144
 s_waitcnt lgkmcnt(2)
 v_mfma_f32_16x16x32_bf16 v[224:227], a[252:255], v[80:83], v[224:227]
 v_exp_f32 v152, v178
 v_mfma_f32_16x16x32_bf16 v[224:227], a[192:195], v[96:99], v[224:227]
 v_cvt_pk_bf16_f32 v216, v156, v157
 v_add_f32 v150, v150, v152
 v_mfma_f32_16x16x32_bf16 v[224:227], a[196:199], v[112:115], v[224:227]
 ds_read_b128 a[208:211], v12 offset:6272
 v_subrev_u32 v16, 49152, v16
 v_mfma_f32_16x16x32_bf16 v[232:235], a[240:243], v[36:39], v[132:135]
 v_exp_f32 v153, v179
 v_mfma_f32_16x16x32_bf16 v[232:235], a[244:247], v[52:55], v[232:235]
 buffer_load_dwordx4 v6, s[32:35], s76 offen offset:2048 nt lds
 v_mfma_f32_16x16x32_bf16 v[232:235], a[248:251], v[68:71], v[232:235]
 v_exp_f32 v154, v180
 v_mfma_f32_16x16x32_bf16 v[232:235], a[252:255], v[84:87], v[232:235]
 ds_read_b128 a[212:215], v13 offset:6272
 v_add_f32 v150, v150, v153
 v_mfma_f32_16x16x32_bf16 v[232:235], a[192:195], v[100:103], v[232:235]
 v_cvt_pk_bf16_f32 v217, v152, v153
 v_add_f32 v150, v150, v154
 v_mfma_f32_16x16x32_bf16 v[232:235], a[196:199], v[116:119], v[232:235]
 v_exp_f32 v155, v181
 v_mfma_f32_16x16x32_bf16 v[240:243], a[240:243], v[40:43], v[136:139]
 ds_read_b128 a[216:219], v12 offset:6400
 v_add_f32 v150, v150, v155
 v_mfma_f32_16x16x32_bf16 v[240:243], a[244:247], v[56:59], v[240:243]
 v_cvt_pk_bf16_f32 v218, v154, v155
 v_subrev_u32 v17, 49152, v17
 v_mfma_f32_16x16x32_bf16 v[240:243], a[248:251], v[72:75], v[240:243]
 v_exp_f32 v156, v182
 v_mfma_f32_16x16x32_bf16 v[240:243], a[252:255], v[88:91], v[240:243]
 ds_read_b128 a[220:223], v13 offset:6400
 v_add_f32 v150, v150, v156
 v_mfma_f32_16x16x32_bf16 v[240:243], a[192:195], v[104:107], v[240:243]
 v_mfma_f32_16x16x32_bf16 v[240:243], a[196:199], v[120:123], v[240:243]
 v_exp_f32 v157, v183
 v_mfma_f32_16x16x32_bf16 v[248:251], a[240:243], v[44:47], v[140:143]
 v_add_f32 v150, v150, v157
 v_cvt_pk_bf16_f32 v219, v156, v157
 v_mfma_f32_16x16x32_bf16 v[248:251], a[244:247], v[60:63], v[248:251]
 s_add_u32 m0, s80, 49152
 s_mov_b32 s76, 147456
 v_mfma_f32_16x16x32_bf16 v[248:251], a[248:251], v[76:79], v[248:251]
 v_exp_f32 v152, v184
 v_mfma_f32_16x16x32_bf16 v[248:251], a[252:255], v[92:95], v[248:251]
 v_max3_f32 v158, v148, v149, v150
 v_mfma_f32_16x16x32_bf16 v[248:251], a[192:195], v[108:111], v[248:251]
 v_mfma_f32_16x16x32_bf16 v[248:251], a[196:199], v[124:127], v[248:251]
 s_waitcnt lgkmcnt(3)
 v_mfma_f32_16x16x32_bf16 v[228:231], a[200:203], v[32:35], v[128:131]
 v_exp_f32 v153, v185
 v_mfma_f32_16x16x32_bf16 v[228:231], a[204:207], v[48:51], v[228:231]
 v_exp_f32 v154, v186
 v_mfma_f32_16x16x32_bf16 v[228:231], a[208:211], v[64:67], v[228:231]
 v_add_f32 v151, v152, v153
 s_waitcnt lgkmcnt(0)
 v_mfma_f32_16x16x32_bf16 v[228:231], a[212:215], v[80:83], v[228:231]
 buffer_load_dwordx4 v1, s[28:31], s76 offen offset:0 nt lds
 v_mfma_f32_16x16x32_bf16 v[228:231], a[216:219], v[96:99], v[228:231]
 v_exp_f32 v155, v187
 v_mfma_f32_16x16x32_bf16 v[228:231], a[220:223], v[112:115], v[228:231]
 v_cvt_pk_bf16_f32 v220, v152, v153
 v_add_f32 v151, v151, v154
 v_mfma_f32_16x16x32_bf16 v[236:239], a[200:203], v[36:39], v[132:135]
 ds_read_b64_tr_b16 a[224:225], v14 offset:0
 v_add_f32 v151, v151, v155
 v_mfma_f32_16x16x32_bf16 v[236:239], a[204:207], v[52:55], v[236:239]
 v_exp_f32 v156, v188
 v_mfma_f32_16x16x32_bf16 v[236:239], a[208:211], v[68:71], v[236:239]
 ds_read_b64_tr_b16 a[226:227], v14 offset:6144
 v_cvt_pk_bf16_f32 v221, v154, v155
 v_mfma_f32_16x16x32_bf16 v[236:239], a[212:215], v[84:87], v[236:239]
 ds_read_b64_tr_b16 a[228:229], v15 offset:0
 v_add_f32 v151, v151, v156
 v_mfma_f32_16x16x32_bf16 v[236:239], a[216:219], v[100:103], v[236:239]
 v_exp_f32 v157, v189
 v_mfma_f32_16x16x32_bf16 v[236:239], a[220:223], v[116:119], v[236:239]
 ds_read_b64_tr_b16 a[230:231], v15 offset:6144
 v_add_f32 v151, v151, v157
 v_mfma_f32_16x16x32_bf16 v[244:247], a[200:203], v[40:43], v[136:139]
 v_cvt_pk_bf16_f32 v222, v156, v157
 v_mfma_f32_16x16x32_bf16 v[244:247], a[204:207], v[56:59], v[244:247]
 v_exp_f32 v152, v190
 v_mfma_f32_16x16x32_bf16 v[244:247], a[208:211], v[72:75], v[244:247]
 ds_read_b64_tr_b16 a[232:233], v16 offset:0
 v_add_f32 v151, v151, v152
 v_mfma_f32_16x16x32_bf16 v[244:247], a[212:215], v[88:91], v[244:247]
 v_mfma_f32_16x16x32_bf16 v[244:247], a[216:219], v[104:107], v[244:247]
 v_exp_f32 v153, v191
 v_mfma_f32_16x16x32_bf16 v[244:247], a[220:223], v[120:123], v[244:247]
 ds_read_b64_tr_b16 a[234:235], v16 offset:6144
 v_add_f32 v151, v151, v153
 v_mfma_f32_16x16x32_bf16 v[252:255], a[200:203], v[44:47], v[140:143]
 ds_read_b64_tr_b16 a[236:237], v17 offset:0
 v_cvt_pk_bf16_f32 v223, v152, v153
 v_mfma_f32_16x16x32_bf16 v[252:255], a[204:207], v[60:63], v[252:255]
 v_mfma_f32_16x16x32_bf16 v[252:255], a[208:211], v[76:79], v[252:255]
 ds_read_b64_tr_b16 a[238:239], v17 offset:6144
 v_max_f32 v158, v158, v151
 v_mfma_f32_16x16x32_bf16 v[252:255], a[212:215], v[92:95], v[252:255]
 v_cmp_lt_f32 vcc, s72, v158
 v_mfma_f32_16x16x32_bf16 v[252:255], a[216:219], v[108:111], v[252:255]
 v_mfma_f32_16x16x32_bf16 v[252:255], a[220:223], v[124:127], v[252:255]
 buffer_load_dwordx4 v2, s[28:31], s76 offen offset:1024 nt lds
 s_cbranch_vccnz L_S_6
L_R_6:
 s_waitcnt lgkmcnt(4)
 v_mfma_f32_16x16x32_bf16 a[0:3], a[224:227], v[208:211], a[0:3]
 v_exp_f32 v152, v224
 v_mfma_f32_16x16x32_bf16 a[4:7], a[224:227], v[212:215], a[4:7]
 ds_read_b64_tr_b16 a[240:241], v14 offset:128
 v_add_f32 v144, v144, v148
 v_mfma_f32_16x16x32_bf16 a[8:11], a[224:227], v[216:219], a[8:11]
 v_exp_f32 v153, v225
 v_mfma_f32_16x16x32_bf16 a[12:15], a[224:227], v[220:223], a[12:15]
 ds_read_b64_tr_b16 a[242:243], v14 offset:6272
 v_add_f32 v148, v152, v153
 v_mfma_f32_16x16x32_bf16 a[16:19], a[228:231], v[208:211], a[16:19]
 ds_read_b64_tr_b16 a[244:245], v15 offset:128
 v_cvt_pk_bf16_f32 v192, v152, v153
 v_mfma_f32_16x16x32_bf16 a[20:23], a[228:231], v[212:215], a[20:23]
 v_exp_f32 v154, v226
 v_mfma_f32_16x16x32_bf16 a[24:27], a[228:231], v[216:219], a[24:27]
 ds_read_b64_tr_b16 a[246:247], v15 offset:6272
 v_add_f32 v148, v148, v154
 v_mfma_f32_16x16x32_bf16 a[28:31], a[228:231], v[220:223], a[28:31]
 v_add_f32 v145, v145, v149
 s_waitcnt lgkmcnt(4)
 v_mfma_f32_16x16x32_bf16 a[32:35], a[232:235], v[208:211], a[32:35]
 v_exp_f32 v155, v227
 v_mfma_f32_16x16x32_bf16 a[36:39], a[232:235], v[212:215], a[36:39]
 ds_read_b64_tr_b16 a[248:249], v16 offset:128
 ds_read_b64_tr_b16 a[250:251], v16 offset:6272
 v_mfma_f32_16x16x32_bf16 a[40:43], a[232:235], v[216:219], a[40:43]
 v_add_f32 v148, v148, v155
 v_cvt_pk_bf16_f32 v193, v154, v155
 v_mfma_f32_16x16x32_bf16 a[44:47], a[232:235], v[220:223], a[44:47]
 v_exp_f32 v156, v228
 v_mfma_f32_16x16x32_bf16 a[48:51], a[236:239], v[208:211], a[48:51]
 ds_read_b64_tr_b16 a[252:253], v17 offset:128
 v_add_f32 v148, v148, v156
 v_mfma_f32_16x16x32_bf16 a[52:55], a[236:239], v[212:215], a[52:55]
 ds_read_b64_tr_b16 a[254:255], v17 offset:6272
 v_add_f32 v146, v146, v150
 v_mfma_f32_16x16x32_bf16 a[56:59], a[236:239], v[216:219], a[56:59]
 v_exp_f32 v157, v229
 v_mfma_f32_16x16x32_bf16 a[60:63], a[236:239], v[220:223], a[60:63]
 v_add_f32 v148, v148, v157
 s_waitcnt lgkmcnt(4)
 v_mfma_f32_16x16x32_bf16 a[64:67], a[240:243], v[208:211], a[64:67]
 ds_read_b64_tr_b16 a[192:193], v14 offset:256
 v_cvt_pk_bf16_f32 v194, v156, v157
 v_mfma_f32_16x16x32_bf16 a[68:71], a[240:243], v[212:215], a[68:71]
 v_exp_f32 v152, v230
 v_mfma_f32_16x16x32_bf16 a[72:75], a[240:243], v[216:219], a[72:75]
 ds_read_b64_tr_b16 a[194:195], v14 offset:6400
 v_add_f32 v148, v148, v152
 v_mfma_f32_16x16x32_bf16 a[76:79], a[240:243], v[220:223], a[76:79]
 v_exp_f32 v153, v231
 v_mfma_f32_16x16x32_bf16 a[80:83], a[244:247], v[208:211], a[80:83]
 buffer_load_dwordx4 v3, s[28:31], s76 offen offset:2048 nt lds
 v_mfma_f32_16x16x32_bf16 a[84:87], a[244:247], v[212:215], a[84:87]
 ds_read_b64_tr_b16 a[196:197], v15 offset:256
 ds_read_b64_tr_b16 a[198:199], v15 offset:6400
 v_mfma_f32_16x16x32_bf16 a[88:91], a[244:247], v[216:219], a[88:91]
 v_exp_f32 v154, v232
 v_mfma_f32_16x16x32_bf16 a[92:95], a[244:247], v[220:223], a[92:95]
 v_add_f32 v148, v148, v153
 s_waitcnt lgkmcnt(4)
 v_mfma_f32_16x16x32_bf16 a[96:99], a[248:251], v[208:211], a[96:99]
 v_cvt_pk_bf16_f32 v195, v152, v153
 ds_read_b64_tr_b16 a[200:201], v16 offset:256
 v_mfma_f32_16x16x32_bf16 a[100:103], a[248:251], v[212:215], a[100:103]
 v_exp_f32 v155, v233
 v_mfma_f32_16x16x32_bf16 a[104:107], a[248:251], v[216:219], a[104:107]
 ds_read_b64_tr_b16 a[202:203], v16 offset:6400
 v_add_f32 v149, v154, v155
 v_mfma_f32_16x16x32_bf16 a[108:111], a[248:251], v[220:223], a[108:111]
 v_cvt_pk_bf16_f32 v196, v154, v155
 v_add_f32 v147, v147, v151
 v_mfma_f32_16x16x32_bf16 a[112:115], a[252:255], v[208:211], a[112:115]
 v_exp_f32 v156, v234
 v_mfma_f32_16x16x32_bf16 a[116:119], a[252:255], v[212:215], a[116:119]
 ds_read_b64_tr_b16 a[204:205], v17 offset:256
 ds_read_b64_tr_b16 a[206:207], v17 offset:6400
 v_mfma_f32_16x16x32_bf16 a[120:123], a[252:255], v[216:219], a[120:123]
 ds_read_b128 a[208:211], v12 offset:12288
 v_add_f32 v149, v149, v156
 v_mfma_f32_16x16x32_bf16 a[124:127], a[252:255], v[220:223], a[124:127]
 s_waitcnt lgkmcnt(5)
 v_mfma_f32_16x16x32_bf16 a[128:131], a[192:195], v[208:211], a[128:131]
 v_exp_f32 v157, v235
 v_mfma_f32_16x16x32_bf16 a[132:135], a[192:195], v[212:215], a[132:135]
 ds_read_b128 a[212:215], v13 offset:12288
 v_add_f32 v149, v149, v157
 v_mfma_f32_16x16x32_bf16 a[136:139], a[192:195], v[216:219], a[136:139]
 v_exp_f32 v152, v236
 v_mfma_f32_16x16x32_bf16 a[140:143], a[192:195], v[220:223], a[140:143]
 ds_read_b128 a[216:219], v12 offset:12416
 v_cvt_pk_bf16_f32 v197, v156, v157
 v_mfma_f32_16x16x32_bf16 a[144:147], a[196:199], v[208:211], a[144:147]
 v_exp_f32 v153, v237
 v_mfma_f32_16x16x32_bf16 a[148:151], a[196:199], v[212:215], a[148:151]
 ds_read_b128 a[220:223], v13 offset:12416
 v_add_f32 v149, v149, v152
 v_mfma_f32_16x16x32_bf16 a[152:155], a[196:199], v[216:219], a[152:155]
 s_add_u32 m0, s80, 122880
 s_mov_b32 s76, 135168
 v_mfma_f32_16x16x32_bf16 a[156:159], a[196:199], v[220:223], a[156:159]
 ds_read_b128 a[224:227], v12 offset:12544
 s_waitcnt lgkmcnt(5)
 v_mfma_f32_16x16x32_bf16 a[160:163], a[200:203], v[208:211], a[160:163]
 v_exp_f32 v154, v238
 v_mfma_f32_16x16x32_bf16 a[164:167], a[200:203], v[212:215], a[164:167]
 ds_read_b128 a[228:231], v13 offset:12544
 v_add_f32 v149, v149, v153
 v_mfma_f32_16x16x32_bf16 a[168:171], a[200:203], v[216:219], a[168:171]
 buffer_load_dwordx4 v4, s[32:35], s76 offen offset:0 nt lds
 v_mfma_f32_16x16x32_bf16 a[172:175], a[200:203], v[220:223], a[172:175]
 v_cvt_pk_bf16_f32 v198, v152, v153
 v_exp_f32 v155, v239
 v_mfma_f32_16x16x32_bf16 a[176:179], a[204:207], v[208:211], a[176:179]
 v_add_f32 v149, v149, v154
 v_add_f32 v149, v149, v155
 v_mfma_f32_16x16x32_bf16 a[180:183], a[204:207], v[212:215], a[180:183]
 v_exp_f32 v156, v240
 v_mfma_f32_16x16x32_bf16 a[184:187], a[204:207], v[216:219], a[184:187]
 v_cvt_pk_bf16_f32 v199, v154, v155
 v_mfma_f32_16x16x32_bf16 a[188:191], a[204:207], v[220:223], a[188:191]
 s_waitcnt lgkmcnt(3)
 v_mfma_f32_16x16x32_bf16 v[160:163], a[208:211], v[32:35], v[128:131]
 v_exp_f32 v157, v241
 v_mfma_f32_16x16x32_bf16 v[160:163], a[212:215], v[48:51], v[160:163]
 ds_read_b128 a[232:235], v12 offset:18432
 v_add_f32 v150, v156, v157
 v_mfma_f32_16x16x32_bf16 v[160:163], a[216:219], v[64:67], v[160:163]
 ds_read_b128 a[236:239], v13 offset:18432
 s_waitcnt lgkmcnt(2)
 v_mfma_f32_16x16x32_bf16 v[160:163], a[220:223], v[80:83], v[160:163]
 v_exp_f32 v152, v242
 v_mfma_f32_16x16x32_bf16 v[160:163], a[224:227], v[96:99], v[160:163]
 v_cvt_pk_bf16_f32 v200, v156, v157
 v_add_f32 v150, v150, v152
 v_mfma_f32_16x16x32_bf16 v[160:163], a[228:231], v[112:115], v[160:163]
 ds_read_b128 a[240:243], v12 offset:18560
 v_mfma_f32_16x16x32_bf16 v[168:171], a[208:211], v[36:39], v[132:135]
 v_exp_f32 v153, v243
 v_mfma_f32_16x16x32_bf16 v[168:171], a[212:215], v[52:55], v[168:171]
 v_add_f32 v150, v150, v153
 v_cvt_pk_bf16_f32 v201, v152, v153
 v_mfma_f32_16x16x32_bf16 v[168:171], a[216:219], v[68:71], v[168:171]
 v_exp_f32 v154, v244
 v_mfma_f32_16x16x32_bf16 v[168:171], a[220:223], v[84:87], v[168:171]
 ds_read_b128 a[244:247], v13 offset:18560
 v_add_f32 v150, v150, v154
 v_mfma_f32_16x16x32_bf16 v[168:171], a[224:227], v[100:103], v[168:171]
 v_mfma_f32_16x16x32_bf16 v[168:171], a[228:231], v[116:119], v[168:171]
 v_exp_f32 v155, v245
 v_mfma_f32_16x16x32_bf16 v[176:179], a[208:211], v[40:43], v[136:139]
 ds_read_b128 a[248:251], v12 offset:18688
 v_add_f32 v150, v150, v155
 v_mfma_f32_16x16x32_bf16 v[176:179], a[212:215], v[56:59], v[176:179]
 buffer_load_dwordx4 v5, s[32:35], s76 offen offset:1024 nt lds
 v_mfma_f32_16x16x32_bf16 v[176:179], a[216:219], v[72:75], v[176:179]
 v_exp_f32 v156, v246
 v_mfma_f32_16x16x32_bf16 v[176:179], a[220:223], v[88:91], v[176:179]
 ds_read_b128 a[252:255], v13 offset:18688
 v_cvt_pk_bf16_f32 v202, v154, v155
 v_mfma_f32_16x16x32_bf16 v[176:179], a[224:227], v[104:107], v[176:179]
 v_add_f32 v150, v150, v156
 v_mfma_f32_16x16x32_bf16 v[176:179], a[228:231], v[120:123], v[176:179]
 v_exp_f32 v157, v247
 v_mfma_f32_16x16x32_bf16 v[184:187], a[208:211], v[44:47], v[140:143]
 v_add_f32 v150, v150, v157
 v_cvt_pk_bf16_f32 v203, v156, v157
 v_mfma_f32_16x16x32_bf16 v[184:187], a[212:215], v[60:63], v[184:187]
 v_max3_f32 v158, v148, v149, v150
 v_mfma_f32_16x16x32_bf16 v[184:187], a[216:219], v[76:79], v[184:187]
 v_exp_f32 v152, v248
 v_mfma_f32_16x16x32_bf16 v[184:187], a[220:223], v[92:95], v[184:187]
 v_mfma_f32_16x16x32_bf16 v[184:187], a[224:227], v[108:111], v[184:187]
 v_mfma_f32_16x16x32_bf16 v[184:187], a[228:231], v[124:127], v[184:187]
 s_waitcnt lgkmcnt(3)
 v_mfma_f32_16x16x32_bf16 v[164:167], a[232:235], v[32:35], v[128:131]
 v_exp_f32 v153, v249
 v_mfma_f32_16x16x32_bf16 v[164:167], a[236:239], v[48:51], v[164:167]
 v_exp_f32 v154, v250
 v_mfma_f32_16x16x32_bf16 v[164:167], a[240:243], v[64:67], v[164:167]
 v_add_f32 v151, v152, v153
 s_waitcnt lgkmcnt(0)
 v_mfma_f32_16x16x32_bf16 v[164:167], a[244:247], v[80:83], v[164:167]
 v_cvt_pk_bf16_f32 v204, v152, v153
 v_add_f32 v151, v151, v154
 v_mfma_f32_16x16x32_bf16 v[164:167], a[248:251], v[96:99], v[164:167]
 s_waitcnt vmcnt(8)
 s_barrier
 v_mfma_f32_16x16x32_bf16 v[164:167], a[252:255], v[112:115], v[164:167]
 v_exp_f32 v155, v251
 v_mfma_f32_16x16x32_bf16 v[172:175], a[232:235], v[36:39], v[132:135]
 ds_read_b64_tr_b16 a[192:193], v14 offset:12288
 v_add_f32 v151, v151, v155
 v_mfma_f32_16x16x32_bf16 v[172:175], a[236:239], v[52:55], v[172:175]
 v_exp_f32 v156, v252
 v_mfma_f32_16x16x32_bf16 v[172:175], a[240:243], v[68:71], v[172:175]
 ds_read_b64_tr_b16 a[194:195], v14 offset:18432
 v_cvt_pk_bf16_f32 v205, v154, v155
 v_mfma_f32_16x16x32_bf16 v[172:175], a[244:247], v[84:87], v[172:175]
 buffer_load_dwordx4 v6, s[32:35], s76 offen offset:2048 nt lds
 v_mfma_f32_16x16x32_bf16 v[172:175], a[248:251], v[100:103], v[172:175]
 v_exp_f32 v157, v253
 v_mfma_f32_16x16x32_bf16 v[172:175], a[252:255], v[116:119], v[172:175]
 ds_read_b64_tr_b16 a[196:197], v15 offset:12288
 ds_read_b64_tr_b16 a[198:199], v15 offset:18432
 v_mfma_f32_16x16x32_bf16 v[180:183], a[232:235], v[40:43], v[136:139]
 v_add_f32 v151, v151, v156
 v_add_f32 v151, v151, v157
 v_mfma_f32_16x16x32_bf16 v[180:183], a[236:239], v[56:59], v[180:183]
 v_exp_f32 v152, v254
 v_mfma_f32_16x16x32_bf16 v[180:183], a[240:243], v[72:75], v[180:183]
 ds_read_b64_tr_b16 a[200:201], v16 offset:12288
 v_cvt_pk_bf16_f32 v206, v156, v157
 v_mfma_f32_16x16x32_bf16 v[180:183], a[244:247], v[88:91], v[180:183]
 v_add_f32 v151, v151, v152
 v_mfma_f32_16x16x32_bf16 v[180:183], a[248:251], v[104:107], v[180:183]
 v_exp_f32 v153, v255
 v_mfma_f32_16x16x32_bf16 v[180:183], a[252:255], v[120:123], v[180:183]
 ds_read_b64_tr_b16 a[202:203], v16 offset:18432
 v_add_f32 v151, v151, v153
 v_mfma_f32_16x16x32_bf16 v[188:191], a[232:235], v[44:47], v[140:143]
 ds_read_b64_tr_b16 a[204:205], v17 offset:12288
 v_cvt_pk_bf16_f32 v207, v152, v153
 v_mfma_f32_16x16x32_bf16 v[188:191], a[236:239], v[60:63], v[188:191]
 v_mfma_f32_16x16x32_bf16 v[188:191], a[240:243], v[76:79], v[188:191]
 ds_read_b64_tr_b16 a[206:207], v17 offset:18432
 v_max_f32 v158, v158, v151
 v_mfma_f32_16x16x32_bf16 v[188:191], a[244:247], v[92:95], v[188:191]
 v_cmp_lt_f32 vcc, s72, v158
 v_mfma_f32_16x16x32_bf16 v[188:191], a[248:251], v[108:111], v[188:191]
 v_mfma_f32_16x16x32_bf16 v[188:191], a[252:255], v[124:127], v[188:191]
 s_cbranch_vccnz L_S_7
L_R_7:
 s_waitcnt lgkmcnt(4)
 v_mfma_f32_16x16x32_bf16 a[0:3], a[192:195], v[192:195], a[0:3]
 v_exp_f32 v152, v160
 v_mfma_f32_16x16x32_bf16 a[4:7], a[192:195], v[196:199], a[4:7]
 ds_read_b64_tr_b16 a[208:209], v14 offset:12416
 v_add_f32 v144, v144, v148
 v_mfma_f32_16x16x32_bf16 a[8:11], a[192:195], v[200:203], a[8:11]
 v_exp_f32 v153, v161
 v_mfma_f32_16x16x32_bf16 a[12:15], a[192:195], v[204:207], a[12:15]
 ds_read_b64_tr_b16 a[210:211], v14 offset:18560
 v_add_f32 v148, v152, v153
 v_mfma_f32_16x16x32_bf16 a[16:19], a[196:199], v[192:195], a[16:19]
 s_add_u32 m0, s80, 61440
 s_mov_b32 s76, 159744
 v_mfma_f32_16x16x32_bf16 a[20:23], a[196:199], v[196:199], a[20:23]
 v_exp_f32 v154, v162
 v_mfma_f32_16x16x32_bf16 a[24:27], a[196:199], v[200:203], a[24:27]
 ds_read_b64_tr_b16 a[212:213], v15 offset:12416
 ds_read_b64_tr_b16 a[214:215], v15 offset:18560
 v_mfma_f32_16x16x32_bf16 a[28:31], a[196:199], v[204:207], a[28:31]
 buffer_load_dwordx4 v1, s[28:31], s76 offen offset:0 nt lds
 s_waitcnt lgkmcnt(4)
 v_mfma_f32_16x16x32_bf16 a[32:35], a[200:203], v[192:195], a[32:35]
 v_cvt_pk_bf16_f32 v208, v152, v153
 ds_read_b64_tr_b16 a[216:217], v16 offset:12416
 v_mfma_f32_16x16x32_bf16 a[36:39], a[200:203], v[196:199], a[36:39]
 v_exp_f32 v155, v163
 v_mfma_f32_16x16x32_bf16 a[40:43], a[200:203], v[200:203], a[40:43]
 ds_read_b64_tr_b16 a[218:219], v16 offset:18560
 v_add_f32 v148, v148, v154
 v_mfma_f32_16x16x32_bf16 a[44:47], a[200:203], v[204:207], a[44:47]
 v_exp_f32 v156, v164
 v_mfma_f32_16x16x32_bf16 a[48:51], a[204:207], v[192:195], a[48:51]
 ds_read_b64_tr_b16 a[220:221], v17 offset:12416
 v_add_f32 v148, v148, v155
 v_mfma_f32_16x16x32_bf16 a[52:55], a[204:207], v[196:199], a[52:55]
 v_cvt_pk_bf16_f32 v209, v154, v155
 ds_read_b64_tr_b16 a[222:223], v17 offset:18560
 v_mfma_f32_16x16x32_bf16 a[56:59], a[204:207], v[200:203], a[56:59]
 v_exp_f32 v157, v165
 v_mfma_f32_16x16x32_bf16 a[60:63], a[204:207], v[204:207], a[60:63]
 v_add_f32 v148, v148, v156
 s_waitcnt lgkmcnt(4)
 v_mfma_f32_16x16x32_bf16 a[64:67], a[208:211], v[192:195], a[64:67]
 ds_read_b64_tr_b16 a[224:225], v14 offset:12544
 v_add_f32 v148, v148, v157
 v_mfma_f32_16x16x32_bf16 a[68:71], a[208:211], v[196:199], a[68:71]
 v_exp_f32 v152, v166
 v_mfma_f32_16x16x32_bf16 a[72:75], a[208:211], v[200:203], a[72:75]
 ds_read_b64_tr_b16 a[226:227], v14 offset:18688
 v_cvt_pk_bf16_f32 v210, v156, v157
 v_mfma_f32_16x16x32_bf16 a[76:79], a[208:211], v[204:207], a[76:79]
 v_exp_f32 v153, v167
 v_mfma_f32_16x16x32_bf16 a[80:83], a[212:215], v[192:195], a[80:83]
 ds_read_b64_tr_b16 a[228:229], v15 offset:12544
 v_add_f32 v148, v148, v152
 v_mfma_f32_16x16x32_bf16 a[84:87], a[212:215], v[196:199], a[84:87]
 ds_read_b64_tr_b16 a[230:231], v15 offset:18688
 v_add_f32 v148, v148, v153
 v_mfma_f32_16x16x32_bf16 a[88:91], a[212:215], v[200:203], a[88:91]
 v_exp_f32 v154, v168
 v_mfma_f32_16x16x32_bf16 a[92:95], a[212:215], v[204:207], a[92:95]
 v_cvt_pk_bf16_f32 v211, v152, v153
 s_waitcnt lgkmcnt(4)
 v_mfma_f32_16x16x32_bf16 a[96:99], a[216:219], v[192:195], a[96:99]
 v_add_f32 v145, v145, v149
 ds_read_b64_tr_b16 a[232:233], v16 offset:12544
 v_mfma_f32_16x16x32_bf16 a[100:103], a[216:219], v[196:199], a[100:103]
 v_exp_f32 v155, v169
 v_mfma_f32_16x16x32_bf16 a[104:107], a[216:219], v[200:203], a[104:107]
 buffer_load_dwordx4 v2, s[28:31], s76 offen offset:1024 nt lds
 v_mfma_f32_16x16x32_bf16 a[108:111], a[216:219], v[204:207], a[108:111]
 ds_read_b64_tr_b16 a[234:235], v16 offset:18688
 v_add_f32 v149, v154, v155
 v_mfma_f32_16x16x32_bf16 a[112:115], a[220:223], v[192:195], a[112:115]
 v_exp_f32 v156, v170
 v_mfma_f32_16x16x32_bf16 a[116:119], a[220:223], v[196:199], a[116:119]
 ds_read_b64_tr_b16 a[236:237], v17 offset:12544
 ds_read_b64_tr_b16 a[238:239], v17 offset:18688
 v_mfma_f32_16x16x32_bf16 a[120:123], a[220:223], v[200:203], a[120:123]
 v_cvt_pk_bf16_f32 v212, v154, v155
 ds_read_b128 a[240:243], v12 offset:24576
 v_mfma_f32_16x16x32_bf16 a[124:127], a[220:223], v[204:207], a[124:127]
 v_add_f32 v149, v149, v156
 s_waitcnt lgkmcnt(5)
 v_mfma_f32_16x16x32_bf16 a[128:131], a[224:227], v[192:195], a[128:131]
 v_exp_f32 v157, v171
 v_mfma_f32_16x16x32_bf16 a[132:135], a[224:227], v[196:199], a[132:135]
 ds_read_b128 a[244:247], v13 offset:24576
 v_add_f32 v149, v149, v157
 v_mfma_f32_16x16x32_bf16 a[136:139], a[224:227], v[200:203], a[136:139]
 v_exp_f32 v152, v172
 v_mfma_f32_16x16x32_bf16 a[140:143], a[224:227], v[204:207], a[140:143]
 ds_read_b128 a[248:251], v12 offset:24704
 v_cvt_pk_bf16_f32 v213, v156, v157
 v_mfma_f32_16x16x32_bf16 a[144:147], a[228:231], v[192:195], a[144:147]
 v_exp_f32 v153, v173
 v_mfma_f32_16x16x32_bf16 a[148:151], a[228:231], v[196:199], a[148:151]
 ds_read_b128 a[252:255], v13 offset:24704
 v_add_f32 v149, v149, v152
 v_mfma_f32_16x16x32_bf16 a[152:155], a[228:231], v[200:203], a[152:155]
 ds_read_b128 a[192:195], v12 offset:24832
 v_add_f32 v149, v149, v153
 v_mfma_f32_16x16x32_bf16 a[156:159], a[228:231], v[204:207], a[156:159]
 v_cvt_pk_bf16_f32 v214, v152, v153
 s_waitcnt lgkmcnt(5)
 v_mfma_f32_16x16x32_bf16 a[160:163], a[232:235], v[192:195], a[160:163]
 v_exp_f32 v154, v174
 v_mfma_f32_16x16x32_bf16 a[164:167], a[232:235], v[196:199], a[164:167]
 ds_read_b128 a[196:199], v13 offset:24832
 v_add_f32 v149, v149, v154
 v_mfma_f32_16x16x32_bf16 a[168:171], a[232:235], v[200:203], a[168:171]
 v_exp_f32 v155, v175
 v_mfma_f32_16x16x32_bf16 a[172:175], a[232:235], v[204:207], a[172:175]
 v_add_f32 v149, v149, v155
 v_cvt_pk_bf16_f32 v215, v154, v155
 v_mfma_f32_16x16x32_bf16 a[176:179], a[236:239], v[192:195], a[176:179]
 buffer_load_dwordx4 v3, s[28:31], s76 offen offset:2048 nt lds
 v_mfma_f32_16x16x32_bf16 a[180:183], a[236:239], v[196:199], a[180:183]
 v_exp_f32 v156, v176
 v_mfma_f32_16x16x32_bf16 a[184:187], a[236:239], v[200:203], a[184:187]
 v_add_f32 v146, v146, v150
 v_add_f32 v147, v147, v151
 v_mfma_f32_16x16x32_bf16 a[188:191], a[236:239], v[204:207], a[188:191]
 s_waitcnt lgkmcnt(3)
 v_mfma_f32_16x16x32_bf16 v[224:227], a[240:243], v[32:35], v[128:131]
 v_exp_f32 v157, v177
 v_mfma_f32_16x16x32_bf16 v[224:227], a[244:247], v[48:51], v[224:227]
 ds_read_b128 a[200:203], v12 offset:30720
 v_add_f32 v150, v156, v157
 v_mfma_f32_16x16x32_bf16 v[224:227], a[248:251], v[64:67], v[224:227]
 ds_read_b128 a[204:207], v13 offset:30720
 s_waitcnt lgkmcnt(2)
 v_mfma_f32_16x16x32_bf16 v[224:227], a[252:255], v[80:83], v[224:227]
 v_exp_f32 v152, v178
 v_mfma_f32_16x16x32_bf16 v[224:227], a[192:195], v[96:99], v[224:227]
 v_cvt_pk_bf16_f32 v216, v156, v157
 v_add_f32 v150, v150, v152
 v_mfma_f32_16x16x32_bf16 v[224:227], a[196:199], v[112:115], v[224:227]
 ds_read_b128 a[208:211], v12 offset:30848
 v_mfma_f32_16x16x32_bf16 v[232:235], a[240:243], v[36:39], v[132:135]
 v_exp_f32 v153, v179
 v_mfma_f32_16x16x32_bf16 v[232:235], a[244:247], v[52:55], v[232:235]
 v_add_f32 v150, v150, v153
 v_cvt_pk_bf16_f32 v217, v152, v153
 v_mfma_f32_16x16x32_bf16 v[232:235], a[248:251], v[68:71], v[232:235]
 v_exp_f32 v154, v180
 v_mfma_f32_16x16x32_bf16 v[232:235], a[252:255], v[84:87], v[232:235]
 ds_read_b128 a[212:215], v13 offset:30848
 v_add_f32 v150, v150, v154
 v_mfma_f32_16x16x32_bf16 v[232:235], a[192:195], v[100:103], v[232:235]
 s_add_u32 m0, s80, 135168
 s_mov_b32 s76, 147456
 v_mfma_f32_16x16x32_bf16 v[232:235], a[196:199], v[116:119], v[232:235]
 v_exp_f32 v155, v181
 v_mfma_f32_16x16x32_bf16 v[240:243], a[240:243], v[40:43], v[136:139]
 ds_read_b128 a[216:219], v12 offset:30976
 v_add_f32 v150, v150, v155
 v_mfma_f32_16x16x32_bf16 v[240:243], a[244:247], v[56:59], v[240:243]
 v_cvt_pk_bf16_f32 v218, v154, v155
 v_mfma_f32_16x16x32_bf16 v[240:243], a[248:251], v[72:75], v[240:243]
 v_exp_f32 v156, v182
 v_mfma_f32_16x16x32_bf16 v[240:243], a[252:255], v[88:91], v[240:243]
 ds_read_b128 a[220:223], v13 offset:30976
 v_add_f32 v150, v150, v156
 v_mfma_f32_16x16x32_bf16 v[240:243], a[192:195], v[104:107], v[240:243]
 buffer_load_dwordx4 v4, s[32:35], s76 offen offset:0 nt lds
 v_mfma_f32_16x16x32_bf16 v[240:243], a[196:199], v[120:123], v[240:243]
 v_exp_f32 v157, v183
 v_mfma_f32_16x16x32_bf16 v[248:251], a[240:243], v[44:47], v[140:143]
 v_add_f32 v150, v150, v157
 v_cvt_pk_bf16_f32 v219, v156, v157
 v_mfma_f32_16x16x32_bf16 v[248:251], a[244:247], v[60:63], v[248:251]
 v_add_u32 v12, 36864, v12
 v_add_u32 v13, 36864, v13
 v_mfma_f32_16x16x32_bf16 v[248:251], a[248:251], v[76:79], v[248:251]
 v_exp_f32 v152, v184
 v_mfma_f32_16x16x32_bf16 v[248:251], a[252:255], v[92:95], v[248:251]
 v_max3_f32 v158, v148, v149, v150
 v_mfma_f32_16x16x32_bf16 v[248:251], a[192:195], v[108:111], v[248:251]
 v_mfma_f32_16x16x32_bf16 v[248:251], a[196:199], v[124:127], v[248:251]
 s_waitcnt lgkmcnt(3)
 v_mfma_f32_16x16x32_bf16 v[228:231], a[200:203], v[32:35], v[128:131]
 v_exp_f32 v153, v185
 v_mfma_f32_16x16x32_bf16 v[228:231], a[204:207], v[48:51], v[228:231]
 v_exp_f32 v154, v186
 v_mfma_f32_16x16x32_bf16 v[228:231], a[208:211], v[64:67], v[228:231]
 v_add_f32 v151, v152, v153
 s_waitcnt lgkmcnt(0)
 v_mfma_f32_16x16x32_bf16 v[228:231], a[212:215], v[80:83], v[228:231]
 v_cvt_pk_bf16_f32 v220, v152, v153
 v_add_f32 v151, v151, v154
 v_mfma_f32_16x16x32_bf16 v[228:231], a[216:219], v[96:99], v[228:231]
 v_exp_f32 v155, v187
 v_mfma_f32_16x16x32_bf16 v[228:231], a[220:223], v[112:115], v[228:231]
 v_add_f32 v151, v151, v155
 v_cvt_pk_bf16_f32 v221, v154, v155
 v_mfma_f32_16x16x32_bf16 v[236:239], a[200:203], v[36:39], v[132:135]
 ds_read_b64_tr_b16 a[224:225], v14 offset:24576
 v_mfma_f32_16x16x32_bf16 v[236:239], a[204:207], v[52:55], v[236:239]
 v_exp_f32 v156, v188
 v_mfma_f32_16x16x32_bf16 v[236:239], a[208:211], v[68:71], v[236:239]
 ds_read_b64_tr_b16 a[226:227], v14 offset:30720
 v_add_f32 v151, v151, v156
 v_mfma_f32_16x16x32_bf16 v[236:239], a[212:215], v[84:87], v[236:239]
 ds_read_b64_tr_b16 a[228:229], v15 offset:24576
 v_mfma_f32_16x16x32_bf16 v[236:239], a[216:219], v[100:103], v[236:239]
 v_exp_f32 v157, v189
 v_mfma_f32_16x16x32_bf16 v[236:239], a[220:223], v[116:119], v[236:239]
 ds_read_b64_tr_b16 a[230:231], v15 offset:30720
 v_add_f32 v151, v151, v157
 v_mfma_f32_16x16x32_bf16 v[244:247], a[200:203], v[40:43], v[136:139]
 buffer_load_dwordx4 v5, s[32:35], s76 offen offset:1024 nt lds
 v_mfma_f32_16x16x32_bf16 v[244:247], a[204:207], v[56:59], v[244:247]
 v_exp_f32 v152, v190
 v_mfma_f32_16x16x32_bf16 v[244:247], a[208:211], v[72:75], v[244:247]
 ds_read_b64_tr_b16 a[232:233], v16 offset:24576
 v_cvt_pk_bf16_f32 v222, v156, v157
 v_mfma_f32_16x16x32_bf16 v[244:247], a[212:215], v[88:91], v[244:247]
 v_add_f32 v151, v151, v152
 v_mfma_f32_16x16x32_bf16 v[244:247], a[216:219], v[104:107], v[244:247]
 v_exp_f32 v153, v191
 v_mfma_f32_16x16x32_bf16 v[244:247], a[220:223], v[120:123], v[244:247]
 ds_read_b64_tr_b16 a[234:235], v16 offset:30720
 v_add_f32 v151, v151, v153
 v_mfma_f32_16x16x32_bf16 v[252:255], a[200:203], v[44:47], v[140:143]
 ds_read_b64_tr_b16 a[236:237], v17 offset:24576
 v_cvt_pk_bf16_f32 v223, v152, v153
 v_mfma_f32_16x16x32_bf16 v[252:255], a[204:207], v[60:63], v[252:255]
 v_mfma_f32_16x16x32_bf16 v[252:255], a[208:211], v[76:79], v[252:255]
 ds_read_b64_tr_b16 a[238:239], v17 offset:30720
 v_max_f32 v158, v158, v151
 v_mfma_f32_16x16x32_bf16 v[252:255], a[212:215], v[92:95], v[252:255]
 v_cmp_lt_f32 vcc, s72, v158
 v_mfma_f32_16x16x32_bf16 v[252:255], a[216:219], v[108:111], v[252:255]
 v_mfma_f32_16x16x32_bf16 v[252:255], a[220:223], v[124:127], v[252:255]
 s_cbranch_vccnz L_S_8
L_R_8:
 s_waitcnt lgkmcnt(4)
 v_mfma_f32_16x16x32_bf16 a[0:3], a[224:227], v[208:211], a[0:3]
 v_exp_f32 v152, v224
 v_mfma_f32_16x16x32_bf16 a[4:7], a[224:227], v[212:215], a[4:7]
 ds_read_b64_tr_b16 a[240:241], v14 offset:24704
 v_add_f32 v144, v144, v148
 v_mfma_f32_16x16x32_bf16 a[8:11], a[224:227], v[216:219], a[8:11]
 v_exp_f32 v153, v225
 v_mfma_f32_16x16x32_bf16 a[12:15], a[224:227], v[220:223], a[12:15]
 ds_read_b64_tr_b16 a[242:243], v14 offset:30848
 v_add_f32 v148, v152, v153
 v_mfma_f32_16x16x32_bf16 a[16:19], a[228:231], v[208:211], a[16:19]
 ds_read_b64_tr_b16 a[244:245], v15 offset:24704
 v_cvt_pk_bf16_f32 v192, v152, v153
 v_mfma_f32_16x16x32_bf16 a[20:23], a[228:231], v[212:215], a[20:23]
 v_exp_f32 v154, v226
 v_mfma_f32_16x16x32_bf16 a[24:27], a[228:231], v[216:219], a[24:27]
 ds_read_b64_tr_b16 a[246:247], v15 offset:30848
 v_add_f32 v148, v148, v154
 v_mfma_f32_16x16x32_bf16 a[28:31], a[228:231], v[220:223], a[28:31]
 v_add_f32 v145, v145, v149
 s_waitcnt lgkmcnt(4)
 v_mfma_f32_16x16x32_bf16 a[32:35], a[232:235], v[208:211], a[32:35]
 v_exp_f32 v155, v227
 v_mfma_f32_16x16x32_bf16 a[36:39], a[232:235], v[212:215], a[36:39]
 ds_read_b64_tr_b16 a[248:249], v16 offset:24704
 ds_read_b64_tr_b16 a[250:251], v16 offset:30848
 v_mfma_f32_16x16x32_bf16 a[40:43], a[232:235], v[216:219], a[40:43]
 buffer_load_dwordx4 v6, s[32:35], s76 offen offset:2048 nt lds
 v_mfma_f32_16x16x32_bf16 a[44:47], a[232:235], v[220:223], a[44:47]
 v_exp_f32 v156, v228
 v_mfma_f32_16x16x32_bf16 a[48:51], a[236:239], v[208:211], a[48:51]
 ds_read_b64_tr_b16 a[252:253], v17 offset:24704
 v_add_f32 v148, v148, v155
 v_mfma_f32_16x16x32_bf16 a[52:55], a[236:239], v[212:215], a[52:55]
 v_cvt_pk_bf16_f32 v193, v154, v155
 ds_read_b64_tr_b16 a[254:255], v17 offset:30848
 v_mfma_f32_16x16x32_bf16 a[56:59], a[236:239], v[216:219], a[56:59]
 v_exp_f32 v157, v229
 v_mfma_f32_16x16x32_bf16 a[60:63], a[236:239], v[220:223], a[60:63]
 v_add_f32 v148, v148, v156
 s_waitcnt lgkmcnt(4)
 v_mfma_f32_16x16x32_bf16 a[64:67], a[240:243], v[208:211], a[64:67]
 ds_read_b64_tr_b16 a[192:193], v14 offset:24832
 v_add_f32 v148, v148, v157
 v_mfma_f32_16x16x32_bf16 a[68:71], a[240:243], v[212:215], a[68:71]
 v_exp_f32 v152, v230
 v_mfma_f32_16x16x32_bf16 a[72:75], a[240:243], v[216:219], a[72:75]
 ds_read_b64_tr_b16 a[194:195], v14 offset:30976
 v_cvt_pk_bf16_f32 v194, v156, v157
 v_mfma_f32_16x16x32_bf16 a[76:79], a[240:243], v[220:223], a[76:79]
 v_exp_f32 v153, v231
 v_mfma_f32_16x16x32_bf16 a[80:83], a[244:247], v[208:211], a[80:83]
 ds_read_b64_tr_b16 a[196:197], v15 offset:24832
 v_add_f32 v148, v148, v152
 v_mfma_f32_16x16x32_bf16 a[84:87], a[244:247], v[212:215], a[84:87]
 ds_read_b64_tr_b16 a[198:199], v15 offset:30976
 v_add_f32 v148, v148, v153
 v_mfma_f32_16x16x32_bf16 a[88:91], a[244:247], v[216:219], a[88:91]
 v_exp_f32 v154, v232
 v_mfma_f32_16x16x32_bf16 a[92:95], a[244:247], v[220:223], a[92:95]
 v_cvt_pk_bf16_f32 v195, v152, v153
 s_waitcnt lgkmcnt(4)
 v_mfma_f32_16x16x32_bf16 a[96:99], a[248:251], v[208:211], a[96:99]
 ds_read_b64_tr_b16 a[200:201], v16 offset:24832
 v_add_f32 v146, v146, v150
 v_mfma_f32_16x16x32_bf16 a[100:103], a[248:251], v[212:215], a[100:103]
 v_exp_f32 v155, v233
 v_mfma_f32_16x16x32_bf16 a[104:107], a[248:251], v[216:219], a[104:107]
 s_add_u32 m0, s80, 0
 s_mov_b32 s76, 172032
 v_mfma_f32_16x16x32_bf16 a[108:111], a[248:251], v[220:223], a[108:111]
 ds_read_b64_tr_b16 a[202:203], v16 offset:30976
 v_add_f32 v149, v154, v155
 v_mfma_f32_16x16x32_bf16 a[112:115], a[252:255], v[208:211], a[112:115]
 v_exp_f32 v156, v234
 v_mfma_f32_16x16x32_bf16 a[116:119], a[252:255], v[212:215], a[116:119]
 buffer_load_dwordx4 v1, s[28:31], s76 offen offset:0 nt lds
 v_mfma_f32_16x16x32_bf16 a[120:123], a[252:255], v[216:219], a[120:123]
 ds_read_b64_tr_b16 a[204:205], v17 offset:24832
 ds_read_b64_tr_b16 a[206:207], v17 offset:30976
 v_mfma_f32_16x16x32_bf16 a[124:127], a[252:255], v[220:223], a[124:127]
 v_cvt_pk_bf16_f32 v196, v154, v155
 s_waitcnt lgkmcnt(4)
 v_mfma_f32_16x16x32_bf16 a[128:131], a[192:195], v[208:211], a[128:131]
 v_exp_f32 v157, v235
 v_mfma_f32_16x16x32_bf16 a[132:135], a[192:195], v[212:215], a[132:135]
 ds_read_b128 a[208:211], v12 offset:0
 ds_read_b128 a[212:215], v13 offset:0
 v_mfma_f32_16x16x32_bf16 a[136:139], a[192:195], v[216:219], a[136:139]
 v_add_f32 v149, v149, v156
 ds_read_b128 a[216:219], v12 offset:128
 v_mfma_f32_16x16x32_bf16 a[140:143], a[192:195], v[220:223], a[140:143]
 v_exp_f32 v152, v236
 v_mfma_f32_16x16x32_bf16 a[144:147], a[196:199], v[208:211], a[144:147]
 v_exp_f32 v153, v237
 v_mfma_f32_16x16x32_bf16 a[148:151], a[196:199], v[212:215], a[148:151]
 v_add_f32 v149, v149, v157
 v_cvt_pk_bf16_f32 v197, v156, v157
 v_mfma_f32_16x16x32_bf16 a[152:155], a[196:199], v[216:219], a[152:155]
 ds_read_b128 a[220:223], v13 offset:128
 ds_read_b128 a[224:227], v12 offset:256
 v_mfma_f32_16x16x32_bf16 a[156:159], a[196:199], v[220:223], a[156:159]
 v_add_f32 v149, v149, v152
 s_waitcnt lgkmcnt(5)
 v_mfma_f32_16x16x32_bf16 a[160:163], a[200:203], v[208:211], a[160:163]
 v_exp_f32 v154, v238
 v_mfma_f32_16x16x32_bf16 a[164:167], a[200:203], v[212:215], a[164:167]
 ds_read_b128 a[228:231], v13 offset:256
 v_add_f32 v149, v149, v153
 v_mfma_f32_16x16x32_bf16 a[168:171], a[200:203], v[216:219], a[168:171]
 v_cvt_pk_bf16_f32 v198, v152, v153
 v_add_f32 v149, v149, v154
 v_mfma_f32_16x16x32_bf16 a[172:175], a[200:203], v[220:223], a[172:175]
 v_exp_f32 v155, v239
 v_mfma_f32_16x16x32_bf16 a[176:179], a[204:207], v[208:211], a[176:179]
 v_add_f32 v149, v149, v155
 v_cvt_pk_bf16_f32 v199, v154, v155
 v_mfma_f32_16x16x32_bf16 a[180:183], a[204:207], v[212:215], a[180:183]
 v_exp_f32 v156, v240
 v_mfma_f32_16x16x32_bf16 a[184:187], a[204:207], v[216:219], a[184:187]
 v_add_f32 v147, v147, v151
 v_mfma_f32_16x16x32_bf16 a[188:191], a[204:207], v[220:223], a[188:191]
 s_waitcnt lgkmcnt(3)
 v_mfma_f32_16x16x32_bf16 v[160:163], a[208:211], v[32:35], v[128:131]
 v_exp_f32 v157, v241
 v_mfma_f32_16x16x32_bf16 v[160:163], a[212:215], v[48:51], v[160:163]
 buffer_load_dwordx4 v2, s[28:31], s76 offen offset:1024 nt lds
 v_mfma_f32_16x16x32_bf16 v[160:163], a[216:219], v[64:67], v[160:163]
 ds_read_b128 a[232:235], v12 offset:6144
 s_waitcnt lgkmcnt(1)
 v_mfma_f32_16x16x32_bf16 v[160:163], a[220:223], v[80:83], v[160:163]
 v_exp_f32 v152, v242
 v_mfma_f32_16x16x32_bf16 v[160:163], a[224:227], v[96:99], v[160:163]
 ds_read_b128 a[236:239], v13 offset:6144
 v_add_f32 v150, v156, v157
 v_mfma_f32_16x16x32_bf16 v[160:163], a[228:231], v[112:115], v[160:163]
 v_cvt_pk_bf16_f32 v200, v156, v157
 ds_read_b128 a[240:243], v12 offset:6272
 v_mfma_f32_16x16x32_bf16 v[168:171], a[208:211], v[36:39], v[132:135]
 v_exp_f32 v153, v243
 v_mfma_f32_16x16x32_bf16 v[168:171], a[212:215], v[52:55], v[168:171]
 v_add_f32 v150, v150, v152
 v_add_f32 v150, v150, v153
 v_mfma_f32_16x16x32_bf16 v[168:171], a[216:219], v[68:71], v[168:171]
 v_exp_f32 v154, v244
 v_mfma_f32_16x16x32_bf16 v[168:171], a[220:223], v[84:87], v[168:171]
 ds_read_b128 a[244:247], v13 offset:6272
 v_cvt_pk_bf16_f32 v201, v152, v153
 v_mfma_f32_16x16x32_bf16 v[168:171], a[224:227], v[100:103], v[168:171]
 v_add_f32 v150, v150, v154
 v_mfma_f32_16x16x32_bf16 v[168:171], a[228:231], v[116:119], v[168:171]
 v_exp_f32 v155, v245
 v_mfma_f32_16x16x32_bf16 v[176:179], a[208:211], v[40:43], v[136:139]
 ds_read_b128 a[248:251], v12 offset:6400
 v_add_f32 v150, v150, v155
 v_mfma_f32_16x16x32_bf16 v[176:179], a[212:215], v[56:59], v[176:179]
 v_cvt_pk_bf16_f32 v202, v154, v155
 v_mfma_f32_16x16x32_bf16 v[176:179], a[216:219], v[72:75], v[176:179]
 v_exp_f32 v156, v246
 v_mfma_f32_16x16x32_bf16 v[176:179], a[220:223], v[88:91], v[176:179]
 ds_read_b128 a[252:255], v13 offset:6400
 v_add_f32 v150, v150, v156
 v_mfma_f32_16x16x32_bf16 v[176:179], a[224:227], v[104:107], v[176:179]
 v_mfma_f32_16x16x32_bf16 v[176:179], a[228:231], v[120:123], v[176:179]
 v_exp_f32 v157, v247
 v_mfma_f32_16x16x32_bf16 v[184:187], a[208:211], v[44:47], v[140:143]
 buffer_load_dwordx4 v3, s[28:31], s76 offen offset:2048 nt lds
 v_mfma_f32_16x16x32_bf16 v[184:187], a[212:215], v[60:63], v[184:187]
 v_add_f32 v150, v150, v157
 v_cvt_pk_bf16_f32 v203, v156, v157
 v_mfma_f32_16x16x32_bf16 v[184:187], a[216:219], v[76:79], v[184:187]
 v_exp_f32 v152, v248
 v_mfma_f32_16x16x32_bf16 v[184:187], a[220:223], v[92:95], v[184:187]
 v_max3_f32 v158, v148, v149, v150
 v_mfma_f32_16x16x32_bf16 v[184:187], a[224:227], v[108:111], v[184:187]
 v_mfma_f32_16x16x32_bf16 v[184:187], a[228:231], v[124:127], v[184:187]
 s_waitcnt lgkmcnt(3)
 v_mfma_f32_16x16x32_bf16 v[164:167], a[232:235], v[32:35], v[128:131]
 v_exp_f32 v153, v249
 v_mfma_f32_16x16x32_bf16 v[164:167], a[236:239], v[48:51], v[164:167]
 v_exp_f32 v154, v250
 v_mfma_f32_16x16x32_bf16 v[164:167], a[240:243], v[64:67], v[164:167]
 v_add_f32 v151, v152, v153
 s_waitcnt lgkmcnt(0)
 v_mfma_f32_16x16x32_bf16 v[164:167], a[244:247], v[80:83], v[164:167]
 v_cvt_pk_bf16_f32 v204, v152, v153
 v_add_f32 v151, v151, v154
 v_mfma_f32_16x16x32_bf16 v[164:167], a[248:251], v[96:99], v[164:167]
 s_waitcnt vmcnt(12)
 s_barrier
 v_mfma_f32_16x16x32_bf16 v[164:167], a[252:255], v[112:115], v[164:167]
 v_exp_f32 v155, v251
 v_mfma_f32_16x16x32_bf16 v[172:175], a[232:235], v[36:39], v[132:135]
 ds_read_b64_tr_b16 a[192:193], v14 offset:36864
 v_add_f32 v151, v151, v155
 v_mfma_f32_16x16x32_bf16 v[172:175], a[236:239], v[52:55], v[172:175]
 v_exp_f32 v156, v252
 v_mfma_f32_16x16x32_bf16 v[172:175], a[240:243], v[68:71], v[172:175]
 ds_read_b64_tr_b16 a[194:195], v14 offset:43008
 v_cvt_pk_bf16_f32 v205, v154, v155
 v_mfma_f32_16x16x32_bf16 v[172:175], a[244:247], v[84:87], v[172:175]
 ds_read_b64_tr_b16 a[196:197], v15 offset:36864
 v_add_f32 v151, v151, v156
 v_mfma_f32_16x16x32_bf16 v[172:175], a[248:251], v[100:103], v[172:175]
 v_exp_f32 v157, v253
 v_mfma_f32_16x16x32_bf16 v[172:175], a[252:255], v[116:119], v[172:175]
 ds_read_b64_tr_b16 a[198:199], v15 offset:43008
 v_add_f32 v151, v151, v157
 v_mfma_f32_16x16x32_bf16 v[180:183], a[232:235], v[40:43], v[136:139]
 s_add_u32 m0, s80, 147456
 s_mov_b32 s76, 159744
 v_mfma_f32_16x16x32_bf16 v[180:183], a[236:239], v[56:59], v[180:183]
 v_exp_f32 v152, v254
 v_mfma_f32_16x16x32_bf16 v[180:183], a[240:243], v[72:75], v[180:183]
 ds_read_b64_tr_b16 a[200:201], v16 offset:36864
 v_cvt_pk_bf16_f32 v206, v156, v157
 v_mfma_f32_16x16x32_bf16 v[180:183], a[244:247], v[88:91], v[180:183]
 buffer_load_dwordx4 v4, s[32:35], s76 offen offset:0 nt lds
 v_mfma_f32_16x16x32_bf16 v[180:183], a[248:251], v[104:107], v[180:183]
 v_exp_f32 v153, v255
 v_mfma_f32_16x16x32_bf16 v[180:183], a[252:255], v[120:123], v[180:183]
 ds_read_b64_tr_b16 a[202:203], v16 offset:43008
 v_add_f32 v151, v151, v152
 v_mfma_f32_16x16x32_bf16 v[188:191], a[232:235], v[44:47], v[140:143]
 ds_read_b64_tr_b16 a[204:205], v17 offset:36864
 v_add_f32 v151, v151, v153
 v_mfma_f32_16x16x32_bf16 v[188:191], a[236:239], v[60:63], v[188:191]
 v_cvt_pk_bf16_f32 v207, v152, v153
 v_mfma_f32_16x16x32_bf16 v[188:191], a[240:243], v[76:79], v[188:191]
 ds_read_b64_tr_b16 a[206:207], v17 offset:43008
 v_max_f32 v158, v158, v151
 v_mfma_f32_16x16x32_bf16 v[188:191], a[244:247], v[92:95], v[188:191]
 v_cmp_lt_f32 vcc, s72, v158
 v_mfma_f32_16x16x32_bf16 v[188:191], a[248:251], v[108:111], v[188:191]
 v_mfma_f32_16x16x32_bf16 v[188:191], a[252:255], v[124:127], v[188:191]
 s_cbranch_vccnz L_S_9
L_R_9:
 s_waitcnt lgkmcnt(4)
 v_mfma_f32_16x16x32_bf16 a[0:3], a[192:195], v[192:195], a[0:3]
 v_exp_f32 v152, v160
 v_mfma_f32_16x16x32_bf16 a[4:7], a[192:195], v[196:199], a[4:7]
 ds_read_b64_tr_b16 a[208:209], v14 offset:36992
 v_add_f32 v144, v144, v148
 v_mfma_f32_16x16x32_bf16 a[8:11], a[192:195], v[200:203], a[8:11]
 v_exp_f32 v153, v161
 v_mfma_f32_16x16x32_bf16 a[12:15], a[192:195], v[204:207], a[12:15]
 ds_read_b64_tr_b16 a[210:211], v14 offset:43136
 v_add_f32 v148, v152, v153
 v_mfma_f32_16x16x32_bf16 a[16:19], a[196:199], v[192:195], a[16:19]
 ds_read_b64_tr_b16 a[212:213], v15 offset:36992
 v_cvt_pk_bf16_f32 v208, v152, v153
 v_mfma_f32_16x16x32_bf16 a[20:23], a[196:199], v[196:199], a[20:23]
 v_exp_f32 v154, v162
 v_mfma_f32_16x16x32_bf16 a[24:27], a[196:199], v[200:203], a[24:27]
 ds_read_b64_tr_b16 a[214:215], v15 offset:43136
 v_add_f32 v148, v148, v154
 v_mfma_f32_16x16x32_bf16 a[28:31], a[196:199], v[204:207], a[28:31]
 v_add_f32 v145, v145, v149
 s_waitcnt lgkmcnt(4)
 v_mfma_f32_16x16x32_bf16 a[32:35], a[200:203], v[192:195], a[32:35]
 v_exp_f32 v155, v163
 v_mfma_f32_16x16x32_bf16 a[36:39], a[200:203], v[196:199], a[36:39]
 ds_read_b64_tr_b16 a[216:217], v16 offset:36992
 ds_read_b64_tr_b16 a[218:219], v16 offset:43136
 v_mfma_f32_16x16x32_bf16 a[40:43], a[200:203], v[200:203], a[40:43]
 buffer_load_dwordx4 v5, s[32:35], s76 offen offset:1024 nt lds
 v_mfma_f32_16x16x32_bf16 a[44:47], a[200:203], v[204:207], a[44:47]
 v_exp_f32 v156, v164
 v_mfma_f32_16x16x32_bf16 a[48:51], a[204:207], v[192:195], a[48:51]
 ds_read_b64_tr_b16 a[220:221], v17 offset:36992
 v_add_f32 v148, v148, v155
 v_mfma_f32_16x16x32_bf16 a[52:55], a[204:207], v[196:199], a[52:55]
 v_cvt_pk_bf16_f32 v209, v154, v155
 ds_read_b64_tr_b16 a[222:223], v17 offset:43136
 v_mfma_f32_16x16x32_bf16 a[56:59], a[204:207], v[200:203], a[56:59]
 v_exp_f32 v157, v165
 v_mfma_f32_16x16x32_bf16 a[60:63], a[204:207], v[204:207], a[60:63]
 v_add_f32 v148, v148, v156
 s_waitcnt lgkmcnt(4)
 v_mfma_f32_16x16x32_bf16 a[64:67], a[208:211], v[192:195], a[64:67]
 ds_read_b64_tr_b16 a[224:225], v14 offset:37120
 v_add_f32 v148, v148, v157
 v_mfma_f32_16x16x32_bf16 a[68:71], a[208:211], v[196:199], a[68:71]
 v_exp_f32 v152, v166
 v_mfma_f32_16x16x32_bf16 a[72:75], a[208:211], v[200:203], a[72:75]
 ds_read_b64_tr_b16 a[226:227], v14 offset:43264
 v_cvt_pk_bf16_f32 v210, v156, v157
 v_mfma_f32_16x16x32_bf16 a[76:79], a[208:211], v[204:207], a[76:79]
 v_exp_f32 v153, v167
 v_mfma_f32_16x16x32_bf16 a[80:83], a[212:215], v[192:195], a[80:83]
 ds_read_b64_tr_b16 a[228:229], v15 offset:37120
 v_add_f32 v148, v148, v152
 v_mfma_f32_16x16x32_bf16 a[84:87], a[212:215], v[196:199], a[84:87]
 ds_read_b64_tr_b16 a[230:231], v15 offset:43264
 v_add_f32 v148, v148, v153
 v_mfma_f32_16x16x32_bf16 a[88:91], a[212:215], v[200:203], a[88:91]
 v_exp_f32 v154, v168
 v_mfma_f32_16x16x32_bf16 a[92:95], a[212:215], v[204:207], a[92:95]
 v_cvt_pk_bf16_f32 v211, v152, v153
 s_waitcnt lgkmcnt(4)
 v_mfma_f32_16x16x32_bf16 a[96:99], a[216:219], v[192:195], a[96:99]
 ds_read_b64_tr_b16 a[232:233], v16 offset:37120
 v_add_f32 v146, v146, v150
 v_mfma_f32_16x16x32_bf16 a[100:103], a[216:219], v[196:199], a[100:103]
 v_exp_f32 v155, v169
 v_mfma_f32_16x16x32_bf16 a[104:107], a[216:219], v[200:203], a[104:107]
 ds_read_b64_tr_b16 a[234:235], v16 offset:43264
 v_add_f32 v149, v154, v155
 v_mfma_f32_16x16x32_bf16 a[108:111], a[216:219], v[204:207], a[108:111]
 v_cvt_pk_bf16_f32 v212, v154, v155
 v_add_f32 v147, v147, v151
 v_mfma_f32_16x16x32_bf16 a[112:115], a[220:223], v[192:195], a[112:115]
 v_exp_f32 v156, v170
 v_mfma_f32_16x16x32_bf16 a[116:119], a[220:223], v[196:199], a[116:119]
 ds_read_b64_tr_b16 a[236:237], v17 offset:37120
 ds_read_b64_tr_b16 a[238:239], v17 offset:43264
 v_mfma_f32_16x16x32_bf16 a[120:123], a[220:223], v[200:203], a[120:123]
 buffer_load_dwordx4 v6, s[32:35], s76 offen offset:2048 nt lds
 v_mfma_f32_16x16x32_bf16 a[124:127], a[220:223], v[204:207], a[124:127]
 ds_read_b128 a[240:243], v12 offset:12288
 s_waitcnt lgkmcnt(5)
 v_mfma_f32_16x16x32_bf16 a[128:131], a[224:227], v[192:195], a[128:131]
 v_exp_f32 v157, v171
 v_mfma_f32_16x16x32_bf16 a[132:135], a[224:227], v[196:199], a[132:135]
 ds_read_b128 a[244:247], v13 offset:12288
 v_add_f32 v149, v149, v156
 v_mfma_f32_16x16x32_bf16 a[136:139], a[224:227], v[200:203], a[136:139]
 v_exp_f32 v152, v172
 v_mfma_f32_16x16x32_bf16 a[140:143], a[224:227], v[204:207], a[140:143]
 ds_read_b128 a[248:251], v12 offset:12416
 v_add_f32 v149, v149, v157
 v_mfma_f32_16x16x32_bf16 a[144:147], a[228:231], v[192:195], a[144:147]
 v_exp_f32 v153, v173
 v_mfma_f32_16x16x32_bf16 a[148:151], a[228:231], v[196:199], a[148:151]
 v_cvt_pk_bf16_f32 v213, v156, v157
 ds_read_b128 a[252:255], v13 offset:12416
 v_mfma_f32_16x16x32_bf16 a[152:155], a[228:231], v[200:203], a[152:155]
 ds_read_b128 a[192:195], v12 offset:12544
 v_add_f32 v149, v149, v152
 v_mfma_f32_16x16x32_bf16 a[156:159], a[228:231], v[204:207], a[156:159]
 v_add_f32 v149, v149, v153
 s_waitcnt lgkmcnt(5)
 v_mfma_f32_16x16x32_bf16 a[160:163], a[232:235], v[192:195], a[160:163]
 v_exp_f32 v154, v174
 v_mfma_f32_16x16x32_bf16 a[164:167], a[232:235], v[196:199], a[164:167]
 ds_read_b128 a[196:199], v13 offset:12544
 v_cvt_pk_bf16_f32 v214, v152, v153
 v_mfma_f32_16x16x32_bf16 a[168:171], a[232:235], v[200:203], a[168:171]
 v_exp_f32 v155, v175
 v_mfma_f32_16x16x32_bf16 a[172:175], a[232:235], v[204:207], a[172:175]
 v_add_f32 v149, v149, v154
 v_add_f32 v149, v149, v155
 v_mfma_f32_16x16x32_bf16 a[176:179], a[236:239], v[192:195], a[176:179]
 s_add_u32 m0, s80, 12288
 s_mov_b32 s76, 184320
 v_mfma_f32_16x16x32_bf16 a[180:183], a[236:239], v[196:199], a[180:183]
 v_exp_f32 v156, v176
 v_mfma_f32_16x16x32_bf16 a[184:187], a[236:239], v[200:203], a[184:187]
 v_cvt_pk_bf16_f32 v215, v154, v155
 v_add_u32 v14, 49152, v14
 v_mfma_f32_16x16x32_bf16 a[188:191], a[236:239], v[204:207], a[188:191]
 v_add_u32 v15, 49152, v15
 s_waitcnt lgkmcnt(3)
 v_mfma_f32_16x16x32_bf16 v[224:227], a[240:243], v[32:35], v[128:131]
 v_exp_f32 v157, v177
 v_mfma_f32_16x16x32_bf16 v[224:227], a[244:247], v[48:51], v[224:227]
 ds_read_b128 a[200:203], v12 offset:18432
 v_add_f32 v150, v156, v157
 v_mfma_f32_16x16x32_bf16 v[224:227], a[248:251], v[64:67], v[224:227]
 ds_read_b128 a[204:207], v13 offset:18432
 s_waitcnt lgkmcnt(2)
 v_mfma_f32_16x16x32_bf16 v[224:227], a[252:255], v[80:83], v[224:227]
 buffer_load_dwordx4 v1, s[28:31], s76 offen offset:0 nt lds
 v_mfma_f32_16x16x32_bf16 v[224:227], a[192:195], v[96:99], v[224:227]
 v_exp_f32 v152, v178
 v_mfma_f32_16x16x32_bf16 v[224:227], a[196:199], v[112:115], v[224:227]
 v_cvt_pk_bf16_f32 v216, v156, v157
 ds_read_b128 a[208:211], v12 offset:18560
 v_mfma_f32_16x16x32_bf16 v[232:235], a[240:243], v[36:39], v[132:135]
 v_exp_f32 v153, v179
 v_mfma_f32_16x16x32_bf16 v[232:235], a[244:247], v[52:55], v[232:235]
 v_add_f32 v150, v150, v152
 v_add_f32 v150, v150, v153
 v_mfma_f32_16x16x32_bf16 v[232:235], a[248:251], v[68:71], v[232:235]
 v_exp_f32 v154, v180
 v_mfma_f32_16x16x32_bf16 v[232:235], a[252:255], v[84:87], v[232:235]
 ds_read_b128 a[212:215], v13 offset:18560
 v_cvt_pk_bf16_f32 v217, v152, v153
 v_mfma_f32_16x16x32_bf16 v[232:235], a[192:195], v[100:103], v[232:235]
 v_add_f32 v150, v150, v154
 v_add_u32 v16, 49152, v16
 v_mfma_f32_16x16x32_bf16 v[232:235], a[196:199], v[116:119], v[232:235]
 v_exp_f32 v155, v181
 v_mfma_f32_16x16x32_bf16 v[240:243], a[240:243], v[40:43], v[136:139]
 ds_read_b128 a[216:219], v12 offset:18688
 v_add_f32 v150, v150, v155
 v_mfma_f32_16x16x32_bf16 v[240:243], a[244:247], v[56:59], v[240:243]
 v_cvt_pk_bf16_f32 v218, v154, v155
 v_add_u32 v17, 49152, v17
 v_mfma_f32_16x16x32_bf16 v[240:243], a[248:251], v[72:75], v[240:243]
 v_exp_f32 v156, v182
 v_mfma_f32_16x16x32_bf16 v[240:243], a[252:255], v[88:91], v[240:243]
 ds_read_b128 a[220:223], v13 offset:18688
 v_add_f32 v150, v150, v156
 v_mfma_f32_16x16x32_bf16 v[240:243], a[192:195], v[104:107], v[240:243]
 v_mfma_f32_16x16x32_bf16 v[240:243], a[196:199], v[120:123], v[240:243]
 v_exp_f32 v157, v183
 v_mfma_f32_16x16x32_bf16 v[248:251], a[240:243], v[44:47], v[140:143]
 v_add_f32 v150, v150, v157
 v_cvt_pk_bf16_f32 v219, v156, v157
 v_mfma_f32_16x16x32_bf16 v[248:251], a[244:247], v[60:63], v[248:251]
 buffer_load_dwordx4 v2, s[28:31], s76 offen offset:1024 nt lds
 v_mfma_f32_16x16x32_bf16 v[248:251], a[248:251], v[76:79], v[248:251]
 v_exp_f32 v152, v184
 v_mfma_f32_16x16x32_bf16 v[248:251], a[252:255], v[92:95], v[248:251]
 v_max3_f32 v158, v148, v149, v150
 v_mfma_f32_16x16x32_bf16 v[248:251], a[192:195], v[108:111], v[248:251]
 v_mfma_f32_16x16x32_bf16 v[248:251], a[196:199], v[124:127], v[248:251]
 s_waitcnt lgkmcnt(3)
 v_mfma_f32_16x16x32_bf16 v[228:231], a[200:203], v[32:35], v[128:131]
 v_exp_f32 v153, v185
 v_mfma_f32_16x16x32_bf16 v[228:231], a[204:207], v[48:51], v[228:231]
 v_exp_f32 v154, v186
 v_mfma_f32_16x16x32_bf16 v[228:231], a[208:211], v[64:67], v[228:231]
 v_add_f32 v151, v152, v153
 s_waitcnt lgkmcnt(0)
 v_mfma_f32_16x16x32_bf16 v[228:231], a[212:215], v[80:83], v[228:231]
 v_cvt_pk_bf16_f32 v220, v152, v153
 v_add_f32 v151, v151, v154
 v_mfma_f32_16x16x32_bf16 v[228:231], a[216:219], v[96:99], v[228:231]
 s_waitcnt vmcnt(11)
 s_barrier
 v_mfma_f32_16x16x32_bf16 v[228:231], a[220:223], v[112:115], v[228:231]
 v_exp_f32 v155, v187
 v_mfma_f32_16x16x32_bf16 v[236:239], a[200:203], v[36:39], v[132:135]
 ds_read_b64_tr_b16 a[224:225], v14 offset:0
 v_add_f32 v151, v151, v155
 v_mfma_f32_16x16x32_bf16 v[236:239], a[204:207], v[52:55], v[236:239]
 v_exp_f32 v156, v188
 v_mfma_f32_16x16x32_bf16 v[236:239], a[208:211], v[68:71], v[236:239]
 ds_read_b64_tr_b16 a[226:227], v14 offset:6144
 v_cvt_pk_bf16_f32 v221, v154, v155
 v_mfma_f32_16x16x32_bf16 v[236:239], a[212:215], v[84:87], v[236:239]
 ds_read_b64_tr_b16 a[228:229], v15 offset:0
 v_add_f32 v151, v151, v156
 v_mfma_f32_16x16x32_bf16 v[236:239], a[216:219], v[100:103], v[236:239]
 v_exp_f32 v157, v189
 v_mfma_f32_16x16x32_bf16 v[236:239], a[220:223], v[116:119], v[236:239]
 ds_read_b64_tr_b16 a[230:231], v15 offset:6144
 v_add_f32 v151, v151, v157
 v_mfma_f32_16x16x32_bf16 v[244:247], a[200:203], v[40:43], v[136:139]
 v_cvt_pk_bf16_f32 v222, v156, v157
 v_mfma_f32_16x16x32_bf16 v[244:247], a[204:207], v[56:59], v[244:247]
 v_exp_f32 v152, v190
 v_mfma_f32_16x16x32_bf16 v[244:247], a[208:211], v[72:75], v[244:247]
 ds_read_b64_tr_b16 a[232:233], v16 offset:0
 v_add_f32 v151, v151, v152
 v_mfma_f32_16x16x32_bf16 v[244:247], a[212:215], v[88:91], v[244:247]
 buffer_load_dwordx4 v3, s[28:31], s76 offen offset:2048 nt lds
 v_mfma_f32_16x16x32_bf16 v[244:247], a[216:219], v[104:107], v[244:247]
 v_exp_f32 v153, v191
 v_mfma_f32_16x16x32_bf16 v[244:247], a[220:223], v[120:123], v[244:247]
 ds_read_b64_tr_b16 a[234:235], v16 offset:6144
 v_add_f32 v151, v151, v153
 v_mfma_f32_16x16x32_bf16 v[252:255], a[200:203], v[44:47], v[140:143]
 ds_read_b64_tr_b16 a[236:237], v17 offset:0
 v_cvt_pk_bf16_f32 v223, v152, v153
 v_mfma_f32_16x16x32_bf16 v[252:255], a[204:207], v[60:63], v[252:255]
 v_mfma_f32_16x16x32_bf16 v[252:255], a[208:211], v[76:79], v[252:255]
 ds_read_b64_tr_b16 a[238:239], v17 offset:6144
 v_max_f32 v158, v158, v151
 v_mfma_f32_16x16x32_bf16 v[252:255], a[212:215], v[92:95], v[252:255]
 v_cmp_lt_f32 vcc, s72, v158
 v_mfma_f32_16x16x32_bf16 v[252:255], a[216:219], v[108:111], v[252:255]
 v_mfma_f32_16x16x32_bf16 v[252:255], a[220:223], v[124:127], v[252:255]
 s_cbranch_vccnz L_S_10
L_R_10:
 s_waitcnt lgkmcnt(4)
 v_mfma_f32_16x16x32_bf16 a[0:3], a[224:227], v[208:211], a[0:3]
 v_exp_f32 v152, v224
 v_mfma_f32_16x16x32_bf16 a[4:7], a[224:227], v[212:215], a[4:7]
 ds_read_b64_tr_b16 a[240:241], v14 offset:128
 v_add_f32 v144, v144, v148
 v_mfma_f32_16x16x32_bf16 a[8:11], a[224:227], v[216:219], a[8:11]
 v_exp_f32 v153, v225
 v_mfma_f32_16x16x32_bf16 a[12:15], a[224:227], v[220:223], a[12:15]
 ds_read_b64_tr_b16 a[242:243], v14 offset:6272
 v_add_f32 v148, v152, v153
 v_mfma_f32_16x16x32_bf16 a[16:19], a[228:231], v[208:211], a[16:19]
 ds_read_b64_tr_b16 a[244:245], v15 offset:128
 v_cvt_pk_bf16_f32 v192, v152, v153
 v_mfma_f32_16x16x32_bf16 a[20:23], a[228:231], v[212:215], a[20:23]
 v_exp_f32 v154, v226
 v_mfma_f32_16x16x32_bf16 a[24:27], a[228:231], v[216:219], a[24:27]
 ds_read_b64_tr_b16 a[246:247], v15 offset:6272
 v_add_f32 v148, v148, v154
 v_mfma_f32_16x16x32_bf16 a[28:31], a[228:231], v[220:223], a[28:31]
 v_add_f32 v145, v145, v149
 s_waitcnt lgkmcnt(4)
 v_mfma_f32_16x16x32_bf16 a[32:35], a[232:235], v[208:211], a[32:35]
 s_add_u32 m0, s80, 73728
 s_mov_b32 s76, 172032
 v_mfma_f32_16x16x32_bf16 a[36:39], a[232:235], v[212:215], a[36:39]
 v_exp_f32 v155, v227
 v_mfma_f32_16x16x32_bf16 a[40:43], a[232:235], v[216:219], a[40:43]
 ds_read_b64_tr_b16 a[248:249], v16 offset:128
 ds_read_b64_tr_b16 a[250:251], v16 offset:6272
 v_mfma_f32_16x16x32_bf16 a[44:47], a[232:235], v[220:223], a[44:47]
 buffer_load_dwordx4 v4, s[32:35], s76 offen offset:0 nt lds
 v_mfma_f32_16x16x32_bf16 a[48:51], a[236:239], v[208:211], a[48:51]
 v_exp_f32 v156, v228
 v_mfma_f32_16x16x32_bf16 a[52:55], a[236:239], v[212:215], a[52:55]
 ds_read_b64_tr_b16 a[252:253], v17 offset:128
 v_add_f32 v148, v148, v155
 v_mfma_f32_16x16x32_bf16 a[56:59], a[236:239], v[216:219], a[56:59]
 v_cvt_pk_bf16_f32 v193, v154, v155
 ds_read_b64_tr_b16 a[254:255], v17 offset:6272
 v_mfma_f32_16x16x32_bf16 a[60:63], a[236:239], v[220:223], a[60:63]
 v_exp_f32 v157, v229
 s_waitcnt lgkmcnt(4)
 v_mfma_f32_16x16x32_bf16 a[64:67], a[240:243], v[208:211], a[64:67]
 v_add_f32 v148, v148, v156
 ds_read_b64_tr_b16 a[192:193], v14 offset:256
 v_mfma_f32_16x16x32_bf16 a[68:71], a[240:243], v[212:215], a[68:71]
 v_exp_f32 v152, v230
 v_mfma_f32_16x16x32_bf16 a[72:75], a[240:243], v[216:219], a[72:75]
 ds_read_b64_tr_b16 a[194:195], v14 offset:6400
 v_add_f32 v148, v148, v157
 v_mfma_f32_16x16x32_bf16 a[76:79], a[240:243], v[220:223], a[76:79]
 v_exp_f32 v153, v231
 v_mfma_f32_16x16x32_bf16 a[80:83], a[244:247], v[208:211], a[80:83]
 v_cvt_pk_bf16_f32 v194, v156, v157
 ds_read_b64_tr_b16 a[196:197], v15 offset:256
 v_mfma_f32_16x16x32_bf16 a[84:87], a[244:247], v[212:215], a[84:87]
 ds_read_b64_tr_b16 a[198:199], v15 offset:6400
 v_add_f32 v148, v148, v152
 v_mfma_f32_16x16x32_bf16 a[88:91], a[244:247], v[216:219], a[88:91]
 v_exp_f32 v154, v232
 v_mfma_f32_16x16x32_bf16 a[92:95], a[244:247], v[220:223], a[92:95]
 v_add_f32 v148, v148, v153
 s_waitcnt lgkmcnt(4)
 v_mfma_f32_16x16x32_bf16 a[96:99], a[248:251], v[208:211], a[96:99]
 v_cvt_pk_bf16_f32 v195, v152, v153
 ds_read_b64_tr_b16 a[200:201], v16 offset:256
 v_mfma_f32_16x16x32_bf16 a[100:103], a[248:251], v[212:215], a[100:103]
 v_exp_f32 v155, v233
 v_mfma_f32_16x16x32_bf16 a[104:107], a[248:251], v[216:219], a[104:107]
 ds_read_b64_tr_b16 a[202:203], v16 offset:6400
 v_add_f32 v149, v154, v155
 v_mfma_f32_16x16x32_bf16 a[108:111], a[248:251], v[220:223], a[108:111]
 v_cvt_pk_bf16_f32 v196, v154, v155
 v_add_f32 v146, v146, v150
 v_mfma_f32_16x16x32_bf16 a[112:115], a[252:255], v[208:211], a[112:115]
 v_exp_f32 v156, v234
 v_mfma_f32_16x16x32_bf16 a[116:119], a[252:255], v[212:215], a[116:119]
 ds_read_b64_tr_b16 a[204:205], v17 offset:256
 ds_read_b64_tr_b16 a[206:207], v17 offset:6400
 v_mfma_f32_16x16x32_bf16 a[120:123], a[252:255], v[216:219], a[120:123]
 buffer_load_dwordx4 v5, s[32:35], s76 offen offset:1024 nt lds
 v_mfma_f32_16x16x32_bf16 a[124:127], a[252:255], v[220:223], a[124:127]
 ds_read_b128 a[208:211], v12 offset:24576
 s_waitcnt lgkmcnt(5)
 v_mfma_f32_16x16x32_bf16 a[128:131], a[192:195], v[208:211], a[128:131]
 v_exp_f32 v157, v235
 v_mfma_f32_16x16x32_bf16 a[132:135], a[192:195], v[212:215], a[132:135]
 ds_read_b128 a[212:215], v13 offset:24576
 v_add_f32 v149, v149, v156
 v_mfma_f32_16x16x32_bf16 a[136:139], a[192:195], v[216:219], a[136:139]
 v_exp_f32 v152, v236
 v_mfma_f32_16x16x32_bf16 a[140:143], a[192:195], v[220:223], a[140:143]
 ds_read_b128 a[216:219], v12 offset:24704
 v_add_f32 v149, v149, v157
 v_mfma_f32_16x16x32_bf16 a[144:147], a[196:199], v[208:211], a[144:147]
 v_exp_f32 v153, v237
 v_mfma_f32_16x16x32_bf16 a[148:151], a[196:199], v[212:215], a[148:151]
 v_cvt_pk_bf16_f32 v197, v156, v157
 ds_read_b128 a[220:223], v13 offset:24704
 v_mfma_f32_16x16x32_bf16 a[152:155], a[196:199], v[216:219], a[152:155]
 ds_read_b128 a[224:227], v12 offset:24832
 v_add_f32 v149, v149, v152
 v_mfma_f32_16x16x32_bf16 a[156:159], a[196:199], v[220:223], a[156:159]
 v_add_f32 v149, v149, v153
 s_waitcnt lgkmcnt(5)
 v_mfma_f32_16x16x32_bf16 a[160:163], a[200:203], v[208:211], a[160:163]
 v_exp_f32 v154, v238
 v_mfma_f32_16x16x32_bf16 a[164:167], a[200:203], v[212:215], a[164:167]
 ds_read_b128 a[228:231], v13 offset:24832
 v_cvt_pk_bf16_f32 v198, v152, v153
 v_mfma_f32_16x16x32_bf16 a[168:171], a[200:203], v[216:219], a[168:171]
 v_exp_f32 v155, v239
 v_mfma_f32_16x16x32_bf16 a[172:175], a[200:203], v[220:223], a[172:175]
 v_add_f32 v149, v149, v154
 v_add_f32 v149, v149, v155
 v_mfma_f32_16x16x32_bf16 a[176:179], a[204:207], v[208:211], a[176:179]
 v_cvt_pk_bf16_f32 v199, v154, v155
 v_add_f32 v147, v147, v151
 v_mfma_f32_16x16x32_bf16 a[180:183], a[204:207], v[212:215], a[180:183]
 v_exp_f32 v156, v240
 v_mfma_f32_16x16x32_bf16 a[184:187], a[204:207], v[216:219], a[184:187]
 v_mfma_f32_16x16x32_bf16 a[188:191], a[204:207], v[220:223], a[188:191]
 s_waitcnt lgkmcnt(3)
 v_mfma_f32_16x16x32_bf16 v[160:163], a[208:211], v[32:35], v[128:131]
 v_exp_f32 v157, v241
 v_mfma_f32_16x16x32_bf16 v[160:163], a[212:215], v[48:51], v[160:163]
 buffer_load_dwordx4 v6, s[32:35], s76 offen offset:2048 nt lds
 v_mfma_f32_16x16x32_bf16 v[160:163], a[216:219], v[64:67], v[160:163]
 ds_read_b128 a[232:235], v12 offset:30720
 s_waitcnt lgkmcnt(1)
 v_mfma_f32_16x16x32_bf16 v[160:163], a[220:223], v[80:83], v[160:163]
 v_exp_f32 v152, v242
 v_mfma_f32_16x16x32_bf16 v[160:163], a[224:227], v[96:99], v[160:163]
 ds_read_b128 a[236:239], v13 offset:30720
 v_add_f32 v150, v156, v157
 v_mfma_f32_16x16x32_bf16 v[160:163], a[228:231], v[112:115], v[160:163]
 v_cvt_pk_bf16_f32 v200, v156, v157
 ds_read_b128 a[240:243], v12 offset:30848
 v_mfma_f32_16x16x32_bf16 v[168:171], a[208:211], v[36:39], v[132:135]
 v_exp_f32 v153, v243
 v_mfma_f32_16x16x32_bf16 v[168:171], a[212:215], v[52:55], v[168:171]
 v_add_f32 v150, v150, v152
 v_add_f32 v150, v150, v153
 v_mfma_f32_16x16x32_bf16 v[168:171], a[216:219], v[68:71], v[168:171]
 v_exp_f32 v154, v244
 v_mfma_f32_16x16x32_bf16 v[168:171], a[220:223], v[84:87], v[168:171]
 ds_read_b128 a[244:247], v13 offset:30848
 v_cvt_pk_bf16_f32 v201, v152, v153
 v_mfma_f32_16x16x32_bf16 v[168:171], a[224:227], v[100:103], v[168:171]
 v_add_f32 v150, v150, v154
 v_mfma_f32_16x16x32_bf16 v[168:171], a[228:231], v[116:119], v[168:171]
 v_exp_f32 v155, v245
 v_mfma_f32_16x16x32_bf16 v[176:179], a[208:211], v[40:43], v[136:139]
 ds_read_b128 a[248:251], v12 offset:30976
 v_add_f32 v150, v150, v155
 v_mfma_f32_16x16x32_bf16 v[176:179], a[212:215], v[56:59], v[176:179]
 s_add_u32 m0, s80, 24576
 s_mov_b32 s76, 196608
 v_mfma_f32_16x16x32_bf16 v[176:179], a[216:219], v[72:75], v[176:179]
 v_exp_f32 v156, v246
 v_mfma_f32_16x16x32_bf16 v[176:179], a[220:223], v[88:91], v[176:179]
 ds_read_b128 a[252:255], v13 offset:30976
 v_cvt_pk_bf16_f32 v202, v154, v155
 v_mfma_f32_16x16x32_bf16 v[176:179], a[224:227], v[104:107], v[176:179]
 v_add_f32 v150, v150, v156
 v_mfma_f32_16x16x32_bf16 v[176:179], a[228:231], v[120:123], v[176:179]
 v_exp_f32 v157, v247
 v_mfma_f32_16x16x32_bf16 v[184:187], a[208:211], v[44:47], v[140:143]
 buffer_load_dwordx4 v1, s[28:31], s76 offen offset:0 nt lds
 v_mfma_f32_16x16x32_bf16 v[184:187], a[212:215], v[60:63], v[184:187]
 v_add_f32 v150, v150, v157
 v_cvt_pk_bf16_f32 v203, v156, v157
 v_mfma_f32_16x16x32_bf16 v[184:187], a[216:219], v[76:79], v[184:187]
 v_exp_f32 v152, v248
 v_mfma_f32_16x16x32_bf16 v[184:187], a[220:223], v[92:95], v[184:187]
 v_subrev_u32 v12, 36864, v12
 v_subrev_u32 v13, 36864, v13
 v_mfma_f32_16x16x32_bf16 v[184:187], a[224:227], v[108:111], v[184:187]
 v_max3_f32 v158, v148, v149, v150
 v_mfma_f32_16x16x32_bf16 v[184:187], a[228:231], v[124:127], v[184:187]
 s_waitcnt lgkmcnt(3)
 v_mfma_f32_16x16x32_bf16 v[164:167], a[232:235], v[32:35], v[128:131]
 v_exp_f32 v153, v249
 v_mfma_f32_16x16x32_bf16 v[164:167], a[236:239], v[48:51], v[164:167]
 v_exp_f32 v154, v250
 v_mfma_f32_16x16x32_bf16 v[164:167], a[240:243], v[64:67], v[164:167]
 v_add_f32 v151, v152, v153
 s_waitcnt lgkmcnt(0)
 v_mfma_f32_16x16x32_bf16 v[164:167], a[244:247], v[80:83], v[164:167]
 v_cvt_pk_bf16_f32 v204, v152, v153
 v_add_f32 v151, v151, v154
 v_mfma_f32_16x16x32_bf16 v[164:167], a[248:251], v[96:99], v[164:167]
 s_waitcnt vmcnt(10)
 s_barrier
 v_mfma_f32_16x16x32_bf16 v[164:167], a[252:255], v[112:115], v[164:167]
 v_exp_f32 v155, v251
 v_mfma_f32_16x16x32_bf16 v[172:175], a[232:235], v[36:39], v[132:135]
 ds_read_b64_tr_b16 a[192:193], v14 offset:12288
 v_add_f32 v151, v151, v155
 v_mfma_f32_16x16x32_bf16 v[172:175], a[236:239], v[52:55], v[172:175]
 v_exp_f32 v156, v252
 v_mfma_f32_16x16x32_bf16 v[172:175], a[240:243], v[68:71], v[172:175]
 ds_read_b64_tr_b16 a[194:195], v14 offset:18432
 v_cvt_pk_bf16_f32 v205, v154, v155
 v_mfma_f32_16x16x32_bf16 v[172:175], a[244:247], v[84:87], v[172:175]
 ds_read_b64_tr_b16 a[196:197], v15 offset:12288
 v_add_f32 v151, v151, v156
 v_mfma_f32_16x16x32_bf16 v[172:175], a[248:251], v[100:103], v[172:175]
 v_exp_f32 v157, v253
 v_mfma_f32_16x16x32_bf16 v[172:175], a[252:255], v[116:119], v[172:175]
 ds_read_b64_tr_b16 a[198:199], v15 offset:18432
 v_add_f32 v151, v151, v157
 v_mfma_f32_16x16x32_bf16 v[180:183], a[232:235], v[40:43], v[136:139]
 buffer_load_dwordx4 v2, s[28:31], s76 offen offset:1024 nt lds
 v_mfma_f32_16x16x32_bf16 v[180:183], a[236:239], v[56:59], v[180:183]
 v_exp_f32 v152, v254
 v_mfma_f32_16x16x32_bf16 v[180:183], a[240:243], v[72:75], v[180:183]
 ds_read_b64_tr_b16 a[200:201], v16 offset:12288
 v_cvt_pk_bf16_f32 v206, v156, v157
 v_mfma_f32_16x16x32_bf16 v[180:183], a[244:247], v[88:91], v[180:183]
 v_add_f32 v151, v151, v152
 v_mfma_f32_16x16x32_bf16 v[180:183], a[248:251], v[104:107], v[180:183]
 v_exp_f32 v153, v255
 v_mfma_f32_16x16x32_bf16 v[180:183], a[252:255], v[120:123], v[180:183]
 ds_read_b64_tr_b16 a[202:203], v16 offset:18432
 v_add_f32 v151, v151, v153
 v_mfma_f32_16x16x32_bf16 v[188:191], a[232:235], v[44:47], v[140:143]
 ds_read_b64_tr_b16 a[204:205], v17 offset:12288
 v_cvt_pk_bf16_f32 v207, v152, v153
 v_mfma_f32_16x16x32_bf16 v[188:191], a[236:239], v[60:63], v[188:191]
 v_mfma_f32_16x16x32_bf16 v[188:191], a[240:243], v[76:79], v[188:191]
 ds_read_b64_tr_b16 a[206:207], v17 offset:18432
 v_max_f32 v158, v158, v151
 v_mfma_f32_16x16x32_bf16 v[188:191], a[244:247], v[92:95], v[188:191]
 v_cmp_lt_f32 vcc, s72, v158
 v_mfma_f32_16x16x32_bf16 v[188:191], a[248:251], v[108:111], v[188:191]
 v_mfma_f32_16x16x32_bf16 v[188:191], a[252:255], v[124:127], v[188:191]
 s_cbranch_vccnz L_S_11
L_R_11:
 s_waitcnt lgkmcnt(4)
 v_mfma_f32_16x16x32_bf16 a[0:3], a[192:195], v[192:195], a[0:3]
 v_exp_f32 v152, v160
 v_mfma_f32_16x16x32_bf16 a[4:7], a[192:195], v[196:199], a[4:7]
 ds_read_b64_tr_b16 a[208:209], v14 offset:12416
 v_add_f32 v144, v144, v148
 v_mfma_f32_16x16x32_bf16 a[8:11], a[192:195], v[200:203], a[8:11]
 v_exp_f32 v153, v161
 v_mfma_f32_16x16x32_bf16 a[12:15], a[192:195], v[204:207], a[12:15]
 ds_read_b64_tr_b16 a[210:211], v14 offset:18560
 v_add_f32 v148, v152, v153
 v_mfma_f32_16x16x32_bf16 a[16:19], a[196:199], v[192:195], a[16:19]
 ds_read_b64_tr_b16 a[212:213], v15 offset:12416
 v_cvt_pk_bf16_f32 v208, v152, v153
 v_mfma_f32_16x16x32_bf16 a[20:23], a[196:199], v[196:199], a[20:23]
 v_exp_f32 v154, v162
 v_mfma_f32_16x16x32_bf16 a[24:27], a[196:199], v[200:203], a[24:27]
 ds_read_b64_tr_b16 a[214:215], v15 offset:18560
 v_add_f32 v148, v148, v154
 v_mfma_f32_16x16x32_bf16 a[28:31], a[196:199], v[204:207], a[28:31]
 v_add_f32 v145, v145, v149
 s_waitcnt lgkmcnt(4)
 v_mfma_f32_16x16x32_bf16 a[32:35], a[200:203], v[192:195], a[32:35]
 v_exp_f32 v155, v163
 v_mfma_f32_16x16x32_bf16 a[36:39], a[200:203], v[196:199], a[36:39]
 buffer_load_dwordx4 v3, s[28:31], s76 offen offset:2048 nt lds
 v_mfma_f32_16x16x32_bf16 a[40:43], a[200:203], v[200:203], a[40:43]
 ds_read_b64_tr_b16 a[216:217], v16 offset:12416
 ds_read_b64_tr_b16 a[218:219], v16 offset:18560
 v_mfma_f32_16x16x32_bf16 a[44:47], a[200:203], v[204:207], a[44:47]
 v_exp_f32 v156, v164
 v_mfma_f32_16x16x32_bf16 a[48:51], a[204:207], v[192:195], a[48:51]
 ds_read_b64_tr_b16 a[220:221], v17 offset:12416
 v_add_f32 v148, v148, v155
 v_mfma_f32_16x16x32_bf16 a[52:55], a[204:207], v[196:199], a[52:55]
 v_cvt_pk_bf16_f32 v209, v154, v155
 ds_read_b64_tr_b16 a[222:223], v17 offset:18560
 v_mfma_f32_16x16x32_bf16 a[56:59], a[204:207], v[200:203], a[56:59]
 v_exp_f32 v157, v165
 v_mfma_f32_16x16x32_bf16 a[60:63], a[204:207], v[204:207], a[60:63]
 v_add_f32 v148, v148, v156
 s_waitcnt lgkmcnt(4)
 v_mfma_f32_16x16x32_bf16 a[64:67], a[208:211], v[192:195], a[64:67]
 ds_read_b64_tr_b16 a[224:225], v14 offset:12544
 v_add_f32 v148, v148, v157
 v_mfma_f32_16x16x32_bf16 a[68:71], a[208:211], v[196:199], a[68:71]
 v_exp_f32 v152, v166
 v_mfma_f32_16x16x32_bf16 a[72:75], a[208:211], v[200:203], a[72:75]
 ds_read_b64_tr_b16 a[226:227], v14 offset:18688
 v_cvt_pk_bf16_f32 v210, v156, v157
 v_mfma_f32_16x16x32_bf16 a[76:79], a[208:211], v[204:207], a[76:79]
 v_exp_f32 v153, v167
 v_mfma_f32_16x16x32_bf16 a[80:83], a[212:215], v[192:195], a[80:83]
 ds_read_b64_tr_b16 a[228:229], v15 offset:12544
 v_add_f32 v148, v148, v152
 v_mfma_f32_16x16x32_bf16 a[84:87], a[212:215], v[196:199], a[84:87]
 ds_read_b64_tr_b16 a[230:231], v15 offset:18688
 v_add_f32 v148, v148, v153
 v_mfma_f32_16x16x32_bf16 a[88:91], a[212:215], v[200:203], a[88:91]
 v_exp_f32 v154, v168
 v_mfma_f32_16x16x32_bf16 a[92:95], a[212:215], v[204:207], a[92:95]
 v_cvt_pk_bf16_f32 v211, v152, v153
 s_waitcnt lgkmcnt(4)
 v_mfma_f32_16x16x32_bf16 a[96:99], a[216:219], v[192:195], a[96:99]
 s_add_u32 m0, s80, 86016
 s_mov_b32 s76, 184320
 v_mfma_f32_16x16x32_bf16 a[100:103], a[216:219], v[196:199], a[100:103]
 v_exp_f32 v155, v169
 v_mfma_f32_16x16x32_bf16 a[104:107], a[216:219], v[200:203], a[104:107]
 ds_read_b64_tr_b16 a[232:233], v16 offset:12544
 ds_read_b64_tr_b16 a[234:235], v16 offset:18688
 v_mfma_f32_16x16x32_bf16 a[108:111], a[216:219], v[204:207], a[108:111]
 buffer_load_dwordx4 v4, s[32:35], s76 offen offset:0 nt lds
 v_mfma_f32_16x16x32_bf16 a[112:115], a[220:223], v[192:195], a[112:115]
 v_exp_f32 v156, v170
 v_mfma_f32_16x16x32_bf16 a[116:119], a[220:223], v[196:199], a[116:119]
 ds_read_b64_tr_b16 a[236:237], v17 offset:12544
 ds_read_b64_tr_b16 a[238:239], v17 offset:18688
 v_mfma_f32_16x16x32_bf16 a[120:123], a[220:223], v[200:203], a[120:123]
 v_add_f32 v149, v154, v155
 v_cvt_pk_bf16_f32 v212, v154, v155
 v_mfma_f32_16x16x32_bf16 a[124:127], a[220:223], v[204:207], a[124:127]
 ds_read_b128 a[240:243], v12 offset:0
 s_waitcnt lgkmcnt(5)
 v_mfma_f32_16x16x32_bf16 a[128:131], a[224:227], v[192:195], a[128:131]
 v_exp_f32 v157, v171
 v_mfma_f32_16x16x32_bf16 a[132:135], a[224:227], v[196:199], a[132:135]
 ds_read_b128 a[244:247], v13 offset:0
 v_add_f32 v149, v149, v156
 v_mfma_f32_16x16x32_bf16 a[136:139], a[224:227], v[200:203], a[136:139]
 v_exp_f32 v152, v172
 v_mfma_f32_16x16x32_bf16 a[140:143], a[224:227], v[204:207], a[140:143]
 ds_read_b128 a[248:251], v12 offset:128
 v_add_f32 v149, v149, v157
 v_mfma_f32_16x16x32_bf16 a[144:147], a[228:231], v[192:195], a[144:147]
 v_exp_f32 v153, v173
 v_mfma_f32_16x16x32_bf16 a[148:151], a[228:231], v[196:199], a[148:151]
 v_cvt_pk_bf16_f32 v213, v156, v157
 ds_read_b128 a[252:255], v13 offset:128
 v_mfma_f32_16x16x32_bf16 a[152:155], a[228:231], v[200:203], a[152:155]
 ds_read_b128 a[192:195], v12 offset:256
 v_add_f32 v149, v149, v152
 v_mfma_f32_16x16x32_bf16 a[156:159], a[228:231], v[204:207], a[156:159]
 v_add_f32 v149, v149, v153
 s_waitcnt lgkmcnt(5)
 v_mfma_f32_16x16x32_bf16 a[160:163], a[232:235], v[192:195], a[160:163]
 v_exp_f32 v154, v174
 v_mfma_f32_16x16x32_bf16 a[164:167], a[232:235], v[196:199], a[164:167]
 ds_read_b128 a[196:199], v13 offset:256
 v_cvt_pk_bf16_f32 v214, v152, v153
 v_mfma_f32_16x16x32_bf16 a[168:171], a[232:235], v[200:203], a[168:171]
 v_exp_f32 v155, v175
 v_mfma_f32_16x16x32_bf16 a[172:175], a[232:235], v[204:207], a[172:175]
 buffer_load_dwordx4 v5, s[32:35], s76 offen offset:1024 nt lds
 v_mfma_f32_16x16x32_bf16 a[176:179], a[236:239], v[192:195], a[176:179]
 v_add_f32 v149, v149, v154
 v_add_f32 v149, v149, v155
 v_mfma_f32_16x16x32_bf16 a[180:183], a[236:239], v[196:199], a[180:183]
 v_exp_f32 v156, v176
 v_mfma_f32_16x16x32_bf16 a[184:187], a[236:239], v[200:203], a[184:187]
 v_cvt_pk_bf16_f32 v215, v154, v155
 v_add_f32 v146, v146, v150
 v_mfma_f32_16x16x32_bf16 a[188:191], a[236:239], v[204:207], a[188:191]
 v_add_f32 v147, v147, v151
 s_waitcnt lgkmcnt(3)
 v_mfma_f32_16x16x32_bf16 v[224:227], a[240:243], v[32:35], v[128:131]
 v_exp_f32 v157, v177
 v_mfma_f32_16x16x32_bf16 v[224:227], a[244:247], v[48:51], v[224:227]
 ds_read_b128 a[200:203], v12 offset:6144
 v_add_f32 v150, v156, v157
 v_mfma_f32_16x16x32_bf16 v[224:227], a[248:251], v[64:67], v[224:227]
 ds_read_b128 a[204:207], v13 offset:6144
 s_waitcnt lgkmcnt(2)
 v_mfma_f32_16x16x32_bf16 v[224:227], a[252:255], v[80:83], v[224:227]
 v_exp_f32 v152, v178
 v_mfma_f32_16x16x32_bf16 v[224:227], a[192:195], v[96:99], v[224:227]
 v_cvt_pk_bf16_f32 v216, v156, v157
 v_add_f32 v150, v150, v152
 v_mfma_f32_16x16x32_bf16 v[224:227], a[196:199], v[112:115], v[224:227]
 ds_read_b128 a[208:211], v12 offset:6272
 v_mfma_f32_16x16x32_bf16 v[232:235], a[240:243], v[36:39], v[132:135]
 v_exp_f32 v153, v179
 v_mfma_f32_16x16x32_bf16 v[232:235], a[244:247], v[52:55], v[232:235]
 v_add_f32 v150, v150, v153
 v_cvt_pk_bf16_f32 v217, v152, v153
 v_mfma_f32_16x16x32_bf16 v[232:235], a[248:251], v[68:71], v[232:235]
 v_exp_f32 v154, v180
 v_mfma_f32_16x16x32_bf16 v[232:235], a[252:255], v[84:87], v[232:235]
 ds_read_b128 a[212:215], v13 offset:6272
 v_add_f32 v150, v150, v154
 v_mfma_f32_16x16x32_bf16 v[232:235], a[192:195], v[100:103], v[232:235]
 v_mfma_f32_16x16x32_bf16 v[232:235], a[196:199], v[116:119], v[232:235]
 v_exp_f32 v155, v181
 v_mfma_f32_16x16x32_bf16 v[240:243], a[240:243], v[40:43], v[136:139]
 ds_read_b128 a[216:219], v12 offset:6400
 v_add_f32 v150, v150, v155
 v_mfma_f32_16x16x32_bf16 v[240:243], a[244:247], v[56:59], v[240:243]
 v_cvt_pk_bf16_f32 v218, v154, v155
 v_mfma_f32_16x16x32_bf16 v[240:243], a[248:251], v[72:75], v[240:243]
 v_exp_f32 v156, v182
 v_mfma_f32_16x16x32_bf16 v[240:243], a[252:255], v[88:91], v[240:243]
 ds_read_b128 a[220:223], v13 offset:6400
 v_add_f32 v150, v150, v156
 v_mfma_f32_16x16x32_bf16 v[240:243], a[192:195], v[104:107], v[240:243]
 buffer_load_dwordx4 v6, s[32:35], s76 offen offset:2048 nt lds
 v_mfma_f32_16x16x32_bf16 v[240:243], a[196:199], v[120:123], v[240:243]
 v_exp_f32 v157, v183
 v_mfma_f32_16x16x32_bf16 v[248:251], a[240:243], v[44:47], v[140:143]
 v_add_f32 v150, v150, v157
 v_cvt_pk_bf16_f32 v219, v156, v157
 v_mfma_f32_16x16x32_bf16 v[248:251], a[244:247], v[60:63], v[248:251]
 v_max3_f32 v158, v148, v149, v150
 v_mfma_f32_16x16x32_bf16 v[248:251], a[248:251], v[76:79], v[248:251]
 v_exp_f32 v152, v184
 v_mfma_f32_16x16x32_bf16 v[248:251], a[252:255], v[92:95], v[248:251]
 v_mfma_f32_16x16x32_bf16 v[248:251], a[192:195], v[108:111], v[248:251]
 v_mfma_f32_16x16x32_bf16 v[248:251], a[196:199], v[124:127], v[248:251]
 s_waitcnt lgkmcnt(3)
 v_mfma_f32_16x16x32_bf16 v[228:231], a[200:203], v[32:35], v[128:131]
 v_exp_f32 v153, v185
 v_mfma_f32_16x16x32_bf16 v[228:231], a[204:207], v[48:51], v[228:231]
 v_exp_f32 v154, v186
 v_mfma_f32_16x16x32_bf16 v[228:231], a[208:211], v[64:67], v[228:231]
 v_add_f32 v151, v152, v153
 s_waitcnt lgkmcnt(0)
 v_mfma_f32_16x16x32_bf16 v[228:231], a[212:215], v[80:83], v[228:231]
 v_cvt_pk_bf16_f32 v220, v152, v153
 v_add_f32 v151, v151, v154
 v_mfma_f32_16x16x32_bf16 v[228:231], a[216:219], v[96:99], v[228:231]
 s_waitcnt vmcnt(9)
 s_barrier
 v_mfma_f32_16x16x32_bf16 v[228:231], a[220:223], v[112:115], v[228:231]
 v_exp_f32 v155, v187
 v_mfma_f32_16x16x32_bf16 v[236:239], a[200:203], v[36:39], v[132:135]
 ds_read_b64_tr_b16 a[224:225], v14 offset:24576
 v_add_f32 v151, v151, v155
 v_mfma_f32_16x16x32_bf16 v[236:239], a[204:207], v[52:55], v[236:239]
 s_add_u32 m0, s80, 36864
 s_mov_b32 s76, 208896
 v_mfma_f32_16x16x32_bf16 v[236:239], a[208:211], v[68:71], v[236:239]
 v_exp_f32 v156, v188
 v_mfma_f32_16x16x32_bf16 v[236:239], a[212:215], v[84:87], v[236:239]
 ds_read_b64_tr_b16 a[226:227], v14 offset:30720
 v_cvt_pk_bf16_f32 v221, v154, v155
 v_mfma_f32_16x16x32_bf16 v[236:239], a[216:219], v[100:103], v[236:239]
 buffer_load_dwordx4 v1, s[28:31], s76 offen offset:0 nt lds
 v_mfma_f32_16x16x32_bf16 v[236:239], a[220:223], v[116:119], v[236:239]
 v_exp_f32 v157, v189
 v_mfma_f32_16x16x32_bf16 v[244:247], a[200:203], v[40:43], v[136:139]
 ds_read_b64_tr_b16 a[228:229], v15 offset:24576
 ds_read_b64_tr_b16 a[230:231], v15 offset:30720
 v_mfma_f32_16x16x32_bf16 v[244:247], a[204:207], v[56:59], v[244:247]
 v_add_f32 v151, v151, v156
 ds_read_b64_tr_b16 a[232:233], v16 offset:24576
 v_mfma_f32_16x16x32_bf16 v[244:247], a[208:211], v[72:75], v[244:247]
 v_exp_f32 v152, v190
 v_mfma_f32_16x16x32_bf16 v[244:247], a[212:215], v[88:91], v[244:247]
 v_add_f32 v151, v151, v157
 v_cvt_pk_bf16_f32 v222, v156, v157
 v_mfma_f32_16x16x32_bf16 v[244:247], a[216:219], v[104:107], v[244:247]
 v_exp_f32 v153, v191
 v_mfma_f32_16x16x32_bf16 v[244:247], a[220:223], v[120:123], v[244:247]
 ds_read_b64_tr_b16 a[234:235], v16 offset:30720
 v_add_f32 v151, v151, v152
 v_mfma_f32_16x16x32_bf16 v[252:255], a[200:203], v[44:47], v[140:143]
 ds_read_b64_tr_b16 a[236:237], v17 offset:24576
 v_add_f32 v151, v151, v153
 v_mfma_f32_16x16x32_bf16 v[252:255], a[204:207], v[60:63], v[252:255]
 v_cvt_pk_bf16_f32 v223, v152, v153
 v_mfma_f32_16x16x32_bf16 v[252:255], a[208:211], v[76:79], v[252:255]
 ds_read_b64_tr_b16 a[238:239], v17 offset:30720
 v_max_f32 v158, v158, v151
 v_mfma_f32_16x16x32_bf16 v[252:255], a[212:215], v[92:95], v[252:255]
 v_cmp_lt_f32 vcc, s72, v158
 v_mfma_f32_16x16x32_bf16 v[252:255], a[216:219], v[108:111], v[252:255]
 v_mfma_f32_16x16x32_bf16 v[252:255], a[220:223], v[124:127], v[252:255]
 s_cbranch_vccnz L_S_12
L_R_12:
 s_waitcnt lgkmcnt(4)
 v_mfma_f32_16x16x32_bf16 a[0:3], a[224:227], v[208:211], a[0:3]
 v_exp_f32 v152, v224
 v_mfma_f32_16x16x32_bf16 a[4:7], a[224:227], v[212:215], a[4:7]
 ds_read_b64_tr_b16 a[240:241], v14 offset:24704
 v_add_f32 v144, v144, v148
 v_mfma_f32_16x16x32_bf16 a[8:11], a[224:227], v[216:219], a[8:11]
 v_exp_f32 v153, v225
 v_mfma_f32_16x16x32_bf16 a[12:15], a[224:227], v[220:223], a[12:15]
 ds_read_b64_tr_b16 a[242:243], v14 offset:30848
 v_add_f32 v148, v152, v153
 v_mfma_f32_16x16x32_bf16 a[16:19], a[228:231], v[208:211], a[16:19]
 buffer_load_dwordx4 v2, s[28:31], s76 offen offset:1024 nt lds
 v_mfma_f32_16x16x32_bf16 a[20:23], a[228:231], v[212:215], a[20:23]
 v_exp_f32 v154, v226
 v_mfma_f32_16x16x32_bf16 a[24:27], a[228:231], v[216:219], a[24:27]
 ds_read_b64_tr_b16 a[244:245], v15 offset:24704
 ds_read_b64_tr_b16 a[246:247], v15 offset:30848
 v_mfma_f32_16x16x32_bf16 a[28:31], a[228:231], v[220:223], a[28:31]
 v_cvt_pk_bf16_f32 v192, v152, v153
 s_waitcnt lgkmcnt(4)
 v_mfma_f32_16x16x32_bf16 a[32:35], a[232:235], v[208:211], a[32:35]
 v_exp_f32 v155, v227
 v_mfma_f32_16x16x32_bf16 a[36:39], a[232:235], v[212:215], a[36:39]
 ds_read_b64_tr_b16 a[248:249], v16 offset:24704
 ds_read_b64_tr_b16 a[250:251], v16 offset:30848
 v_mfma_f32_16x16x32_bf16 a[40:43], a[232:235], v[216:219], a[40:43]
 v_add_f32 v148, v148, v154
 v_add_f32 v148, v148, v155
 v_mfma_f32_16x16x32_bf16 a[44:47], a[232:235], v[220:223], a[44:47]
 v_exp_f32 v156, v228
 v_mfma_f32_16x16x32_bf16 a[48:51], a[236:239], v[208:211], a[48:51]
 ds_read_b64_tr_b16 a[252:253], v17 offset:24704
 v_cvt_pk_bf16_f32 v193, v154, v155
 v_mfma_f32_16x16x32_bf16 a[52:55], a[236:239], v[212:215], a[52:55]
 ds_read_b64_tr_b16 a[254:255], v17 offset:30848
 v_add_f32 v148, v148, v156
 v_mfma_f32_16x16x32_bf16 a[56:59], a[236:239], v[216:219], a[56:59]
 v_exp_f32 v157, v229
 v_mfma_f32_16x16x32_bf16 a[60:63], a[236:239], v[220:223], a[60:63]
 v_add_f32 v148, v148, v157
 s_waitcnt lgkmcnt(4)
 v_mfma_f32_16x16x32_bf16 a[64:67], a[240:243], v[208:211], a[64:67]
 ds_read_b64_tr_b16 a[192:193], v14 offset:24832
 v_cvt_pk_bf16_f32 v194, v156, v157
 v_mfma_f32_16x16x32_bf16 a[68:71], a[240:243], v[212:215], a[68:71]
 v_exp_f32 v152, v230
 v_mfma_f32_16x16x32_bf16 a[72:75], a[240:243], v[216:219], a[72:75]
 ds_read_b64_tr_b16 a[194:195], v14 offset:30976
 v_add_f32 v148, v148, v152
 v_mfma_f32_16x16x32_bf16 a[76:79], a[240:243], v[220:223], a[76:79]
 v_exp_f32 v153, v231
 v_mfma_f32_16x16x32_bf16 a[80:83], a[244:247], v[208:211], a[80:83]
 ds_read_b64_tr_b16 a[196:197], v15 offset:24832
 v_add_f32 v148, v148, v153
 v_mfma_f32_16x16x32_bf16 a[84:87], a[244:247], v[212:215], a[84:87]
 buffer_load_dwordx4 v3, s[28:31], s76 offen offset:2048 nt lds
 v_mfma_f32_16x16x32_bf16 a[88:91], a[244:247], v[216:219], a[88:91]
 v_exp_f32 v154, v232
 v_mfma_f32_16x16x32_bf16 a[92:95], a[244:247], v[220:223], a[92:95]
 ds_read_b64_tr_b16 a[198:199], v15 offset:30976
 s_waitcnt lgkmcnt(4)
 v_mfma_f32_16x16x32_bf16 a[96:99], a[248:251], v[208:211], a[96:99]
 v_cvt_pk_bf16_f32 v195, v152, v153
 v_add_f32 v145, v145, v149
 v_mfma_f32_16x16x32_bf16 a[100:103], a[248:251], v[212:215], a[100:103]
 v_exp_f32 v155, v233
 v_mfma_f32_16x16x32_bf16 a[104:107], a[248:251], v[216:219], a[104:107]
 ds_read_b64_tr_b16 a[200:201], v16 offset:24832
 ds_read_b64_tr_b16 a[202:203], v16 offset:30976
 v_mfma_f32_16x16x32_bf16 a[108:111], a[248:251], v[220:223], a[108:111]
 v_add_f32 v149, v154, v155
 v_cvt_pk_bf16_f32 v196, v154, v155
 v_mfma_f32_16x16x32_bf16 a[112:115], a[252:255], v[208:211], a[112:115]
 v_exp_f32 v156, v234
 v_mfma_f32_16x16x32_bf16 a[116:119], a[252:255], v[212:215], a[116:119]
 ds_read_b64_tr_b16 a[204:205], v17 offset:24832
 ds_read_b64_tr_b16 a[206:207], v17 offset:30976
 v_mfma_f32_16x16x32_bf16 a[120:123], a[252:255], v[216:219], a[120:123]
 ds_read_b128 a[208:211], v12 offset:12288
 v_add_f32 v149, v149, v156
 v_mfma_f32_16x16x32_bf16 a[124:127], a[252:255], v[220:223], a[124:127]
 v_add_f32 v146, v146, v150
 s_waitcnt lgkmcnt(5)
 v_mfma_f32_16x16x32_bf16 a[128:131], a[192:195], v[208:211], a[128:131]
 v_exp_f32 v157, v235
 v_mfma_f32_16x16x32_bf16 a[132:135], a[192:195], v[212:215], a[132:135]
 ds_read_b128 a[212:215], v13 offset:12288
 v_add_f32 v149, v149, v157
 v_mfma_f32_16x16x32_bf16 a[136:139], a[192:195], v[216:219], a[136:139]
 v_exp_f32 v152, v236
 v_mfma_f32_16x16x32_bf16 a[140:143], a[192:195], v[220:223], a[140:143]
 ds_read_b128 a[216:219], v12 offset:12416
 v_cvt_pk_bf16_f32 v197, v156, v157
 v_mfma_f32_16x16x32_bf16 a[144:147], a[196:199], v[208:211], a[144:147]
 v_exp_f32 v153, v237
 v_mfma_f32_16x16x32_bf16 a[148:151], a[196:199], v[212:215], a[148:151]
 ds_read_b128 a[220:223], v13 offset:12416
 v_add_f32 v149, v149, v152
 v_mfma_f32_16x16x32_bf16 a[152:155], a[196:199], v[216:219], a[152:155]
 s_add_u32 m0, s80, 98304
 s_mov_b32 s76, 196608
 v_mfma_f32_16x16x32_bf16 a[156:159], a[196:199], v[220:223], a[156:159]
 ds_read_b128 a[224:227], v12 offset:12544
 s_waitcnt lgkmcnt(5)
 v_mfma_f32_16x16x32_bf16 a[160:163], a[200:203], v[208:211], a[160:163]
 v_exp_f32 v154, v238
 v_mfma_f32_16x16x32_bf16 a[164:167], a[200:203], v[212:215], a[164:167]
 ds_read_b128 a[228:231], v13 offset:12544
 v_add_f32 v149, v149, v153
 v_mfma_f32_16x16x32_bf16 a[168:171], a[200:203], v[216:219], a[168:171]
 buffer_load_dwordx4 v4, s[32:35], s76 offen offset:0 nt lds
 v_mfma_f32_16x16x32_bf16 a[172:175], a[200:203], v[220:223], a[172:175]
 v_cvt_pk_bf16_f32 v198, v152, v153
 v_exp_f32 v155, v239
 v_mfma_f32_16x16x32_bf16 a[176:179], a[204:207], v[208:211], a[176:179]
 v_add_f32 v149, v149, v154
 v_add_f32 v149, v149, v155
 v_mfma_f32_16x16x32_bf16 a[180:183], a[204:207], v[212:215], a[180:183]
 v_exp_f32 v156, v240
 v_mfma_f32_16x16x32_bf16 a[184:187], a[204:207], v[216:219], a[184:187]
 v_cvt_pk_bf16_f32 v199, v154, v155
 v_add_f32 v147, v147, v151
 v_mfma_f32_16x16x32_bf16 a[188:191], a[204:207], v[220:223], a[188:191]
 v_subrev_u32 v14, 49152, v14
 s_waitcnt lgkmcnt(3)
 v_mfma_f32_16x16x32_bf16 v[160:163], a[208:211], v[32:35], v[128:131]
 v_exp_f32 v157, v241
 v_mfma_f32_16x16x32_bf16 v[160:163], a[212:215], v[48:51], v[160:163]
 ds_read_b128 a[232:235], v12 offset:18432
 v_add_f32 v150, v156, v157
 v_mfma_f32_16x16x32_bf16 v[160:163], a[216:219], v[64:67], v[160:163]
 ds_read_b128 a[236:239], v13 offset:18432
 s_waitcnt lgkmcnt(2)
 v_mfma_f32_16x16x32_bf16 v[160:163], a[220:223], v[80:83], v[160:163]
 v_exp_f32 v152, v242
 v_mfma_f32_16x16x32_bf16 v[160:163], a[224:227], v[96:99], v[160:163]
 v_cvt_pk_bf16_f32 v200, v156, v157
 v_add_f32 v150, v150, v152
 v_mfma_f32_16x16x32_bf16 v[160:163], a[228:231], v[112:115], v[160:163]
 ds_read_b128 a[240:243], v12 offset:18560
 v_subrev_u32 v15, 49152, v15
 v_mfma_f32_16x16x32_bf16 v[168:171], a[208:211], v[36:39], v[132:135]
 v_exp_f32 v153, v243
 v_mfma_f32_16x16x32_bf16 v[168:171], a[212:215], v[52:55], v[168:171]
 v_add_f32 v150, v150, v153
 v_cvt_pk_bf16_f32 v201, v152, v153
 v_mfma_f32_16x16x32_bf16 v[168:171], a[216:219], v[68:71], v[168:171]
 v_exp_f32 v154, v244
 v_mfma_f32_16x16x32_bf16 v[168:171], a[220:223], v[84:87], v[168:171]
 ds_read_b128 a[244:247], v13 offset:18560
 v_add_f32 v150, v150, v154
 v_mfma_f32_16x16x32_bf16 v[168:171], a[224:227], v[100:103], v[168:171]
 buffer_load_dwordx4 v5, s[32:35], s76 offen offset:1024 nt lds
 v_mfma_f32_16x16x32_bf16 v[168:171], a[228:231], v[116:119], v[168:171]
 v_exp_f32 v155, v245
 v_mfma_f32_16x16x32_bf16 v[176:179], a[208:211], v[40:43], v[136:139]
 ds_read_b128 a[248:251], v12 offset:18688
 v_add_f32 v150, v150, v155
 v_mfma_f32_16x16x32_bf16 v[176:179], a[212:215], v[56:59], v[176:179]
 v_cvt_pk_bf16_f32 v202, v154, v155
 v_subrev_u32 v16, 49152, v16
 v_mfma_f32_16x16x32_bf16 v[176:179], a[216:219], v[72:75], v[176:179]
 v_exp_f32 v156, v246
 v_mfma_f32_16x16x32_bf16 v[176:179], a[220:223], v[88:91], v[176:179]
 ds_read_b128 a[252:255], v13 offset:18688
 v_add_f32 v150, v150, v156
 v_mfma_f32_16x16x32_bf16 v[176:179], a[224:227], v[104:107], v[176:179]
 v_subrev_u32 v17, 49152, v17
 v_mfma_f32_16x16x32_bf16 v[176:179], a[228:231], v[120:123], v[176:179]
 v_exp_f32 v157, v247
 v_mfma_f32_16x16x32_bf16 v[184:187], a[208:211], v[44:47], v[140:143]
 v_add_f32 v150, v150, v157
 v_cvt_pk_bf16_f32 v203, v156, v157
 v_mfma_f32_16x16x32_bf16 v[184:187], a[212:215], v[60:63], v[184:187]
 v_max3_f32 v158, v148, v149, v150
 v_mfma_f32_16x16x32_bf16 v[184:187], a[216:219], v[76:79], v[184:187]
 v_exp_f32 v152, v248
 v_mfma_f32_16x16x32_bf16 v[184:187], a[220:223], v[92:95], v[184:187]
 v_mfma_f32_16x16x32_bf16 v[184:187], a[224:227], v[108:111], v[184:187]
 v_mfma_f32_16x16x32_bf16 v[184:187], a[228:231], v[124:127], v[184:187]
 s_waitcnt lgkmcnt(3)
 v_mfma_f32_16x16x32_bf16 v[164:167], a[232:235], v[32:35], v[128:131]
 v_exp_f32 v153, v249
 v_mfma_f32_16x16x32_bf16 v[164:167], a[236:239], v[48:51], v[164:167]
 v_exp_f32 v154, v250
 v_mfma_f32_16x16x32_bf16 v[164:167], a[240:243], v[64:67], v[164:167]
 v_add_f32 v151, v152, v153
 s_waitcnt lgkmcnt(0)
 v_mfma_f32_16x16x32_bf16 v[164:167], a[244:247], v[80:83], v[164:167]
 buffer_load_dwordx4 v6, s[32:35], s76 offen offset:2048 nt lds
 v_mfma_f32_16x16x32_bf16 v[164:167], a[248:251], v[96:99], v[164:167]
 s_waitcnt vmcnt(9)
 s_barrier
 v_mfma_f32_16x16x32_bf16 v[164:167], a[252:255], v[112:115], v[164:167]
 v_exp_f32 v155, v251
 v_mfma_f32_16x16x32_bf16 v[172:175], a[232:235], v[36:39], v[132:135]
 v_cvt_pk_bf16_f32 v204, v152, v153
 ds_read_b64_tr_b16 a[192:193], v14 offset:0
 v_mfma_f32_16x16x32_bf16 v[172:175], a[236:239], v[52:55], v[172:175]
 v_add_f32 v151, v151, v154
 ds_read_b64_tr_b16 a[194:195], v14 offset:6144
 v_mfma_f32_16x16x32_bf16 v[172:175], a[240:243], v[68:71], v[172:175]
 v_exp_f32 v156, v252
 v_mfma_f32_16x16x32_bf16 v[172:175], a[244:247], v[84:87], v[172:175]
 v_add_f32 v151, v151, v155
 v_cvt_pk_bf16_f32 v205, v154, v155
 v_mfma_f32_16x16x32_bf16 v[172:175], a[248:251], v[100:103], v[172:175]
 v_exp_f32 v157, v253
 v_mfma_f32_16x16x32_bf16 v[172:175], a[252:255], v[116:119], v[172:175]
 ds_read_b64_tr_b16 a[196:197], v15 offset:0
 ds_read_b64_tr_b16 a[198:199], v15 offset:6144
 v_mfma_f32_16x16x32_bf16 v[180:183], a[232:235], v[40:43], v[136:139]
 v_add_f32 v151, v151, v156
 v_add_f32 v151, v151, v157
 v_mfma_f32_16x16x32_bf16 v[180:183], a[236:239], v[56:59], v[180:183]
 v_exp_f32 v152, v254
 v_mfma_f32_16x16x32_bf16 v[180:183], a[240:243], v[72:75], v[180:183]
 ds_read_b64_tr_b16 a[200:201], v16 offset:0
 v_cvt_pk_bf16_f32 v206, v156, v157
 v_mfma_f32_16x16x32_bf16 v[180:183], a[244:247], v[88:91], v[180:183]
 s_add_u32 m0, s80, 49152
 s_mov_b32 s76, 221184
 v_mfma_f32_16x16x32_bf16 v[180:183], a[248:251], v[104:107], v[180:183]
 v_exp_f32 v153, v255
 v_mfma_f32_16x16x32_bf16 v[180:183], a[252:255], v[120:123], v[180:183]
 ds_read_b64_tr_b16 a[202:203], v16 offset:6144
 v_add_f32 v151, v151, v152
 v_mfma_f32_16x16x32_bf16 v[188:191], a[232:235], v[44:47], v[140:143]
 ds_read_b64_tr_b16 a[204:205], v17 offset:0
 v_add_f32 v151, v151, v153
 v_mfma_f32_16x16x32_bf16 v[188:191], a[236:239], v[60:63], v[188:191]
 v_cvt_pk_bf16_f32 v207, v152, v153
 v_mfma_f32_16x16x32_bf16 v[188:191], a[240:243], v[76:79], v[188:191]
 ds_read_b64_tr_b16 a[206:207], v17 offset:6144
 v_max_f32 v158, v158, v151
 v_mfma_f32_16x16x32_bf16 v[188:191], a[244:247], v[92:95], v[188:191]
 buffer_load_dwordx4 v1, s[28:31], s76 offen offset:0 nt lds
 v_mfma_f32_16x16x32_bf16 v[188:191], a[248:251], v[108:111], v[188:191]
 v_cmp_lt_f32 vcc, s72, v158
 v_mfma_f32_16x16x32_bf16 v[188:191], a[252:255], v[124:127], v[188:191]
 s_cbranch_vccnz L_S_13
L_R_13:
 s_waitcnt lgkmcnt(4)
 v_mfma_f32_16x16x32_bf16 a[0:3], a[192:195], v[192:195], a[0:3]
 v_exp_f32 v152, v160
 v_mfma_f32_16x16x32_bf16 a[4:7], a[192:195], v[196:199], a[4:7]
 ds_read_b64_tr_b16 a[208:209], v14 offset:128
 v_add_f32 v144, v144, v148
 v_mfma_f32_16x16x32_bf16 a[8:11], a[192:195], v[200:203], a[8:11]
 v_exp_f32 v153, v161
 v_mfma_f32_16x16x32_bf16 a[12:15], a[192:195], v[204:207], a[12:15]
 ds_read_b64_tr_b16 a[210:211], v14 offset:6272
 v_add_f32 v148, v152, v153
 v_mfma_f32_16x16x32_bf16 a[16:19], a[196:199], v[192:195], a[16:19]
 ds_read_b64_tr_b16 a[212:213], v15 offset:128
 v_cvt_pk_bf16_f32 v208, v152, v153
 v_mfma_f32_16x16x32_bf16 a[20:23], a[196:199], v[196:199], a[20:23]
 v_exp_f32 v154, v162
 v_mfma_f32_16x16x32_bf16 a[24:27], a[196:199], v[200:203], a[24:27]
 ds_read_b64_tr_b16 a[214:215], v15 offset:6272
 v_add_f32 v148, v148, v154
 v_mfma_f32_16x16x32_bf16 a[28:31], a[196:199], v[204:207], a[28:31]
 v_add_f32 v145, v145, v149
 s_waitcnt lgkmcnt(4)
 v_mfma_f32_16x16x32_bf16 a[32:35], a[200:203], v[192:195], a[32:35]
 v_exp_f32 v155, v163
 v_mfma_f32_16x16x32_bf16 a[36:39], a[200:203], v[196:199], a[36:39]
 ds_read_b64_tr_b16 a[216:217], v16 offset:128
 ds_read_b64_tr_b16 a[218:219], v16 offset:6272
 v_mfma_f32_16x16x32_bf16 a[40:43], a[200:203], v[200:203], a[40:43]
 v_add_f32 v148, v148, v155
 v_cvt_pk_bf16_f32 v209, v154, v155
 v_mfma_f32_16x16x32_bf16 a[44:47], a[200:203], v[204:207], a[44:47]
 v_exp_f32 v156, v164
 v_mfma_f32_16x16x32_bf16 a[48:51], a[204:207], v[192:195], a[48:51]
 ds_read_b64_tr_b16 a[220:221], v17 offset:128
 v_add_f32 v148, v148, v156
 v_mfma_f32_16x16x32_bf16 a[52:55], a[204:207], v[196:199], a[52:55]
 ds_read_b64_tr_b16 a[222:223], v17 offset:6272
 v_add_f32 v146, v146, v150
 v_mfma_f32_16x16x32_bf16 a[56:59], a[204:207], v[200:203], a[56:59]
 v_exp_f32 v157, v165
 v_mfma_f32_16x16x32_bf16 a[60:63], a[204:207], v[204:207], a[60:63]
 v_add_f32 v148, v148, v157
 s_waitcnt lgkmcnt(4)
 v_mfma_f32_16x16x32_bf16 a[64:67], a[208:211], v[192:195], a[64:67]
 buffer_load_dwordx4 v2, s[28:31], s76 offen offset:1024 nt lds
 v_mfma_f32_16x16x32_bf16 a[68:71], a[208:211], v[196:199], a[68:71]
 v_exp_f32 v152, v166
 v_mfma_f32_16x16x32_bf16 a[72:75], a[208:211], v[200:203], a[72:75]
 ds_read_b64_tr_b16 a[224:225], v14 offset:256
 ds_read_b64_tr_b16 a[226:227], v14 offset:6400
 v_mfma_f32_16x16x32_bf16 a[76:79], a[208:211], v[204:207], a[76:79]
 v_exp_f32 v153, v167
 v_mfma_f32_16x16x32_bf16 a[80:83], a[212:215], v[192:195], a[80:83]
 v_cvt_pk_bf16_f32 v210, v156, v157
 ds_read_b64_tr_b16 a[228:229], v15 offset:256
 v_mfma_f32_16x16x32_bf16 a[84:87], a[212:215], v[196:199], a[84:87]
 ds_read_b64_tr_b16 a[230:231], v15 offset:6400
 v_add_f32 v148, v148, v152
 v_mfma_f32_16x16x32_bf16 a[88:91], a[212:215], v[200:203], a[88:91]
 v_exp_f32 v154, v168
 v_mfma_f32_16x16x32_bf16 a[92:95], a[212:215], v[204:207], a[92:95]
 v_add_f32 v148, v148, v153
 s_waitcnt lgkmcnt(4)
 v_mfma_f32_16x16x32_bf16 a[96:99], a[216:219], v[192:195], a[96:99]
 v_cvt_pk_bf16_f32 v211, v152, v153
 ds_read_b64_tr_b16 a[232:233], v16 offset:256
 v_mfma_f32_16x16x32_bf16 a[100:103], a[216:219], v[196:199], a[100:103]
 v_exp_f32 v155, v169
 v_mfma_f32_16x16x32_bf16 a[104:107], a[216:219], v[200:203], a[104:107]
 ds_read_b64_tr_b16 a[234:235], v16 offset:6400
 v_add_f32 v149, v154, v155
 v_mfma_f32_16x16x32_bf16 a[108:111], a[216:219], v[204:207], a[108:111]
 v_cvt_pk_bf16_f32 v212, v154, v155
 v_add_f32 v147, v147, v151
 v_mfma_f32_16x16x32_bf16 a[112:115], a[220:223], v[192:195], a[112:115]
 v_exp_f32 v156, v170
 v_mfma_f32_16x16x32_bf16 a[116:119], a[220:223], v[196:199], a[116:119]
 ds_read_b64_tr_b16 a[236:237], v17 offset:256
 ds_read_b64_tr_b16 a[238:239], v17 offset:6400
 v_mfma_f32_16x16x32_bf16 a[120:123], a[220:223], v[200:203], a[120:123]
 ds_read_b128 a[240:243], v12 offset:24576
 v_add_f32 v149, v149, v156
 v_mfma_f32_16x16x32_bf16 a[124:127], a[220:223], v[204:207], a[124:127]
 s_waitcnt lgkmcnt(5)
 v_mfma_f32_16x16x32_bf16 a[128:131], a[224:227], v[192:195], a[128:131]
 v_exp_f32 v157, v171
 v_mfma_f32_16x16x32_bf16 a[132:135], a[224:227], v[196:199], a[132:135]
 ds_read_b128 a[244:247], v13 offset:24576
 v_add_f32 v149, v149, v157
 v_mfma_f32_16x16x32_bf16 a[136:139], a[224:227], v[200:203], a[136:139]
 buffer_load_dwordx4 v3, s[28:31], s76 offen offset:2048 nt lds
 v_mfma_f32_16x16x32_bf16 a[140:143], a[224:227], v[204:207], a[140:143]
 v_exp_f32 v152, v172
 v_mfma_f32_16x16x32_bf16 a[144:147], a[228:231], v[192:195], a[144:147]
 ds_read_b128 a[248:251], v12 offset:24704
 v_cvt_pk_bf16_f32 v213, v156, v157
 v_mfma_f32_16x16x32_bf16 a[148:151], a[228:231], v[196:199], a[148:151]
 v_exp_f32 v153, v173
 v_mfma_f32_16x16x32_bf16 a[152:155], a[228:231], v[200:203], a[152:155]
 ds_read_b128 a[252:255], v13 offset:24704
 ds_read_b128 a[192:195], v12 offset:24832
 v_mfma_f32_16x16x32_bf16 a[156:159], a[228:231], v[204:207], a[156:159]
 v_add_f32 v149, v149, v152
 s_waitcnt lgkmcnt(5)
 v_mfma_f32_16x16x32_bf16 a[160:163], a[232:235], v[192:195], a[160:163]
 v_exp_f32 v154, v174
 v_mfma_f32_16x16x32_bf16 a[164:167], a[232:235], v[196:199], a[164:167]
 ds_read_b128 a[196:199], v13 offset:24832
 v_add_f32 v149, v149, v153
 v_mfma_f32_16x16x32_bf16 a[168:171], a[232:235], v[200:203], a[168:171]
 v_cvt_pk_bf16_f32 v214, v152, v153
 v_add_f32 v149, v149, v154
 v_mfma_f32_16x16x32_bf16 a[172:175], a[232:235], v[204:207], a[172:175]
 v_exp_f32 v155, v175
 v_mfma_f32_16x16x32_bf16 a[176:179], a[236:239], v[192:195], a[176:179]
 s_add_u32 m0, s80, 110592
 s_mov_b32 s76, 208896
 v_mfma_f32_16x16x32_bf16 a[180:183], a[236:239], v[196:199], a[180:183]
 v_exp_f32 v156, v176
 v_mfma_f32_16x16x32_bf16 a[184:187], a[236:239], v[200:203], a[184:187]
 v_add_f32 v149, v149, v155
 v_cvt_pk_bf16_f32 v215, v154, v155
 v_mfma_f32_16x16x32_bf16 a[188:191], a[236:239], v[204:207], a[188:191]
 s_waitcnt lgkmcnt(3)
 v_mfma_f32_16x16x32_bf16 v[224:227], a[240:243], v[32:35], v[128:131]
 v_exp_f32 v157, v177
 v_mfma_f32_16x16x32_bf16 v[224:227], a[244:247], v[48:51], v[224:227]
 ds_read_b128 a[200:203], v12 offset:30720
 v_add_f32 v150, v156, v157
 v_mfma_f32_16x16x32_bf16 v[224:227], a[248:251], v[64:67], v[224:227]
 ds_read_b128 a[204:207], v13 offset:30720
 s_waitcnt lgkmcnt(2)
 v_mfma_f32_16x16x32_bf16 v[224:227], a[252:255], v[80:83], v[224:227]
 buffer_load_dwordx4 v4, s[32:35], s76 offen offset:0 nt lds
 v_mfma_f32_16x16x32_bf16 v[224:227], a[192:195], v[96:99], v[224:227]
 v_exp_f32 v152, v178
 v_mfma_f32_16x16x32_bf16 v[224:227], a[196:199], v[112:115], v[224:227]
 v_cvt_pk_bf16_f32 v216, v156, v157
 ds_read_b128 a[208:211], v12 offset:30848
 v_mfma_f32_16x16x32_bf16 v[232:235], a[240:243], v[36:39], v[132:135]
 v_exp_f32 v153, v179
 v_mfma_f32_16x16x32_bf16 v[232:235], a[244:247], v[52:55], v[232:235]
 v_add_f32 v150, v150, v152
 v_add_f32 v150, v150, v153
 v_mfma_f32_16x16x32_bf16 v[232:235], a[248:251], v[68:71], v[232:235]
 v_exp_f32 v154, v180
 v_mfma_f32_16x16x32_bf16 v[232:235], a[252:255], v[84:87], v[232:235]
 ds_read_b128 a[212:215], v13 offset:30848
 v_cvt_pk_bf16_f32 v217, v152, v153
 v_mfma_f32_16x16x32_bf16 v[232:235], a[192:195], v[100:103], v[232:235]
 v_add_f32 v150, v150, v154
 v_mfma_f32_16x16x32_bf16 v[232:235], a[196:199], v[116:119], v[232:235]
 v_exp_f32 v155, v181
 v_mfma_f32_16x16x32_bf16 v[240:243], a[240:243], v[40:43], v[136:139]
 ds_read_b128 a[216:219], v12 offset:30976
 v_add_f32 v150, v150, v155
 v_mfma_f32_16x16x32_bf16 v[240:243], a[244:247], v[56:59], v[240:243]
 v_cvt_pk_bf16_f32 v218, v154, v155
 v_mfma_f32_16x16x32_bf16 v[240:243], a[248:251], v[72:75], v[240:243]
 v_exp_f32 v156, v182
 v_mfma_f32_16x16x32_bf16 v[240:243], a[252:255], v[88:91], v[240:243]
 ds_read_b128 a[220:223], v13 offset:30976
 v_add_f32 v150, v150, v156
 v_mfma_f32_16x16x32_bf16 v[240:243], a[192:195], v[104:107], v[240:243]
 v_mfma_f32_16x16x32_bf16 v[240:243], a[196:199], v[120:123], v[240:243]
 v_exp_f32 v157, v183
 v_mfma_f32_16x16x32_bf16 v[248:251], a[240:243], v[44:47], v[140:143]
 v_add_f32 v150, v150, v157
 v_cvt_pk_bf16_f32 v219, v156, v157
 v_mfma_f32_16x16x32_bf16 v[248:251], a[244:247], v[60:63], v[248:251]
 buffer_load_dwordx4 v5, s[32:35], s76 offen offset:1024 nt lds
 v_mfma_f32_16x16x32_bf16 v[248:251], a[248:251], v[76:79], v[248:251]
 v_exp_f32 v152, v184
 v_mfma_f32_16x16x32_bf16 v[248:251], a[252:255], v[92:95], v[248:251]
 v_add_u32 v12, 36864, v12
 v_add_u32 v13, 36864, v13
 v_mfma_f32_16x16x32_bf16 v[248:251], a[192:195], v[108:111], v[248:251]
 v_max3_f32 v158, v148, v149, v150
 v_mfma_f32_16x16x32_bf16 v[248:251], a[196:199], v[124:127], v[248:251]
 s_waitcnt lgkmcnt(3)
 v_mfma_f32_16x16x32_bf16 v[228:231], a[200:203], v[32:35], v[128:131]
 v_exp_f32 v153, v185
 v_mfma_f32_16x16x32_bf16 v[228:231], a[204:207], v[48:51], v[228:231]
 v_exp_f32 v154, v186
 v_mfma_f32_16x16x32_bf16 v[228:231], a[208:211], v[64:67], v[228:231]
 v_add_f32 v151, v152, v153
 s_waitcnt lgkmcnt(0)
 v_mfma_f32_16x16x32_bf16 v[228:231], a[212:215], v[80:83], v[228:231]
 v_cvt_pk_bf16_f32 v220, v152, v153
 v_add_f32 v151, v151, v154
 v_mfma_f32_16x16x32_bf16 v[228:231], a[216:219], v[96:99], v[228:231]
 s_waitcnt vmcnt(8)
 s_barrier
 v_mfma_f32_16x16x32_bf16 v[228:231], a[220:223], v[112:115], v[228:231]
 v_exp_f32 v155, v187
 v_mfma_f32_16x16x32_bf16 v[236:239], a[200:203], v[36:39], v[132:135]
 ds_read_b64_tr_b16 a[224:225], v14 offset:12288
 v_add_f32 v151, v151, v155
 v_mfma_f32_16x16x32_bf16 v[236:239], a[204:207], v[52:55], v[236:239]
 v_exp_f32 v156, v188
 v_mfma_f32_16x16x32_bf16 v[236:239], a[208:211], v[68:71], v[236:239]
 ds_read_b64_tr_b16 a[226:227], v14 offset:18432
 v_cvt_pk_bf16_f32 v221, v154, v155
 v_mfma_f32_16x16x32_bf16 v[236:239], a[212:215], v[84:87], v[236:239]
 ds_read_b64_tr_b16 a[228:229], v15 offset:12288
 v_add_f32 v151, v151, v156
 v_mfma_f32_16x16x32_bf16 v[236:239], a[216:219], v[100:103], v[236:239]
 v_exp_f32 v157, v189
 v_mfma_f32_16x16x32_bf16 v[236:239], a[220:223], v[116:119], v[236:239]
 ds_read_b64_tr_b16 a[230:231], v15 offset:18432
 v_add_f32 v151, v151, v157
 v_mfma_f32_16x16x32_bf16 v[244:247], a[200:203], v[40:43], v[136:139]
 buffer_load_dwordx4 v6, s[32:35], s76 offen offset:2048 nt lds
 v_mfma_f32_16x16x32_bf16 v[244:247], a[204:207], v[56:59], v[244:247]
 v_exp_f32 v152, v190
 v_mfma_f32_16x16x32_bf16 v[244:247], a[208:211], v[72:75], v[244:247]
 ds_read_b64_tr_b16 a[232:233], v16 offset:12288
 v_cvt_pk_bf16_f32 v222, v156, v157
 v_mfma_f32_16x16x32_bf16 v[244:247], a[212:215], v[88:91], v[244:247]
 v_add_f32 v151, v151, v152
 v_mfma_f32_16x16x32_bf16 v[244:247], a[216:219], v[104:107], v[244:247]
 v_exp_f32 v153, v191
 v_mfma_f32_16x16x32_bf16 v[244:247], a[220:223], v[120:123], v[244:247]
 ds_read_b64_tr_b16 a[234:235], v16 offset:18432
 v_add_f32 v151, v151, v153
 v_mfma_f32_16x16x32_bf16 v[252:255], a[200:203], v[44:47], v[140:143]
 ds_read_b64_tr_b16 a[236:237], v17 offset:12288
 v_cvt_pk_bf16_f32 v223, v152, v153
 v_mfma_f32_16x16x32_bf16 v[252:255], a[204:207], v[60:63], v[252:255]
 v_mfma_f32_16x16x32_bf16 v[252:255], a[208:211], v[76:79], v[252:255]
 ds_read_b64_tr_b16 a[238:239], v17 offset:18432
 v_max_f32 v158, v158, v151
 v_mfma_f32_16x16x32_bf16 v[252:255], a[212:215], v[92:95], v[252:255]
 v_cmp_lt_f32 vcc, s72, v158
 v_mfma_f32_16x16x32_bf16 v[252:255], a[216:219], v[108:111], v[252:255]
 v_mfma_f32_16x16x32_bf16 v[252:255], a[220:223], v[124:127], v[252:255]
 s_cbranch_vccnz L_S_14
L_R_14:
 s_waitcnt lgkmcnt(4)
 v_mfma_f32_16x16x32_bf16 a[0:3], a[224:227], v[208:211], a[0:3]
 v_exp_f32 v152, v224
 v_mfma_f32_16x16x32_bf16 a[4:7], a[224:227], v[212:215], a[4:7]
 ds_read_b64_tr_b16 a[240:241], v14 offset:12416
 v_add_f32 v144, v144, v148
 v_mfma_f32_16x16x32_bf16 a[8:11], a[224:227], v[216:219], a[8:11]
 v_exp_f32 v153, v225
 v_mfma_f32_16x16x32_bf16 a[12:15], a[224:227], v[220:223], a[12:15]
 ds_read_b64_tr_b16 a[242:243], v14 offset:18560
 v_add_f32 v148, v152, v153
 v_mfma_f32_16x16x32_bf16 a[16:19], a[228:231], v[208:211], a[16:19]
 s_add_u32 m0, s80, 61440
 s_mov_b32 s76, 233472
 v_mfma_f32_16x16x32_bf16 a[20:23], a[228:231], v[212:215], a[20:23]
 v_exp_f32 v154, v226
 v_mfma_f32_16x16x32_bf16 a[24:27], a[228:231], v[216:219], a[24:27]
 ds_read_b64_tr_b16 a[244:245], v15 offset:12416
 ds_read_b64_tr_b16 a[246:247], v15 offset:18560
 v_mfma_f32_16x16x32_bf16 a[28:31], a[228:231], v[220:223], a[28:31]
 v_cvt_pk_bf16_f32 v192, v152, v153
 s_waitcnt lgkmcnt(4)
 v_mfma_f32_16x16x32_bf16 a[32:35], a[232:235], v[208:211], a[32:35]
 buffer_load_dwordx4 v1, s[28:31], s76 offen offset:0 nt lds
 v_mfma_f32_16x16x32_bf16 a[36:39], a[232:235], v[212:215], a[36:39]
 v_exp_f32 v155, v227
 v_mfma_f32_16x16x32_bf16 a[40:43], a[232:235], v[216:219], a[40:43]
 ds_read_b64_tr_b16 a[248:249], v16 offset:12416
 ds_read_b64_tr_b16 a[250:251], v16 offset:18560
 v_mfma_f32_16x16x32_bf16 a[44:47], a[232:235], v[220:223], a[44:47]
 v_add_f32 v148, v148, v154
 v_add_f32 v148, v148, v155
 v_mfma_f32_16x16x32_bf16 a[48:51], a[236:239], v[208:211], a[48:51]
 v_exp_f32 v156, v228
 v_mfma_f32_16x16x32_bf16 a[52:55], a[236:239], v[212:215], a[52:55]
 ds_read_b64_tr_b16 a[252:253], v17 offset:12416
 v_cvt_pk_bf16_f32 v193, v154, v155
 v_mfma_f32_16x16x32_bf16 a[56:59], a[236:239], v[216:219], a[56:59]
 v_exp_f32 v157, v229
 v_mfma_f32_16x16x32_bf16 a[60:63], a[236:239], v[220:223], a[60:63]
 ds_read_b64_tr_b16 a[254:255], v17 offset:18560
 s_waitcnt lgkmcnt(4)
 v_mfma_f32_16x16x32_bf16 a[64:67], a[240:243], v[208:211], a[64:67]
 v_add_f32 v148, v148, v156
 ds_read_b64_tr_b16 a[192:193], v14 offset:12544
 v_mfma_f32_16x16x32_bf16 a[68:71], a[240:243], v[212:215], a[68:71]
 v_exp_f32 v152, v230
 v_mfma_f32_16x16x32_bf16 a[72:75], a[240:243], v[216:219], a[72:75]
 ds_read_b64_tr_b16 a[194:195], v14 offset:18688
 v_add_f32 v148, v148, v157
 v_mfma_f32_16x16x32_bf16 a[76:79], a[240:243], v[220:223], a[76:79]
 v_exp_f32 v153, v231
 v_mfma_f32_16x16x32_bf16 a[80:83], a[244:247], v[208:211], a[80:83]
 v_cvt_pk_bf16_f32 v194, v156, v157
 ds_read_b64_tr_b16 a[196:197], v15 offset:12544
 v_mfma_f32_16x16x32_bf16 a[84:87], a[244:247], v[212:215], a[84:87]
 ds_read_b64_tr_b16 a[198:199], v15 offset:18688
 v_add_f32 v148, v148, v152
 v_mfma_f32_16x16x32_bf16 a[88:91], a[244:247], v[216:219], a[88:91]
 v_exp_f32 v154, v232
 v_mfma_f32_16x16x32_bf16 a[92:95], a[244:247], v[220:223], a[92:95]
 v_add_f32 v148, v148, v153
 s_waitcnt lgkmcnt(4)
 v_mfma_f32_16x16x32_bf16 a[96:99], a[248:251], v[208:211], a[96:99]
 buffer_load_dwordx4 v2, s[28:31], s76 offen offset:1024 nt lds
 v_mfma_f32_16x16x32_bf16 a[100:103], a[248:251], v[212:215], a[100:103]
 v_cvt_pk_bf16_f32 v195, v152, v153
 v_add_f32 v145, v145, v149
 v_mfma_f32_16x16x32_bf16 a[104:107], a[248:251], v[216:219], a[104:107]
 v_exp_f32 v155, v233
 v_mfma_f32_16x16x32_bf16 a[108:111], a[248:251], v[220:223], a[108:111]
 ds_read_b64_tr_b16 a[200:201], v16 offset:12544
 ds_read_b64_tr_b16 a[202:203], v16 offset:18688
 v_mfma_f32_16x16x32_bf16 a[112:115], a[252:255], v[208:211], a[112:115]
 v_exp_f32 v156, v234
 v_mfma_f32_16x16x32_bf16 a[116:119], a[252:255], v[212:215], a[116:119]
 ds_read_b64_tr_b16 a[204:205], v17 offset:12544
 ds_read_b64_tr_b16 a[206:207], v17 offset:18688
 v_mfma_f32_16x16x32_bf16 a[120:123], a[252:255], v[216:219], a[120:123]
 v_add_f32 v149, v154, v155
 v_cvt_pk_bf16_f32 v196, v154, v155
 v_mfma_f32_16x16x32_bf16 a[124:127], a[252:255], v[220:223], a[124:127]
 ds_read_b128 a[208:211], v12 offset:0
 s_waitcnt lgkmcnt(5)
 v_mfma_f32_16x16x32_bf16 a[128:131], a[192:195], v[208:211], a[128:131]
 v_exp_f32 v157, v235
 v_mfma_f32_16x16x32_bf16 a[132:135], a[192:195], v[212:215], a[132:135]
 ds_read_b128 a[212:215], v13 offset:0
 v_add_f32 v149, v149, v156
 v_mfma_f32_16x16x32_bf16 a[136:139], a[192:195], v[216:219], a[136:139]
 v_exp_f32 v152, v236
 v_mfma_f32_16x16x32_bf16 a[140:143], a[192:195], v[220:223], a[140:143]
 ds_read_b128 a[216:219], v12 offset:128
 v_add_f32 v149, v149, v157
 v_mfma_f32_16x16x32_bf16 a[144:147], a[196:199], v[208:211], a[144:147]
 v_exp_f32 v153, v237
 v_mfma_f32_16x16x32_bf16 a[148:151], a[196:199], v[212:215], a[148:151]
 v_cvt_pk_bf16_f32 v197, v156, v157
 ds_read_b128 a[220:223], v13 offset:128
 v_mfma_f32_16x16x32_bf16 a[152:155], a[196:199], v[216:219], a[152:155]
 ds_read_b128 a[224:227], v12 offset:256
 v_add_f32 v149, v149, v152
 v_mfma_f32_16x16x32_bf16 a[156:159], a[196:199], v[220:223], a[156:159]
 v_add_f32 v149, v149, v153
 s_waitcnt lgkmcnt(5)
 v_mfma_f32_16x16x32_bf16 a[160:163], a[200:203], v[208:211], a[160:163]
 v_exp_f32 v154, v238
 v_mfma_f32_16x16x32_bf16 a[164:167], a[200:203], v[212:215], a[164:167]
 ds_read_b128 a[228:231], v13 offset:256
 v_cvt_pk_bf16_f32 v198, v152, v153
 v_mfma_f32_16x16x32_bf16 a[168:171], a[200:203], v[216:219], a[168:171]
 buffer_load_dwordx4 v3, s[28:31], s76 offen offset:2048 nt lds
 v_mfma_f32_16x16x32_bf16 a[172:175], a[200:203], v[220:223], a[172:175]
 v_exp_f32 v155, v239
 v_mfma_f32_16x16x32_bf16 a[176:179], a[204:207], v[208:211], a[176:179]
 v_add_f32 v149, v149, v154
 v_add_f32 v149, v149, v155
 v_mfma_f32_16x16x32_bf16 a[180:183], a[204:207], v[212:215], a[180:183]
 v_exp_f32 v156, v240
 v_mfma_f32_16x16x32_bf16 a[184:187], a[204:207], v[216:219], a[184:187]
 v_cvt_pk_bf16_f32 v199, v154, v155
 v_add_f32 v146, v146, v150
 v_mfma_f32_16x16x32_bf16 a[188:191], a[204:207], v[220:223], a[188:191]
 v_add_f32 v147, v147, v151
 s_waitcnt lgkmcnt(3)
 v_mfma_f32_16x16x32_bf16 v[160:163], a[208:211], v[32:35], v[128:131]
 v_exp_f32 v157, v241
 v_mfma_f32_16x16x32_bf16 v[160:163], a[212:215], v[48:51], v[160:163]
 ds_read_b128 a[232:235], v12 offset:6144
 v_add_f32 v150, v156, v157
 v_mfma_f32_16x16x32_bf16 v[160:163], a[216:219], v[64:67], v[160:163]
 ds_read_b128 a[236:239], v13 offset:6144
 s_waitcnt lgkmcnt(2)
 v_mfma_f32_16x16x32_bf16 v[160:163], a[220:223], v[80:83], v[160:163]
 v_exp_f32 v152, v242
 v_mfma_f32_16x16x32_bf16 v[160:163], a[224:227], v[96:99], v[160:163]
 v_cvt_pk_bf16_f32 v200, v156, v157
 v_add_f32 v150, v150, v152
 v_mfma_f32_16x16x32_bf16 v[160:163], a[228:231], v[112:115], v[160:163]
 ds_read_b128 a[240:243], v12 offset:6272
 v_mfma_f32_16x16x32_bf16 v[168:171], a[208:211], v[36:39], v[132:135]
 v_exp_f32 v153, v243
 v_mfma_f32_16x16x32_bf16 v[168:171], a[212:215], v[52:55], v[168:171]
 s_add_u32 m0, s80, 122880
 s_mov_b32 s76, 221184
 v_mfma_f32_16x16x32_bf16 v[168:171], a[216:219], v[68:71], v[168:171]
 v_exp_f32 v154, v244
 v_mfma_f32_16x16x32_bf16 v[168:171], a[220:223], v[84:87], v[168:171]
 ds_read_b128 a[244:247], v13 offset:6272
 v_add_f32 v150, v150, v153
 v_mfma_f32_16x16x32_bf16 v[168:171], a[224:227], v[100:103], v[168:171]
 buffer_load_dwordx4 v4, s[32:35], s76 offen offset:0 nt lds
 v_mfma_f32_16x16x32_bf16 v[168:171], a[228:231], v[116:119], v[168:171]
 v_exp_f32 v155, v245
 v_mfma_f32_16x16x32_bf16 v[176:179], a[208:211], v[40:43], v[136:139]
 v_cvt_pk_bf16_f32 v201, v152, v153
 ds_read_b128 a[248:251], v12 offset:6400
 v_mfma_f32_16x16x32_bf16 v[176:179], a[212:215], v[56:59], v[176:179]
 v_add_f32 v150, v150, v154
 v_add_f32 v150, v150, v155
 v_mfma_f32_16x16x32_bf16 v[176:179], a[216:219], v[72:75], v[176:179]
 v_exp_f32 v156, v246
 v_mfma_f32_16x16x32_bf16 v[176:179], a[220:223], v[88:91], v[176:179]
 ds_read_b128 a[252:255], v13 offset:6400
 v_cvt_pk_bf16_f32 v202, v154, v155
 v_mfma_f32_16x16x32_bf16 v[176:179], a[224:227], v[104:107], v[176:179]
 v_add_f32 v150, v150, v156
 v_mfma_f32_16x16x32_bf16 v[176:179], a[228:231], v[120:123], v[176:179]
 v_exp_f32 v157, v247
 v_mfma_f32_16x16x32_bf16 v[184:187], a[208:211], v[44:47], v[140:143]
 v_add_f32 v150, v150, v157
 v_cvt_pk_bf16_f32 v203, v156, v157
 v_mfma_f32_16x16x32_bf16 v[184:187], a[212:215], v[60:63], v[184:187]
 v_max3_f32 v158, v148, v149, v150
 v_mfma_f32_16x16x32_bf16 v[184:187], a[216:219], v[76:79], v[184:187]
 v_exp_f32 v152, v248
 v_mfma_f32_16x16x32_bf16 v[184:187], a[220:223], v[92:95], v[184:187]
 v_mfma_f32_16x16x32_bf16 v[184:187], a[224:227], v[108:111], v[184:187]
 v_mfma_f32_16x16x32_bf16 v[184:187], a[228:231], v[124:127], v[184:187]
 s_waitcnt lgkmcnt(3)
 v_mfma_f32_16x16x32_bf16 v[164:167], a[232:235], v[32:35], v[128:131]
 v_exp_f32 v153, v249
 v_mfma_f32_16x16x32_bf16 v[164:167], a[236:239], v[48:51], v[164:167]
 v_exp_f32 v154, v250
 v_mfma_f32_16x16x32_bf16 v[164:167], a[240:243], v[64:67], v[164:167]
 v_add_f32 v151, v152, v153
 s_waitcnt lgkmcnt(0)
 v_mfma_f32_16x16x32_bf16 v[164:167], a[244:247], v[80:83], v[164:167]
 buffer_load_dwordx4 v5, s[32:35], s76 offen offset:1024 nt lds
 v_mfma_f32_16x16x32_bf16 v[164:167], a[248:251], v[96:99], v[164:167]
 s_waitcnt vmcnt(8)
 s_barrier
 v_mfma_f32_16x16x32_bf16 v[164:167], a[252:255], v[112:115], v[164:167]
 v_exp_f32 v155, v251
 v_mfma_f32_16x16x32_bf16 v[172:175], a[232:235], v[36:39], v[132:135]
 v_cvt_pk_bf16_f32 v204, v152, v153
 ds_read_b64_tr_b16 a[192:193], v14 offset:24576
 v_mfma_f32_16x16x32_bf16 v[172:175], a[236:239], v[52:55], v[172:175]
 v_add_f32 v151, v151, v154
 ds_read_b64_tr_b16 a[194:195], v14 offset:30720
 v_mfma_f32_16x16x32_bf16 v[172:175], a[240:243], v[68:71], v[172:175]
 v_exp_f32 v156, v252
 v_mfma_f32_16x16x32_bf16 v[172:175], a[244:247], v[84:87], v[172:175]
 v_add_f32 v151, v151, v155
 v_cvt_pk_bf16_f32 v205, v154, v155
 v_mfma_f32_16x16x32_bf16 v[172:175], a[248:251], v[100:103], v[172:175]
 v_exp_f32 v157, v253
 v_mfma_f32_16x16x32_bf16 v[172:175], a[252:255], v[116:119], v[172:175]
 ds_read_b64_tr_b16 a[196:197], v15 offset:24576
 ds_read_b64_tr_b16 a[198:199], v15 offset:30720
 v_mfma_f32_16x16x32_bf16 v[180:183], a[232:235], v[40:43], v[136:139]
 v_add_f32 v151, v151, v156
 v_add_f32 v151, v151, v157
 v_mfma_f32_16x16x32_bf16 v[180:183], a[236:239], v[56:59], v[180:183]
 v_exp_f32 v152, v254
 v_mfma_f32_16x16x32_bf16 v[180:183], a[240:243], v[72:75], v[180:183]
 ds_read_b64_tr_b16 a[200:201], v16 offset:24576
 v_cvt_pk_bf16_f32 v206, v156, v157
 v_mfma_f32_16x16x32_bf16 v[180:183], a[244:247], v[88:91], v[180:183]
 v_add_f32 v151, v151, v152
 v_mfma_f32_16x16x32_bf16 v[180:183], a[248:251], v[104:107], v[180:183]
 v_exp_f32 v153, v255
 v_mfma_f32_16x16x32_bf16 v[180:183], a[252:255], v[120:123], v[180:183]
 ds_read_b64_tr_b16 a[202:203], v16 offset:30720
 v_add_f32 v151, v151, v153
 v_mfma_f32_16x16x32_bf16 v[188:191], a[232:235], v[44:47], v[140:143]
 ds_read_b64_tr_b16 a[204:205], v17 offset:24576
 v_cvt_pk_bf16_f32 v207, v152, v153
 v_mfma_f32_16x16x32_bf16 v[188:191], a[236:239], v[60:63], v[188:191]
 buffer_load_dwordx4 v6, s[32:35], s76 offen offset:2048 nt lds
 v_mfma_f32_16x16x32_bf16 v[188:191], a[240:243], v[76:79], v[188:191]
 ds_read_b64_tr_b16 a[206:207], v17 offset:30720
 v_max_f32 v158, v158, v151
 v_mfma_f32_16x16x32_bf16 v[188:191], a[244:247], v[92:95], v[188:191]
 v_cmp_lt_f32 vcc, s72, v158
 v_mfma_f32_16x16x32_bf16 v[188:191], a[248:251], v[108:111], v[188:191]
 v_mfma_f32_16x16x32_bf16 v[188:191], a[252:255], v[124:127], v[188:191]
 s_cbranch_vccnz L_S_15
L_R_15:
 s_waitcnt lgkmcnt(4)
 v_mfma_f32_16x16x32_bf16 a[0:3], a[192:195], v[192:195], a[0:3]
 v_exp_f32 v152, v160
 v_mfma_f32_16x16x32_bf16 a[4:7], a[192:195], v[196:199], a[4:7]
 ds_read_b64_tr_b16 a[208:209], v14 offset:24704
 v_add_f32 v144, v144, v148
 v_mfma_f32_16x16x32_bf16 a[8:11], a[192:195], v[200:203], a[8:11]
 v_exp_f32 v153, v161
 v_mfma_f32_16x16x32_bf16 a[12:15], a[192:195], v[204:207], a[12:15]
 ds_read_b64_tr_b16 a[210:211], v14 offset:30848
 v_add_f32 v148, v152, v153
 v_mfma_f32_16x16x32_bf16 a[16:19], a[196:199], v[192:195], a[16:19]
 ds_read_b64_tr_b16 a[212:213], v15 offset:24704
 v_cvt_pk_bf16_f32 v208, v152, v153
 v_mfma_f32_16x16x32_bf16 a[20:23], a[196:199], v[196:199], a[20:23]
 v_exp_f32 v154, v162
 v_mfma_f32_16x16x32_bf16 a[24:27], a[196:199], v[200:203], a[24:27]
 ds_read_b64_tr_b16 a[214:215], v15 offset:30848
 v_add_f32 v148, v148, v154
 v_mfma_f32_16x16x32_bf16 a[28:31], a[196:199], v[204:207], a[28:31]
 v_add_f32 v145, v145, v149
 s_waitcnt lgkmcnt(4)
 v_mfma_f32_16x16x32_bf16 a[32:35], a[200:203], v[192:195], a[32:35]
 v_exp_f32 v155, v163
 v_mfma_f32_16x16x32_bf16 a[36:39], a[200:203], v[196:199], a[36:39]
 ds_read_b64_tr_b16 a[216:217], v16 offset:24704
 ds_read_b64_tr_b16 a[218:219], v16 offset:30848
 v_mfma_f32_16x16x32_bf16 a[40:43], a[200:203], v[200:203], a[40:43]
 s_add_u32 m0, s80, 0
 s_mov_b32 s76, 245760
 v_mfma_f32_16x16x32_bf16 a[44:47], a[200:203], v[204:207], a[44:47]
 v_exp_f32 v156, v164
 v_mfma_f32_16x16x32_bf16 a[48:51], a[204:207], v[192:195], a[48:51]
 ds_read_b64_tr_b16 a[220:221], v17 offset:24704
 v_add_f32 v148, v148, v155
 v_mfma_f32_16x16x32_bf16 a[52:55], a[204:207], v[196:199], a[52:55]
 buffer_load_dwordx4 v1, s[28:31], s76 offen offset:0 nt lds
 v_mfma_f32_16x16x32_bf16 a[56:59], a[204:207], v[200:203], a[56:59]
 v_cvt_pk_bf16_f32 v209, v154, v155
 ds_read_b64_tr_b16 a[222:223], v17 offset:30848
 v_mfma_f32_16x16x32_bf16 a[60:63], a[204:207], v[204:207], a[60:63]
 v_exp_f32 v157, v165
 s_waitcnt lgkmcnt(4)
 v_mfma_f32_16x16x32_bf16 a[64:67], a[208:211], v[192:195], a[64:67]
 v_add_f32 v148, v148, v156
 ds_read_b64_tr_b16 a[224:225], v14 offset:24832
 v_mfma_f32_16x16x32_bf16 a[68:71], a[208:211], v[196:199], a[68:71]
 v_exp_f32 v152, v166
 v_mfma_f32_16x16x32_bf16 a[72:75], a[208:211], v[200:203], a[72:75]
 ds_read_b64_tr_b16 a[226:227], v14 offset:30976
 v_add_f32 v148, v148, v157
 v_mfma_f32_16x16x32_bf16 a[76:79], a[208:211], v[204:207], a[76:79]
 v_exp_f32 v153, v167
 v_mfma_f32_16x16x32_bf16 a[80:83], a[212:215], v[192:195], a[80:83]
 v_cvt_pk_bf16_f32 v210, v156, v157
 ds_read_b64_tr_b16 a[228:229], v15 offset:24832
 v_mfma_f32_16x16x32_bf16 a[84:87], a[212:215], v[196:199], a[84:87]
 ds_read_b64_tr_b16 a[230:231], v15 offset:30976
 v_add_f32 v148, v148, v152
 v_mfma_f32_16x16x32_bf16 a[88:91], a[212:215], v[200:203], a[88:91]
 v_exp_f32 v154, v168
 v_mfma_f32_16x16x32_bf16 a[92:95], a[212:215], v[204:207], a[92:95]
 v_add_f32 v148, v148, v153
 s_waitcnt lgkmcnt(4)
 v_mfma_f32_16x16x32_bf16 a[96:99], a[216:219], v[192:195], a[96:99]
 v_cvt_pk_bf16_f32 v211, v152, v153
 ds_read_b64_tr_b16 a[232:233], v16 offset:24832
 v_mfma_f32_16x16x32_bf16 a[100:103], a[216:219], v[196:199], a[100:103]
 v_exp_f32 v155, v169
 v_mfma_f32_16x16x32_bf16 a[104:107], a[216:219], v[200:203], a[104:107]
 ds_read_b64_tr_b16 a[234:235], v16 offset:30976
 v_add_f32 v149, v154, v155
 v_mfma_f32_16x16x32_bf16 a[108:111], a[216:219], v[204:207], a[108:111]
 v_cvt_pk_bf16_f32 v212, v154, v155
 v_add_f32 v146, v146, v150
 v_mfma_f32_16x16x32_bf16 a[112:115], a[220:223], v[192:195], a[112:115]
 v_exp_f32 v156, v170
 v_mfma_f32_16x16x32_bf16 a[116:119], a[220:223], v[196:199], a[116:119]
 ds_read_b64_tr_b16 a[236:237], v17 offset:24832
 ds_read_b64_tr_b16 a[238:239], v17 offset:30976
 v_mfma_f32_16x16x32_bf16 a[120:123], a[220:223], v[200:203], a[120:123]
 buffer_load_dwordx4 v2, s[28:31], s76 offen offset:1024 nt lds
 v_mfma_f32_16x16x32_bf16 a[124:127], a[220:223], v[204:207], a[124:127]
 ds_read_b128 a[240:243], v12 offset:12288
 s_waitcnt lgkmcnt(5)
 v_mfma_f32_16x16x32_bf16 a[128:131], a[224:227], v[192:195], a[128:131]
 v_exp_f32 v157, v171
 v_mfma_f32_16x16x32_bf16 a[132:135], a[224:227], v[196:199], a[132:135]
 ds_read_b128 a[244:247], v13 offset:12288
 v_add_f32 v149, v149, v156
 v_mfma_f32_16x16x32_bf16 a[136:139], a[224:227], v[200:203], a[136:139]
 v_exp_f32 v152, v172
 v_mfma_f32_16x16x32_bf16 a[140:143], a[224:227], v[204:207], a[140:143]
 ds_read_b128 a[248:251], v12 offset:12416
 v_add_f32 v149, v149, v157
 v_mfma_f32_16x16x32_bf16 a[144:147], a[228:231], v[192:195], a[144:147]
 v_exp_f32 v153, v173
 v_mfma_f32_16x16x32_bf16 a[148:151], a[228:231], v[196:199], a[148:151]
 v_cvt_pk_bf16_f32 v213, v156, v157
 ds_read_b128 a[252:255], v13 offset:12416
 v_mfma_f32_16x16x32_bf16 a[152:155], a[228:231], v[200:203], a[152:155]
 ds_read_b128 a[192:195], v12 offset:12544
 v_add_f32 v149, v149, v152
 v_mfma_f32_16x16x32_bf16 a[156:159], a[228:231], v[204:207], a[156:159]
 v_add_f32 v149, v149, v153
 s_waitcnt lgkmcnt(5)
 v_mfma_f32_16x16x32_bf16 a[160:163], a[232:235], v[192:195], a[160:163]
 v_exp_f32 v154, v174
 v_mfma_f32_16x16x32_bf16 a[164:167], a[232:235], v[196:199], a[164:167]
 ds_read_b128 a[196:199], v13 offset:12544
 v_cvt_pk_bf16_f32 v214, v152, v153
 v_mfma_f32_16x16x32_bf16 a[168:171], a[232:235], v[200:203], a[168:171]
 v_exp_f32 v155, v175
 v_mfma_f32_16x16x32_bf16 a[172:175], a[232:235], v[204:207], a[172:175]
 v_add_f32 v149, v149, v154
 v_add_f32 v149, v149, v155
 v_mfma_f32_16x16x32_bf16 a[176:179], a[236:239], v[192:195], a[176:179]
 v_cvt_pk_bf16_f32 v215, v154, v155
 v_add_f32 v147, v147, v151
 v_mfma_f32_16x16x32_bf16 a[180:183], a[236:239], v[196:199], a[180:183]
 v_exp_f32 v156, v176
 v_mfma_f32_16x16x32_bf16 a[184:187], a[236:239], v[200:203], a[184:187]
 buffer_load_dwordx4 v3, s[28:31], s76 offen offset:2048 nt lds
 v_mfma_f32_16x16x32_bf16 a[188:191], a[236:239], v[204:207], a[188:191]
 s_waitcnt lgkmcnt(3)
 v_mfma_f32_16x16x32_bf16 v[224:227], a[240:243], v[32:35], v[128:131]
 v_exp_f32 v157, v177
 v_mfma_f32_16x16x32_bf16 v[224:227], a[244:247], v[48:51], v[224:227]
 ds_read_b128 a[200:203], v12 offset:18432
 v_add_f32 v150, v156, v157
 v_mfma_f32_16x16x32_bf16 v[224:227], a[248:251], v[64:67], v[224:227]
 ds_read_b128 a[204:207], v13 offset:18432
 s_waitcnt lgkmcnt(2)
 v_mfma_f32_16x16x32_bf16 v[224:227], a[252:255], v[80:83], v[224:227]
 v_exp_f32 v152, v178
 v_mfma_f32_16x16x32_bf16 v[224:227], a[192:195], v[96:99], v[224:227]
 v_cvt_pk_bf16_f32 v216, v156, v157
 v_add_f32 v150, v150, v152
 v_mfma_f32_16x16x32_bf16 v[224:227], a[196:199], v[112:115], v[224:227]
 ds_read_b128 a[208:211], v12 offset:18560
 v_mfma_f32_16x16x32_bf16 v[232:235], a[240:243], v[36:39], v[132:135]
 v_exp_f32 v153, v179
 v_mfma_f32_16x16x32_bf16 v[232:235], a[244:247], v[52:55], v[232:235]
 v_add_f32 v150, v150, v153
 v_cvt_pk_bf16_f32 v217, v152, v153
 v_mfma_f32_16x16x32_bf16 v[232:235], a[248:251], v[68:71], v[232:235]
 v_exp_f32 v154, v180
 v_mfma_f32_16x16x32_bf16 v[232:235], a[252:255], v[84:87], v[232:235]
 ds_read_b128 a[212:215], v13 offset:18560
 v_add_f32 v150, v150, v154
 v_mfma_f32_16x16x32_bf16 v[232:235], a[192:195], v[100:103], v[232:235]
 s_add_u32 m0, s80, 135168
 s_mov_b32 s76, 233472
 v_mfma_f32_16x16x32_bf16 v[232:235], a[196:199], v[116:119], v[232:235]
 v_exp_f32 v155, v181
 v_mfma_f32_16x16x32_bf16 v[240:243], a[240:243], v[40:43], v[136:139]
 ds_read_b128 a[216:219], v12 offset:18688
 v_add_f32 v150, v150, v155
 v_mfma_f32_16x16x32_bf16 v[240:243], a[244:247], v[56:59], v[240:243]
 v_cvt_pk_bf16_f32 v218, v154, v155
 v_mfma_f32_16x16x32_bf16 v[240:243], a[248:251], v[72:75], v[240:243]
 v_exp_f32 v156, v182
 v_mfma_f32_16x16x32_bf16 v[240:243], a[252:255], v[88:91], v[240:243]
 ds_read_b128 a[220:223], v13 offset:18688
 v_add_f32 v150, v150, v156
 v_mfma_f32_16x16x32_bf16 v[240:243], a[192:195], v[104:107], v[240:243]
 buffer_load_dwordx4 v4, s[32:35], s76 offen offset:0 nt lds
 v_mfma_f32_16x16x32_bf16 v[240:243], a[196:199], v[120:123], v[240:243]
 v_exp_f32 v157, v183
 v_mfma_f32_16x16x32_bf16 v[248:251], a[240:243], v[44:47], v[140:143]
 v_add_f32 v150, v150, v157
 v_cvt_pk_bf16_f32 v219, v156, v157
 v_mfma_f32_16x16x32_bf16 v[248:251], a[244:247], v[60:63], v[248:251]
 v_max3_f32 v158, v148, v149, v150
 v_mfma_f32_16x16x32_bf16 v[248:251], a[248:251], v[76:79], v[248:251]
 v_exp_f32 v152, v184
 v_mfma_f32_16x16x32_bf16 v[248:251], a[252:255], v[92:95], v[248:251]
 v_mfma_f32_16x16x32_bf16 v[248:251], a[192:195], v[108:111], v[248:251]
 v_mfma_f32_16x16x32_bf16 v[248:251], a[196:199], v[124:127], v[248:251]
 s_waitcnt lgkmcnt(3)
 v_mfma_f32_16x16x32_bf16 v[228:231], a[200:203], v[32:35], v[128:131]
 v_exp_f32 v153, v185
 v_mfma_f32_16x16x32_bf16 v[228:231], a[204:207], v[48:51], v[228:231]
 v_exp_f32 v154, v186
 v_mfma_f32_16x16x32_bf16 v[228:231], a[208:211], v[64:67], v[228:231]
 v_add_f32 v151, v152, v153
 s_waitcnt lgkmcnt(0)
 v_mfma_f32_16x16x32_bf16 v[228:231], a[212:215], v[80:83], v[228:231]
 v_cvt_pk_bf16_f32 v220, v152, v153
 v_add_f32 v151, v151, v154
 v_mfma_f32_16x16x32_bf16 v[228:231], a[216:219], v[96:99], v[228:231]
 s_waitcnt vmcnt(7)
 s_barrier
 v_mfma_f32_16x16x32_bf16 v[228:231], a[220:223], v[112:115], v[228:231]
 v_exp_f32 v155, v187
 v_mfma_f32_16x16x32_bf16 v[236:239], a[200:203], v[36:39], v[132:135]
 ds_read_b64_tr_b16 a[224:225], v14 offset:36864
 v_add_f32 v151, v151, v155
 v_mfma_f32_16x16x32_bf16 v[236:239], a[204:207], v[52:55], v[236:239]
 v_exp_f32 v156, v188
 v_mfma_f32_16x16x32_bf16 v[236:239], a[208:211], v[68:71], v[236:239]
 ds_read_b64_tr_b16 a[226:227], v14 offset:43008
 v_cvt_pk_bf16_f32 v221, v154, v155
 v_mfma_f32_16x16x32_bf16 v[236:239], a[212:215], v[84:87], v[236:239]
 buffer_load_dwordx4 v5, s[32:35], s76 offen offset:1024 nt lds
 v_mfma_f32_16x16x32_bf16 v[236:239], a[216:219], v[100:103], v[236:239]
 v_exp_f32 v157, v189
 v_mfma_f32_16x16x32_bf16 v[236:239], a[220:223], v[116:119], v[236:239]
 ds_read_b64_tr_b16 a[228:229], v15 offset:36864
 ds_read_b64_tr_b16 a[230:231], v15 offset:43008
 v_mfma_f32_16x16x32_bf16 v[244:247], a[200:203], v[40:43], v[136:139]
 v_add_f32 v151, v151, v156
 v_add_f32 v151, v151, v157
 v_mfma_f32_16x16x32_bf16 v[244:247], a[204:207], v[56:59], v[244:247]
 v_exp_f32 v152, v190
 v_mfma_f32_16x16x32_bf16 v[244:247], a[208:211], v[72:75], v[244:247]
 ds_read_b64_tr_b16 a[232:233], v16 offset:36864
 v_cvt_pk_bf16_f32 v222, v156, v157
 v_mfma_f32_16x16x32_bf16 v[244:247], a[212:215], v[88:91], v[244:247]
 v_add_f32 v151, v151, v152
 v_mfma_f32_16x16x32_bf16 v[244:247], a[216:219], v[104:107], v[244:247]
 v_exp_f32 v153, v191
 v_mfma_f32_16x16x32_bf16 v[244:247], a[220:223], v[120:123], v[244:247]
 ds_read_b64_tr_b16 a[234:235], v16 offset:43008
 v_add_f32 v151, v151, v153
 v_mfma_f32_16x16x32_bf16 v[252:255], a[200:203], v[44:47], v[140:143]
 ds_read_b64_tr_b16 a[236:237], v17 offset:36864
 v_cvt_pk_bf16_f32 v223, v152, v153
 v_mfma_f32_16x16x32_bf16 v[252:255], a[204:207], v[60:63], v[252:255]
 v_mfma_f32_16x16x32_bf16 v[252:255], a[208:211], v[76:79], v[252:255]
 ds_read_b64_tr_b16 a[238:239], v17 offset:43008
 v_max_f32 v158, v158, v151
 v_mfma_f32_16x16x32_bf16 v[252:255], a[212:215], v[92:95], v[252:255]
 v_cmp_lt_f32 vcc, s72, v158
 v_mfma_f32_16x16x32_bf16 v[252:255], a[216:219], v[108:111], v[252:255]
 v_mfma_f32_16x16x32_bf16 v[252:255], a[220:223], v[124:127], v[252:255]
 s_cbranch_vccnz L_S_16
L_R_16:
 s_waitcnt lgkmcnt(4)
 v_mfma_f32_16x16x32_bf16 a[0:3], a[224:227], v[208:211], a[0:3]
 v_exp_f32 v152, v224
 v_mfma_f32_16x16x32_bf16 a[4:7], a[224:227], v[212:215], a[4:7]
 ds_read_b64_tr_b16 a[240:241], v14 offset:36992
 v_add_f32 v144, v144, v148
 v_mfma_f32_16x16x32_bf16 a[8:11], a[224:227], v[216:219], a[8:11]
 buffer_load_dwordx4 v6, s[32:35], s76 offen offset:2048 nt lds
 v_mfma_f32_16x16x32_bf16 a[12:15], a[224:227], v[220:223], a[12:15]
 v_exp_f32 v153, v225
 v_mfma_f32_16x16x32_bf16 a[16:19], a[228:231], v[208:211], a[16:19]
 ds_read_b64_tr_b16 a[242:243], v14 offset:43136
 ds_read_b64_tr_b16 a[244:245], v15 offset:36992
 v_mfma_f32_16x16x32_bf16 a[20:23], a[228:231], v[212:215], a[20:23]
 v_exp_f32 v154, v226
 v_mfma_f32_16x16x32_bf16 a[24:27], a[228:231], v[216:219], a[24:27]
 ds_read_b64_tr_b16 a[246:247], v15 offset:43136
 v_add_f32 v148, v152, v153
 v_mfma_f32_16x16x32_bf16 a[28:31], a[228:231], v[220:223], a[28:31]
 v_cvt_pk_bf16_f32 v192, v152, v153
 s_waitcnt lgkmcnt(4)
 v_mfma_f32_16x16x32_bf16 a[32:35], a[232:235], v[208:211], a[32:35]
 v_exp_f32 v155, v227
 v_mfma_f32_16x16x32_bf16 a[36:39], a[232:235], v[212:215], a[36:39]
 ds_read_b64_tr_b16 a[248:249], v16 offset:36992
 ds_read_b64_tr_b16 a[250:251], v16 offset:43136
 v_mfma_f32_16x16x32_bf16 a[40:43], a[232:235], v[216:219], a[40:43]
 v_add_f32 v148, v148, v154
 v_add_f32 v148, v148, v155
 v_mfma_f32_16x16x32_bf16 a[44:47], a[232:235], v[220:223], a[44:47]
 v_exp_f32 v156, v228
 v_mfma_f32_16x16x32_bf16 a[48:51], a[236:239], v[208:211], a[48:51]
 ds_read_b64_tr_b16 a[252:253], v17 offset:36992
 v_cvt_pk_bf16_f32 v193, v154, v155
 v_mfma_f32_16x16x32_bf16 a[52:55], a[236:239], v[212:215], a[52:55]
 ds_read_b64_tr_b16 a[254:255], v17 offset:43136
 v_add_f32 v148, v148, v156
 v_mfma_f32_16x16x32_bf16 a[56:59], a[236:239], v[216:219], a[56:59]
 v_exp_f32 v157, v229
 v_mfma_f32_16x16x32_bf16 a[60:63], a[236:239], v[220:223], a[60:63]
 v_add_f32 v148, v148, v157
 s_waitcnt lgkmcnt(4)
 v_mfma_f32_16x16x32_bf16 a[64:67], a[240:243], v[208:211], a[64:67]
 s_add_u32 m0, s80, 12288
 s_mov_b32 s76, 258048
 v_mfma_f32_16x16x32_bf16 a[68:71], a[240:243], v[212:215], a[68:71]
 v_exp_f32 v152, v230
 v_mfma_f32_16x16x32_bf16 a[72:75], a[240:243], v[216:219], a[72:75]
 ds_read_b64_tr_b16 a[192:193], v14 offset:37120
 ds_read_b64_tr_b16 a[194:195], v14 offset:43264
 v_mfma_f32_16x16x32_bf16 a[76:79], a[240:243], v[220:223], a[76:79]
 buffer_load_dwordx4 v1, s[28:31], s76 offen offset:0 nt lds
 v_mfma_f32_16x16x32_bf16 a[80:83], a[244:247], v[208:211], a[80:83]
 v_exp_f32 v153, v231
 v_mfma_f32_16x16x32_bf16 a[84:87], a[244:247], v[212:215], a[84:87]
 v_cvt_pk_bf16_f32 v194, v156, v157
 ds_read_b64_tr_b16 a[196:197], v15 offset:37120
 v_mfma_f32_16x16x32_bf16 a[88:91], a[244:247], v[216:219], a[88:91]
 v_exp_f32 v154, v232
 v_mfma_f32_16x16x32_bf16 a[92:95], a[244:247], v[220:223], a[92:95]
 ds_read_b64_tr_b16 a[198:199], v15 offset:43264
 s_waitcnt lgkmcnt(4)
 v_mfma_f32_16x16x32_bf16 a[96:99], a[248:251], v[208:211], a[96:99]
 v_add_f32 v148, v148, v152
 v_add_f32 v148, v148, v153
 v_mfma_f32_16x16x32_bf16 a[100:103], a[248:251], v[212:215], a[100:103]
 v_cvt_pk_bf16_f32 v195, v152, v153
 v_add_f32 v145, v145, v149
 v_mfma_f32_16x16x32_bf16 a[104:107], a[248:251], v[216:219], a[104:107]
 v_exp_f32 v155, v233
 v_mfma_f32_16x16x32_bf16 a[108:111], a[248:251], v[220:223], a[108:111]
 ds_read_b64_tr_b16 a[200:201], v16 offset:37120
 ds_read_b64_tr_b16 a[202:203], v16 offset:43264
 v_mfma_f32_16x16x32_bf16 a[112:115], a[252:255], v[208:211], a[112:115]
 v_exp_f32 v156, v234
 v_mfma_f32_16x16x32_bf16 a[116:119], a[252:255], v[212:215], a[116:119]
 ds_read_b64_tr_b16 a[204:205], v17 offset:37120
 ds_read_b64_tr_b16 a[206:207], v17 offset:43264
 v_mfma_f32_16x16x32_bf16 a[120:123], a[252:255], v[216:219], a[120:123]
 v_add_f32 v149, v154, v155
 v_cvt_pk_bf16_f32 v196, v154, v155
 v_mfma_f32_16x16x32_bf16 a[124:127], a[252:255], v[220:223], a[124:127]
 ds_read_b128 a[208:211], v12 offset:24576
 s_waitcnt lgkmcnt(5)
 v_mfma_f32_16x16x32_bf16 a[128:131], a[192:195], v[208:211], a[128:131]
 v_exp_f32 v157, v235
 v_mfma_f32_16x16x32_bf16 a[132:135], a[192:195], v[212:215], a[132:135]
 ds_read_b128 a[212:215], v13 offset:24576
 v_add_f32 v149, v149, v156
 v_mfma_f32_16x16x32_bf16 a[136:139], a[192:195], v[216:219], a[136:139]
 buffer_load_dwordx4 v2, s[28:31], s76 offen offset:1024 nt lds
 v_mfma_f32_16x16x32_bf16 a[140:143], a[192:195], v[220:223], a[140:143]
 v_exp_f32 v152, v236
 v_mfma_f32_16x16x32_bf16 a[144:147], a[196:199], v[208:211], a[144:147]
 ds_read_b128 a[216:219], v12 offset:24704
 v_add_f32 v149, v149, v157
 v_mfma_f32_16x16x32_bf16 a[148:151], a[196:199], v[212:215], a[148:151]
 v_exp_f32 v153, v237
 v_mfma_f32_16x16x32_bf16 a[152:155], a[196:199], v[216:219], a[152:155]
 v_cvt_pk_bf16_f32 v197, v156, v157
 ds_read_b128 a[220:223], v13 offset:24704
 v_mfma_f32_16x16x32_bf16 a[156:159], a[196:199], v[220:223], a[156:159]
 ds_read_b128 a[224:227], v12 offset:24832
 s_waitcnt lgkmcnt(5)
 v_mfma_f32_16x16x32_bf16 a[160:163], a[200:203], v[208:211], a[160:163]
 v_exp_f32 v154, v238
 v_mfma_f32_16x16x32_bf16 a[164:167], a[200:203], v[212:215], a[164:167]
 v_add_f32 v149, v149, v152
 ds_read_b128 a[228:231], v13 offset:24832
 v_mfma_f32_16x16x32_bf16 a[168:171], a[200:203], v[216:219], a[168:171]
 v_add_f32 v149, v149, v153
 v_cvt_pk_bf16_f32 v198, v152, v153
 v_mfma_f32_16x16x32_bf16 a[172:175], a[200:203], v[220:223], a[172:175]
 v_exp_f32 v155, v239
 v_mfma_f32_16x16x32_bf16 a[176:179], a[204:207], v[208:211], a[176:179]
 v_add_f32 v149, v149, v154
 v_add_f32 v149, v149, v155
 v_mfma_f32_16x16x32_bf16 a[180:183], a[204:207], v[212:215], a[180:183]
 v_exp_f32 v156, v240
 v_mfma_f32_16x16x32_bf16 a[184:187], a[204:207], v[216:219], a[184:187]
 v_cvt_pk_bf16_f32 v199, v154, v155
 v_add_f32 v146, v146, v150
 v_mfma_f32_16x16x32_bf16 a[188:191], a[204:207], v[220:223], a[188:191]
 v_add_f32 v147, v147, v151
 s_waitcnt lgkmcnt(3)
 v_mfma_f32_16x16x32_bf16 v[160:163], a[208:211], v[32:35], v[128:131]
 v_exp_f32 v157, v241
 v_mfma_f32_16x16x32_bf16 v[160:163], a[212:215], v[48:51], v[160:163]
 ds_read_b128 a[232:235], v12 offset:30720
 v_add_f32 v150, v156, v157
 v_mfma_f32_16x16x32_bf16 v[160:163], a[216:219], v[64:67], v[160:163]
 ds_read_b128 a[236:239], v13 offset:30720
 s_waitcnt lgkmcnt(2)
 v_mfma_f32_16x16x32_bf16 v[160:163], a[220:223], v[80:83], v[160:163]
 buffer_load_dwordx4 v3, s[28:31], s76 offen offset:2048 nt lds
 v_mfma_f32_16x16x32_bf16 v[160:163], a[224:227], v[96:99], v[160:163]
 v_exp_f32 v152, v242
 v_mfma_f32_16x16x32_bf16 v[160:163], a[228:231], v[112:115], v[160:163]
 v_cvt_pk_bf16_f32 v200, v156, v157
 ds_read_b128 a[240:243], v12 offset:30848
 v_mfma_f32_16x16x32_bf16 v[168:171], a[208:211], v[36:39], v[132:135]
 v_exp_f32 v153, v243
 v_mfma_f32_16x16x32_bf16 v[168:171], a[212:215], v[52:55], v[168:171]
 v_add_f32 v150, v150, v152
 v_add_f32 v150, v150, v153
 v_mfma_f32_16x16x32_bf16 v[168:171], a[216:219], v[68:71], v[168:171]
 v_exp_f32 v154, v244
 v_mfma_f32_16x16x32_bf16 v[168:171], a[220:223], v[84:87], v[168:171]
 ds_read_b128 a[244:247], v13 offset:30848
 v_cvt_pk_bf16_f32 v201, v152, v153
 v_mfma_f32_16x16x32_bf16 v[168:171], a[224:227], v[100:103], v[168:171]
 v_add_f32 v150, v150, v154
 v_add_u32 v14, 49152, v14
 v_mfma_f32_16x16x32_bf16 v[168:171], a[228:231], v[116:119], v[168:171]
 v_exp_f32 v155, v245
 v_mfma_f32_16x16x32_bf16 v[176:179], a[208:211], v[40:43], v[136:139]
 ds_read_b128 a[248:251], v12 offset:30976
 v_add_f32 v150, v150, v155
 v_mfma_f32_16x16x32_bf16 v[176:179], a[212:215], v[56:59], v[176:179]
 s_add_u32 m0, s80, 147456
 s_mov_b32 s76, 245760
 v_mfma_f32_16x16x32_bf16 v[176:179], a[216:219], v[72:75], v[176:179]
 v_exp_f32 v156, v246
 v_mfma_f32_16x16x32_bf16 v[176:179], a[220:223], v[88:91], v[176:179]
 ds_read_b128 a[252:255], v13 offset:30976
 v_cvt_pk_bf16_f32 v202, v154, v155
 v_mfma_f32_16x16x32_bf16 v[176:179], a[224:227], v[104:107], v[176:179]
 v_add_f32 v150, v150, v156
 v_add_u32 v15, 49152, v15
 v_mfma_f32_16x16x32_bf16 v[176:179], a[228:231], v[120:123], v[176:179]
 v_exp_f32 v157, v247
 v_mfma_f32_16x16x32_bf16 v[184:187], a[208:211], v[44:47], v[140:143]
 buffer_load_dwordx4 v4, s[32:35], s76 offen offset:0 nt lds
 v_mfma_f32_16x16x32_bf16 v[184:187], a[212:215], v[60:63], v[184:187]
 v_add_f32 v150, v150, v157
 v_cvt_pk_bf16_f32 v203, v156, v157
 v_mfma_f32_16x16x32_bf16 v[184:187], a[216:219], v[76:79], v[184:187]
 v_exp_f32 v152, v248
 v_mfma_f32_16x16x32_bf16 v[184:187], a[220:223], v[92:95], v[184:187]
 v_add_u32 v16, 49152, v16
 v_add_u32 v17, 49152, v17
 v_mfma_f32_16x16x32_bf16 v[184:187], a[224:227], v[108:111], v[184:187]
 v_subrev_u32 v12, 36864, v12
 v_subrev_u32 v13, 36864, v13
 v_mfma_f32_16x16x32_bf16 v[184:187], a[228:231], v[124:127], v[184:187]
 v_max3_f32 v158, v148, v149, v150
 s_waitcnt lgkmcnt(3)
 v_mfma_f32_16x16x32_bf16 v[164:167], a[232:235], v[32:35], v[128:131]
 v_exp_f32 v153, v249
 v_mfma_f32_16x16x32_bf16 v[164:167], a[236:239], v[48:51], v[164:167]
 v_exp_f32 v154, v250
 v_mfma_f32_16x16x32_bf16 v[164:167], a[240:243], v[64:67], v[164:167]
 v_add_f32 v151, v152, v153
 s_waitcnt lgkmcnt(0)
 v_mfma_f32_16x16x32_bf16 v[164:167], a[244:247], v[80:83], v[164:167]
 v_cvt_pk_bf16_f32 v204, v152, v153
 v_add_f32 v151, v151, v154
 v_mfma_f32_16x16x32_bf16 v[164:167], a[248:251], v[96:99], v[164:167]
 s_waitcnt vmcnt(7)
 s_barrier
 v_mfma_f32_16x16x32_bf16 v[164:167], a[252:255], v[112:115], v[164:167]
 v_exp_f32 v155, v251
 v_mfma_f32_16x16x32_bf16 v[172:175], a[232:235], v[36:39], v[132:135]
 ds_read_b64_tr_b16 a[192:193], v14 offset:0
 v_add_f32 v151, v151, v155
 v_mfma_f32_16x16x32_bf16 v[172:175], a[236:239], v[52:55], v[172:175]
 v_exp_f32 v156, v252
 v_mfma_f32_16x16x32_bf16 v[172:175], a[240:243], v[68:71], v[172:175]
 ds_read_b64_tr_b16 a[194:195], v14 offset:6144
 v_cvt_pk_bf16_f32 v205, v154, v155
 v_mfma_f32_16x16x32_bf16 v[172:175], a[244:247], v[84:87], v[172:175]
 ds_read_b64_tr_b16 a[196:197], v15 offset:0
 v_add_f32 v151, v151, v156
 v_mfma_f32_16x16x32_bf16 v[172:175], a[248:251], v[100:103], v[172:175]
 v_exp_f32 v157, v253
 v_mfma_f32_16x16x32_bf16 v[172:175], a[252:255], v[116:119], v[172:175]
 buffer_load_dwordx4 v5, s[32:35], s76 offen offset:1024 nt lds
 v_mfma_f32_16x16x32_bf16 v[180:183], a[232:235], v[40:43], v[136:139]
 ds_read_b64_tr_b16 a[198:199], v15 offset:6144
 v_add_f32 v151, v151, v157
 v_mfma_f32_16x16x32_bf16 v[180:183], a[236:239], v[56:59], v[180:183]
 v_exp_f32 v152, v254
 v_mfma_f32_16x16x32_bf16 v[180:183], a[240:243], v[72:75], v[180:183]
 ds_read_b64_tr_b16 a[200:201], v16 offset:0
 v_cvt_pk_bf16_f32 v206, v156, v157
 v_mfma_f32_16x16x32_bf16 v[180:183], a[244:247], v[88:91], v[180:183]
 v_add_f32 v151, v151, v152
 v_mfma_f32_16x16x32_bf16 v[180:183], a[248:251], v[104:107], v[180:183]
 v_exp_f32 v153, v255
 v_mfma_f32_16x16x32_bf16 v[180:183], a[252:255], v[120:123], v[180:183]
 ds_read_b64_tr_b16 a[202:203], v16 offset:6144
 v_add_f32 v151, v151, v153
 v_mfma_f32_16x16x32_bf16 v[188:191], a[232:235], v[44:47], v[140:143]
 ds_read_b64_tr_b16 a[204:205], v17 offset:0
 v_cvt_pk_bf16_f32 v207, v152, v153
 v_mfma_f32_16x16x32_bf16 v[188:191], a[236:239], v[60:63], v[188:191]
 v_mfma_f32_16x16x32_bf16 v[188:191], a[240:243], v[76:79], v[188:191]
 ds_read_b64_tr_b16 a[206:207], v17 offset:6144
 v_max_f32 v158, v158, v151
 v_mfma_f32_16x16x32_bf16 v[188:191], a[244:247], v[92:95], v[188:191]
 v_cmp_lt_f32 vcc, s72, v158
 v_mfma_f32_16x16x32_bf16 v[188:191], a[248:251], v[108:111], v[188:191]
 v_mfma_f32_16x16x32_bf16 v[188:191], a[252:255], v[124:127], v[188:191]
 s_cbranch_vccnz L_S_17
L_R_17:
 s_waitcnt lgkmcnt(4)
 v_mfma_f32_16x16x32_bf16 a[0:3], a[192:195], v[192:195], a[0:3]
 v_exp_f32 v152, v160
 v_mfma_f32_16x16x32_bf16 a[4:7], a[192:195], v[196:199], a[4:7]
 ds_read_b64_tr_b16 a[208:209], v14 offset:128
 v_add_f32 v144, v144, v148
 v_mfma_f32_16x16x32_bf16 a[8:11], a[192:195], v[200:203], a[8:11]
 v_exp_f32 v153, v161
 v_mfma_f32_16x16x32_bf16 a[12:15], a[192:195], v[204:207], a[12:15]
 ds_read_b64_tr_b16 a[210:211], v14 offset:6272
 v_add_f32 v148, v152, v153
 v_mfma_f32_16x16x32_bf16 a[16:19], a[196:199], v[192:195], a[16:19]
 buffer_load_dwordx4 v6, s[32:35], s76 offen offset:2048 nt lds
 v_mfma_f32_16x16x32_bf16 a[20:23], a[196:199], v[196:199], a[20:23]
 v_exp_f32 v154, v162
 v_mfma_f32_16x16x32_bf16 a[24:27], a[196:199], v[200:203], a[24:27]
 ds_read_b64_tr_b16 a[212:213], v15 offset:128
 ds_read_b64_tr_b16 a[214:215], v15 offset:6272
 v_mfma_f32_16x16x32_bf16 a[28:31], a[196:199], v[204:207], a[28:31]
 v_cvt_pk_bf16_f32 v208, v152, v153
 s_waitcnt lgkmcnt(4)
 v_mfma_f32_16x16x32_bf16 a[32:35], a[200:203], v[192:195], a[32:35]
 v_exp_f32 v155, v163
 v_mfma_f32_16x16x32_bf16 a[36:39], a[200:203], v[196:199], a[36:39]
 ds_read_b64_tr_b16 a[216:217], v16 offset:128
 ds_read_b64_tr_b16 a[218:219], v16 offset:6272
 v_mfma_f32_16x16x32_bf16 a[40:43], a[200:203], v[200:203], a[40:43]
 v_add_f32 v148, v148, v154
 v_add_f32 v148, v148, v155
 v_mfma_f32_16x16x32_bf16 a[44:47], a[200:203], v[204:207], a[44:47]
 v_exp_f32 v156, v164
 v_mfma_f32_16x16x32_bf16 a[48:51], a[204:207], v[192:195], a[48:51]
 ds_read_b64_tr_b16 a[220:221], v17 offset:128
 v_cvt_pk_bf16_f32 v209, v154, v155
 v_mfma_f32_16x16x32_bf16 a[52:55], a[204:207], v[196:199], a[52:55]
 ds_read_b64_tr_b16 a[222:223], v17 offset:6272
 v_add_f32 v148, v148, v156
 v_mfma_f32_16x16x32_bf16 a[56:59], a[204:207], v[200:203], a[56:59]
 v_exp_f32 v157, v165
 v_mfma_f32_16x16x32_bf16 a[60:63], a[204:207], v[204:207], a[60:63]
 v_add_f32 v148, v148, v157
 s_waitcnt lgkmcnt(4)
 v_mfma_f32_16x16x32_bf16 a[64:67], a[208:211], v[192:195], a[64:67]
 s_add_u32 m0, s80, 24576
 s_mov_b32 s76, 270336
 v_mfma_f32_16x16x32_bf16 a[68:71], a[208:211], v[196:199], a[68:71]
 v_exp_f32 v152, v166
 v_mfma_f32_16x16x32_bf16 a[72:75], a[208:211], v[200:203], a[72:75]
 ds_read_b64_tr_b16 a[224:225], v14 offset:256
 ds_read_b64_tr_b16 a[226:227], v14 offset:6400
 v_mfma_f32_16x16x32_bf16 a[76:79], a[208:211], v[204:207], a[76:79]
 buffer_load_dwordx4 v1, s[28:31], s76 offen offset:0 nt lds
 v_mfma_f32_16x16x32_bf16 a[80:83], a[212:215], v[192:195], a[80:83]
 v_exp_f32 v153, v167
 v_mfma_f32_16x16x32_bf16 a[84:87], a[212:215], v[196:199], a[84:87]
 v_cvt_pk_bf16_f32 v210, v156, v157
 ds_read_b64_tr_b16 a[228:229], v15 offset:256
 v_mfma_f32_16x16x32_bf16 a[88:91], a[212:215], v[200:203], a[88:91]
 v_exp_f32 v154, v168
 v_mfma_f32_16x16x32_bf16 a[92:95], a[212:215], v[204:207], a[92:95]
 ds_read_b64_tr_b16 a[230:231], v15 offset:6400
 s_waitcnt lgkmcnt(4)
 v_mfma_f32_16x16x32_bf16 a[96:99], a[216:219], v[192:195], a[96:99]
 v_add_f32 v148, v148, v152
 v_add_f32 v148, v148, v153
 v_mfma_f32_16x16x32_bf16 a[100:103], a[216:219], v[196:199], a[100:103]
 v_cvt_pk_bf16_f32 v211, v152, v153
 v_add_f32 v145, v145, v149
 v_mfma_f32_16x16x32_bf16 a[104:107], a[216:219], v[200:203], a[104:107]
 v_exp_f32 v155, v169
 v_mfma_f32_16x16x32_bf16 a[108:111], a[216:219], v[204:207], a[108:111]
 ds_read_b64_tr_b16 a[232:233], v16 offset:256
 ds_read_b64_tr_b16 a[234:235], v16 offset:6400
 v_mfma_f32_16x16x32_bf16 a[112:115], a[220:223], v[192:195], a[112:115]
 v_exp_f32 v156, v170
 v_mfma_f32_16x16x32_bf16 a[116:119], a[220:223], v[196:199], a[116:119]
 ds_read_b64_tr_b16 a[236:237], v17 offset:256
 ds_read_b64_tr_b16 a[238:239], v17 offset:6400
 v_mfma_f32_16x16x32_bf16 a[120:123], a[220:223], v[200:203], a[120:123]
 v_add_f32 v149, v154, v155
 v_cvt_pk_bf16_f32 v212, v154, v155
 v_mfma_f32_16x16x32_bf16 a[124:127], a[220:223], v[204:207], a[124:127]
 ds_read_b128 a[240:243], v12 offset:0
 s_waitcnt lgkmcnt(5)
 v_mfma_f32_16x16x32_bf16 a[128:131], a[224:227], v[192:195], a[128:131]
 v_exp_f32 v157, v171
 v_mfma_f32_16x16x32_bf16 a[132:135], a[224:227], v[196:199], a[132:135]
 ds_read_b128 a[244:247], v13 offset:0
 v_add_f32 v149, v149, v156
 v_mfma_f32_16x16x32_bf16 a[136:139], a[224:227], v[200:203], a[136:139]
 v_exp_f32 v152, v172
 v_mfma_f32_16x16x32_bf16 a[140:143], a[224:227], v[204:207], a[140:143]
 buffer_load_dwordx4 v2, s[28:31], s76 offen offset:1024 nt lds
 v_mfma_f32_16x16x32_bf16 a[144:147], a[228:231], v[192:195], a[144:147]
 ds_read_b128 a[248:251], v12 offset:128
 v_add_f32 v149, v149, v157
 v_mfma_f32_16x16x32_bf16 a[148:151], a[228:231], v[196:199], a[148:151]
 v_exp_f32 v153, v173
 v_mfma_f32_16x16x32_bf16 a[152:155], a[228:231], v[200:203], a[152:155]
 v_cvt_pk_bf16_f32 v213, v156, v157
 ds_read_b128 a[252:255], v13 offset:128
 v_mfma_f32_16x16x32_bf16 a[156:159], a[228:231], v[204:207], a[156:159]
 ds_read_b128 a[192:195], v12 offset:256
 s_waitcnt lgkmcnt(5)
 v_mfma_f32_16x16x32_bf16 a[160:163], a[232:235], v[192:195], a[160:163]
 v_exp_f32 v154, v174
 v_mfma_f32_16x16x32_bf16 a[164:167], a[232:235], v[196:199], a[164:167]
 v_add_f32 v149, v149, v152
 ds_read_b128 a[196:199], v13 offset:256
 v_mfma_f32_16x16x32_bf16 a[168:171], a[232:235], v[200:203], a[168:171]
 v_add_f32 v149, v149, v153
 v_cvt_pk_bf16_f32 v214, v152, v153
 v_mfma_f32_16x16x32_bf16 a[172:175], a[232:235], v[204:207], a[172:175]
 v_exp_f32 v155, v175
 v_mfma_f32_16x16x32_bf16 a[176:179], a[236:239], v[192:195], a[176:179]
 v_add_f32 v149, v149, v154
 v_add_f32 v149, v149, v155
 v_mfma_f32_16x16x32_bf16 a[180:183], a[236:239], v[196:199], a[180:183]
 v_exp_f32 v156, v176
 v_mfma_f32_16x16x32_bf16 a[184:187], a[236:239], v[200:203], a[184:187]
 v_cvt_pk_bf16_f32 v215, v154, v155
 v_add_f32 v146, v146, v150
 v_mfma_f32_16x16x32_bf16 a[188:191], a[236:239], v[204:207], a[188:191]
 v_add_f32 v147, v147, v151
 s_waitcnt lgkmcnt(3)
 v_mfma_f32_16x16x32_bf16 v[224:227], a[240:243], v[32:35], v[128:131]
 v_exp_f32 v157, v177
 v_mfma_f32_16x16x32_bf16 v[224:227], a[244:247], v[48:51], v[224:227]
 ds_read_b128 a[200:203], v12 offset:6144
 v_add_f32 v150, v156, v157
 v_mfma_f32_16x16x32_bf16 v[224:227], a[248:251], v[64:67], v[224:227]
 ds_read_b128 a[204:207], v13 offset:6144
 s_waitcnt lgkmcnt(2)
 v_mfma_f32_16x16x32_bf16 v[224:227], a[252:255], v[80:83], v[224:227]
 buffer_load_dwordx4 v3, s[28:31], s76 offen offset:2048 nt lds
 v_mfma_f32_16x16x32_bf16 v[224:227], a[192:195], v[96:99], v[224:227]
 v_exp_f32 v152, v178
 v_mfma_f32_16x16x32_bf16 v[224:227], a[196:199], v[112:115], v[224:227]
 v_cvt_pk_bf16_f32 v216, v156, v157
 ds_read_b128 a[208:211], v12 offset:6272
 v_mfma_f32_16x16x32_bf16 v[232:235], a[240:243], v[36:39], v[132:135]
 v_exp_f32 v153, v179
 v_mfma_f32_16x16x32_bf16 v[232:235], a[244:247], v[52:55], v[232:235]
 v_add_f32 v150, v150, v152
 v_add_f32 v150, v150, v153
 v_mfma_f32_16x16x32_bf16 v[232:235], a[248:251], v[68:71], v[232:235]
 v_exp_f32 v154, v180
 v_mfma_f32_16x16x32_bf16 v[232:235], a[252:255], v[84:87], v[232:235]
 ds_read_b128 a[212:215], v13 offset:6272
 v_cvt_pk_bf16_f32 v217, v152, v153
 v_mfma_f32_16x16x32_bf16 v[232:235], a[192:195], v[100:103], v[232:235]
 v_add_f32 v150, v150, v154
 v_mfma_f32_16x16x32_bf16 v[232:235], a[196:199], v[116:119], v[232:235]
 v_exp_f32 v155, v181
 v_mfma_f32_16x16x32_bf16 v[240:243], a[240:243], v[40:43], v[136:139]
 ds_read_b128 a[216:219], v12 offset:6400
 v_add_f32 v150, v150, v155
 v_mfma_f32_16x16x32_bf16 v[240:243], a[244:247], v[56:59], v[240:243]
 s_add_u32 m0, s80, 73728
 s_mov_b32 s76, 258048
 v_mfma_f32_16x16x32_bf16 v[240:243], a[248:251], v[72:75], v[240:243]
 v_exp_f32 v156, v182
 v_mfma_f32_16x16x32_bf16 v[240:243], a[252:255], v[88:91], v[240:243]
 ds_read_b128 a[220:223], v13 offset:6400
 v_cvt_pk_bf16_f32 v218, v154, v155
 v_mfma_f32_16x16x32_bf16 v[240:243], a[192:195], v[104:107], v[240:243]
 v_add_f32 v150, v150, v156
 v_mfma_f32_16x16x32_bf16 v[240:243], a[196:199], v[120:123], v[240:243]
 v_exp_f32 v157, v183
 v_mfma_f32_16x16x32_bf16 v[248:251], a[240:243], v[44:47], v[140:143]
 buffer_load_dwordx4 v4, s[32:35], s76 offen offset:0 nt lds
 v_mfma_f32_16x16x32_bf16 v[248:251], a[244:247], v[60:63], v[248:251]
 v_add_f32 v150, v150, v157
 v_cvt_pk_bf16_f32 v219, v156, v157
 v_mfma_f32_16x16x32_bf16 v[248:251], a[248:251], v[76:79], v[248:251]
 v_exp_f32 v152, v184
 v_mfma_f32_16x16x32_bf16 v[248:251], a[252:255], v[92:95], v[248:251]
 v_max3_f32 v158, v148, v149, v150
 v_mfma_f32_16x16x32_bf16 v[248:251], a[192:195], v[108:111], v[248:251]
 v_mfma_f32_16x16x32_bf16 v[248:251], a[196:199], v[124:127], v[248:251]
 s_waitcnt lgkmcnt(3)
 v_mfma_f32_16x16x32_bf16 v[228:231], a[200:203], v[32:35], v[128:131]
 v_exp_f32 v153, v185
 v_mfma_f32_16x16x32_bf16 v[228:231], a[204:207], v[48:51], v[228:231]
 v_exp_f32 v154, v186
 v_mfma_f32_16x16x32_bf16 v[228:231], a[208:211], v[64:67], v[228:231]
 v_add_f32 v151, v152, v153
 s_waitcnt lgkmcnt(0)
 v_mfma_f32_16x16x32_bf16 v[228:231], a[212:215], v[80:83], v[228:231]
 v_cvt_pk_bf16_f32 v220, v152, v153
 v_add_f32 v151, v151, v154
 v_mfma_f32_16x16x32_bf16 v[228:231], a[216:219], v[96:99], v[228:231]
 s_waitcnt vmcnt(7)
 s_barrier
 v_mfma_f32_16x16x32_bf16 v[228:231], a[220:223], v[112:115], v[228:231]
 v_exp_f32 v155, v187
 v_mfma_f32_16x16x32_bf16 v[236:239], a[200:203], v[36:39], v[132:135]
 ds_read_b64_tr_b16 a[224:225], v14 offset:12288
 v_add_f32 v151, v151, v155
 v_mfma_f32_16x16x32_bf16 v[236:239], a[204:207], v[52:55], v[236:239]
 v_exp_f32 v156, v188
 v_mfma_f32_16x16x32_bf16 v[236:239], a[208:211], v[68:71], v[236:239]
 ds_read_b64_tr_b16 a[226:227], v14 offset:18432
 v_cvt_pk_bf16_f32 v221, v154, v155
 v_mfma_f32_16x16x32_bf16 v[236:239], a[212:215], v[84:87], v[236:239]
 ds_read_b64_tr_b16 a[228:229], v15 offset:12288
 v_add_f32 v151, v151, v156
 v_mfma_f32_16x16x32_bf16 v[236:239], a[216:219], v[100:103], v[236:239]
 v_exp_f32 v157, v189
 v_mfma_f32_16x16x32_bf16 v[236:239], a[220:223], v[116:119], v[236:239]
 buffer_load_dwordx4 v5, s[32:35], s76 offen offset:1024 nt lds
 v_mfma_f32_16x16x32_bf16 v[244:247], a[200:203], v[40:43], v[136:139]
 ds_read_b64_tr_b16 a[230:231], v15 offset:18432
 v_add_f32 v151, v151, v157
 v_mfma_f32_16x16x32_bf16 v[244:247], a[204:207], v[56:59], v[244:247]
 v_exp_f32 v152, v190
 v_mfma_f32_16x16x32_bf16 v[244:247], a[208:211], v[72:75], v[244:247]
 ds_read_b64_tr_b16 a[232:233], v16 offset:12288
 v_cvt_pk_bf16_f32 v222, v156, v157
 v_mfma_f32_16x16x32_bf16 v[244:247], a[212:215], v[88:91], v[244:247]
 v_add_f32 v151, v151, v152
 v_mfma_f32_16x16x32_bf16 v[244:247], a[216:219], v[104:107], v[244:247]
 v_exp_f32 v153, v191
 v_mfma_f32_16x16x32_bf16 v[244:247], a[220:223], v[120:123], v[244:247]
 ds_read_b64_tr_b16 a[234:235], v16 offset:18432
 v_add_f32 v151, v151, v153
 v_mfma_f32_16x16x32_bf16 v[252:255], a[200:203], v[44:47], v[140:143]
 ds_read_b64_tr_b16 a[236:237], v17 offset:12288
 v_cvt_pk_bf16_f32 v223, v152, v153
 v_mfma_f32_16x16x32_bf16 v[252:255], a[204:207], v[60:63], v[252:255]
 v_mfma_f32_16x16x32_bf16 v[252:255], a[208:211], v[76:79], v[252:255]
 ds_read_b64_tr_b16 a[238:239], v17 offset:18432
 v_max_f32 v158, v158, v151
 v_mfma_f32_16x16x32_bf16 v[252:255], a[212:215], v[92:95], v[252:255]
 v_cmp_lt_f32 vcc, s72, v158
 v_mfma_f32_16x16x32_bf16 v[252:255], a[216:219], v[108:111], v[252:255]
 v_mfma_f32_16x16x32_bf16 v[252:255], a[220:223], v[124:127], v[252:255]
 s_cbranch_vccnz L_S_18
L_R_18:
 s_waitcnt lgkmcnt(4)
 v_mfma_f32_16x16x32_bf16 a[0:3], a[224:227], v[208:211], a[0:3]
 v_exp_f32 v152, v224
 v_mfma_f32_16x16x32_bf16 a[4:7], a[224:227], v[212:215], a[4:7]
 ds_read_b64_tr_b16 a[240:241], v14 offset:12416
 v_add_f32 v144, v144, v148
 v_mfma_f32_16x16x32_bf16 a[8:11], a[224:227], v[216:219], a[8:11]
 v_exp_f32 v153, v225
 v_mfma_f32_16x16x32_bf16 a[12:15], a[224:227], v[220:223], a[12:15]
 ds_read_b64_tr_b16 a[242:243], v14 offset:18560
 v_add_f32 v148, v152, v153
 v_mfma_f32_16x16x32_bf16 a[16:19], a[228:231], v[208:211], a[16:19]
 buffer_load_dwordx4 v6, s[32:35], s76 offen offset:2048 nt lds
 v_mfma_f32_16x16x32_bf16 a[20:23], a[228:231], v[212:215], a[20:23]
 v_exp_f32 v154, v226
 v_mfma_f32_16x16x32_bf16 a[24:27], a[228:231], v[216:219], a[24:27]
 ds_read_b64_tr_b16 a[244:245], v15 offset:12416
 ds_read_b64_tr_b16 a[246:247], v15 offset:18560
 v_mfma_f32_16x16x32_bf16 a[28:31], a[228:231], v[220:223], a[28:31]
 v_cvt_pk_bf16_f32 v192, v152, v153
 s_waitcnt lgkmcnt(4)
 v_mfma_f32_16x16x32_bf16 a[32:35], a[232:235], v[208:211], a[32:35]
 v_exp_f32 v155, v227
 v_mfma_f32_16x16x32_bf16 a[36:39], a[232:235], v[212:215], a[36:39]
 ds_read_b64_tr_b16 a[248:249], v16 offset:12416
 ds_read_b64_tr_b16 a[250:251], v16 offset:18560
 v_mfma_f32_16x16x32_bf16 a[40:43], a[232:235], v[216:219], a[40:43]
 v_add_f32 v148, v148, v154
 v_add_f32 v148, v148, v155
 v_mfma_f32_16x16x32_bf16 a[44:47], a[232:235], v[220:223], a[44:47]
 v_exp_f32 v156, v228
 v_mfma_f32_16x16x32_bf16 a[48:51], a[236:239], v[208:211], a[48:51]
 ds_read_b64_tr_b16 a[252:253], v17 offset:12416
 v_cvt_pk_bf16_f32 v193, v154, v155
 v_mfma_f32_16x16x32_bf16 a[52:55], a[236:239], v[212:215], a[52:55]
 ds_read_b64_tr_b16 a[254:255], v17 offset:18560
 v_add_f32 v148, v148, v156
 v_mfma_f32_16x16x32_bf16 a[56:59], a[236:239], v[216:219], a[56:59]
 v_exp_f32 v157, v229
 v_mfma_f32_16x16x32_bf16 a[60:63], a[236:239], v[220:223], a[60:63]
 v_add_f32 v148, v148, v157
 s_waitcnt lgkmcnt(4)
 v_mfma_f32_16x16x32_bf16 a[64:67], a[240:243], v[208:211], a[64:67]
 s_add_u32 m0, s80, 36864
 s_mov_b32 s76, 282624
 v_mfma_f32_16x16x32_bf16 a[68:71], a[240:243], v[212:215], a[68:71]
 v_exp_f32 v152, v230
 v_mfma_f32_16x16x32_bf16 a[72:75], a[240:243], v[216:219], a[72:75]
 ds_read_b64_tr_b16 a[192:193], v14 offset:12544
 ds_read_b64_tr_b16 a[194:195], v14 offset:18688
 v_mfma_f32_16x16x32_bf16 a[76:79], a[240:243], v[220:223], a[76:79]
 buffer_load_dwordx4 v1, s[28:31], s76 offen offset:0 nt lds
 v_mfma_f32_16x16x32_bf16 a[80:83], a[244:247], v[208:211], a[80:83]
 v_exp_f32 v153, v231
 v_mfma_f32_16x16x32_bf16 a[84:87], a[244:247], v[212:215], a[84:87]
 v_cvt_pk_bf16_f32 v194, v156, v157
 ds_read_b64_tr_b16 a[196:197], v15 offset:12544
 v_mfma_f32_16x16x32_bf16 a[88:91], a[244:247], v[216:219], a[88:91]
 v_exp_f32 v154, v232
 v_mfma_f32_16x16x32_bf16 a[92:95], a[244:247], v[220:223], a[92:95]
 ds_read_b64_tr_b16 a[198:199], v15 offset:18688
 s_waitcnt lgkmcnt(4)
 v_mfma_f32_16x16x32_bf16 a[96:99], a[248:251], v[208:211], a[96:99]
 v_add_f32 v148, v148, v152
 v_add_f32 v148, v148, v153
 v_mfma_f32_16x16x32_bf16 a[100:103], a[248:251], v[212:215], a[100:103]
 v_cvt_pk_bf16_f32 v195, v152, v153
 v_add_f32 v145, v145, v149
 v_mfma_f32_16x16x32_bf16 a[104:107], a[248:251], v[216:219], a[104:107]
 v_exp_f32 v155, v233
 v_mfma_f32_16x16x32_bf16 a[108:111], a[248:251], v[220:223], a[108:111]
 ds_read_b64_tr_b16 a[200:201], v16 offset:12544
 ds_read_b64_tr_b16 a[202:203], v16 offset:18688
 v_mfma_f32_16x16x32_bf16 a[112:115], a[252:255], v[208:211], a[112:115]
 v_exp_f32 v156, v234
 v_mfma_f32_16x16x32_bf16 a[116:119], a[252:255], v[212:215], a[116:119]
 ds_read_b64_tr_b16 a[204:205], v17 offset:12544
 ds_read_b64_tr_b16 a[206:207], v17 offset:18688
 v_mfma_f32_16x16x32_bf16 a[120:123], a[252:255], v[216:219], a[120:123]
 v_add_f32 v149, v154, v155
 v_cvt_pk_bf16_f32 v196, v154, v155
 v_mfma_f32_16x16x32_bf16 a[124:127], a[252:255], v[220:223], a[124:127]
 ds_read_b128 a[208:211], v12 offset:12288
 s_waitcnt lgkmcnt(5)
 v_mfma_f32_16x16x32_bf16 a[128:131], a[192:195], v[208:211], a[128:131]
 v_exp_f32 v157, v235
 v_mfma_f32_16x16x32_bf16 a[132:135], a[192:195], v[212:215], a[132:135]
 ds_read_b128 a[212:215], v13 offset:12288
 v_add_f32 v149, v149, v156
 v_mfma_f32_16x16x32_bf16 a[136:139], a[192:195], v[216:219], a[136:139]
 v_exp_f32 v152, v236
 v_mfma_f32_16x16x32_bf16 a[140:143], a[192:195], v[220:223], a[140:143]
 buffer_load_dwordx4 v2, s[28:31], s76 offen offset:1024 nt lds
 v_mfma_f32_16x16x32_bf16 a[144:147], a[196:199], v[208:211], a[144:147]
 ds_read_b128 a[216:219], v12 offset:12416
 v_add_f32 v149, v149, v157
 v_mfma_f32_16x16x32_bf16 a[148:151], a[196:199], v[212:215], a[148:151]
 v_exp_f32 v153, v237
 v_mfma_f32_16x16x32_bf16 a[152:155], a[196:199], v[216:219], a[152:155]
 v_cvt_pk_bf16_f32 v197, v156, v157
 ds_read_b128 a[220:223], v13 offset:12416
 v_mfma_f32_16x16x32_bf16 a[156:159], a[196:199], v[220:223], a[156:159]
 ds_read_b128 a[224:227], v12 offset:12544
 s_waitcnt lgkmcnt(5)
 v_mfma_f32_16x16x32_bf16 a[160:163], a[200:203], v[208:211], a[160:163]
 v_exp_f32 v154, v238
 v_mfma_f32_16x16x32_bf16 a[164:167], a[200:203], v[212:215], a[164:167]
 v_add_f32 v149, v149, v152
 ds_read_b128 a[228:231], v13 offset:12544
 v_mfma_f32_16x16x32_bf16 a[168:171], a[200:203], v[216:219], a[168:171]
 v_add_f32 v149, v149, v153
 v_cvt_pk_bf16_f32 v198, v152, v153
 v_mfma_f32_16x16x32_bf16 a[172:175], a[200:203], v[220:223], a[172:175]
 v_exp_f32 v155, v239
 v_mfma_f32_16x16x32_bf16 a[176:179], a[204:207], v[208:211], a[176:179]
 v_add_f32 v149, v149, v154
 v_add_f32 v149, v149, v155
 v_mfma_f32_16x16x32_bf16 a[180:183], a[204:207], v[212:215], a[180:183]
 v_exp_f32 v156, v240
 v_mfma_f32_16x16x32_bf16 a[184:187], a[204:207], v[216:219], a[184:187]
 v_cvt_pk_bf16_f32 v199, v154, v155
 v_add_f32 v146, v146, v150
 v_mfma_f32_16x16x32_bf16 a[188:191], a[204:207], v[220:223], a[188:191]
 v_add_f32 v147, v147, v151
 s_waitcnt lgkmcnt(3)
 v_mfma_f32_16x16x32_bf16 v[160:163], a[208:211], v[32:35], v[128:131]
 v_exp_f32 v157, v241
 v_mfma_f32_16x16x32_bf16 v[160:163], a[212:215], v[48:51], v[160:163]
 ds_read_b128 a[232:235], v12 offset:18432
 v_add_f32 v150, v156, v157
 v_mfma_f32_16x16x32_bf16 v[160:163], a[216:219], v[64:67], v[160:163]
 ds_read_b128 a[236:239], v13 offset:18432
 s_waitcnt lgkmcnt(2)
 v_mfma_f32_16x16x32_bf16 v[160:163], a[220:223], v[80:83], v[160:163]
 buffer_load_dwordx4 v3, s[28:31], s76 offen offset:2048 nt lds
 v_mfma_f32_16x16x32_bf16 v[160:163], a[224:227], v[96:99], v[160:163]
 v_exp_f32 v152, v242
 v_mfma_f32_16x16x32_bf16 v[160:163], a[228:231], v[112:115], v[160:163]
 v_cvt_pk_bf16_f32 v200, v156, v157
 ds_read_b128 a[240:243], v12 offset:18560
 v_mfma_f32_16x16x32_bf16 v[168:171], a[208:211], v[36:39], v[132:135]
 v_exp_f32 v153, v243
 v_mfma_f32_16x16x32_bf16 v[168:171], a[212:215], v[52:55], v[168:171]
 v_add_f32 v150, v150, v152
 v_add_f32 v150, v150, v153
 v_mfma_f32_16x16x32_bf16 v[168:171], a[216:219], v[68:71], v[168:171]
 v_exp_f32 v154, v244
 v_mfma_f32_16x16x32_bf16 v[168:171], a[220:223], v[84:87], v[168:171]
 ds_read_b128 a[244:247], v13 offset:18560
 v_cvt_pk_bf16_f32 v201, v152, v153
 v_mfma_f32_16x16x32_bf16 v[168:171], a[224:227], v[100:103], v[168:171]
 v_add_f32 v150, v150, v154
 v_mfma_f32_16x16x32_bf16 v[168:171], a[228:231], v[116:119], v[168:171]
 v_exp_f32 v155, v245
 v_mfma_f32_16x16x32_bf16 v[176:179], a[208:211], v[40:43], v[136:139]
 ds_read_b128 a[248:251], v12 offset:18688
 v_add_f32 v150, v150, v155
 v_mfma_f32_16x16x32_bf16 v[176:179], a[212:215], v[56:59], v[176:179]
 s_add_u32 m0, s80, 86016
 s_mov_b32 s76, 270336
 v_mfma_f32_16x16x32_bf16 v[176:179], a[216:219], v[72:75], v[176:179]
 v_exp_f32 v156, v246
 v_mfma_f32_16x16x32_bf16 v[176:179], a[220:223], v[88:91], v[176:179]
 ds_read_b128 a[252:255], v13 offset:18688
 v_cvt_pk_bf16_f32 v202, v154, v155
 v_mfma_f32_16x16x32_bf16 v[176:179], a[224:227], v[104:107], v[176:179]
 v_add_f32 v150, v150, v156
 v_mfma_f32_16x16x32_bf16 v[176:179], a[228:231], v[120:123], v[176:179]
 v_exp_f32 v157, v247
 v_mfma_f32_16x16x32_bf16 v[184:187], a[208:211], v[44:47], v[140:143]
 buffer_load_dwordx4 v4, s[32:35], s76 offen offset:0 nt lds
 v_mfma_f32_16x16x32_bf16 v[184:187], a[212:215], v[60:63], v[184:187]
 v_add_f32 v150, v150, v157
 v_cvt_pk_bf16_f32 v203, v156, v157
 v_mfma_f32_16x16x32_bf16 v[184:187], a[216:219], v[76:79], v[184:187]
 v_exp_f32 v152, v248
 v_mfma_f32_16x16x32_bf16 v[184:187], a[220:223], v[92:95], v[184:187]
 v_max3_f32 v158, v148, v149, v150
 v_mfma_f32_16x16x32_bf16 v[184:187], a[224:227], v[108:111], v[184:187]
 v_mfma_f32_16x16x32_bf16 v[184:187], a[228:231], v[124:127], v[184:187]
 s_waitcnt lgkmcnt(3)
 v_mfma_f32_16x16x32_bf16 v[164:167], a[232:235], v[32:35], v[128:131]
 v_exp_f32 v153, v249
 v_mfma_f32_16x16x32_bf16 v[164:167], a[236:239], v[48:51], v[164:167]
 v_exp_f32 v154, v250
 v_mfma_f32_16x16x32_bf16 v[164:167], a[240:243], v[64:67], v[164:167]
 v_add_f32 v151, v152, v153
 s_waitcnt lgkmcnt(0)
 v_mfma_f32_16x16x32_bf16 v[164:167], a[244:247], v[80:83], v[164:167]
 v_cvt_pk_bf16_f32 v204, v152, v153
 v_add_f32 v151, v151, v154
 v_mfma_f32_16x16x32_bf16 v[164:167], a[248:251], v[96:99], v[164:167]
 s_waitcnt vmcnt(7)
 s_barrier
 v_mfma_f32_16x16x32_bf16 v[164:167], a[252:255], v[112:115], v[164:167]
 v_exp_f32 v155, v251
 v_mfma_f32_16x16x32_bf16 v[172:175], a[232:235], v[36:39], v[132:135]
 ds_read_b64_tr_b16 a[192:193], v14 offset:24576
 v_add_f32 v151, v151, v155
 v_mfma_f32_16x16x32_bf16 v[172:175], a[236:239], v[52:55], v[172:175]
 v_exp_f32 v156, v252
 v_mfma_f32_16x16x32_bf16 v[172:175], a[240:243], v[68:71], v[172:175]
 ds_read_b64_tr_b16 a[194:195], v14 offset:30720
 v_cvt_pk_bf16_f32 v205, v154, v155
 v_mfma_f32_16x16x32_bf16 v[172:175], a[244:247], v[84:87], v[172:175]
 ds_read_b64_tr_b16 a[196:197], v15 offset:24576
 v_add_f32 v151, v151, v156
 v_mfma_f32_16x16x32_bf16 v[172:175], a[248:251], v[100:103], v[172:175]
 v_exp_f32 v157, v253
 v_mfma_f32_16x16x32_bf16 v[172:175], a[252:255], v[116:119], v[172:175]
 buffer_load_dwordx4 v5, s[32:35], s76 offen offset:1024 nt lds
 v_mfma_f32_16x16x32_bf16 v[180:183], a[232:235], v[40:43], v[136:139]
 ds_read_b64_tr_b16 a[198:199], v15 offset:30720
 v_add_f32 v151, v151, v157
 v_mfma_f32_16x16x32_bf16 v[180:183], a[236:239], v[56:59], v[180:183]
 v_exp_f32 v152, v254
 v_mfma_f32_16x16x32_bf16 v[180:183], a[240:243], v[72:75], v[180:183]
 ds_read_b64_tr_b16 a[200:201], v16 offset:24576
 v_cvt_pk_bf16_f32 v206, v156, v157
 v_mfma_f32_16x16x32_bf16 v[180:183], a[244:247], v[88:91], v[180:183]
 v_add_f32 v151, v151, v152
 v_mfma_f32_16x16x32_bf16 v[180:183], a[248:251], v[104:107], v[180:183]
 v_exp_f32 v153, v255
 v_mfma_f32_16x16x32_bf16 v[180:183], a[252:255], v[120:123], v[180:183]
 ds_read_b64_tr_b16 a[202:203], v16 offset:30720
 v_add_f32 v151, v151, v153
 v_mfma_f32_16x16x32_bf16 v[188:191], a[232:235], v[44:47], v[140:143]
 ds_read_b64_tr_b16 a[204:205], v17 offset:24576
 v_cvt_pk_bf16_f32 v207, v152, v153
 v_mfma_f32_16x16x32_bf16 v[188:191], a[236:239], v[60:63], v[188:191]
 v_mfma_f32_16x16x32_bf16 v[188:191], a[240:243], v[76:79], v[188:191]
 ds_read_b64_tr_b16 a[206:207], v17 offset:30720
 v_max_f32 v158, v158, v151
 v_mfma_f32_16x16x32_bf16 v[188:191], a[244:247], v[92:95], v[188:191]
 v_cmp_lt_f32 vcc, s72, v158
 v_mfma_f32_16x16x32_bf16 v[188:191], a[248:251], v[108:111], v[188:191]
 v_mfma_f32_16x16x32_bf16 v[188:191], a[252:255], v[124:127], v[188:191]
 s_cbranch_vccnz L_S_19
L_R_19:
 s_cmp_lg_u32 s3, 0
 s_cbranch_scc1 L_NONON2
 v_mov_b32 v23, 159744
 v_mov_b32 v22, s82
 ds_write_b32 v23, v22
 s_waitcnt lgkmcnt(0)
L_NONON2:
 s_waitcnt lgkmcnt(4)
 v_mfma_f32_16x16x32_bf16 a[0:3], a[192:195], v[192:195], a[0:3]
 v_exp_f32 v152, v160
 v_mfma_f32_16x16x32_bf16 a[4:7], a[192:195], v[196:199], a[4:7]
 ds_read_b64_tr_b16 a[208:209], v14 offset:24704
 v_add_f32 v144, v144, v148
 v_mfma_f32_16x16x32_bf16 a[8:11], a[192:195], v[200:203], a[8:11]
 v_exp_f32 v153, v161
 v_mfma_f32_16x16x32_bf16 a[12:15], a[192:195], v[204:207], a[12:15]
 ds_read_b64_tr_b16 a[210:211], v14 offset:30848
 v_add_f32 v148, v152, v153
 v_mfma_f32_16x16x32_bf16 a[16:19], a[196:199], v[192:195], a[16:19]
 buffer_load_dwordx4 v6, s[32:35], s76 offen offset:2048 nt lds
 v_mfma_f32_16x16x32_bf16 a[20:23], a[196:199], v[196:199], a[20:23]
 v_exp_f32 v154, v162
 v_mfma_f32_16x16x32_bf16 a[24:27], a[196:199], v[200:203], a[24:27]
 ds_read_b64_tr_b16 a[212:213], v15 offset:24704
 ds_read_b64_tr_b16 a[214:215], v15 offset:30848
 v_mfma_f32_16x16x32_bf16 a[28:31], a[196:199], v[204:207], a[28:31]
 v_cvt_pk_bf16_f32 v208, v152, v153
 s_waitcnt lgkmcnt(4)
 v_mfma_f32_16x16x32_bf16 a[32:35], a[200:203], v[192:195], a[32:35]
 v_exp_f32 v155, v163
 v_mfma_f32_16x16x32_bf16 a[36:39], a[200:203], v[196:199], a[36:39]
 ds_read_b64_tr_b16 a[216:217], v16 offset:24704
 ds_read_b64_tr_b16 a[218:219], v16 offset:30848
 v_mfma_f32_16x16x32_bf16 a[40:43], a[200:203], v[200:203], a[40:43]
 v_add_f32 v148, v148, v154
 v_add_f32 v148, v148, v155
 v_mfma_f32_16x16x32_bf16 a[44:47], a[200:203], v[204:207], a[44:47]
 v_exp_f32 v156, v164
 v_mfma_f32_16x16x32_bf16 a[48:51], a[204:207], v[192:195], a[48:51]
 ds_read_b64_tr_b16 a[220:221], v17 offset:24704
 v_cvt_pk_bf16_f32 v209, v154, v155
 v_mfma_f32_16x16x32_bf16 a[52:55], a[204:207], v[196:199], a[52:55]
 ds_read_b64_tr_b16 a[222:223], v17 offset:30848
 v_add_f32 v148, v148, v156
 v_mfma_f32_16x16x32_bf16 a[56:59], a[204:207], v[200:203], a[56:59]
 v_exp_f32 v157, v165
 v_mfma_f32_16x16x32_bf16 a[60:63], a[204:207], v[204:207], a[60:63]
 v_add_f32 v148, v148, v157
 s_waitcnt lgkmcnt(4)
 v_mfma_f32_16x16x32_bf16 a[64:67], a[208:211], v[192:195], a[64:67]
 s_add_u32 m0, s80, 49152
 s_mov_b32 s76, 294912
 v_mfma_f32_16x16x32_bf16 a[68:71], a[208:211], v[196:199], a[68:71]
 v_exp_f32 v152, v166
 v_mfma_f32_16x16x32_bf16 a[72:75], a[208:211], v[200:203], a[72:75]
 ds_read_b64_tr_b16 a[224:225], v14 offset:24832
 ds_read_b64_tr_b16 a[226:227], v14 offset:30976
 v_mfma_f32_16x16x32_bf16 a[76:79], a[208:211], v[204:207], a[76:79]
 buffer_load_dwordx4 v1, s[28:31], s76 offen offset:0 nt lds
 v_mfma_f32_16x16x32_bf16 a[80:83], a[212:215], v[192:195], a[80:83]
 v_exp_f32 v153, v167
 v_mfma_f32_16x16x32_bf16 a[84:87], a[212:215], v[196:199], a[84:87]
 v_cvt_pk_bf16_f32 v210, v156, v157
 ds_read_b64_tr_b16 a[228:229], v15 offset:24832
 v_mfma_f32_16x16x32_bf16 a[88:91], a[212:215], v[200:203], a[88:91]
 v_exp_f32 v154, v168
 v_mfma_f32_16x16x32_bf16 a[92:95], a[212:215], v[204:207], a[92:95]
 ds_read_b64_tr_b16 a[230:231], v15 offset:30976
 s_waitcnt lgkmcnt(4)
 v_mfma_f32_16x16x32_bf16 a[96:99], a[216:219], v[192:195], a[96:99]
 v_add_f32 v148, v148, v152
 v_add_f32 v148, v148, v153
 v_mfma_f32_16x16x32_bf16 a[100:103], a[216:219], v[196:199], a[100:103]
 v_cvt_pk_bf16_f32 v211, v152, v153
 v_add_f32 v145, v145, v149
 v_mfma_f32_16x16x32_bf16 a[104:107], a[216:219], v[200:203], a[104:107]
 v_exp_f32 v155, v169
 v_mfma_f32_16x16x32_bf16 a[108:111], a[216:219], v[204:207], a[108:111]
 ds_read_b64_tr_b16 a[232:233], v16 offset:24832
 ds_read_b64_tr_b16 a[234:235], v16 offset:30976
 v_mfma_f32_16x16x32_bf16 a[112:115], a[220:223], v[192:195], a[112:115]
 v_exp_f32 v156, v170
 v_mfma_f32_16x16x32_bf16 a[116:119], a[220:223], v[196:199], a[116:119]
 ds_read_b64_tr_b16 a[236:237], v17 offset:24832
 ds_read_b64_tr_b16 a[238:239], v17 offset:30976
 v_mfma_f32_16x16x32_bf16 a[120:123], a[220:223], v[200:203], a[120:123]
 v_add_f32 v149, v154, v155
 v_cvt_pk_bf16_f32 v212, v154, v155
 v_mfma_f32_16x16x32_bf16 a[124:127], a[220:223], v[204:207], a[124:127]
 ds_read_b128 a[240:243], v12 offset:24576
 s_waitcnt lgkmcnt(5)
 v_mfma_f32_16x16x32_bf16 a[128:131], a[224:227], v[192:195], a[128:131]
 v_exp_f32 v157, v171
 v_mfma_f32_16x16x32_bf16 a[132:135], a[224:227], v[196:199], a[132:135]
 ds_read_b128 a[244:247], v13 offset:24576
 v_add_f32 v149, v149, v156
 v_mfma_f32_16x16x32_bf16 a[136:139], a[224:227], v[200:203], a[136:139]
 v_exp_f32 v152, v172
 v_mfma_f32_16x16x32_bf16 a[140:143], a[224:227], v[204:207], a[140:143]
 buffer_load_dwordx4 v2, s[28:31], s76 offen offset:1024 nt lds
 v_mfma_f32_16x16x32_bf16 a[144:147], a[228:231], v[192:195], a[144:147]
 ds_read_b128 a[248:251], v12 offset:24704
 v_add_f32 v149, v149, v157
 v_mfma_f32_16x16x32_bf16 a[148:151], a[228:231], v[196:199], a[148:151]
 v_exp_f32 v153, v173
 v_mfma_f32_16x16x32_bf16 a[152:155], a[228:231], v[200:203], a[152:155]
 v_cvt_pk_bf16_f32 v213, v156, v157
 ds_read_b128 a[252:255], v13 offset:24704
 v_mfma_f32_16x16x32_bf16 a[156:159], a[228:231], v[204:207], a[156:159]
 ds_read_b128 a[192:195], v12 offset:24832
 s_waitcnt lgkmcnt(5)
 v_mfma_f32_16x16x32_bf16 a[160:163], a[232:235], v[192:195], a[160:163]
 v_exp_f32 v154, v174
 v_mfma_f32_16x16x32_bf16 a[164:167], a[232:235], v[196:199], a[164:167]
 v_add_f32 v149, v149, v152
 ds_read_b128 a[196:199], v13 offset:24832
 v_mfma_f32_16x16x32_bf16 a[168:171], a[232:235], v[200:203], a[168:171]
 v_add_f32 v149, v149, v153
 v_cvt_pk_bf16_f32 v214, v152, v153
 v_mfma_f32_16x16x32_bf16 a[172:175], a[232:235], v[204:207], a[172:175]
 v_exp_f32 v155, v175
 v_mfma_f32_16x16x32_bf16 a[176:179], a[236:239], v[192:195], a[176:179]
 v_add_f32 v149, v149, v154
 v_add_f32 v149, v149, v155
 v_mfma_f32_16x16x32_bf16 a[180:183], a[236:239], v[196:199], a[180:183]
 v_exp_f32 v156, v176
 v_mfma_f32_16x16x32_bf16 a[184:187], a[236:239], v[200:203], a[184:187]
 v_cvt_pk_bf16_f32 v215, v154, v155
 v_add_f32 v146, v146, v150
 v_mfma_f32_16x16x32_bf16 a[188:191], a[236:239], v[204:207], a[188:191]
 v_add_f32 v147, v147, v151
 s_waitcnt lgkmcnt(3)
 v_mfma_f32_16x16x32_bf16 v[224:227], a[240:243], v[32:35], v[128:131]
 v_exp_f32 v157, v177
 v_mfma_f32_16x16x32_bf16 v[224:227], a[244:247], v[48:51], v[224:227]
 ds_read_b128 a[200:203], v12 offset:30720
 v_add_f32 v150, v156, v157
 v_mfma_f32_16x16x32_bf16 v[224:227], a[248:251], v[64:67], v[224:227]
 ds_read_b128 a[204:207], v13 offset:30720
 s_waitcnt lgkmcnt(2)
 v_mfma_f32_16x16x32_bf16 v[224:227], a[252:255], v[80:83], v[224:227]
 buffer_load_dwordx4 v3, s[28:31], s76 offen offset:2048 nt lds
 v_mfma_f32_16x16x32_bf16 v[224:227], a[192:195], v[96:99], v[224:227]
 v_exp_f32 v152, v178
 v_mfma_f32_16x16x32_bf16 v[224:227], a[196:199], v[112:115], v[224:227]
 v_cvt_pk_bf16_f32 v216, v156, v157
 ds_read_b128 a[208:211], v12 offset:30848
 v_mfma_f32_16x16x32_bf16 v[232:235], a[240:243], v[36:39], v[132:135]
 v_exp_f32 v153, v179
 v_mfma_f32_16x16x32_bf16 v[232:235], a[244:247], v[52:55], v[232:235]
 v_add_f32 v150, v150, v152
 v_add_f32 v150, v150, v153
 v_mfma_f32_16x16x32_bf16 v[232:235], a[248:251], v[68:71], v[232:235]
 v_exp_f32 v154, v180
 v_mfma_f32_16x16x32_bf16 v[232:235], a[252:255], v[84:87], v[232:235]
 ds_read_b128 a[212:215], v13 offset:30848
 v_cvt_pk_bf16_f32 v217, v152, v153
 v_mfma_f32_16x16x32_bf16 v[232:235], a[192:195], v[100:103], v[232:235]
 v_add_f32 v150, v150, v154
 v_subrev_u32 v14, 49152, v14
 v_mfma_f32_16x16x32_bf16 v[232:235], a[196:199], v[116:119], v[232:235]
 v_exp_f32 v155, v181
 v_mfma_f32_16x16x32_bf16 v[240:243], a[240:243], v[40:43], v[136:139]
 ds_read_b128 a[216:219], v12 offset:30976
 v_add_f32 v150, v150, v155
 v_mfma_f32_16x16x32_bf16 v[240:243], a[244:247], v[56:59], v[240:243]
 s_add_u32 m0, s80, 98304
 s_mov_b32 s76, 282624
 v_mfma_f32_16x16x32_bf16 v[240:243], a[248:251], v[72:75], v[240:243]
 v_exp_f32 v156, v182
 v_mfma_f32_16x16x32_bf16 v[240:243], a[252:255], v[88:91], v[240:243]
 ds_read_b128 a[220:223], v13 offset:30976
 v_cvt_pk_bf16_f32 v218, v154, v155
 v_mfma_f32_16x16x32_bf16 v[240:243], a[192:195], v[104:107], v[240:243]
 v_add_f32 v150, v150, v156
 v_subrev_u32 v15, 49152, v15
 v_mfma_f32_16x16x32_bf16 v[240:243], a[196:199], v[120:123], v[240:243]
 v_exp_f32 v157, v183
 v_mfma_f32_16x16x32_bf16 v[248:251], a[240:243], v[44:47], v[140:143]
 buffer_load_dwordx4 v4, s[32:35], s76 offen offset:0 nt lds
 v_mfma_f32_16x16x32_bf16 v[248:251], a[244:247], v[60:63], v[248:251]
 v_add_f32 v150, v150, v157
 v_cvt_pk_bf16_f32 v219, v156, v157
 v_mfma_f32_16x16x32_bf16 v[248:251], a[248:251], v[76:79], v[248:251]
 v_exp_f32 v152, v184
 v_mfma_f32_16x16x32_bf16 v[248:251], a[252:255], v[92:95], v[248:251]
 v_subrev_u32 v16, 49152, v16
 v_subrev_u32 v17, 49152, v17
 v_mfma_f32_16x16x32_bf16 v[248:251], a[192:195], v[108:111], v[248:251]
 v_add_u32 v12, 36864, v12
 v_add_u32 v13, 36864, v13
 v_mfma_f32_16x16x32_bf16 v[248:251], a[196:199], v[124:127], v[248:251]
 v_max3_f32 v158, v148, v149, v150
 s_waitcnt lgkmcnt(3)
 v_mfma_f32_16x16x32_bf16 v[228:231], a[200:203], v[32:35], v[128:131]
 v_exp_f32 v153, v185
 v_mfma_f32_16x16x32_bf16 v[228:231], a[204:207], v[48:51], v[228:231]
 v_exp_f32 v154, v186
 v_mfma_f32_16x16x32_bf16 v[228:231], a[208:211], v[64:67], v[228:231]
 v_add_f32 v151, v152, v153
 s_waitcnt lgkmcnt(0)
 v_mfma_f32_16x16x32_bf16 v[228:231], a[212:215], v[80:83], v[228:231]
 v_cvt_pk_bf16_f32 v220, v152, v153
 v_add_f32 v151, v151, v154
 v_mfma_f32_16x16x32_bf16 v[228:231], a[216:219], v[96:99], v[228:231]
 s_waitcnt vmcnt(7)
 s_barrier
 v_mfma_f32_16x16x32_bf16 v[228:231], a[220:223], v[112:115], v[228:231]
 v_exp_f32 v155, v187
 v_mfma_f32_16x16x32_bf16 v[236:239], a[200:203], v[36:39], v[132:135]
 ds_read_b64_tr_b16 a[224:225], v14 offset:0
 v_add_f32 v151, v151, v155
 v_mfma_f32_16x16x32_bf16 v[236:239], a[204:207], v[52:55], v[236:239]
 v_exp_f32 v156, v188
 v_mfma_f32_16x16x32_bf16 v[236:239], a[208:211], v[68:71], v[236:239]
 ds_read_b64_tr_b16 a[226:227], v14 offset:6144
 v_cvt_pk_bf16_f32 v221, v154, v155
 v_mfma_f32_16x16x32_bf16 v[236:239], a[212:215], v[84:87], v[236:239]
 ds_read_b64_tr_b16 a[228:229], v15 offset:0
 v_add_f32 v151, v151, v156
 v_mfma_f32_16x16x32_bf16 v[236:239], a[216:219], v[100:103], v[236:239]
 v_exp_f32 v157, v189
 v_mfma_f32_16x16x32_bf16 v[236:239], a[220:223], v[116:119], v[236:239]
 buffer_load_dwordx4 v5, s[32:35], s76 offen offset:1024 nt lds
 v_mfma_f32_16x16x32_bf16 v[244:247], a[200:203], v[40:43], v[136:139]
 ds_read_b64_tr_b16 a[230:231], v15 offset:6144
 v_add_f32 v151, v151, v157
 v_mfma_f32_16x16x32_bf16 v[244:247], a[204:207], v[56:59], v[244:247]
 v_exp_f32 v152, v190
 v_mfma_f32_16x16x32_bf16 v[244:247], a[208:211], v[72:75], v[244:247]
 ds_read_b64_tr_b16 a[232:233], v16 offset:0
 v_cvt_pk_bf16_f32 v222, v156, v157
 v_mfma_f32_16x16x32_bf16 v[244:247], a[212:215], v[88:91], v[244:247]
 v_add_f32 v151, v151, v152
 v_mfma_f32_16x16x32_bf16 v[244:247], a[216:219], v[104:107], v[244:247]
 v_exp_f32 v153, v191
 v_mfma_f32_16x16x32_bf16 v[244:247], a[220:223], v[120:123], v[244:247]
 ds_read_b64_tr_b16 a[234:235], v16 offset:6144
 v_add_f32 v151, v151, v153
 v_mfma_f32_16x16x32_bf16 v[252:255], a[200:203], v[44:47], v[140:143]
 ds_read_b64_tr_b16 a[236:237], v17 offset:0
 v_cvt_pk_bf16_f32 v223, v152, v153
 v_mfma_f32_16x16x32_bf16 v[252:255], a[204:207], v[60:63], v[252:255]
 v_mfma_f32_16x16x32_bf16 v[252:255], a[208:211], v[76:79], v[252:255]
 ds_read_b64_tr_b16 a[238:239], v17 offset:6144
 v_max_f32 v158, v158, v151
 v_mfma_f32_16x16x32_bf16 v[252:255], a[212:215], v[92:95], v[252:255]
 v_cmp_lt_f32 vcc, s72, v158
 v_mfma_f32_16x16x32_bf16 v[252:255], a[216:219], v[108:111], v[252:255]
 v_mfma_f32_16x16x32_bf16 v[252:255], a[220:223], v[124:127], v[252:255]
 s_cbranch_vccnz L_S_20
L_R_20:
 s_waitcnt lgkmcnt(4)
 v_mfma_f32_16x16x32_bf16 a[0:3], a[224:227], v[208:211], a[0:3]
 v_exp_f32 v152, v224
 v_mfma_f32_16x16x32_bf16 a[4:7], a[224:227], v[212:215], a[4:7]
 ds_read_b64_tr_b16 a[240:241], v14 offset:128
 v_add_f32 v144, v144, v148
 v_mfma_f32_16x16x32_bf16 a[8:11], a[224:227], v[216:219], a[8:11]
 v_exp_f32 v153, v225
 v_mfma_f32_16x16x32_bf16 a[12:15], a[224:227], v[220:223], a[12:15]
 ds_read_b64_tr_b16 a[242:243], v14 offset:6272
 v_add_f32 v148, v152, v153
 v_mfma_f32_16x16x32_bf16 a[16:19], a[228:231], v[208:211], a[16:19]
 buffer_load_dwordx4 v6, s[32:35], s76 offen offset:2048 nt lds
 v_mfma_f32_16x16x32_bf16 a[20:23], a[228:231], v[212:215], a[20:23]
 v_exp_f32 v154, v226
 v_mfma_f32_16x16x32_bf16 a[24:27], a[228:231], v[216:219], a[24:27]
 ds_read_b64_tr_b16 a[244:245], v15 offset:128
 ds_read_b64_tr_b16 a[246:247], v15 offset:6272
 v_mfma_f32_16x16x32_bf16 a[28:31], a[228:231], v[220:223], a[28:31]
 v_cvt_pk_bf16_f32 v192, v152, v153
 s_waitcnt lgkmcnt(4)
 v_mfma_f32_16x16x32_bf16 a[32:35], a[232:235], v[208:211], a[32:35]
 v_exp_f32 v155, v227
 v_mfma_f32_16x16x32_bf16 a[36:39], a[232:235], v[212:215], a[36:39]
 ds_read_b64_tr_b16 a[248:249], v16 offset:128
 ds_read_b64_tr_b16 a[250:251], v16 offset:6272
 v_mfma_f32_16x16x32_bf16 a[40:43], a[232:235], v[216:219], a[40:43]
 v_add_f32 v148, v148, v154
 v_add_f32 v148, v148, v155
 v_mfma_f32_16x16x32_bf16 a[44:47], a[232:235], v[220:223], a[44:47]
 v_exp_f32 v156, v228
 v_mfma_f32_16x16x32_bf16 a[48:51], a[236:239], v[208:211], a[48:51]
 ds_read_b64_tr_b16 a[252:253], v17 offset:128
 v_cvt_pk_bf16_f32 v193, v154, v155
 v_mfma_f32_16x16x32_bf16 a[52:55], a[236:239], v[212:215], a[52:55]
 ds_read_b64_tr_b16 a[254:255], v17 offset:6272
 v_add_f32 v148, v148, v156
 v_mfma_f32_16x16x32_bf16 a[56:59], a[236:239], v[216:219], a[56:59]
 v_exp_f32 v157, v229
 v_mfma_f32_16x16x32_bf16 a[60:63], a[236:239], v[220:223], a[60:63]
 v_add_f32 v148, v148, v157
 s_waitcnt lgkmcnt(4)
 v_mfma_f32_16x16x32_bf16 a[64:67], a[240:243], v[208:211], a[64:67]
 s_add_u32 m0, s80, 61440
 s_mov_b32 s76, 307200
 v_mfma_f32_16x16x32_bf16 a[68:71], a[240:243], v[212:215], a[68:71]
 v_exp_f32 v152, v230
 v_mfma_f32_16x16x32_bf16 a[72:75], a[240:243], v[216:219], a[72:75]
 ds_read_b64_tr_b16 a[192:193], v14 offset:256
 ds_read_b64_tr_b16 a[194:195], v14 offset:6400
 v_mfma_f32_16x16x32_bf16 a[76:79], a[240:243], v[220:223], a[76:79]
 buffer_load_dwordx4 v1, s[28:31], s76 offen offset:0 nt lds
 v_mfma_f32_16x16x32_bf16 a[80:83], a[244:247], v[208:211], a[80:83]
 v_exp_f32 v153, v231
 v_mfma_f32_16x16x32_bf16 a[84:87], a[244:247], v[212:215], a[84:87]
 v_cvt_pk_bf16_f32 v194, v156, v157
 ds_read_b64_tr_b16 a[196:197], v15 offset:256
 v_mfma_f32_16x16x32_bf16 a[88:91], a[244:247], v[216:219], a[88:91]
 v_exp_f32 v154, v232
 v_mfma_f32_16x16x32_bf16 a[92:95], a[244:247], v[220:223], a[92:95]
 ds_read_b64_tr_b16 a[198:199], v15 offset:6400
 s_waitcnt lgkmcnt(4)
 v_mfma_f32_16x16x32_bf16 a[96:99], a[248:251], v[208:211], a[96:99]
 v_add_f32 v148, v148, v152
 v_add_f32 v148, v148, v153
 v_mfma_f32_16x16x32_bf16 a[100:103], a[248:251], v[212:215], a[100:103]
 v_cvt_pk_bf16_f32 v195, v152, v153
 v_add_f32 v145, v145, v149
 v_mfma_f32_16x16x32_bf16 a[104:107], a[248:251], v[216:219], a[104:107]
 v_exp_f32 v155, v233
 v_mfma_f32_16x16x32_bf16 a[108:111], a[248:251], v[220:223], a[108:111]
 ds_read_b64_tr_b16 a[200:201], v16 offset:256
 ds_read_b64_tr_b16 a[202:203], v16 offset:6400
 v_mfma_f32_16x16x32_bf16 a[112:115], a[252:255], v[208:211], a[112:115]
 v_exp_f32 v156, v234
 v_mfma_f32_16x16x32_bf16 a[116:119], a[252:255], v[212:215], a[116:119]
 ds_read_b64_tr_b16 a[204:205], v17 offset:256
 ds_read_b64_tr_b16 a[206:207], v17 offset:6400
 v_mfma_f32_16x16x32_bf16 a[120:123], a[252:255], v[216:219], a[120:123]
 v_add_f32 v149, v154, v155
 v_cvt_pk_bf16_f32 v196, v154, v155
 v_mfma_f32_16x16x32_bf16 a[124:127], a[252:255], v[220:223], a[124:127]
 ds_read_b128 a[208:211], v12 offset:0
 s_waitcnt lgkmcnt(5)
 v_mfma_f32_16x16x32_bf16 a[128:131], a[192:195], v[208:211], a[128:131]
 v_exp_f32 v157, v235
 v_mfma_f32_16x16x32_bf16 a[132:135], a[192:195], v[212:215], a[132:135]
 ds_read_b128 a[212:215], v13 offset:0
 v_add_f32 v149, v149, v156
 v_mfma_f32_16x16x32_bf16 a[136:139], a[192:195], v[216:219], a[136:139]
 v_exp_f32 v152, v236
 v_mfma_f32_16x16x32_bf16 a[140:143], a[192:195], v[220:223], a[140:143]
 buffer_load_dwordx4 v2, s[28:31], s76 offen offset:1024 nt lds
 v_mfma_f32_16x16x32_bf16 a[144:147], a[196:199], v[208:211], a[144:147]
 ds_read_b128 a[216:219], v12 offset:128
 v_add_f32 v149, v149, v157
 v_mfma_f32_16x16x32_bf16 a[148:151], a[196:199], v[212:215], a[148:151]
 v_exp_f32 v153, v237
 v_mfma_f32_16x16x32_bf16 a[152:155], a[196:199], v[216:219], a[152:155]
 v_cvt_pk_bf16_f32 v197, v156, v157
 ds_read_b128 a[220:223], v13 offset:128
 v_mfma_f32_16x16x32_bf16 a[156:159], a[196:199], v[220:223], a[156:159]
 ds_read_b128 a[224:227], v12 offset:256
 s_waitcnt lgkmcnt(5)
 v_mfma_f32_16x16x32_bf16 a[160:163], a[200:203], v[208:211], a[160:163]
 v_exp_f32 v154, v238
 v_mfma_f32_16x16x32_bf16 a[164:167], a[200:203], v[212:215], a[164:167]
 v_add_f32 v149, v149, v152
 ds_read_b128 a[228:231], v13 offset:256
 v_mfma_f32_16x16x32_bf16 a[168:171], a[200:203], v[216:219], a[168:171]
 v_add_f32 v149, v149, v153
 v_cvt_pk_bf16_f32 v198, v152, v153
 v_mfma_f32_16x16x32_bf16 a[172:175], a[200:203], v[220:223], a[172:175]
 v_exp_f32 v155, v239
 v_mfma_f32_16x16x32_bf16 a[176:179], a[204:207], v[208:211], a[176:179]
 v_add_f32 v149, v149, v154
 v_add_f32 v149, v149, v155
 v_mfma_f32_16x16x32_bf16 a[180:183], a[204:207], v[212:215], a[180:183]
 v_exp_f32 v156, v240
 v_mfma_f32_16x16x32_bf16 a[184:187], a[204:207], v[216:219], a[184:187]
 v_cvt_pk_bf16_f32 v199, v154, v155
 v_add_f32 v146, v146, v150
 v_mfma_f32_16x16x32_bf16 a[188:191], a[204:207], v[220:223], a[188:191]
 v_add_f32 v147, v147, v151
 s_waitcnt lgkmcnt(3)
 v_mfma_f32_16x16x32_bf16 v[160:163], a[208:211], v[32:35], v[128:131]
 v_exp_f32 v157, v241
 v_mfma_f32_16x16x32_bf16 v[160:163], a[212:215], v[48:51], v[160:163]
 ds_read_b128 a[232:235], v12 offset:6144
 v_add_f32 v150, v156, v157
 v_mfma_f32_16x16x32_bf16 v[160:163], a[216:219], v[64:67], v[160:163]
 ds_read_b128 a[236:239], v13 offset:6144
 s_waitcnt lgkmcnt(2)
 v_mfma_f32_16x16x32_bf16 v[160:163], a[220:223], v[80:83], v[160:163]
 buffer_load_dwordx4 v3, s[28:31], s76 offen offset:2048 nt lds
 v_mfma_f32_16x16x32_bf16 v[160:163], a[224:227], v[96:99], v[160:163]
 v_exp_f32 v152, v242
 v_mfma_f32_16x16x32_bf16 v[160:163], a[228:231], v[112:115], v[160:163]
 v_cvt_pk_bf16_f32 v200, v156, v157
 ds_read_b128 a[240:243], v12 offset:6272
 v_mfma_f32_16x16x32_bf16 v[168:171], a[208:211], v[36:39], v[132:135]
 v_exp_f32 v153, v243
 v_mfma_f32_16x16x32_bf16 v[168:171], a[212:215], v[52:55], v[168:171]
 v_add_f32 v150, v150, v152
 v_add_f32 v150, v150, v153
 v_mfma_f32_16x16x32_bf16 v[168:171], a[216:219], v[68:71], v[168:171]
 v_exp_f32 v154, v244
 v_mfma_f32_16x16x32_bf16 v[168:171], a[220:223], v[84:87], v[168:171]
 ds_read_b128 a[244:247], v13 offset:6272
 v_cvt_pk_bf16_f32 v201, v152, v153
 v_mfma_f32_16x16x32_bf16 v[168:171], a[224:227], v[100:103], v[168:171]
 v_add_f32 v150, v150, v154
 v_mfma_f32_16x16x32_bf16 v[168:171], a[228:231], v[116:119], v[168:171]
 v_exp_f32 v155, v245
 v_mfma_f32_16x16x32_bf16 v[176:179], a[208:211], v[40:43], v[136:139]
 ds_read_b128 a[248:251], v12 offset:6400
 v_add_f32 v150, v150, v155
 v_mfma_f32_16x16x32_bf16 v[176:179], a[212:215], v[56:59], v[176:179]
 s_add_u32 m0, s80, 110592
 s_mov_b32 s76, 294912
 v_mfma_f32_16x16x32_bf16 v[176:179], a[216:219], v[72:75], v[176:179]
 v_exp_f32 v156, v246
 v_mfma_f32_16x16x32_bf16 v[176:179], a[220:223], v[88:91], v[176:179]
 ds_read_b128 a[252:255], v13 offset:6400
 v_cvt_pk_bf16_f32 v202, v154, v155
 v_mfma_f32_16x16x32_bf16 v[176:179], a[224:227], v[104:107], v[176:179]
 v_add_f32 v150, v150, v156
 v_mfma_f32_16x16x32_bf16 v[176:179], a[228:231], v[120:123], v[176:179]
 v_exp_f32 v157, v247
 v_mfma_f32_16x16x32_bf16 v[184:187], a[208:211], v[44:47], v[140:143]
 buffer_load_dwordx4 v4, s[32:35], s76 offen offset:0 nt lds
 v_mfma_f32_16x16x32_bf16 v[184:187], a[212:215], v[60:63], v[184:187]
 v_add_f32 v150, v150, v157
 v_cvt_pk_bf16_f32 v203, v156, v157
 v_mfma_f32_16x16x32_bf16 v[184:187], a[216:219], v[76:79], v[184:187]
 v_exp_f32 v152, v248
 v_mfma_f32_16x16x32_bf16 v[184:187], a[220:223], v[92:95], v[184:187]
 v_max3_f32 v158, v148, v149, v150
 v_mfma_f32_16x16x32_bf16 v[184:187], a[224:227], v[108:111], v[184:187]
 v_mfma_f32_16x16x32_bf16 v[184:187], a[228:231], v[124:127], v[184:187]
 s_waitcnt lgkmcnt(3)
 v_mfma_f32_16x16x32_bf16 v[164:167], a[232:235], v[32:35], v[128:131]
 v_exp_f32 v153, v249
 v_mfma_f32_16x16x32_bf16 v[164:167], a[236:239], v[48:51], v[164:167]
 v_exp_f32 v154, v250
 v_mfma_f32_16x16x32_bf16 v[164:167], a[240:243], v[64:67], v[164:167]
 v_add_f32 v151, v152, v153
 s_waitcnt lgkmcnt(0)
 v_mfma_f32_16x16x32_bf16 v[164:167], a[244:247], v[80:83], v[164:167]
 v_cvt_pk_bf16_f32 v204, v152, v153
 v_add_f32 v151, v151, v154
 v_mfma_f32_16x16x32_bf16 v[164:167], a[248:251], v[96:99], v[164:167]
 s_waitcnt vmcnt(7)
 s_barrier
 v_mfma_f32_16x16x32_bf16 v[164:167], a[252:255], v[112:115], v[164:167]
 v_exp_f32 v155, v251
 v_mfma_f32_16x16x32_bf16 v[172:175], a[232:235], v[36:39], v[132:135]
 ds_read_b64_tr_b16 a[192:193], v14 offset:12288
 v_add_f32 v151, v151, v155
 v_mfma_f32_16x16x32_bf16 v[172:175], a[236:239], v[52:55], v[172:175]
 v_exp_f32 v156, v252
 v_mfma_f32_16x16x32_bf16 v[172:175], a[240:243], v[68:71], v[172:175]
 ds_read_b64_tr_b16 a[194:195], v14 offset:18432
 v_cvt_pk_bf16_f32 v205, v154, v155
 v_mfma_f32_16x16x32_bf16 v[172:175], a[244:247], v[84:87], v[172:175]
 ds_read_b64_tr_b16 a[196:197], v15 offset:12288
 v_add_f32 v151, v151, v156
 v_mfma_f32_16x16x32_bf16 v[172:175], a[248:251], v[100:103], v[172:175]
 v_exp_f32 v157, v253
 v_mfma_f32_16x16x32_bf16 v[172:175], a[252:255], v[116:119], v[172:175]
 buffer_load_dwordx4 v5, s[32:35], s76 offen offset:1024 nt lds
 v_mfma_f32_16x16x32_bf16 v[180:183], a[232:235], v[40:43], v[136:139]
 ds_read_b64_tr_b16 a[198:199], v15 offset:18432
 v_add_f32 v151, v151, v157
 v_mfma_f32_16x16x32_bf16 v[180:183], a[236:239], v[56:59], v[180:183]
 v_exp_f32 v152, v254
 v_mfma_f32_16x16x32_bf16 v[180:183], a[240:243], v[72:75], v[180:183]
 ds_read_b64_tr_b16 a[200:201], v16 offset:12288
 v_cvt_pk_bf16_f32 v206, v156, v157
 v_mfma_f32_16x16x32_bf16 v[180:183], a[244:247], v[88:91], v[180:183]
 v_add_f32 v151, v151, v152
 v_mfma_f32_16x16x32_bf16 v[180:183], a[248:251], v[104:107], v[180:183]
 v_exp_f32 v153, v255
 v_mfma_f32_16x16x32_bf16 v[180:183], a[252:255], v[120:123], v[180:183]
 ds_read_b64_tr_b16 a[202:203], v16 offset:18432
 v_add_f32 v151, v151, v153
 v_mfma_f32_16x16x32_bf16 v[188:191], a[232:235], v[44:47], v[140:143]
 ds_read_b64_tr_b16 a[204:205], v17 offset:12288
 v_cvt_pk_bf16_f32 v207, v152, v153
 v_mfma_f32_16x16x32_bf16 v[188:191], a[236:239], v[60:63], v[188:191]
 v_mfma_f32_16x16x32_bf16 v[188:191], a[240:243], v[76:79], v[188:191]
 ds_read_b64_tr_b16 a[206:207], v17 offset:18432
 v_max_f32 v158, v158, v151
 v_mfma_f32_16x16x32_bf16 v[188:191], a[244:247], v[92:95], v[188:191]
 v_cmp_lt_f32 vcc, s72, v158
 v_mfma_f32_16x16x32_bf16 v[188:191], a[248:251], v[108:111], v[188:191]
 v_mfma_f32_16x16x32_bf16 v[188:191], a[252:255], v[124:127], v[188:191]
 s_cbranch_vccnz L_S_21
L_R_21:
 s_waitcnt lgkmcnt(4)
 v_mfma_f32_16x16x32_bf16 a[0:3], a[192:195], v[192:195], a[0:3]
 v_exp_f32 v152, v160
 v_mfma_f32_16x16x32_bf16 a[4:7], a[192:195], v[196:199], a[4:7]
 ds_read_b64_tr_b16 a[208:209], v14 offset:12416
 v_add_f32 v144, v144, v148
 v_mfma_f32_16x16x32_bf16 a[8:11], a[192:195], v[200:203], a[8:11]
 v_exp_f32 v153, v161
 v_mfma_f32_16x16x32_bf16 a[12:15], a[192:195], v[204:207], a[12:15]
 ds_read_b64_tr_b16 a[210:211], v14 offset:18560
 v_add_f32 v148, v152, v153
 v_mfma_f32_16x16x32_bf16 a[16:19], a[196:199], v[192:195], a[16:19]
 buffer_load_dwordx4 v6, s[32:35], s76 offen offset:2048 nt lds
 v_mfma_f32_16x16x32_bf16 a[20:23], a[196:199], v[196:199], a[20:23]
 v_exp_f32 v154, v162
 v_mfma_f32_16x16x32_bf16 a[24:27], a[196:199], v[200:203], a[24:27]
 ds_read_b64_tr_b16 a[212:213], v15 offset:12416
 ds_read_b64_tr_b16 a[214:215], v15 offset:18560
 v_mfma_f32_16x16x32_bf16 a[28:31], a[196:199], v[204:207], a[28:31]
 v_cvt_pk_bf16_f32 v208, v152, v153
 s_waitcnt lgkmcnt(4)
 v_mfma_f32_16x16x32_bf16 a[32:35], a[200:203], v[192:195], a[32:35]
 v_exp_f32 v155, v163
 v_mfma_f32_16x16x32_bf16 a[36:39], a[200:203], v[196:199], a[36:39]
 ds_read_b64_tr_b16 a[216:217], v16 offset:12416
 ds_read_b64_tr_b16 a[218:219], v16 offset:18560
 v_mfma_f32_16x16x32_bf16 a[40:43], a[200:203], v[200:203], a[40:43]
 v_add_f32 v148, v148, v154
 v_add_f32 v148, v148, v155
 v_mfma_f32_16x16x32_bf16 a[44:47], a[200:203], v[204:207], a[44:47]
 v_exp_f32 v156, v164
 v_mfma_f32_16x16x32_bf16 a[48:51], a[204:207], v[192:195], a[48:51]
 ds_read_b64_tr_b16 a[220:221], v17 offset:12416
 v_cvt_pk_bf16_f32 v209, v154, v155
 v_mfma_f32_16x16x32_bf16 a[52:55], a[204:207], v[196:199], a[52:55]
 ds_read_b64_tr_b16 a[222:223], v17 offset:18560
 v_add_f32 v148, v148, v156
 v_mfma_f32_16x16x32_bf16 a[56:59], a[204:207], v[200:203], a[56:59]
 v_exp_f32 v157, v165
 v_mfma_f32_16x16x32_bf16 a[60:63], a[204:207], v[204:207], a[60:63]
 v_add_f32 v148, v148, v157
 s_waitcnt lgkmcnt(4)
 v_mfma_f32_16x16x32_bf16 a[64:67], a[208:211], v[192:195], a[64:67]
 s_add_u32 m0, s80, 0
 s_mov_b32 s76, 319488
 v_mfma_f32_16x16x32_bf16 a[68:71], a[208:211], v[196:199], a[68:71]
 v_exp_f32 v152, v166
 v_mfma_f32_16x16x32_bf16 a[72:75], a[208:211], v[200:203], a[72:75]
 ds_read_b64_tr_b16 a[224:225], v14 offset:12544
 ds_read_b64_tr_b16 a[226:227], v14 offset:18688
 v_mfma_f32_16x16x32_bf16 a[76:79], a[208:211], v[204:207], a[76:79]
 buffer_load_dwordx4 v1, s[28:31], s76 offen offset:0 nt lds
 v_mfma_f32_16x16x32_bf16 a[80:83], a[212:215], v[192:195], a[80:83]
 v_exp_f32 v153, v167
 v_mfma_f32_16x16x32_bf16 a[84:87], a[212:215], v[196:199], a[84:87]
 v_cvt_pk_bf16_f32 v210, v156, v157
 ds_read_b64_tr_b16 a[228:229], v15 offset:12544
 v_mfma_f32_16x16x32_bf16 a[88:91], a[212:215], v[200:203], a[88:91]
 v_exp_f32 v154, v168
 v_mfma_f32_16x16x32_bf16 a[92:95], a[212:215], v[204:207], a[92:95]
 ds_read_b64_tr_b16 a[230:231], v15 offset:18688
 s_waitcnt lgkmcnt(4)
 v_mfma_f32_16x16x32_bf16 a[96:99], a[216:219], v[192:195], a[96:99]
 v_add_f32 v148, v148, v152
 v_add_f32 v148, v148, v153
 v_mfma_f32_16x16x32_bf16 a[100:103], a[216:219], v[196:199], a[100:103]
 v_cvt_pk_bf16_f32 v211, v152, v153
 v_add_f32 v145, v145, v149
 v_mfma_f32_16x16x32_bf16 a[104:107], a[216:219], v[200:203], a[104:107]
 v_exp_f32 v155, v169
 v_mfma_f32_16x16x32_bf16 a[108:111], a[216:219], v[204:207], a[108:111]
 ds_read_b64_tr_b16 a[232:233], v16 offset:12544
 ds_read_b64_tr_b16 a[234:235], v16 offset:18688
 v_mfma_f32_16x16x32_bf16 a[112:115], a[220:223], v[192:195], a[112:115]
 v_exp_f32 v156, v170
 v_mfma_f32_16x16x32_bf16 a[116:119], a[220:223], v[196:199], a[116:119]
 ds_read_b64_tr_b16 a[236:237], v17 offset:12544
 ds_read_b64_tr_b16 a[238:239], v17 offset:18688
 v_mfma_f32_16x16x32_bf16 a[120:123], a[220:223], v[200:203], a[120:123]
 v_add_f32 v149, v154, v155
 v_cvt_pk_bf16_f32 v212, v154, v155
 v_mfma_f32_16x16x32_bf16 a[124:127], a[220:223], v[204:207], a[124:127]
 ds_read_b128 a[240:243], v12 offset:12288
 s_waitcnt lgkmcnt(5)
 v_mfma_f32_16x16x32_bf16 a[128:131], a[224:227], v[192:195], a[128:131]
 v_exp_f32 v157, v171
 v_mfma_f32_16x16x32_bf16 a[132:135], a[224:227], v[196:199], a[132:135]
 ds_read_b128 a[244:247], v13 offset:12288
 v_add_f32 v149, v149, v156
 v_mfma_f32_16x16x32_bf16 a[136:139], a[224:227], v[200:203], a[136:139]
 v_exp_f32 v152, v172
 v_mfma_f32_16x16x32_bf16 a[140:143], a[224:227], v[204:207], a[140:143]
 buffer_load_dwordx4 v2, s[28:31], s76 offen offset:1024 nt lds
 v_mfma_f32_16x16x32_bf16 a[144:147], a[228:231], v[192:195], a[144:147]
 ds_read_b128 a[248:251], v12 offset:12416
 v_add_f32 v149, v149, v157
 v_mfma_f32_16x16x32_bf16 a[148:151], a[228:231], v[196:199], a[148:151]
 v_exp_f32 v153, v173
 v_mfma_f32_16x16x32_bf16 a[152:155], a[228:231], v[200:203], a[152:155]
 v_cvt_pk_bf16_f32 v213, v156, v157
 ds_read_b128 a[252:255], v13 offset:12416
 v_mfma_f32_16x16x32_bf16 a[156:159], a[228:231], v[204:207], a[156:159]
 ds_read_b128 a[192:195], v12 offset:12544
 s_waitcnt lgkmcnt(5)
 v_mfma_f32_16x16x32_bf16 a[160:163], a[232:235], v[192:195], a[160:163]
 v_exp_f32 v154, v174
 v_mfma_f32_16x16x32_bf16 a[164:167], a[232:235], v[196:199], a[164:167]
 v_add_f32 v149, v149, v152
 ds_read_b128 a[196:199], v13 offset:12544
 v_mfma_f32_16x16x32_bf16 a[168:171], a[232:235], v[200:203], a[168:171]
 v_add_f32 v149, v149, v153
 v_cvt_pk_bf16_f32 v214, v152, v153
 v_mfma_f32_16x16x32_bf16 a[172:175], a[232:235], v[204:207], a[172:175]
 v_exp_f32 v155, v175
 v_mfma_f32_16x16x32_bf16 a[176:179], a[236:239], v[192:195], a[176:179]
 v_add_f32 v149, v149, v154
 v_add_f32 v149, v149, v155
 v_mfma_f32_16x16x32_bf16 a[180:183], a[236:239], v[196:199], a[180:183]
 v_exp_f32 v156, v176
 v_mfma_f32_16x16x32_bf16 a[184:187], a[236:239], v[200:203], a[184:187]
 v_cvt_pk_bf16_f32 v215, v154, v155
 v_add_f32 v146, v146, v150
 v_mfma_f32_16x16x32_bf16 a[188:191], a[236:239], v[204:207], a[188:191]
 v_add_f32 v147, v147, v151
 s_waitcnt lgkmcnt(3)
 v_mfma_f32_16x16x32_bf16 v[224:227], a[240:243], v[32:35], v[128:131]
 v_exp_f32 v157, v177
 v_mfma_f32_16x16x32_bf16 v[224:227], a[244:247], v[48:51], v[224:227]
 ds_read_b128 a[200:203], v12 offset:18432
 v_add_f32 v150, v156, v157
 v_mfma_f32_16x16x32_bf16 v[224:227], a[248:251], v[64:67], v[224:227]
 ds_read_b128 a[204:207], v13 offset:18432
 s_waitcnt lgkmcnt(2)
 v_mfma_f32_16x16x32_bf16 v[224:227], a[252:255], v[80:83], v[224:227]
 buffer_load_dwordx4 v3, s[28:31], s76 offen offset:2048 nt lds
 v_mfma_f32_16x16x32_bf16 v[224:227], a[192:195], v[96:99], v[224:227]
 v_exp_f32 v152, v178
 v_mfma_f32_16x16x32_bf16 v[224:227], a[196:199], v[112:115], v[224:227]
 v_cvt_pk_bf16_f32 v216, v156, v157
 ds_read_b128 a[208:211], v12 offset:18560
 v_mfma_f32_16x16x32_bf16 v[232:235], a[240:243], v[36:39], v[132:135]
 v_exp_f32 v153, v179
 v_mfma_f32_16x16x32_bf16 v[232:235], a[244:247], v[52:55], v[232:235]
 v_add_f32 v150, v150, v152
 v_add_f32 v150, v150, v153
 v_mfma_f32_16x16x32_bf16 v[232:235], a[248:251], v[68:71], v[232:235]
 v_exp_f32 v154, v180
 v_mfma_f32_16x16x32_bf16 v[232:235], a[252:255], v[84:87], v[232:235]
 ds_read_b128 a[212:215], v13 offset:18560
 v_cvt_pk_bf16_f32 v217, v152, v153
 v_mfma_f32_16x16x32_bf16 v[232:235], a[192:195], v[100:103], v[232:235]
 v_add_f32 v150, v150, v154
 v_mfma_f32_16x16x32_bf16 v[232:235], a[196:199], v[116:119], v[232:235]
 v_exp_f32 v155, v181
 v_mfma_f32_16x16x32_bf16 v[240:243], a[240:243], v[40:43], v[136:139]
 ds_read_b128 a[216:219], v12 offset:18688
 v_add_f32 v150, v150, v155
 v_mfma_f32_16x16x32_bf16 v[240:243], a[244:247], v[56:59], v[240:243]
 s_add_u32 m0, s80, 122880
 s_mov_b32 s76, 307200
 v_mfma_f32_16x16x32_bf16 v[240:243], a[248:251], v[72:75], v[240:243]
 v_exp_f32 v156, v182
 v_mfma_f32_16x16x32_bf16 v[240:243], a[252:255], v[88:91], v[240:243]
 ds_read_b128 a[220:223], v13 offset:18688
 v_cvt_pk_bf16_f32 v218, v154, v155
 v_mfma_f32_16x16x32_bf16 v[240:243], a[192:195], v[104:107], v[240:243]
 v_add_f32 v150, v150, v156
 v_mfma_f32_16x16x32_bf16 v[240:243], a[196:199], v[120:123], v[240:243]
 v_exp_f32 v157, v183
 v_mfma_f32_16x16x32_bf16 v[248:251], a[240:243], v[44:47], v[140:143]
 buffer_load_dwordx4 v4, s[32:35], s76 offen offset:0 nt lds
 v_mfma_f32_16x16x32_bf16 v[248:251], a[244:247], v[60:63], v[248:251]
 v_add_f32 v150, v150, v157
 v_cvt_pk_bf16_f32 v219, v156, v157
 v_mfma_f32_16x16x32_bf16 v[248:251], a[248:251], v[76:79], v[248:251]
 v_exp_f32 v152, v184
 v_mfma_f32_16x16x32_bf16 v[248:251], a[252:255], v[92:95], v[248:251]
 v_max3_f32 v158, v148, v149, v150
 v_mfma_f32_16x16x32_bf16 v[248:251], a[192:195], v[108:111], v[248:251]
 v_mfma_f32_16x16x32_bf16 v[248:251], a[196:199], v[124:127], v[248:251]
 s_waitcnt lgkmcnt(3)
 v_mfma_f32_16x16x32_bf16 v[228:231], a[200:203], v[32:35], v[128:131]
 v_exp_f32 v153, v185
 v_mfma_f32_16x16x32_bf16 v[228:231], a[204:207], v[48:51], v[228:231]
 v_exp_f32 v154, v186
 v_mfma_f32_16x16x32_bf16 v[228:231], a[208:211], v[64:67], v[228:231]
 v_add_f32 v151, v152, v153
 s_waitcnt lgkmcnt(0)
 v_mfma_f32_16x16x32_bf16 v[228:231], a[212:215], v[80:83], v[228:231]
 v_cvt_pk_bf16_f32 v220, v152, v153
 v_add_f32 v151, v151, v154
 v_mfma_f32_16x16x32_bf16 v[228:231], a[216:219], v[96:99], v[228:231]
 s_waitcnt vmcnt(7)
 s_barrier
 v_mfma_f32_16x16x32_bf16 v[228:231], a[220:223], v[112:115], v[228:231]
 v_exp_f32 v155, v187
 v_mfma_f32_16x16x32_bf16 v[236:239], a[200:203], v[36:39], v[132:135]
 ds_read_b64_tr_b16 a[224:225], v14 offset:24576
 v_add_f32 v151, v151, v155
 v_mfma_f32_16x16x32_bf16 v[236:239], a[204:207], v[52:55], v[236:239]
 v_exp_f32 v156, v188
 v_mfma_f32_16x16x32_bf16 v[236:239], a[208:211], v[68:71], v[236:239]
 ds_read_b64_tr_b16 a[226:227], v14 offset:30720
 v_cvt_pk_bf16_f32 v221, v154, v155
 v_mfma_f32_16x16x32_bf16 v[236:239], a[212:215], v[84:87], v[236:239]
 ds_read_b64_tr_b16 a[228:229], v15 offset:24576
 v_add_f32 v151, v151, v156
 v_mfma_f32_16x16x32_bf16 v[236:239], a[216:219], v[100:103], v[236:239]
 v_exp_f32 v157, v189
 v_mfma_f32_16x16x32_bf16 v[236:239], a[220:223], v[116:119], v[236:239]
 buffer_load_dwordx4 v5, s[32:35], s76 offen offset:1024 nt lds
 v_mfma_f32_16x16x32_bf16 v[244:247], a[200:203], v[40:43], v[136:139]
 ds_read_b64_tr_b16 a[230:231], v15 offset:30720
 v_add_f32 v151, v151, v157
 v_mfma_f32_16x16x32_bf16 v[244:247], a[204:207], v[56:59], v[244:247]
 v_exp_f32 v152, v190
 v_mfma_f32_16x16x32_bf16 v[244:247], a[208:211], v[72:75], v[244:247]
 ds_read_b64_tr_b16 a[232:233], v16 offset:24576
 v_cvt_pk_bf16_f32 v222, v156, v157
 v_mfma_f32_16x16x32_bf16 v[244:247], a[212:215], v[88:91], v[244:247]
 v_add_f32 v151, v151, v152
 v_mfma_f32_16x16x32_bf16 v[244:247], a[216:219], v[104:107], v[244:247]
 v_exp_f32 v153, v191
 v_mfma_f32_16x16x32_bf16 v[244:247], a[220:223], v[120:123], v[244:247]
 ds_read_b64_tr_b16 a[234:235], v16 offset:30720
 v_add_f32 v151, v151, v153
 v_mfma_f32_16x16x32_bf16 v[252:255], a[200:203], v[44:47], v[140:143]
 ds_read_b64_tr_b16 a[236:237], v17 offset:24576
 v_cvt_pk_bf16_f32 v223, v152, v153
 v_mfma_f32_16x16x32_bf16 v[252:255], a[204:207], v[60:63], v[252:255]
 v_mfma_f32_16x16x32_bf16 v[252:255], a[208:211], v[76:79], v[252:255]
 ds_read_b64_tr_b16 a[238:239], v17 offset:30720
 v_max_f32 v158, v158, v151
 v_mfma_f32_16x16x32_bf16 v[252:255], a[212:215], v[92:95], v[252:255]
 v_cmp_lt_f32 vcc, s72, v158
 v_mfma_f32_16x16x32_bf16 v[252:255], a[216:219], v[108:111], v[252:255]
 v_mfma_f32_16x16x32_bf16 v[252:255], a[220:223], v[124:127], v[252:255]
 s_cbranch_vccnz L_S_22
L_R_22:
 s_waitcnt lgkmcnt(4)
 v_mfma_f32_16x16x32_bf16 a[0:3], a[224:227], v[208:211], a[0:3]
 v_exp_f32 v152, v224
 v_mfma_f32_16x16x32_bf16 a[4:7], a[224:227], v[212:215], a[4:7]
 ds_read_b64_tr_b16 a[240:241], v14 offset:24704
 v_add_f32 v144, v144, v148
 v_mfma_f32_16x16x32_bf16 a[8:11], a[224:227], v[216:219], a[8:11]
 v_exp_f32 v153, v225
 v_mfma_f32_16x16x32_bf16 a[12:15], a[224:227], v[220:223], a[12:15]
 ds_read_b64_tr_b16 a[242:243], v14 offset:30848
 v_add_f32 v148, v152, v153
 v_mfma_f32_16x16x32_bf16 a[16:19], a[228:231], v[208:211], a[16:19]
 buffer_load_dwordx4 v6, s[32:35], s76 offen offset:2048 nt lds
 v_mfma_f32_16x16x32_bf16 a[20:23], a[228:231], v[212:215], a[20:23]
 v_exp_f32 v154, v226
 v_mfma_f32_16x16x32_bf16 a[24:27], a[228:231], v[216:219], a[24:27]
 ds_read_b64_tr_b16 a[244:245], v15 offset:24704
 ds_read_b64_tr_b16 a[246:247], v15 offset:30848
 v_mfma_f32_16x16x32_bf16 a[28:31], a[228:231], v[220:223], a[28:31]
 v_cvt_pk_bf16_f32 v192, v152, v153
 s_waitcnt lgkmcnt(4)
 v_mfma_f32_16x16x32_bf16 a[32:35], a[232:235], v[208:211], a[32:35]
 v_exp_f32 v155, v227
 v_mfma_f32_16x16x32_bf16 a[36:39], a[232:235], v[212:215], a[36:39]
 ds_read_b64_tr_b16 a[248:249], v16 offset:24704
 ds_read_b64_tr_b16 a[250:251], v16 offset:30848
 v_mfma_f32_16x16x32_bf16 a[40:43], a[232:235], v[216:219], a[40:43]
 v_add_f32 v148, v148, v154
 v_add_f32 v148, v148, v155
 v_mfma_f32_16x16x32_bf16 a[44:47], a[232:235], v[220:223], a[44:47]
 v_exp_f32 v156, v228
 v_mfma_f32_16x16x32_bf16 a[48:51], a[236:239], v[208:211], a[48:51]
 ds_read_b64_tr_b16 a[252:253], v17 offset:24704
 v_cvt_pk_bf16_f32 v193, v154, v155
 v_mfma_f32_16x16x32_bf16 a[52:55], a[236:239], v[212:215], a[52:55]
 ds_read_b64_tr_b16 a[254:255], v17 offset:30848
 v_add_f32 v148, v148, v156
 v_mfma_f32_16x16x32_bf16 a[56:59], a[236:239], v[216:219], a[56:59]
 v_exp_f32 v157, v229
 v_mfma_f32_16x16x32_bf16 a[60:63], a[236:239], v[220:223], a[60:63]
 v_add_f32 v148, v148, v157
 s_waitcnt lgkmcnt(4)
 v_mfma_f32_16x16x32_bf16 a[64:67], a[240:243], v[208:211], a[64:67]
 s_add_u32 m0, s80, 12288
 s_mov_b32 s76, 331776
 v_mfma_f32_16x16x32_bf16 a[68:71], a[240:243], v[212:215], a[68:71]
 v_exp_f32 v152, v230
 v_mfma_f32_16x16x32_bf16 a[72:75], a[240:243], v[216:219], a[72:75]
 ds_read_b64_tr_b16 a[192:193], v14 offset:24832
 ds_read_b64_tr_b16 a[194:195], v14 offset:30976
 v_mfma_f32_16x16x32_bf16 a[76:79], a[240:243], v[220:223], a[76:79]
 buffer_load_dwordx4 v1, s[28:31], s76 offen offset:0 nt lds
 v_mfma_f32_16x16x32_bf16 a[80:83], a[244:247], v[208:211], a[80:83]
 v_exp_f32 v153, v231
 v_mfma_f32_16x16x32_bf16 a[84:87], a[244:247], v[212:215], a[84:87]
 v_cvt_pk_bf16_f32 v194, v156, v157
 ds_read_b64_tr_b16 a[196:197], v15 offset:24832
 v_mfma_f32_16x16x32_bf16 a[88:91], a[244:247], v[216:219], a[88:91]
 v_exp_f32 v154, v232
 v_mfma_f32_16x16x32_bf16 a[92:95], a[244:247], v[220:223], a[92:95]
 ds_read_b64_tr_b16 a[198:199], v15 offset:30976
 s_waitcnt lgkmcnt(4)
 v_mfma_f32_16x16x32_bf16 a[96:99], a[248:251], v[208:211], a[96:99]
 v_add_f32 v148, v148, v152
 v_add_f32 v148, v148, v153
 v_mfma_f32_16x16x32_bf16 a[100:103], a[248:251], v[212:215], a[100:103]
 v_cvt_pk_bf16_f32 v195, v152, v153
 v_add_f32 v145, v145, v149
 v_mfma_f32_16x16x32_bf16 a[104:107], a[248:251], v[216:219], a[104:107]
 v_exp_f32 v155, v233
 v_mfma_f32_16x16x32_bf16 a[108:111], a[248:251], v[220:223], a[108:111]
 ds_read_b64_tr_b16 a[200:201], v16 offset:24832
 ds_read_b64_tr_b16 a[202:203], v16 offset:30976
 v_mfma_f32_16x16x32_bf16 a[112:115], a[252:255], v[208:211], a[112:115]
 v_exp_f32 v156, v234
 v_mfma_f32_16x16x32_bf16 a[116:119], a[252:255], v[212:215], a[116:119]
 ds_read_b64_tr_b16 a[204:205], v17 offset:24832
 ds_read_b64_tr_b16 a[206:207], v17 offset:30976
 v_mfma_f32_16x16x32_bf16 a[120:123], a[252:255], v[216:219], a[120:123]
 v_add_f32 v149, v154, v155
 v_cvt_pk_bf16_f32 v196, v154, v155
 v_mfma_f32_16x16x32_bf16 a[124:127], a[252:255], v[220:223], a[124:127]
 ds_read_b128 a[208:211], v12 offset:24576
 s_waitcnt lgkmcnt(5)
 v_mfma_f32_16x16x32_bf16 a[128:131], a[192:195], v[208:211], a[128:131]
 v_exp_f32 v157, v235
 v_mfma_f32_16x16x32_bf16 a[132:135], a[192:195], v[212:215], a[132:135]
 ds_read_b128 a[212:215], v13 offset:24576
 v_add_f32 v149, v149, v156
 v_mfma_f32_16x16x32_bf16 a[136:139], a[192:195], v[216:219], a[136:139]
 v_exp_f32 v152, v236
 v_mfma_f32_16x16x32_bf16 a[140:143], a[192:195], v[220:223], a[140:143]
 buffer_load_dwordx4 v2, s[28:31], s76 offen offset:1024 nt lds
 v_mfma_f32_16x16x32_bf16 a[144:147], a[196:199], v[208:211], a[144:147]
 ds_read_b128 a[216:219], v12 offset:24704
 v_add_f32 v149, v149, v157
 v_mfma_f32_16x16x32_bf16 a[148:151], a[196:199], v[212:215], a[148:151]
 v_exp_f32 v153, v237
 v_mfma_f32_16x16x32_bf16 a[152:155], a[196:199], v[216:219], a[152:155]
 v_cvt_pk_bf16_f32 v197, v156, v157
 ds_read_b128 a[220:223], v13 offset:24704
 v_mfma_f32_16x16x32_bf16 a[156:159], a[196:199], v[220:223], a[156:159]
 ds_read_b128 a[224:227], v12 offset:24832
 s_waitcnt lgkmcnt(5)
 v_mfma_f32_16x16x32_bf16 a[160:163], a[200:203], v[208:211], a[160:163]
 v_exp_f32 v154, v238
 v_mfma_f32_16x16x32_bf16 a[164:167], a[200:203], v[212:215], a[164:167]
 v_add_f32 v149, v149, v152
 ds_read_b128 a[228:231], v13 offset:24832
 v_mfma_f32_16x16x32_bf16 a[168:171], a[200:203], v[216:219], a[168:171]
 v_add_f32 v149, v149, v153
 v_cvt_pk_bf16_f32 v198, v152, v153
 v_mfma_f32_16x16x32_bf16 a[172:175], a[200:203], v[220:223], a[172:175]
 v_exp_f32 v155, v239
 v_mfma_f32_16x16x32_bf16 a[176:179], a[204:207], v[208:211], a[176:179]
 v_add_f32 v149, v149, v154
 v_add_f32 v149, v149, v155
 v_mfma_f32_16x16x32_bf16 a[180:183], a[204:207], v[212:215], a[180:183]
 v_exp_f32 v156, v240
 v_mfma_f32_16x16x32_bf16 a[184:187], a[204:207], v[216:219], a[184:187]
 v_cvt_pk_bf16_f32 v199, v154, v155
 v_add_f32 v146, v146, v150
 v_mfma_f32_16x16x32_bf16 a[188:191], a[204:207], v[220:223], a[188:191]
 v_add_f32 v147, v147, v151
 s_waitcnt lgkmcnt(3)
 v_mfma_f32_16x16x32_bf16 v[160:163], a[208:211], v[32:35], v[128:131]
 v_exp_f32 v157, v241
 v_mfma_f32_16x16x32_bf16 v[160:163], a[212:215], v[48:51], v[160:163]
 ds_read_b128 a[232:235], v12 offset:30720
 v_add_f32 v150, v156, v157
 v_mfma_f32_16x16x32_bf16 v[160:163], a[216:219], v[64:67], v[160:163]
 ds_read_b128 a[236:239], v13 offset:30720
 s_waitcnt lgkmcnt(2)
 v_mfma_f32_16x16x32_bf16 v[160:163], a[220:223], v[80:83], v[160:163]
 buffer_load_dwordx4 v3, s[28:31], s76 offen offset:2048 nt lds
 v_mfma_f32_16x16x32_bf16 v[160:163], a[224:227], v[96:99], v[160:163]
 v_exp_f32 v152, v242
 v_mfma_f32_16x16x32_bf16 v[160:163], a[228:231], v[112:115], v[160:163]
 v_cvt_pk_bf16_f32 v200, v156, v157
 ds_read_b128 a[240:243], v12 offset:30848
 v_mfma_f32_16x16x32_bf16 v[168:171], a[208:211], v[36:39], v[132:135]
 v_exp_f32 v153, v243
 v_mfma_f32_16x16x32_bf16 v[168:171], a[212:215], v[52:55], v[168:171]
 v_add_f32 v150, v150, v152
 v_add_f32 v150, v150, v153
 v_mfma_f32_16x16x32_bf16 v[168:171], a[216:219], v[68:71], v[168:171]
 v_exp_f32 v154, v244
 v_mfma_f32_16x16x32_bf16 v[168:171], a[220:223], v[84:87], v[168:171]
 ds_read_b128 a[244:247], v13 offset:30848
 v_cvt_pk_bf16_f32 v201, v152, v153
 v_mfma_f32_16x16x32_bf16 v[168:171], a[224:227], v[100:103], v[168:171]
 v_add_f32 v150, v150, v154
 v_mfma_f32_16x16x32_bf16 v[168:171], a[228:231], v[116:119], v[168:171]
 v_exp_f32 v155, v245
 v_mfma_f32_16x16x32_bf16 v[176:179], a[208:211], v[40:43], v[136:139]
 ds_read_b128 a[248:251], v12 offset:30976
 v_add_f32 v150, v150, v155
 v_mfma_f32_16x16x32_bf16 v[176:179], a[212:215], v[56:59], v[176:179]
 s_add_u32 m0, s80, 135168
 s_mov_b32 s76, 319488
 v_mfma_f32_16x16x32_bf16 v[176:179], a[216:219], v[72:75], v[176:179]
 v_exp_f32 v156, v246
 v_mfma_f32_16x16x32_bf16 v[176:179], a[220:223], v[88:91], v[176:179]
 ds_read_b128 a[252:255], v13 offset:30976
 v_cvt_pk_bf16_f32 v202, v154, v155
 v_mfma_f32_16x16x32_bf16 v[176:179], a[224:227], v[104:107], v[176:179]
 v_add_f32 v150, v150, v156
 v_mfma_f32_16x16x32_bf16 v[176:179], a[228:231], v[120:123], v[176:179]
 v_exp_f32 v157, v247
 v_mfma_f32_16x16x32_bf16 v[184:187], a[208:211], v[44:47], v[140:143]
 buffer_load_dwordx4 v4, s[32:35], s76 offen offset:0 nt lds
 v_mfma_f32_16x16x32_bf16 v[184:187], a[212:215], v[60:63], v[184:187]
 v_mov_b32 v23, 159744
 v_add_f32 v150, v150, v157
 v_mfma_f32_16x16x32_bf16 v[184:187], a[216:219], v[76:79], v[184:187]
 v_exp_f32 v152, v248
 v_mfma_f32_16x16x32_bf16 v[184:187], a[220:223], v[92:95], v[184:187]
 v_cvt_pk_bf16_f32 v203, v156, v157
 ds_read_b32 v22, v23
 v_mfma_f32_16x16x32_bf16 v[184:187], a[224:227], v[108:111], v[184:187]
 v_subrev_u32 v12, 36864, v12
 v_subrev_u32 v13, 36864, v13
 v_mfma_f32_16x16x32_bf16 v[184:187], a[228:231], v[124:127], v[184:187]
 v_max3_f32 v158, v148, v149, v150
 s_waitcnt lgkmcnt(4)
 v_mfma_f32_16x16x32_bf16 v[164:167], a[232:235], v[32:35], v[128:131]
 v_exp_f32 v153, v249
 v_mfma_f32_16x16x32_bf16 v[164:167], a[236:239], v[48:51], v[164:167]
 v_exp_f32 v154, v250
 v_mfma_f32_16x16x32_bf16 v[164:167], a[240:243], v[64:67], v[164:167]
 v_lshlrev_b32 v29, 3, v0
 s_waitcnt lgkmcnt(1)
 v_mfma_f32_16x16x32_bf16 v[164:167], a[244:247], v[80:83], v[164:167]
 v_add_f32 v151, v152, v153
 v_cvt_pk_bf16_f32 v204, v152, v153
 v_mfma_f32_16x16x32_bf16 v[164:167], a[248:251], v[96:99], v[164:167]
 s_waitcnt vmcnt(7)
 s_barrier
 v_mfma_f32_16x16x32_bf16 v[164:167], a[252:255], v[112:115], v[164:167]
 v_exp_f32 v155, v251
 v_mfma_f32_16x16x32_bf16 v[172:175], a[232:235], v[36:39], v[132:135]
 ds_read_b64_tr_b16 a[192:193], v14 offset:36864
 v_add_f32 v151, v151, v154
 v_mfma_f32_16x16x32_bf16 v[172:175], a[236:239], v[52:55], v[172:175]
 v_exp_f32 v156, v252
 v_mfma_f32_16x16x32_bf16 v[172:175], a[240:243], v[68:71], v[172:175]
 ds_read_b64_tr_b16 a[194:195], v14 offset:43008
 v_add_f32 v151, v151, v155
 v_mfma_f32_16x16x32_bf16 v[172:175], a[244:247], v[84:87], v[172:175]
 v_cvt_pk_bf16_f32 v205, v154, v155
 ds_read_b64_tr_b16 a[196:197], v15 offset:36864
 v_mfma_f32_16x16x32_bf16 v[172:175], a[248:251], v[100:103], v[172:175]
 v_exp_f32 v157, v253
 v_mfma_f32_16x16x32_bf16 v[172:175], a[252:255], v[116:119], v[172:175]
 buffer_load_dwordx4 v5, s[32:35], s76 offen offset:1024 nt lds
 v_mfma_f32_16x16x32_bf16 v[180:183], a[232:235], v[40:43], v[136:139]
 ds_read_b64_tr_b16 a[198:199], v15 offset:43008
 v_add_f32 v151, v151, v156
 v_mfma_f32_16x16x32_bf16 v[180:183], a[236:239], v[56:59], v[180:183]
 v_exp_f32 v152, v254
 v_mfma_f32_16x16x32_bf16 v[180:183], a[240:243], v[72:75], v[180:183]
 ds_read_b64_tr_b16 a[200:201], v16 offset:36864
 v_add_f32 v151, v151, v157
 v_mfma_f32_16x16x32_bf16 v[180:183], a[244:247], v[88:91], v[180:183]
 v_cvt_pk_bf16_f32 v206, v156, v157
 v_add_f32 v151, v151, v152
 v_mfma_f32_16x16x32_bf16 v[180:183], a[248:251], v[104:107], v[180:183]
 v_exp_f32 v153, v255
 v_mfma_f32_16x16x32_bf16 v[180:183], a[252:255], v[120:123], v[180:183]
 ds_read_b64_tr_b16 a[202:203], v16 offset:43008
 v_add_f32 v151, v151, v153
 v_mfma_f32_16x16x32_bf16 v[188:191], a[232:235], v[44:47], v[140:143]
 ds_read_b64_tr_b16 a[204:205], v17 offset:36864
 v_cvt_pk_bf16_f32 v207, v152, v153
 v_mfma_f32_16x16x32_bf16 v[188:191], a[236:239], v[60:63], v[188:191]
 v_mfma_f32_16x16x32_bf16 v[188:191], a[240:243], v[76:79], v[188:191]
 ds_read_b64_tr_b16 a[206:207], v17 offset:43008
 v_max_f32 v158, v158, v151
 v_mfma_f32_16x16x32_bf16 v[188:191], a[244:247], v[92:95], v[188:191]
 v_cmp_lt_f32 vcc, s72, v158
 v_mfma_f32_16x16x32_bf16 v[188:191], a[248:251], v[108:111], v[188:191]
 v_mfma_f32_16x16x32_bf16 v[188:191], a[252:255], v[124:127], v[188:191]
 s_cbranch_vccnz L_S_23
L_R_23:
 s_waitcnt lgkmcnt(4)
 v_mfma_f32_16x16x32_bf16 a[0:3], a[192:195], v[192:195], a[0:3]
 v_exp_f32 v152, v160
 v_mfma_f32_16x16x32_bf16 a[4:7], a[192:195], v[196:199], a[4:7]
 ds_read_b64_tr_b16 a[208:209], v14 offset:36992
 v_add_f32 v144, v144, v148
 v_mfma_f32_16x16x32_bf16 a[8:11], a[192:195], v[200:203], a[8:11]
 v_exp_f32 v153, v161
 v_mfma_f32_16x16x32_bf16 a[12:15], a[192:195], v[204:207], a[12:15]
 ds_read_b64_tr_b16 a[210:211], v14 offset:43136
 v_add_f32 v148, v152, v153
 v_mfma_f32_16x16x32_bf16 a[16:19], a[196:199], v[192:195], a[16:19]
 buffer_load_dwordx4 v6, s[32:35], s76 offen offset:2048 nt lds
 v_mfma_f32_16x16x32_bf16 a[20:23], a[196:199], v[196:199], a[20:23]
 v_exp_f32 v154, v162
 v_mfma_f32_16x16x32_bf16 a[24:27], a[196:199], v[200:203], a[24:27]
 ds_read_b64_tr_b16 a[212:213], v15 offset:36992
 ds_read_b64_tr_b16 a[214:215], v15 offset:43136
 v_mfma_f32_16x16x32_bf16 a[28:31], a[196:199], v[204:207], a[28:31]
 v_cvt_pk_bf16_f32 v208, v152, v153
 s_waitcnt lgkmcnt(4)
 v_mfma_f32_16x16x32_bf16 a[32:35], a[200:203], v[192:195], a[32:35]
 v_exp_f32 v155, v163
 v_mfma_f32_16x16x32_bf16 a[36:39], a[200:203], v[196:199], a[36:39]
 ds_read_b64_tr_b16 a[216:217], v16 offset:36992
 ds_read_b64_tr_b16 a[218:219], v16 offset:43136
 v_mfma_f32_16x16x32_bf16 a[40:43], a[200:203], v[200:203], a[40:43]
 v_add_f32 v148, v148, v154
 v_add_f32 v148, v148, v155
 v_mfma_f32_16x16x32_bf16 a[44:47], a[200:203], v[204:207], a[44:47]
 v_exp_f32 v156, v164
 v_mfma_f32_16x16x32_bf16 a[48:51], a[204:207], v[192:195], a[48:51]
 ds_read_b64_tr_b16 a[220:221], v17 offset:36992
 v_cvt_pk_bf16_f32 v209, v154, v155
 v_mfma_f32_16x16x32_bf16 a[52:55], a[204:207], v[196:199], a[52:55]
 ds_read_b64_tr_b16 a[222:223], v17 offset:43136
 v_add_f32 v148, v148, v156
 v_mfma_f32_16x16x32_bf16 a[56:59], a[204:207], v[200:203], a[56:59]
 v_exp_f32 v157, v165
 v_mfma_f32_16x16x32_bf16 a[60:63], a[204:207], v[204:207], a[60:63]
 v_add_f32 v148, v148, v157
 s_waitcnt lgkmcnt(4)
 v_mfma_f32_16x16x32_bf16 a[64:67], a[208:211], v[192:195], a[64:67]
 s_add_u32 m0, s80, 24576
 s_mov_b32 s76, 344064
 v_mfma_f32_16x16x32_bf16 a[68:71], a[208:211], v[196:199], a[68:71]
 v_exp_f32 v152, v166
 v_mfma_f32_16x16x32_bf16 a[72:75], a[208:211], v[200:203], a[72:75]
 ds_read_b64_tr_b16 a[224:225], v14 offset:37120
 ds_read_b64_tr_b16 a[226:227], v14 offset:43264
 v_mfma_f32_16x16x32_bf16 a[76:79], a[208:211], v[204:207], a[76:79]
 buffer_load_dwordx4 v1, s[28:31], s76 offen offset:0 nt lds
 v_mfma_f32_16x16x32_bf16 a[80:83], a[212:215], v[192:195], a[80:83]
 v_exp_f32 v153, v167
 v_mfma_f32_16x16x32_bf16 a[84:87], a[212:215], v[196:199], a[84:87]
 v_cvt_pk_bf16_f32 v210, v156, v157
 ds_read_b64_tr_b16 a[228:229], v15 offset:37120
 v_mfma_f32_16x16x32_bf16 a[88:91], a[212:215], v[200:203], a[88:91]
 v_exp_f32 v154, v168
 v_mfma_f32_16x16x32_bf16 a[92:95], a[212:215], v[204:207], a[92:95]
 ds_read_b64_tr_b16 a[230:231], v15 offset:43264
 s_waitcnt lgkmcnt(4)
 v_mfma_f32_16x16x32_bf16 a[96:99], a[216:219], v[192:195], a[96:99]
 v_add_f32 v148, v148, v152
 v_add_f32 v148, v148, v153
 v_mfma_f32_16x16x32_bf16 a[100:103], a[216:219], v[196:199], a[100:103]
 v_cvt_pk_bf16_f32 v211, v152, v153
 v_add_f32 v145, v145, v149
 v_mfma_f32_16x16x32_bf16 a[104:107], a[216:219], v[200:203], a[104:107]
 v_exp_f32 v155, v169
 v_mfma_f32_16x16x32_bf16 a[108:111], a[216:219], v[204:207], a[108:111]
 ds_read_b64_tr_b16 a[232:233], v16 offset:37120
 ds_read_b64_tr_b16 a[234:235], v16 offset:43264
 v_mfma_f32_16x16x32_bf16 a[112:115], a[220:223], v[192:195], a[112:115]
 v_exp_f32 v156, v170
 v_mfma_f32_16x16x32_bf16 a[116:119], a[220:223], v[196:199], a[116:119]
 ds_read_b64_tr_b16 a[236:237], v17 offset:37120
 ds_read_b64_tr_b16 a[238:239], v17 offset:43264
 v_mfma_f32_16x16x32_bf16 a[120:123], a[220:223], v[200:203], a[120:123]
 v_add_f32 v149, v154, v155
 v_cvt_pk_bf16_f32 v212, v154, v155
 v_mfma_f32_16x16x32_bf16 a[124:127], a[220:223], v[204:207], a[124:127]
 ds_read_b128 a[240:243], v12 offset:0
 s_waitcnt lgkmcnt(5)
 v_mfma_f32_16x16x32_bf16 a[128:131], a[224:227], v[192:195], a[128:131]
 v_exp_f32 v157, v171
 v_mfma_f32_16x16x32_bf16 a[132:135], a[224:227], v[196:199], a[132:135]
 ds_read_b128 a[244:247], v13 offset:0
 v_add_f32 v149, v149, v156
 v_mfma_f32_16x16x32_bf16 a[136:139], a[224:227], v[200:203], a[136:139]
 v_exp_f32 v152, v172
 v_mfma_f32_16x16x32_bf16 a[140:143], a[224:227], v[204:207], a[140:143]
 buffer_load_dwordx4 v2, s[28:31], s76 offen offset:1024 nt lds
 v_mfma_f32_16x16x32_bf16 a[144:147], a[228:231], v[192:195], a[144:147]
 ds_read_b128 a[248:251], v12 offset:128
 v_add_f32 v149, v149, v157
 v_mfma_f32_16x16x32_bf16 a[148:151], a[228:231], v[196:199], a[148:151]
 v_exp_f32 v153, v173
 v_mfma_f32_16x16x32_bf16 a[152:155], a[228:231], v[200:203], a[152:155]
 v_cvt_pk_bf16_f32 v213, v156, v157
 ds_read_b128 a[252:255], v13 offset:128
 v_mfma_f32_16x16x32_bf16 a[156:159], a[228:231], v[204:207], a[156:159]
 ds_read_b128 a[192:195], v12 offset:256
 s_waitcnt lgkmcnt(5)
 v_mfma_f32_16x16x32_bf16 a[160:163], a[232:235], v[192:195], a[160:163]
 v_exp_f32 v154, v174
 v_mfma_f32_16x16x32_bf16 a[164:167], a[232:235], v[196:199], a[164:167]
 v_add_f32 v149, v149, v152
 ds_read_b128 a[196:199], v13 offset:256
 v_mfma_f32_16x16x32_bf16 a[168:171], a[232:235], v[200:203], a[168:171]
 v_add_f32 v149, v149, v153
 v_cvt_pk_bf16_f32 v214, v152, v153
 v_mfma_f32_16x16x32_bf16 a[172:175], a[232:235], v[204:207], a[172:175]
 v_exp_f32 v155, v175
 v_mfma_f32_16x16x32_bf16 a[176:179], a[236:239], v[192:195], a[176:179]
 v_add_f32 v149, v149, v154
 v_add_f32 v149, v149, v155
 v_mfma_f32_16x16x32_bf16 a[180:183], a[236:239], v[196:199], a[180:183]
 v_exp_f32 v156, v176
 v_mfma_f32_16x16x32_bf16 a[184:187], a[236:239], v[200:203], a[184:187]
 v_cvt_pk_bf16_f32 v215, v154, v155
 v_add_f32 v146, v146, v150
 v_mfma_f32_16x16x32_bf16 a[188:191], a[236:239], v[204:207], a[188:191]
 v_add_f32 v147, v147, v151
 s_waitcnt lgkmcnt(3)
 v_mfma_f32_16x16x32_bf16 v[224:227], a[240:243], v[32:35], v[128:131]
 v_exp_f32 v157, v177
 v_mfma_f32_16x16x32_bf16 v[224:227], a[244:247], v[48:51], v[224:227]
 ds_read_b128 a[200:203], v12 offset:6144
 v_add_f32 v150, v156, v157
 v_mfma_f32_16x16x32_bf16 v[224:227], a[248:251], v[64:67], v[224:227]
 ds_read_b128 a[204:207], v13 offset:6144
 s_waitcnt lgkmcnt(2)
 v_mfma_f32_16x16x32_bf16 v[224:227], a[252:255], v[80:83], v[224:227]
 buffer_load_dwordx4 v3, s[28:31], s76 offen offset:2048 nt lds
 v_mfma_f32_16x16x32_bf16 v[224:227], a[192:195], v[96:99], v[224:227]
 v_exp_f32 v152, v178
 v_mfma_f32_16x16x32_bf16 v[224:227], a[196:199], v[112:115], v[224:227]
 v_cvt_pk_bf16_f32 v216, v156, v157
 ds_read_b128 a[208:211], v12 offset:6272
 v_mfma_f32_16x16x32_bf16 v[232:235], a[240:243], v[36:39], v[132:135]
 v_exp_f32 v153, v179
 v_mfma_f32_16x16x32_bf16 v[232:235], a[244:247], v[52:55], v[232:235]
 v_add_f32 v150, v150, v152
 v_add_f32 v150, v150, v153
 v_mfma_f32_16x16x32_bf16 v[232:235], a[248:251], v[68:71], v[232:235]
 v_exp_f32 v154, v180
 v_mfma_f32_16x16x32_bf16 v[232:235], a[252:255], v[84:87], v[232:235]
 ds_read_b128 a[212:215], v13 offset:6272
 v_cvt_pk_bf16_f32 v217, v152, v153
 v_mfma_f32_16x16x32_bf16 v[232:235], a[192:195], v[100:103], v[232:235]
 v_add_f32 v150, v150, v154
 v_add_u32 v14, 49152, v14
 v_mfma_f32_16x16x32_bf16 v[232:235], a[196:199], v[116:119], v[232:235]
 v_exp_f32 v155, v181
 v_mfma_f32_16x16x32_bf16 v[240:243], a[240:243], v[40:43], v[136:139]
 ds_read_b128 a[216:219], v12 offset:6400
 v_add_f32 v150, v150, v155
 v_mfma_f32_16x16x32_bf16 v[240:243], a[244:247], v[56:59], v[240:243]
 s_add_u32 m0, s80, 147456
 s_mov_b32 s76, 331776
 v_mfma_f32_16x16x32_bf16 v[240:243], a[248:251], v[72:75], v[240:243]
 v_exp_f32 v156, v182
 v_mfma_f32_16x16x32_bf16 v[240:243], a[252:255], v[88:91], v[240:243]
 ds_read_b128 a[220:223], v13 offset:6400
 v_cvt_pk_bf16_f32 v218, v154, v155
 v_mfma_f32_16x16x32_bf16 v[240:243], a[192:195], v[104:107], v[240:243]
 v_add_f32 v150, v150, v156
 v_add_u32 v15, 49152, v15
 v_mfma_f32_16x16x32_bf16 v[240:243], a[196:199], v[120:123], v[240:243]
 v_exp_f32 v157, v183
 v_mfma_f32_16x16x32_bf16 v[248:251], a[240:243], v[44:47], v[140:143]
 buffer_load_dwordx4 v4, s[32:35], s76 offen offset:0 nt lds
 v_mfma_f32_16x16x32_bf16 v[248:251], a[244:247], v[60:63], v[248:251]
 v_add_f32 v150, v150, v157
 v_cvt_pk_bf16_f32 v219, v156, v157
 v_mfma_f32_16x16x32_bf16 v[248:251], a[248:251], v[76:79], v[248:251]
 v_exp_f32 v152, v184
 v_mfma_f32_16x16x32_bf16 v[248:251], a[252:255], v[92:95], v[248:251]
 v_readfirstlane_b32 s82, v22
 v_mfma_f32_16x16x32_bf16 v[248:251], a[192:195], v[108:111], v[248:251]
 v_add_u32 v16, 49152, v16
 v_add_u32 v17, 49152, v17
 v_mfma_f32_16x16x32_bf16 v[248:251], a[196:199], v[124:127], v[248:251]
 s_mul_i32 s83, s82, 0x9e3779b1
 s_waitcnt lgkmcnt(3)
 v_mfma_f32_16x16x32_bf16 v[228:231], a[200:203], v[32:35], v[128:131]
 v_exp_f32 v153, v185
 v_mfma_f32_16x16x32_bf16 v[228:231], a[204:207], v[48:51], v[228:231]
 v_exp_f32 v154, v186
 v_mfma_f32_16x16x32_bf16 v[228:231], a[208:211], v[64:67], v[228:231]
 v_add_f32 v151, v152, v153
 s_waitcnt lgkmcnt(0)
 v_mfma_f32_16x16x32_bf16 v[228:231], a[212:215], v[80:83], v[228:231]
 v_cvt_pk_bf16_f32 v220, v152, v153
 v_add_f32 v151, v151, v154
 v_mfma_f32_16x16x32_bf16 v[228:231], a[216:219], v[96:99], v[228:231]
 s_waitcnt vmcnt(7)
 s_barrier
 v_mfma_f32_16x16x32_bf16 v[228:231], a[220:223], v[112:115], v[228:231]
 v_exp_f32 v155, v187
 v_mfma_f32_16x16x32_bf16 v[236:239], a[200:203], v[36:39], v[132:135]
 ds_read_b64_tr_b16 a[224:225], v14 offset:0
 v_add_f32 v151, v151, v155
 v_mfma_f32_16x16x32_bf16 v[236:239], a[204:207], v[52:55], v[236:239]
 v_exp_f32 v156, v188
 v_mfma_f32_16x16x32_bf16 v[236:239], a[208:211], v[68:71], v[236:239]
 ds_read_b64_tr_b16 a[226:227], v14 offset:6144
 v_cvt_pk_bf16_f32 v221, v154, v155
 v_mfma_f32_16x16x32_bf16 v[236:239], a[212:215], v[84:87], v[236:239]
 ds_read_b64_tr_b16 a[228:229], v15 offset:0
 v_add_f32 v151, v151, v156
 v_mfma_f32_16x16x32_bf16 v[236:239], a[216:219], v[100:103], v[236:239]
 v_exp_f32 v157, v189
 v_mfma_f32_16x16x32_bf16 v[236:239], a[220:223], v[116:119], v[236:239]
 buffer_load_dwordx4 v5, s[32:35], s76 offen offset:1024 nt lds
 v_mfma_f32_16x16x32_bf16 v[244:247], a[200:203], v[40:43], v[136:139]
 ds_read_b64_tr_b16 a[230:231], v15 offset:6144
 v_add_f32 v151, v151, v157
 v_mfma_f32_16x16x32_bf16 v[244:247], a[204:207], v[56:59], v[244:247]
 v_exp_f32 v152, v190
 v_mfma_f32_16x16x32_bf16 v[244:247], a[208:211], v[72:75], v[244:247]
 ds_read_b64_tr_b16 a[232:233], v16 offset:0
 v_cvt_pk_bf16_f32 v222, v156, v157
 v_mfma_f32_16x16x32_bf16 v[244:247], a[212:215], v[88:91], v[244:247]
 v_add_f32 v151, v151, v152
 v_max3_f32 v158, v148, v149, v150
 v_mfma_f32_16x16x32_bf16 v[244:247], a[216:219], v[104:107], v[244:247]
 v_exp_f32 v153, v191
 v_mfma_f32_16x16x32_bf16 v[244:247], a[220:223], v[120:123], v[244:247]
 ds_read_b64_tr_b16 a[234:235], v16 offset:6144
 v_add_f32 v151, v151, v153
 v_mfma_f32_16x16x32_bf16 v[252:255], a[200:203], v[44:47], v[140:143]
 ds_read_b64_tr_b16 a[236:237], v17 offset:0
 v_cvt_pk_bf16_f32 v223, v152, v153
 v_mfma_f32_16x16x32_bf16 v[252:255], a[204:207], v[60:63], v[252:255]
 v_mfma_f32_16x16x32_bf16 v[252:255], a[208:211], v[76:79], v[252:255]
 ds_read_b64_tr_b16 a[238:239], v17 offset:6144
 v_max_f32 v158, v158, v151
 v_mfma_f32_16x16x32_bf16 v[252:255], a[212:215], v[92:95], v[252:255]
 v_cmp_lt_f32 vcc, s72, v158
 v_mfma_f32_16x16x32_bf16 v[252:255], a[216:219], v[108:111], v[252:255]
 v_mfma_f32_16x16x32_bf16 v[252:255], a[220:223], v[124:127], v[252:255]
 s_cbranch_vccnz L_S_24
L_R_24:
 s_waitcnt lgkmcnt(4)
 v_mfma_f32_16x16x32_bf16 a[0:3], a[224:227], v[208:211], a[0:3]
 v_exp_f32 v152, v224
 v_mfma_f32_16x16x32_bf16 a[4:7], a[224:227], v[212:215], a[4:7]
 ds_read_b64_tr_b16 a[240:241], v14 offset:128
 v_add_f32 v144, v144, v148
 v_mfma_f32_16x16x32_bf16 a[8:11], a[224:227], v[216:219], a[8:11]
 v_exp_f32 v153, v225
 v_mfma_f32_16x16x32_bf16 a[12:15], a[224:227], v[220:223], a[12:15]
 ds_read_b64_tr_b16 a[242:243], v14 offset:6272
 v_add_f32 v148, v152, v153
 v_mfma_f32_16x16x32_bf16 a[16:19], a[228:231], v[208:211], a[16:19]
 buffer_load_dwordx4 v6, s[32:35], s76 offen offset:2048 nt lds
 v_mfma_f32_16x16x32_bf16 a[20:23], a[228:231], v[212:215], a[20:23]
 v_exp_f32 v154, v226
 v_mfma_f32_16x16x32_bf16 a[24:27], a[228:231], v[216:219], a[24:27]
 ds_read_b64_tr_b16 a[244:245], v15 offset:128
 ds_read_b64_tr_b16 a[246:247], v15 offset:6272
 v_mfma_f32_16x16x32_bf16 a[28:31], a[228:231], v[220:223], a[28:31]
 v_cvt_pk_bf16_f32 v192, v152, v153
 s_waitcnt lgkmcnt(4)
 v_mfma_f32_16x16x32_bf16 a[32:35], a[232:235], v[208:211], a[32:35]
 v_exp_f32 v155, v227
 v_mfma_f32_16x16x32_bf16 a[36:39], a[232:235], v[212:215], a[36:39]
 ds_read_b64_tr_b16 a[248:249], v16 offset:128
 ds_read_b64_tr_b16 a[250:251], v16 offset:6272
 v_mfma_f32_16x16x32_bf16 a[40:43], a[232:235], v[216:219], a[40:43]
 v_add_f32 v148, v148, v154
 v_add_f32 v148, v148, v155
 v_mfma_f32_16x16x32_bf16 a[44:47], a[232:235], v[220:223], a[44:47]
 v_exp_f32 v156, v228
 v_mfma_f32_16x16x32_bf16 a[48:51], a[236:239], v[208:211], a[48:51]
 ds_read_b64_tr_b16 a[252:253], v17 offset:128
 v_cvt_pk_bf16_f32 v193, v154, v155
 v_mfma_f32_16x16x32_bf16 a[52:55], a[236:239], v[212:215], a[52:55]
 ds_read_b64_tr_b16 a[254:255], v17 offset:6272
 v_add_f32 v148, v148, v156
 v_mfma_f32_16x16x32_bf16 a[56:59], a[236:239], v[216:219], a[56:59]
 v_exp_f32 v157, v229
 v_mfma_f32_16x16x32_bf16 a[60:63], a[236:239], v[220:223], a[60:63]
 v_add_f32 v148, v148, v157
 s_waitcnt lgkmcnt(4)
 v_mfma_f32_16x16x32_bf16 a[64:67], a[240:243], v[208:211], a[64:67]
 s_add_u32 m0, s80, 36864
 s_mov_b32 s76, 356352
 v_mfma_f32_16x16x32_bf16 a[68:71], a[240:243], v[212:215], a[68:71]
 v_exp_f32 v152, v230
 v_mfma_f32_16x16x32_bf16 a[72:75], a[240:243], v[216:219], a[72:75]
 ds_read_b64_tr_b16 a[192:193], v14 offset:256
 ds_read_b64_tr_b16 a[194:195], v14 offset:6400
 v_mfma_f32_16x16x32_bf16 a[76:79], a[240:243], v[220:223], a[76:79]
 buffer_load_dwordx4 v1, s[28:31], s76 offen offset:0 nt lds
 v_mfma_f32_16x16x32_bf16 a[80:83], a[244:247], v[208:211], a[80:83]
 v_exp_f32 v153, v231
 v_mfma_f32_16x16x32_bf16 a[84:87], a[244:247], v[212:215], a[84:87]
 v_cvt_pk_bf16_f32 v194, v156, v157
 ds_read_b64_tr_b16 a[196:197], v15 offset:256
 v_mfma_f32_16x16x32_bf16 a[88:91], a[244:247], v[216:219], a[88:91]
 v_exp_f32 v154, v232
 v_mfma_f32_16x16x32_bf16 a[92:95], a[244:247], v[220:223], a[92:95]
 ds_read_b64_tr_b16 a[198:199], v15 offset:6400
 s_waitcnt lgkmcnt(4)
 v_mfma_f32_16x16x32_bf16 a[96:99], a[248:251], v[208:211], a[96:99]
 v_add_f32 v148, v148, v152
 v_add_f32 v148, v148, v153
 v_mfma_f32_16x16x32_bf16 a[100:103], a[248:251], v[212:215], a[100:103]
 v_cvt_pk_bf16_f32 v195, v152, v153
 v_add_f32 v145, v145, v149
 v_mfma_f32_16x16x32_bf16 a[104:107], a[248:251], v[216:219], a[104:107]
 v_exp_f32 v155, v233
 v_mfma_f32_16x16x32_bf16 a[108:111], a[248:251], v[220:223], a[108:111]
 ds_read_b64_tr_b16 a[200:201], v16 offset:256
 ds_read_b64_tr_b16 a[202:203], v16 offset:6400
 v_mfma_f32_16x16x32_bf16 a[112:115], a[252:255], v[208:211], a[112:115]
 v_exp_f32 v156, v234
 v_mfma_f32_16x16x32_bf16 a[116:119], a[252:255], v[212:215], a[116:119]
 ds_read_b64_tr_b16 a[204:205], v17 offset:256
 ds_read_b64_tr_b16 a[206:207], v17 offset:6400
 v_mfma_f32_16x16x32_bf16 a[120:123], a[252:255], v[216:219], a[120:123]
 v_add_f32 v149, v154, v155
 v_cvt_pk_bf16_f32 v196, v154, v155
 v_mfma_f32_16x16x32_bf16 a[124:127], a[252:255], v[220:223], a[124:127]
 ds_read_b128 a[208:211], v12 offset:12288
 s_waitcnt lgkmcnt(5)
 v_mfma_f32_16x16x32_bf16 a[128:131], a[192:195], v[208:211], a[128:131]
 v_exp_f32 v157, v235
 v_mfma_f32_16x16x32_bf16 a[132:135], a[192:195], v[212:215], a[132:135]
 ds_read_b128 a[212:215], v13 offset:12288
 v_add_f32 v149, v149, v156
 v_mfma_f32_16x16x32_bf16 a[136:139], a[192:195], v[216:219], a[136:139]
 v_exp_f32 v152, v236
 v_mfma_f32_16x16x32_bf16 a[140:143], a[192:195], v[220:223], a[140:143]
 buffer_load_dwordx4 v2, s[28:31], s76 offen offset:1024 nt lds
 v_mfma_f32_16x16x32_bf16 a[144:147], a[196:199], v[208:211], a[144:147]
 ds_read_b128 a[216:219], v12 offset:12416
 v_add_f32 v149, v149, v157
 v_mfma_f32_16x16x32_bf16 a[148:151], a[196:199], v[212:215], a[148:151]
 v_exp_f32 v153, v237
 v_mfma_f32_16x16x32_bf16 a[152:155], a[196:199], v[216:219], a[152:155]
 v_cvt_pk_bf16_f32 v197, v156, v157
 ds_read_b128 a[220:223], v13 offset:12416
 v_mfma_f32_16x16x32_bf16 a[156:159], a[196:199], v[220:223], a[156:159]
 ds_read_b128 a[224:227], v12 offset:12544
 s_waitcnt lgkmcnt(5)
 v_mfma_f32_16x16x32_bf16 a[160:163], a[200:203], v[208:211], a[160:163]
 v_exp_f32 v154, v238
 v_mfma_f32_16x16x32_bf16 a[164:167], a[200:203], v[212:215], a[164:167]
 v_add_f32 v149, v149, v152
 ds_read_b128 a[228:231], v13 offset:12544
 v_mfma_f32_16x16x32_bf16 a[168:171], a[200:203], v[216:219], a[168:171]
 v_add_f32 v149, v149, v153
 v_cvt_pk_bf16_f32 v198, v152, v153
 v_mfma_f32_16x16x32_bf16 a[172:175], a[200:203], v[220:223], a[172:175]
 v_exp_f32 v155, v239
 v_mfma_f32_16x16x32_bf16 a[176:179], a[204:207], v[208:211], a[176:179]
 v_add_f32 v149, v149, v154
 v_add_f32 v149, v149, v155
 v_mfma_f32_16x16x32_bf16 a[180:183], a[204:207], v[212:215], a[180:183]
 v_exp_f32 v156, v240
 v_mfma_f32_16x16x32_bf16 a[184:187], a[204:207], v[216:219], a[184:187]
 v_cvt_pk_bf16_f32 v199, v154, v155
 v_add_f32 v146, v146, v150
 v_mfma_f32_16x16x32_bf16 a[188:191], a[204:207], v[220:223], a[188:191]
 v_add_f32 v147, v147, v151
 s_waitcnt lgkmcnt(3)
 v_mfma_f32_16x16x32_bf16 v[160:163], a[208:211], v[32:35], v[128:131]
 v_exp_f32 v157, v241
 v_mfma_f32_16x16x32_bf16 v[160:163], a[212:215], v[48:51], v[160:163]
 ds_read_b128 a[232:235], v12 offset:18432
 v_add_f32 v150, v156, v157
 v_mfma_f32_16x16x32_bf16 v[160:163], a[216:219], v[64:67], v[160:163]
 ds_read_b128 a[236:239], v13 offset:18432
 s_waitcnt lgkmcnt(2)
 v_mfma_f32_16x16x32_bf16 v[160:163], a[220:223], v[80:83], v[160:163]
 buffer_load_dwordx4 v3, s[28:31], s76 offen offset:2048 nt lds
 v_mfma_f32_16x16x32_bf16 v[160:163], a[224:227], v[96:99], v[160:163]
 v_exp_f32 v152, v242
 v_mfma_f32_16x16x32_bf16 v[160:163], a[228:231], v[112:115], v[160:163]
 v_cvt_pk_bf16_f32 v200, v156, v157
 ds_read_b128 a[240:243], v12 offset:18560
 v_mfma_f32_16x16x32_bf16 v[168:171], a[208:211], v[36:39], v[132:135]
 v_exp_f32 v153, v243
 v_mfma_f32_16x16x32_bf16 v[168:171], a[212:215], v[52:55], v[168:171]
 v_add_f32 v150, v150, v152
 v_add_f32 v150, v150, v153
 v_mfma_f32_16x16x32_bf16 v[168:171], a[216:219], v[68:71], v[168:171]
 v_exp_f32 v154, v244
 v_mfma_f32_16x16x32_bf16 v[168:171], a[220:223], v[84:87], v[168:171]
 ds_read_b128 a[244:247], v13 offset:18560
 v_cvt_pk_bf16_f32 v201, v152, v153
 v_mfma_f32_16x16x32_bf16 v[168:171], a[224:227], v[100:103], v[168:171]
 v_add_f32 v150, v150, v154
 v_mfma_f32_16x16x32_bf16 v[168:171], a[228:231], v[116:119], v[168:171]
 v_exp_f32 v155, v245
 v_mfma_f32_16x16x32_bf16 v[176:179], a[208:211], v[40:43], v[136:139]
 ds_read_b128 a[248:251], v12 offset:18688
 v_add_f32 v150, v150, v155
 v_mfma_f32_16x16x32_bf16 v[176:179], a[212:215], v[56:59], v[176:179]
 s_add_u32 m0, s80, 73728
 s_mov_b32 s76, 344064
 v_mfma_f32_16x16x32_bf16 v[176:179], a[216:219], v[72:75], v[176:179]
 v_exp_f32 v156, v246
 v_mfma_f32_16x16x32_bf16 v[176:179], a[220:223], v[88:91], v[176:179]
 ds_read_b128 a[252:255], v13 offset:18688
 v_cvt_pk_bf16_f32 v202, v154, v155
 v_mfma_f32_16x16x32_bf16 v[176:179], a[224:227], v[104:107], v[176:179]
 v_add_f32 v150, v150, v156
 v_mfma_f32_16x16x32_bf16 v[176:179], a[228:231], v[120:123], v[176:179]
 v_exp_f32 v157, v247
 v_mfma_f32_16x16x32_bf16 v[184:187], a[208:211], v[44:47], v[140:143]
 buffer_load_dwordx4 v4, s[32:35], s76 offen offset:0 nt lds
 v_mfma_f32_16x16x32_bf16 v[184:187], a[212:215], v[60:63], v[184:187]
 v_add_f32 v150, v150, v157
 v_cvt_pk_bf16_f32 v203, v156, v157
 v_mfma_f32_16x16x32_bf16 v[184:187], a[216:219], v[76:79], v[184:187]
 v_exp_f32 v152, v248
 v_mfma_f32_16x16x32_bf16 v[184:187], a[220:223], v[92:95], v[184:187]
 v_max3_f32 v158, v148, v149, v150
 v_mfma_f32_16x16x32_bf16 v[184:187], a[224:227], v[108:111], v[184:187]
 v_mfma_f32_16x16x32_bf16 v[184:187], a[228:231], v[124:127], v[184:187]
 s_waitcnt lgkmcnt(3)
 v_mfma_f32_16x16x32_bf16 v[164:167], a[232:235], v[32:35], v[128:131]
 v_exp_f32 v153, v249
 v_mfma_f32_16x16x32_bf16 v[164:167], a[236:239], v[48:51], v[164:167]
 v_exp_f32 v154, v250
 v_mfma_f32_16x16x32_bf16 v[164:167], a[240:243], v[64:67], v[164:167]
 v_add_f32 v151, v152, v153
 s_waitcnt lgkmcnt(0)
 v_mfma_f32_16x16x32_bf16 v[164:167], a[244:247], v[80:83], v[164:167]
 v_cvt_pk_bf16_f32 v204, v152, v153
 v_add_f32 v151, v151, v154
 v_mfma_f32_16x16x32_bf16 v[164:167], a[248:251], v[96:99], v[164:167]
 s_waitcnt vmcnt(7)
 s_barrier
 v_mfma_f32_16x16x32_bf16 v[164:167], a[252:255], v[112:115], v[164:167]
 v_exp_f32 v155, v251
 v_mfma_f32_16x16x32_bf16 v[172:175], a[232:235], v[36:39], v[132:135]
 ds_read_b64_tr_b16 a[192:193], v14 offset:12288
 v_add_f32 v151, v151, v155
 v_mfma_f32_16x16x32_bf16 v[172:175], a[236:239], v[52:55], v[172:175]
 v_exp_f32 v156, v252
 v_mfma_f32_16x16x32_bf16 v[172:175], a[240:243], v[68:71], v[172:175]
 ds_read_b64_tr_b16 a[194:195], v14 offset:18432
 v_cvt_pk_bf16_f32 v205, v154, v155
 v_mfma_f32_16x16x32_bf16 v[172:175], a[244:247], v[84:87], v[172:175]
 ds_read_b64_tr_b16 a[196:197], v15 offset:12288
 v_add_f32 v151, v151, v156
 v_mfma_f32_16x16x32_bf16 v[172:175], a[248:251], v[100:103], v[172:175]
 v_exp_f32 v157, v253
 v_mfma_f32_16x16x32_bf16 v[172:175], a[252:255], v[116:119], v[172:175]
 buffer_load_dwordx4 v5, s[32:35], s76 offen offset:1024 nt lds
 v_mfma_f32_16x16x32_bf16 v[180:183], a[232:235], v[40:43], v[136:139]
 ds_read_b64_tr_b16 a[198:199], v15 offset:18432
 v_add_f32 v151, v151, v157
 v_mfma_f32_16x16x32_bf16 v[180:183], a[236:239], v[56:59], v[180:183]
 v_exp_f32 v152, v254
 v_mfma_f32_16x16x32_bf16 v[180:183], a[240:243], v[72:75], v[180:183]
 ds_read_b64_tr_b16 a[200:201], v16 offset:12288
 v_cvt_pk_bf16_f32 v206, v156, v157
 v_mfma_f32_16x16x32_bf16 v[180:183], a[244:247], v[88:91], v[180:183]
 v_add_f32 v151, v151, v152
 v_mfma_f32_16x16x32_bf16 v[180:183], a[248:251], v[104:107], v[180:183]
 v_exp_f32 v153, v255
 v_mfma_f32_16x16x32_bf16 v[180:183], a[252:255], v[120:123], v[180:183]
 ds_read_b64_tr_b16 a[202:203], v16 offset:18432
 v_add_f32 v151, v151, v153
 v_mfma_f32_16x16x32_bf16 v[188:191], a[232:235], v[44:47], v[140:143]
 ds_read_b64_tr_b16 a[204:205], v17 offset:12288
 v_cvt_pk_bf16_f32 v207, v152, v153
 v_mfma_f32_16x16x32_bf16 v[188:191], a[236:239], v[60:63], v[188:191]
 v_mfma_f32_16x16x32_bf16 v[188:191], a[240:243], v[76:79], v[188:191]
 ds_read_b64_tr_b16 a[206:207], v17 offset:18432
 v_max_f32 v158, v158, v151
 v_mfma_f32_16x16x32_bf16 v[188:191], a[244:247], v[92:95], v[188:191]
 v_cmp_lt_f32 vcc, s72, v158
 v_mfma_f32_16x16x32_bf16 v[188:191], a[248:251], v[108:111], v[188:191]
 v_mfma_f32_16x16x32_bf16 v[188:191], a[252:255], v[124:127], v[188:191]
 s_cbranch_vccnz L_S_25
L_R_25:
 s_waitcnt lgkmcnt(4)
 v_mfma_f32_16x16x32_bf16 a[0:3], a[192:195], v[192:195], a[0:3]
 v_exp_f32 v152, v160
 v_mfma_f32_16x16x32_bf16 a[4:7], a[192:195], v[196:199], a[4:7]
 ds_read_b64_tr_b16 a[208:209], v14 offset:12416
 v_add_f32 v144, v144, v148
 v_mfma_f32_16x16x32_bf16 a[8:11], a[192:195], v[200:203], a[8:11]
 v_exp_f32 v153, v161
 v_mfma_f32_16x16x32_bf16 a[12:15], a[192:195], v[204:207], a[12:15]
 ds_read_b64_tr_b16 a[210:211], v14 offset:18560
 v_add_f32 v148, v152, v153
 v_mfma_f32_16x16x32_bf16 a[16:19], a[196:199], v[192:195], a[16:19]
 buffer_load_dwordx4 v6, s[32:35], s76 offen offset:2048 nt lds
 v_mfma_f32_16x16x32_bf16 a[20:23], a[196:199], v[196:199], a[20:23]
 v_exp_f32 v154, v162
 v_mfma_f32_16x16x32_bf16 a[24:27], a[196:199], v[200:203], a[24:27]
 ds_read_b64_tr_b16 a[212:213], v15 offset:12416
 ds_read_b64_tr_b16 a[214:215], v15 offset:18560
 v_mfma_f32_16x16x32_bf16 a[28:31], a[196:199], v[204:207], a[28:31]
 v_cvt_pk_bf16_f32 v208, v152, v153
 s_waitcnt lgkmcnt(4)
 v_mfma_f32_16x16x32_bf16 a[32:35], a[200:203], v[192:195], a[32:35]
 v_exp_f32 v155, v163
 v_mfma_f32_16x16x32_bf16 a[36:39], a[200:203], v[196:199], a[36:39]
 ds_read_b64_tr_b16 a[216:217], v16 offset:12416
 ds_read_b64_tr_b16 a[218:219], v16 offset:18560
 v_mfma_f32_16x16x32_bf16 a[40:43], a[200:203], v[200:203], a[40:43]
 v_add_f32 v148, v148, v154
 v_add_f32 v148, v148, v155
 v_mfma_f32_16x16x32_bf16 a[44:47], a[200:203], v[204:207], a[44:47]
 v_exp_f32 v156, v164
 v_mfma_f32_16x16x32_bf16 a[48:51], a[204:207], v[192:195], a[48:51]
 ds_read_b64_tr_b16 a[220:221], v17 offset:12416
 v_cvt_pk_bf16_f32 v209, v154, v155
 v_mfma_f32_16x16x32_bf16 a[52:55], a[204:207], v[196:199], a[52:55]
 ds_read_b64_tr_b16 a[222:223], v17 offset:18560
 v_add_f32 v148, v148, v156
 v_mfma_f32_16x16x32_bf16 a[56:59], a[204:207], v[200:203], a[56:59]
 v_exp_f32 v157, v165
 v_mfma_f32_16x16x32_bf16 a[60:63], a[204:207], v[204:207], a[60:63]
 v_add_f32 v148, v148, v157
 s_waitcnt lgkmcnt(4)
 v_mfma_f32_16x16x32_bf16 a[64:67], a[208:211], v[192:195], a[64:67]
 s_add_u32 m0, s80, 49152
 s_mov_b32 s76, 368640
 v_mfma_f32_16x16x32_bf16 a[68:71], a[208:211], v[196:199], a[68:71]
 v_exp_f32 v152, v166
 v_mfma_f32_16x16x32_bf16 a[72:75], a[208:211], v[200:203], a[72:75]
 ds_read_b64_tr_b16 a[224:225], v14 offset:12544
 ds_read_b64_tr_b16 a[226:227], v14 offset:18688
 v_mfma_f32_16x16x32_bf16 a[76:79], a[208:211], v[204:207], a[76:79]
 buffer_load_dwordx4 v1, s[28:31], s76 offen offset:0 nt lds
 v_mfma_f32_16x16x32_bf16 a[80:83], a[212:215], v[192:195], a[80:83]
 v_exp_f32 v153, v167
 v_mfma_f32_16x16x32_bf16 a[84:87], a[212:215], v[196:199], a[84:87]
 v_cvt_pk_bf16_f32 v210, v156, v157
 ds_read_b64_tr_b16 a[228:229], v15 offset:12544
 v_mfma_f32_16x16x32_bf16 a[88:91], a[212:215], v[200:203], a[88:91]
 v_exp_f32 v154, v168
 v_mfma_f32_16x16x32_bf16 a[92:95], a[212:215], v[204:207], a[92:95]
 ds_read_b64_tr_b16 a[230:231], v15 offset:18688
 s_waitcnt lgkmcnt(4)
 v_mfma_f32_16x16x32_bf16 a[96:99], a[216:219], v[192:195], a[96:99]
 v_add_f32 v148, v148, v152
 v_add_f32 v148, v148, v153
 v_mfma_f32_16x16x32_bf16 a[100:103], a[216:219], v[196:199], a[100:103]
 v_cvt_pk_bf16_f32 v211, v152, v153
 v_add_f32 v145, v145, v149
 v_mfma_f32_16x16x32_bf16 a[104:107], a[216:219], v[200:203], a[104:107]
 v_exp_f32 v155, v169
 v_mfma_f32_16x16x32_bf16 a[108:111], a[216:219], v[204:207], a[108:111]
 ds_read_b64_tr_b16 a[232:233], v16 offset:12544
 ds_read_b64_tr_b16 a[234:235], v16 offset:18688
 v_mfma_f32_16x16x32_bf16 a[112:115], a[220:223], v[192:195], a[112:115]
 v_exp_f32 v156, v170
 v_mfma_f32_16x16x32_bf16 a[116:119], a[220:223], v[196:199], a[116:119]
 ds_read_b64_tr_b16 a[236:237], v17 offset:12544
 ds_read_b64_tr_b16 a[238:239], v17 offset:18688
 v_mfma_f32_16x16x32_bf16 a[120:123], a[220:223], v[200:203], a[120:123]
 v_add_f32 v149, v154, v155
 v_cvt_pk_bf16_f32 v212, v154, v155
 v_mfma_f32_16x16x32_bf16 a[124:127], a[220:223], v[204:207], a[124:127]
 ds_read_b128 a[240:243], v12 offset:24576
 s_waitcnt lgkmcnt(5)
 v_mfma_f32_16x16x32_bf16 a[128:131], a[224:227], v[192:195], a[128:131]
 v_exp_f32 v157, v171
 v_mfma_f32_16x16x32_bf16 a[132:135], a[224:227], v[196:199], a[132:135]
 ds_read_b128 a[244:247], v13 offset:24576
 v_add_f32 v149, v149, v156
 v_mfma_f32_16x16x32_bf16 a[136:139], a[224:227], v[200:203], a[136:139]
 v_exp_f32 v152, v172
 v_mfma_f32_16x16x32_bf16 a[140:143], a[224:227], v[204:207], a[140:143]
 buffer_load_dwordx4 v2, s[28:31], s76 offen offset:1024 nt lds
 v_mfma_f32_16x16x32_bf16 a[144:147], a[228:231], v[192:195], a[144:147]
 ds_read_b128 a[248:251], v12 offset:24704
 v_add_f32 v149, v149, v157
 v_mfma_f32_16x16x32_bf16 a[148:151], a[228:231], v[196:199], a[148:151]
 v_exp_f32 v153, v173
 v_mfma_f32_16x16x32_bf16 a[152:155], a[228:231], v[200:203], a[152:155]
 v_cvt_pk_bf16_f32 v213, v156, v157
 ds_read_b128 a[252:255], v13 offset:24704
 v_mfma_f32_16x16x32_bf16 a[156:159], a[228:231], v[204:207], a[156:159]
 ds_read_b128 a[192:195], v12 offset:24832
 s_waitcnt lgkmcnt(5)
 v_mfma_f32_16x16x32_bf16 a[160:163], a[232:235], v[192:195], a[160:163]
 v_exp_f32 v154, v174
 v_mfma_f32_16x16x32_bf16 a[164:167], a[232:235], v[196:199], a[164:167]
 v_add_f32 v149, v149, v152
 ds_read_b128 a[196:199], v13 offset:24832
 v_mfma_f32_16x16x32_bf16 a[168:171], a[232:235], v[200:203], a[168:171]
 v_add_f32 v149, v149, v153
 v_cvt_pk_bf16_f32 v214, v152, v153
 v_mfma_f32_16x16x32_bf16 a[172:175], a[232:235], v[204:207], a[172:175]
 v_exp_f32 v155, v175
 v_mfma_f32_16x16x32_bf16 a[176:179], a[236:239], v[192:195], a[176:179]
 v_add_f32 v149, v149, v154
 v_add_f32 v149, v149, v155
 v_mfma_f32_16x16x32_bf16 a[180:183], a[236:239], v[196:199], a[180:183]
 v_exp_f32 v156, v176
 v_mfma_f32_16x16x32_bf16 a[184:187], a[236:239], v[200:203], a[184:187]
 v_cvt_pk_bf16_f32 v215, v154, v155
 v_add_f32 v146, v146, v150
 v_mfma_f32_16x16x32_bf16 a[188:191], a[236:239], v[204:207], a[188:191]
 v_add_f32 v147, v147, v151
 s_waitcnt lgkmcnt(3)
 v_mfma_f32_16x16x32_bf16 v[224:227], a[240:243], v[32:35], v[128:131]
 v_exp_f32 v157, v177
 v_mfma_f32_16x16x32_bf16 v[224:227], a[244:247], v[48:51], v[224:227]
 ds_read_b128 a[200:203], v12 offset:30720
 v_add_f32 v150, v156, v157
 v_mfma_f32_16x16x32_bf16 v[224:227], a[248:251], v[64:67], v[224:227]
 ds_read_b128 a[204:207], v13 offset:30720
 s_waitcnt lgkmcnt(2)
 v_mfma_f32_16x16x32_bf16 v[224:227], a[252:255], v[80:83], v[224:227]
 buffer_load_dwordx4 v3, s[28:31], s76 offen offset:2048 nt lds
 v_mfma_f32_16x16x32_bf16 v[224:227], a[192:195], v[96:99], v[224:227]
 v_exp_f32 v152, v178
 v_mfma_f32_16x16x32_bf16 v[224:227], a[196:199], v[112:115], v[224:227]
 v_cvt_pk_bf16_f32 v216, v156, v157
 ds_read_b128 a[208:211], v12 offset:30848
 v_mfma_f32_16x16x32_bf16 v[232:235], a[240:243], v[36:39], v[132:135]
 v_exp_f32 v153, v179
 v_mfma_f32_16x16x32_bf16 v[232:235], a[244:247], v[52:55], v[232:235]
 v_add_f32 v150, v150, v152
 v_add_f32 v150, v150, v153
 v_mfma_f32_16x16x32_bf16 v[232:235], a[248:251], v[68:71], v[232:235]
 v_exp_f32 v154, v180
 v_mfma_f32_16x16x32_bf16 v[232:235], a[252:255], v[84:87], v[232:235]
 ds_read_b128 a[212:215], v13 offset:30848
 v_cvt_pk_bf16_f32 v217, v152, v153
 v_mfma_f32_16x16x32_bf16 v[232:235], a[192:195], v[100:103], v[232:235]
 v_add_f32 v150, v150, v154
 v_mfma_f32_16x16x32_bf16 v[232:235], a[196:199], v[116:119], v[232:235]
 v_exp_f32 v155, v181
 v_mfma_f32_16x16x32_bf16 v[240:243], a[240:243], v[40:43], v[136:139]
 ds_read_b128 a[216:219], v12 offset:30976
 v_add_f32 v150, v150, v155
 v_mfma_f32_16x16x32_bf16 v[240:243], a[244:247], v[56:59], v[240:243]
 s_add_u32 m0, s80, 86016
 s_mov_b32 s76, 356352
 v_mfma_f32_16x16x32_bf16 v[240:243], a[248:251], v[72:75], v[240:243]
 v_exp_f32 v156, v182
 v_mfma_f32_16x16x32_bf16 v[240:243], a[252:255], v[88:91], v[240:243]
 ds_read_b128 a[220:223], v13 offset:30976
 v_cvt_pk_bf16_f32 v218, v154, v155
 v_mfma_f32_16x16x32_bf16 v[240:243], a[192:195], v[104:107], v[240:243]
 v_add_f32 v150, v150, v156
 v_mfma_f32_16x16x32_bf16 v[240:243], a[196:199], v[120:123], v[240:243]
 v_exp_f32 v157, v183
 v_mfma_f32_16x16x32_bf16 v[248:251], a[240:243], v[44:47], v[140:143]
 buffer_load_dwordx4 v4, s[32:35], s76 offen offset:0 nt lds
 v_mfma_f32_16x16x32_bf16 v[248:251], a[244:247], v[60:63], v[248:251]
 v_add_f32 v150, v150, v157
 v_cvt_pk_bf16_f32 v219, v156, v157
 v_mfma_f32_16x16x32_bf16 v[248:251], a[248:251], v[76:79], v[248:251]
 v_exp_f32 v152, v184
 v_mfma_f32_16x16x32_bf16 v[248:251], a[252:255], v[92:95], v[248:251]
 v_add_u32 v12, 36864, v12
 v_add_u32 v13, 36864, v13
 v_mfma_f32_16x16x32_bf16 v[248:251], a[192:195], v[108:111], v[248:251]
 v_max3_f32 v158, v148, v149, v150
 v_mfma_f32_16x16x32_bf16 v[248:251], a[196:199], v[124:127], v[248:251]
 s_waitcnt lgkmcnt(3)
 v_mfma_f32_16x16x32_bf16 v[228:231], a[200:203], v[32:35], v[128:131]
 v_exp_f32 v153, v185
 v_mfma_f32_16x16x32_bf16 v[228:231], a[204:207], v[48:51], v[228:231]
 v_exp_f32 v154, v186
 v_mfma_f32_16x16x32_bf16 v[228:231], a[208:211], v[64:67], v[228:231]
 v_add_f32 v151, v152, v153
 s_waitcnt lgkmcnt(0)
 v_mfma_f32_16x16x32_bf16 v[228:231], a[212:215], v[80:83], v[228:231]
 v_cvt_pk_bf16_f32 v220, v152, v153
 v_add_f32 v151, v151, v154
 v_mfma_f32_16x16x32_bf16 v[228:231], a[216:219], v[96:99], v[228:231]
 s_waitcnt vmcnt(7)
 s_barrier
 v_mfma_f32_16x16x32_bf16 v[228:231], a[220:223], v[112:115], v[228:231]
 v_exp_f32 v155, v187
 v_mfma_f32_16x16x32_bf16 v[236:239], a[200:203], v[36:39], v[132:135]
 ds_read_b64_tr_b16 a[224:225], v14 offset:24576
 v_add_f32 v151, v151, v155
 v_mfma_f32_16x16x32_bf16 v[236:239], a[204:207], v[52:55], v[236:239]
 v_exp_f32 v156, v188
 v_mfma_f32_16x16x32_bf16 v[236:239], a[208:211], v[68:71], v[236:239]
 ds_read_b64_tr_b16 a[226:227], v14 offset:30720
 v_cvt_pk_bf16_f32 v221, v154, v155
 v_mfma_f32_16x16x32_bf16 v[236:239], a[212:215], v[84:87], v[236:239]
 ds_read_b64_tr_b16 a[228:229], v15 offset:24576
 v_add_f32 v151, v151, v156
 v_mfma_f32_16x16x32_bf16 v[236:239], a[216:219], v[100:103], v[236:239]
 v_exp_f32 v157, v189
 v_mfma_f32_16x16x32_bf16 v[236:239], a[220:223], v[116:119], v[236:239]
 buffer_load_dwordx4 v5, s[32:35], s76 offen offset:1024 nt lds
 v_mfma_f32_16x16x32_bf16 v[244:247], a[200:203], v[40:43], v[136:139]
 ds_read_b64_tr_b16 a[230:231], v15 offset:30720
 v_add_f32 v151, v151, v157
 v_mfma_f32_16x16x32_bf16 v[244:247], a[204:207], v[56:59], v[244:247]
 v_exp_f32 v152, v190
 v_mfma_f32_16x16x32_bf16 v[244:247], a[208:211], v[72:75], v[244:247]
 ds_read_b64_tr_b16 a[232:233], v16 offset:24576
 v_cvt_pk_bf16_f32 v222, v156, v157
 v_mfma_f32_16x16x32_bf16 v[244:247], a[212:215], v[88:91], v[244:247]
 v_add_f32 v151, v151, v152
 v_mfma_f32_16x16x32_bf16 v[244:247], a[216:219], v[104:107], v[244:247]
 v_exp_f32 v153, v191
 v_mfma_f32_16x16x32_bf16 v[244:247], a[220:223], v[120:123], v[244:247]
 ds_read_b64_tr_b16 a[234:235], v16 offset:30720
 v_add_f32 v151, v151, v153
 v_mfma_f32_16x16x32_bf16 v[252:255], a[200:203], v[44:47], v[140:143]
 ds_read_b64_tr_b16 a[236:237], v17 offset:24576
 v_cvt_pk_bf16_f32 v223, v152, v153
 v_mfma_f32_16x16x32_bf16 v[252:255], a[204:207], v[60:63], v[252:255]
 v_mfma_f32_16x16x32_bf16 v[252:255], a[208:211], v[76:79], v[252:255]
 ds_read_b64_tr_b16 a[238:239], v17 offset:30720
 v_max_f32 v158, v158, v151
 v_mfma_f32_16x16x32_bf16 v[252:255], a[212:215], v[92:95], v[252:255]
 v_cmp_lt_f32 vcc, s72, v158
 v_mfma_f32_16x16x32_bf16 v[252:255], a[216:219], v[108:111], v[252:255]
 v_mfma_f32_16x16x32_bf16 v[252:255], a[220:223], v[124:127], v[252:255]
 s_cbranch_vccnz L_S_26
L_R_26:
 s_waitcnt lgkmcnt(4)
 v_mfma_f32_16x16x32_bf16 a[0:3], a[224:227], v[208:211], a[0:3]
 v_exp_f32 v152, v224
 v_mfma_f32_16x16x32_bf16 a[4:7], a[224:227], v[212:215], a[4:7]
 ds_read_b64_tr_b16 a[240:241], v14 offset:24704
 v_add_f32 v144, v144, v148
 v_mfma_f32_16x16x32_bf16 a[8:11], a[224:227], v[216:219], a[8:11]
 v_exp_f32 v153, v225
 v_mfma_f32_16x16x32_bf16 a[12:15], a[224:227], v[220:223], a[12:15]
 ds_read_b64_tr_b16 a[242:243], v14 offset:30848
 v_add_f32 v148, v152, v153
 v_mfma_f32_16x16x32_bf16 a[16:19], a[228:231], v[208:211], a[16:19]
 buffer_load_dwordx4 v6, s[32:35], s76 offen offset:2048 nt lds
 v_mfma_f32_16x16x32_bf16 a[20:23], a[228:231], v[212:215], a[20:23]
 v_exp_f32 v154, v226
 v_mfma_f32_16x16x32_bf16 a[24:27], a[228:231], v[216:219], a[24:27]
 ds_read_b64_tr_b16 a[244:245], v15 offset:24704
 ds_read_b64_tr_b16 a[246:247], v15 offset:30848
 v_mfma_f32_16x16x32_bf16 a[28:31], a[228:231], v[220:223], a[28:31]
 v_cvt_pk_bf16_f32 v192, v152, v153
 s_waitcnt lgkmcnt(4)
 v_mfma_f32_16x16x32_bf16 a[32:35], a[232:235], v[208:211], a[32:35]
 v_exp_f32 v155, v227
 v_mfma_f32_16x16x32_bf16 a[36:39], a[232:235], v[212:215], a[36:39]
 ds_read_b64_tr_b16 a[248:249], v16 offset:24704
 ds_read_b64_tr_b16 a[250:251], v16 offset:30848
 v_mfma_f32_16x16x32_bf16 a[40:43], a[232:235], v[216:219], a[40:43]
 v_add_f32 v148, v148, v154
 v_add_f32 v148, v148, v155
 v_mfma_f32_16x16x32_bf16 a[44:47], a[232:235], v[220:223], a[44:47]
 v_exp_f32 v156, v228
 v_mfma_f32_16x16x32_bf16 a[48:51], a[236:239], v[208:211], a[48:51]
 ds_read_b64_tr_b16 a[252:253], v17 offset:24704
 v_cvt_pk_bf16_f32 v193, v154, v155
 v_mfma_f32_16x16x32_bf16 a[52:55], a[236:239], v[212:215], a[52:55]
 ds_read_b64_tr_b16 a[254:255], v17 offset:30848
 v_add_f32 v148, v148, v156
 v_mfma_f32_16x16x32_bf16 a[56:59], a[236:239], v[216:219], a[56:59]
 v_exp_f32 v157, v229
 v_mfma_f32_16x16x32_bf16 a[60:63], a[236:239], v[220:223], a[60:63]
 v_add_f32 v148, v148, v157
 s_waitcnt lgkmcnt(4)
 v_mfma_f32_16x16x32_bf16 a[64:67], a[240:243], v[208:211], a[64:67]
 s_add_u32 m0, s80, 61440
 s_mov_b32 s76, 380928
 v_mfma_f32_16x16x32_bf16 a[68:71], a[240:243], v[212:215], a[68:71]
 v_exp_f32 v152, v230
 v_mfma_f32_16x16x32_bf16 a[72:75], a[240:243], v[216:219], a[72:75]
 ds_read_b64_tr_b16 a[192:193], v14 offset:24832
 ds_read_b64_tr_b16 a[194:195], v14 offset:30976
 v_mfma_f32_16x16x32_bf16 a[76:79], a[240:243], v[220:223], a[76:79]
 buffer_load_dwordx4 v1, s[28:31], s76 offen offset:0 nt lds
 v_mfma_f32_16x16x32_bf16 a[80:83], a[244:247], v[208:211], a[80:83]
 v_exp_f32 v153, v231
 v_mfma_f32_16x16x32_bf16 a[84:87], a[244:247], v[212:215], a[84:87]
 v_cvt_pk_bf16_f32 v194, v156, v157
 ds_read_b64_tr_b16 a[196:197], v15 offset:24832
 v_mfma_f32_16x16x32_bf16 a[88:91], a[244:247], v[216:219], a[88:91]
 v_exp_f32 v154, v232
 v_mfma_f32_16x16x32_bf16 a[92:95], a[244:247], v[220:223], a[92:95]
 ds_read_b64_tr_b16 a[198:199], v15 offset:30976
 s_waitcnt lgkmcnt(4)
 v_mfma_f32_16x16x32_bf16 a[96:99], a[248:251], v[208:211], a[96:99]
 v_add_f32 v148, v148, v152
 v_add_f32 v148, v148, v153
 v_mfma_f32_16x16x32_bf16 a[100:103], a[248:251], v[212:215], a[100:103]
 v_cvt_pk_bf16_f32 v195, v152, v153
 v_add_f32 v145, v145, v149
 v_mfma_f32_16x16x32_bf16 a[104:107], a[248:251], v[216:219], a[104:107]
 v_exp_f32 v155, v233
 v_mfma_f32_16x16x32_bf16 a[108:111], a[248:251], v[220:223], a[108:111]
 ds_read_b64_tr_b16 a[200:201], v16 offset:24832
 ds_read_b64_tr_b16 a[202:203], v16 offset:30976
 v_mfma_f32_16x16x32_bf16 a[112:115], a[252:255], v[208:211], a[112:115]
 v_exp_f32 v156, v234
 v_mfma_f32_16x16x32_bf16 a[116:119], a[252:255], v[212:215], a[116:119]
 ds_read_b64_tr_b16 a[204:205], v17 offset:24832
 ds_read_b64_tr_b16 a[206:207], v17 offset:30976
 v_mfma_f32_16x16x32_bf16 a[120:123], a[252:255], v[216:219], a[120:123]
 v_add_f32 v149, v154, v155
 v_cvt_pk_bf16_f32 v196, v154, v155
 v_mfma_f32_16x16x32_bf16 a[124:127], a[252:255], v[220:223], a[124:127]
 ds_read_b128 a[208:211], v12 offset:0
 s_waitcnt lgkmcnt(5)
 v_mfma_f32_16x16x32_bf16 a[128:131], a[192:195], v[208:211], a[128:131]
 v_exp_f32 v157, v235
 v_mfma_f32_16x16x32_bf16 a[132:135], a[192:195], v[212:215], a[132:135]
 ds_read_b128 a[212:215], v13 offset:0
 v_add_f32 v149, v149, v156
 v_mfma_f32_16x16x32_bf16 a[136:139], a[192:195], v[216:219], a[136:139]
 v_exp_f32 v152, v236
 v_mfma_f32_16x16x32_bf16 a[140:143], a[192:195], v[220:223], a[140:143]
 buffer_load_dwordx4 v2, s[28:31], s76 offen offset:1024 nt lds
 v_mfma_f32_16x16x32_bf16 a[144:147], a[196:199], v[208:211], a[144:147]
 ds_read_b128 a[216:219], v12 offset:128
 v_add_f32 v149, v149, v157
 v_mfma_f32_16x16x32_bf16 a[148:151], a[196:199], v[212:215], a[148:151]
 v_exp_f32 v153, v237
 v_mfma_f32_16x16x32_bf16 a[152:155], a[196:199], v[216:219], a[152:155]
 v_cvt_pk_bf16_f32 v197, v156, v157
 ds_read_b128 a[220:223], v13 offset:128
 v_mfma_f32_16x16x32_bf16 a[156:159], a[196:199], v[220:223], a[156:159]
 ds_read_b128 a[224:227], v12 offset:256
 s_waitcnt lgkmcnt(5)
 v_mfma_f32_16x16x32_bf16 a[160:163], a[200:203], v[208:211], a[160:163]
 v_exp_f32 v154, v238
 v_mfma_f32_16x16x32_bf16 a[164:167], a[200:203], v[212:215], a[164:167]
 v_add_f32 v149, v149, v152
 ds_read_b128 a[228:231], v13 offset:256
 v_mfma_f32_16x16x32_bf16 a[168:171], a[200:203], v[216:219], a[168:171]
 v_add_f32 v149, v149, v153
 v_cvt_pk_bf16_f32 v198, v152, v153
 v_mfma_f32_16x16x32_bf16 a[172:175], a[200:203], v[220:223], a[172:175]
 v_exp_f32 v155, v239
 v_mfma_f32_16x16x32_bf16 a[176:179], a[204:207], v[208:211], a[176:179]
 v_add_f32 v149, v149, v154
 v_add_f32 v149, v149, v155
 v_mfma_f32_16x16x32_bf16 a[180:183], a[204:207], v[212:215], a[180:183]
 v_exp_f32 v156, v240
 v_mfma_f32_16x16x32_bf16 a[184:187], a[204:207], v[216:219], a[184:187]
 v_cvt_pk_bf16_f32 v199, v154, v155
 v_add_f32 v146, v146, v150
 v_mfma_f32_16x16x32_bf16 a[188:191], a[204:207], v[220:223], a[188:191]
 v_add_f32 v147, v147, v151
 s_waitcnt lgkmcnt(3)
 v_mfma_f32_16x16x32_bf16 v[160:163], a[208:211], v[32:35], v[128:131]
 v_exp_f32 v157, v241
 v_mfma_f32_16x16x32_bf16 v[160:163], a[212:215], v[48:51], v[160:163]
 ds_read_b128 a[232:235], v12 offset:6144
 v_add_f32 v150, v156, v157
 v_mfma_f32_16x16x32_bf16 v[160:163], a[216:219], v[64:67], v[160:163]
 ds_read_b128 a[236:239], v13 offset:6144
 s_waitcnt lgkmcnt(2)
 v_mfma_f32_16x16x32_bf16 v[160:163], a[220:223], v[80:83], v[160:163]
 buffer_load_dwordx4 v3, s[28:31], s76 offen offset:2048 nt lds
 v_mfma_f32_16x16x32_bf16 v[160:163], a[224:227], v[96:99], v[160:163]
 v_exp_f32 v152, v242
 v_mfma_f32_16x16x32_bf16 v[160:163], a[228:231], v[112:115], v[160:163]
 v_cvt_pk_bf16_f32 v200, v156, v157
 ds_read_b128 a[240:243], v12 offset:6272
 v_mfma_f32_16x16x32_bf16 v[168:171], a[208:211], v[36:39], v[132:135]
 v_exp_f32 v153, v243
 v_mfma_f32_16x16x32_bf16 v[168:171], a[212:215], v[52:55], v[168:171]
 v_add_f32 v150, v150, v152
 v_add_f32 v150, v150, v153
 v_mfma_f32_16x16x32_bf16 v[168:171], a[216:219], v[68:71], v[168:171]
 v_exp_f32 v154, v244
 v_mfma_f32_16x16x32_bf16 v[168:171], a[220:223], v[84:87], v[168:171]
 ds_read_b128 a[244:247], v13 offset:6272
 v_cvt_pk_bf16_f32 v201, v152, v153
 v_mfma_f32_16x16x32_bf16 v[168:171], a[224:227], v[100:103], v[168:171]
 v_add_f32 v150, v150, v154
 v_subrev_u32 v14, 49152, v14
 v_mfma_f32_16x16x32_bf16 v[168:171], a[228:231], v[116:119], v[168:171]
 v_exp_f32 v155, v245
 v_mfma_f32_16x16x32_bf16 v[176:179], a[208:211], v[40:43], v[136:139]
 ds_read_b128 a[248:251], v12 offset:6400
 v_add_f32 v150, v150, v155
 v_mfma_f32_16x16x32_bf16 v[176:179], a[212:215], v[56:59], v[176:179]
 s_add_u32 m0, s80, 98304
 s_mov_b32 s76, 368640
 v_mfma_f32_16x16x32_bf16 v[176:179], a[216:219], v[72:75], v[176:179]
 v_exp_f32 v156, v246
 v_mfma_f32_16x16x32_bf16 v[176:179], a[220:223], v[88:91], v[176:179]
 ds_read_b128 a[252:255], v13 offset:6400
 v_cvt_pk_bf16_f32 v202, v154, v155
 v_mfma_f32_16x16x32_bf16 v[176:179], a[224:227], v[104:107], v[176:179]
 v_add_f32 v150, v150, v156
 v_subrev_u32 v15, 49152, v15
 v_mfma_f32_16x16x32_bf16 v[176:179], a[228:231], v[120:123], v[176:179]
 v_exp_f32 v157, v247
 v_mfma_f32_16x16x32_bf16 v[184:187], a[208:211], v[44:47], v[140:143]
 buffer_load_dwordx4 v4, s[32:35], s76 offen offset:0 nt lds
 v_mfma_f32_16x16x32_bf16 v[184:187], a[212:215], v[60:63], v[184:187]
 v_add_f32 v150, v150, v157
 v_cvt_pk_bf16_f32 v203, v156, v157
 v_mfma_f32_16x16x32_bf16 v[184:187], a[216:219], v[76:79], v[184:187]
 v_exp_f32 v152, v248
 v_mfma_f32_16x16x32_bf16 v[184:187], a[220:223], v[92:95], v[184:187]
 v_subrev_u32 v16, 49152, v16
 v_subrev_u32 v17, 49152, v17
 v_mfma_f32_16x16x32_bf16 v[184:187], a[224:227], v[108:111], v[184:187]
 v_max3_f32 v158, v148, v149, v150
 v_mfma_f32_16x16x32_bf16 v[184:187], a[228:231], v[124:127], v[184:187]
 s_waitcnt lgkmcnt(3)
 v_mfma_f32_16x16x32_bf16 v[164:167], a[232:235], v[32:35], v[128:131]
 v_exp_f32 v153, v249
 v_mfma_f32_16x16x32_bf16 v[164:167], a[236:239], v[48:51], v[164:167]
 v_exp_f32 v154, v250
 v_mfma_f32_16x16x32_bf16 v[164:167], a[240:243], v[64:67], v[164:167]
 v_add_f32 v151, v152, v153
 s_waitcnt lgkmcnt(0)
 v_mfma_f32_16x16x32_bf16 v[164:167], a[244:247], v[80:83], v[164:167]
 v_cvt_pk_bf16_f32 v204, v152, v153
 v_add_f32 v151, v151, v154
 v_mfma_f32_16x16x32_bf16 v[164:167], a[248:251], v[96:99], v[164:167]
 s_waitcnt vmcnt(7)
 s_barrier
 v_mfma_f32_16x16x32_bf16 v[164:167], a[252:255], v[112:115], v[164:167]
 v_exp_f32 v155, v251
 v_mfma_f32_16x16x32_bf16 v[172:175], a[232:235], v[36:39], v[132:135]
 ds_read_b64_tr_b16 a[192:193], v14 offset:0
 v_add_f32 v151, v151, v155
 v_mfma_f32_16x16x32_bf16 v[172:175], a[236:239], v[52:55], v[172:175]
 buffer_load_dwordx4 v5, s[32:35], s76 offen offset:1024 nt lds
 v_mfma_f32_16x16x32_bf16 v[172:175], a[240:243], v[68:71], v[172:175]
 v_exp_f32 v156, v252
 v_mfma_f32_16x16x32_bf16 v[172:175], a[244:247], v[84:87], v[172:175]
 ds_read_b64_tr_b16 a[194:195], v14 offset:6144
 v_cvt_pk_bf16_f32 v205, v154, v155
 v_mfma_f32_16x16x32_bf16 v[172:175], a[248:251], v[100:103], v[172:175]
 v_exp_f32 v157, v253
 v_mfma_f32_16x16x32_bf16 v[172:175], a[252:255], v[116:119], v[172:175]
 ds_read_b64_tr_b16 a[196:197], v15 offset:0
 ds_read_b64_tr_b16 a[198:199], v15 offset:6144
 v_mfma_f32_16x16x32_bf16 v[180:183], a[232:235], v[40:43], v[136:139]
 v_add_f32 v151, v151, v156
 v_add_f32 v151, v151, v157
 v_mfma_f32_16x16x32_bf16 v[180:183], a[236:239], v[56:59], v[180:183]
 v_exp_f32 v152, v254
 v_mfma_f32_16x16x32_bf16 v[180:183], a[240:243], v[72:75], v[180:183]
 ds_read_b64_tr_b16 a[200:201], v16 offset:0
 v_cvt_pk_bf16_f32 v206, v156, v157
 v_mfma_f32_16x16x32_bf16 v[180:183], a[244:247], v[88:91], v[180:183]
 v_add_f32 v151, v151, v152
 v_mfma_f32_16x16x32_bf16 v[180:183], a[248:251], v[104:107], v[180:183]
 v_exp_f32 v153, v255
 v_mfma_f32_16x16x32_bf16 v[180:183], a[252:255], v[120:123], v[180:183]
 ds_read_b64_tr_b16 a[202:203], v16 offset:6144
 v_add_f32 v151, v151, v153
 v_mfma_f32_16x16x32_bf16 v[188:191], a[232:235], v[44:47], v[140:143]
 buffer_load_dwordx4 v6, s[32:35], s76 offen offset:2048 nt lds
 v_mfma_f32_16x16x32_bf16 v[188:191], a[236:239], v[60:63], v[188:191]
 ds_read_b64_tr_b16 a[204:205], v17 offset:0
 v_cvt_pk_bf16_f32 v207, v152, v153
 v_mfma_f32_16x16x32_bf16 v[188:191], a[240:243], v[76:79], v[188:191]
 ds_read_b64_tr_b16 a[206:207], v17 offset:6144
 v_max_f32 v158, v158, v151
 v_mfma_f32_16x16x32_bf16 v[188:191], a[244:247], v[92:95], v[188:191]
 v_cmp_lt_f32 vcc, s72, v158
 v_mfma_f32_16x16x32_bf16 v[188:191], a[248:251], v[108:111], v[188:191]
 v_mfma_f32_16x16x32_bf16 v[188:191], a[252:255], v[124:127], v[188:191]
 s_cbranch_vccnz L_S_27
L_R_27:
 s_waitcnt lgkmcnt(4)
 v_mfma_f32_16x16x32_bf16 a[0:3], a[192:195], v[192:195], a[0:3]
 v_exp_f32 v152, v160
 v_mfma_f32_16x16x32_bf16 a[4:7], a[192:195], v[196:199], a[4:7]
 ds_read_b64_tr_b16 a[208:209], v14 offset:128
 v_add_f32 v144, v144, v148
 v_mfma_f32_16x16x32_bf16 a[8:11], a[192:195], v[200:203], a[8:11]
 v_exp_f32 v153, v161
 v_mfma_f32_16x16x32_bf16 a[12:15], a[192:195], v[204:207], a[12:15]
 ds_read_b64_tr_b16 a[210:211], v14 offset:6272
 v_add_f32 v148, v152, v153
 v_mfma_f32_16x16x32_bf16 a[16:19], a[196:199], v[192:195], a[16:19]
 s_add_u32 m0, s80, 110592
 s_mov_b32 s76, 380928
 v_mfma_f32_16x16x32_bf16 a[20:23], a[196:199], v[196:199], a[20:23]
 v_exp_f32 v154, v162
 v_mfma_f32_16x16x32_bf16 a[24:27], a[196:199], v[200:203], a[24:27]
 ds_read_b64_tr_b16 a[212:213], v15 offset:128
 ds_read_b64_tr_b16 a[214:215], v15 offset:6272
 v_mfma_f32_16x16x32_bf16 a[28:31], a[196:199], v[204:207], a[28:31]
 v_cvt_pk_bf16_f32 v208, v152, v153
 s_waitcnt lgkmcnt(4)
 v_mfma_f32_16x16x32_bf16 a[32:35], a[200:203], v[192:195], a[32:35]
 buffer_load_dwordx4 v4, s[32:35], s76 offen offset:0 nt lds
 v_mfma_f32_16x16x32_bf16 a[36:39], a[200:203], v[196:199], a[36:39]
 v_exp_f32 v155, v163
 v_mfma_f32_16x16x32_bf16 a[40:43], a[200:203], v[200:203], a[40:43]
 ds_read_b64_tr_b16 a[216:217], v16 offset:128
 ds_read_b64_tr_b16 a[218:219], v16 offset:6272
 v_mfma_f32_16x16x32_bf16 a[44:47], a[200:203], v[204:207], a[44:47]
 v_add_f32 v148, v148, v154
 v_add_f32 v148, v148, v155
 v_mfma_f32_16x16x32_bf16 a[48:51], a[204:207], v[192:195], a[48:51]
 v_exp_f32 v156, v164
 v_mfma_f32_16x16x32_bf16 a[52:55], a[204:207], v[196:199], a[52:55]
 ds_read_b64_tr_b16 a[220:221], v17 offset:128
 v_cvt_pk_bf16_f32 v209, v154, v155
 v_mfma_f32_16x16x32_bf16 a[56:59], a[204:207], v[200:203], a[56:59]
 v_exp_f32 v157, v165
 v_mfma_f32_16x16x32_bf16 a[60:63], a[204:207], v[204:207], a[60:63]
 ds_read_b64_tr_b16 a[222:223], v17 offset:6272
 s_waitcnt lgkmcnt(4)
 v_mfma_f32_16x16x32_bf16 a[64:67], a[208:211], v[192:195], a[64:67]
 v_add_f32 v148, v148, v156
 ds_read_b64_tr_b16 a[224:225], v14 offset:256
 v_mfma_f32_16x16x32_bf16 a[68:71], a[208:211], v[196:199], a[68:71]
 v_exp_f32 v152, v166
 v_mfma_f32_16x16x32_bf16 a[72:75], a[208:211], v[200:203], a[72:75]
 ds_read_b64_tr_b16 a[226:227], v14 offset:6400
 v_add_f32 v148, v148, v157
 v_mfma_f32_16x16x32_bf16 a[76:79], a[208:211], v[204:207], a[76:79]
 buffer_load_dwordx4 v5, s[32:35], s76 offen offset:1024 nt lds
 v_mfma_f32_16x16x32_bf16 a[80:83], a[212:215], v[192:195], a[80:83]
 v_exp_f32 v153, v167
 v_mfma_f32_16x16x32_bf16 a[84:87], a[212:215], v[196:199], a[84:87]
 v_cvt_pk_bf16_f32 v210, v156, v157
 ds_read_b64_tr_b16 a[228:229], v15 offset:256
 v_mfma_f32_16x16x32_bf16 a[88:91], a[212:215], v[200:203], a[88:91]
 v_exp_f32 v154, v168
 v_mfma_f32_16x16x32_bf16 a[92:95], a[212:215], v[204:207], a[92:95]
 ds_read_b64_tr_b16 a[230:231], v15 offset:6400
 s_waitcnt lgkmcnt(4)
 v_mfma_f32_16x16x32_bf16 a[96:99], a[216:219], v[192:195], a[96:99]
 v_add_f32 v148, v148, v152
 v_add_f32 v148, v148, v153
 v_mfma_f32_16x16x32_bf16 a[100:103], a[216:219], v[196:199], a[100:103]
 v_cvt_pk_bf16_f32 v211, v152, v153
 v_add_f32 v145, v145, v149
 v_mfma_f32_16x16x32_bf16 a[104:107], a[216:219], v[200:203], a[104:107]
 v_exp_f32 v155, v169
 v_mfma_f32_16x16x32_bf16 a[108:111], a[216:219], v[204:207], a[108:111]
 ds_read_b64_tr_b16 a[232:233], v16 offset:256
 ds_read_b64_tr_b16 a[234:235], v16 offset:6400
 v_mfma_f32_16x16x32_bf16 a[112:115], a[220:223], v[192:195], a[112:115]
 v_exp_f32 v156, v170
 v_mfma_f32_16x16x32_bf16 a[116:119], a[220:223], v[196:199], a[116:119]
 ds_read_b64_tr_b16 a[236:237], v17 offset:256
 ds_read_b64_tr_b16 a[238:239], v17 offset:6400
 v_mfma_f32_16x16x32_bf16 a[120:123], a[220:223], v[200:203], a[120:123]
 buffer_load_dwordx4 v6, s[32:35], s76 offen offset:2048 nt lds
 v_mfma_f32_16x16x32_bf16 a[124:127], a[220:223], v[204:207], a[124:127]
 v_add_f32 v149, v154, v155
 s_waitcnt lgkmcnt(4)
 v_mfma_f32_16x16x32_bf16 a[128:131], a[224:227], v[192:195], a[128:131]
 v_cvt_pk_bf16_f32 v212, v154, v155
 v_exp_f32 v157, v171
 v_mfma_f32_16x16x32_bf16 a[132:135], a[224:227], v[196:199], a[132:135]
 ds_read_b128 a[240:243], v12 offset:12288
 ds_read_b128 a[244:247], v13 offset:12288
 v_mfma_f32_16x16x32_bf16 a[136:139], a[224:227], v[200:203], a[136:139]
 v_add_f32 v149, v149, v156
 ds_read_b128 a[248:251], v12 offset:12416
 v_mfma_f32_16x16x32_bf16 a[140:143], a[224:227], v[204:207], a[140:143]
 v_exp_f32 v152, v172
 v_mfma_f32_16x16x32_bf16 a[144:147], a[228:231], v[192:195], a[144:147]
 v_exp_f32 v153, v173
 v_mfma_f32_16x16x32_bf16 a[148:151], a[228:231], v[196:199], a[148:151]
 v_add_f32 v149, v149, v157
 v_cvt_pk_bf16_f32 v213, v156, v157
 v_mfma_f32_16x16x32_bf16 a[152:155], a[228:231], v[200:203], a[152:155]
 ds_read_b128 a[252:255], v13 offset:12416
 ds_read_b128 a[192:195], v12 offset:12544
 v_mfma_f32_16x16x32_bf16 a[156:159], a[228:231], v[204:207], a[156:159]
 v_add_f32 v149, v149, v152
 s_waitcnt lgkmcnt(5)
 v_mfma_f32_16x16x32_bf16 a[160:163], a[232:235], v[192:195], a[160:163]
 v_exp_f32 v154, v174
 v_mfma_f32_16x16x32_bf16 a[164:167], a[232:235], v[196:199], a[164:167]
 s_add_u32 m0, s80, 0
 s_add_u32 s76, s90, s84
 v_mfma_f32_16x16x32_bf16 a[168:171], a[232:235], v[200:203], a[168:171]
 ds_read_b128 a[196:199], v13 offset:12544
 v_add_f32 v149, v149, v153
 v_mfma_f32_16x16x32_bf16 a[172:175], a[232:235], v[204:207], a[172:175]
 v_cvt_pk_bf16_f32 v214, v152, v153
 v_exp_f32 v155, v175
 v_mfma_f32_16x16x32_bf16 a[176:179], a[236:239], v[192:195], a[176:179]
 buffer_load_dwordx4 v7, s[40:43], s76 offen offset:0 lds
 v_mfma_f32_16x16x32_bf16 a[180:183], a[236:239], v[196:199], a[180:183]
 v_add_f32 v149, v149, v154
 v_add_f32 v149, v149, v155
 v_mfma_f32_16x16x32_bf16 a[184:187], a[236:239], v[200:203], a[184:187]
 v_exp_f32 v156, v176
 v_mfma_f32_16x16x32_bf16 a[188:191], a[236:239], v[204:207], a[188:191]
 v_cvt_pk_bf16_f32 v215, v154, v155
 s_waitcnt lgkmcnt(3)
 v_mfma_f32_16x16x32_bf16 v[224:227], a[240:243], v[32:35], v[128:131]
 buffer_load_dwordx4 v8, s[40:43], s76 offen offset:1024 lds
 v_mfma_f32_16x16x32_bf16 v[224:227], a[244:247], v[48:51], v[224:227]
 v_exp_f32 v157, v177
 v_add_f32 v146, v146, v150
 v_mfma_f32_16x16x32_bf16 v[224:227], a[248:251], v[64:67], v[224:227]
 ds_read_b128 a[200:203], v12 offset:18432
 s_waitcnt lgkmcnt(1)
 v_mfma_f32_16x16x32_bf16 v[224:227], a[252:255], v[80:83], v[224:227]
 v_exp_f32 v152, v178
 v_mfma_f32_16x16x32_bf16 v[224:227], a[192:195], v[96:99], v[224:227]
 ds_read_b128 a[204:207], v13 offset:18432
 v_add_f32 v150, v156, v157
 v_mfma_f32_16x16x32_bf16 v[224:227], a[196:199], v[112:115], v[224:227]
 buffer_load_dwordx4 v9, s[40:43], s76 offen offset:2048 lds
 v_mfma_f32_16x16x32_bf16 v[232:235], a[240:243], v[36:39], v[132:135]
 v_cvt_pk_bf16_f32 v216, v156, v157
 ds_read_b128 a[208:211], v12 offset:18560
 v_mfma_f32_16x16x32_bf16 v[232:235], a[244:247], v[52:55], v[232:235]
 v_exp_f32 v153, v179
 v_mfma_f32_16x16x32_bf16 v[232:235], a[248:251], v[68:71], v[232:235]
 s_add_u32 m0, s80, 12288
 s_add_u32 s76, s90, s84
 s_add_u32 s76, s76, 128
 v_mfma_f32_16x16x32_bf16 v[232:235], a[252:255], v[84:87], v[232:235]
 v_exp_f32 v154, v180
 v_mfma_f32_16x16x32_bf16 v[232:235], a[192:195], v[100:103], v[232:235]
 v_add_f32 v150, v150, v152
 ds_read_b128 a[212:215], v13 offset:18560
 v_mfma_f32_16x16x32_bf16 v[232:235], a[196:199], v[116:119], v[232:235]
 buffer_load_dwordx4 v7, s[40:43], s76 offen offset:0 lds
 v_mfma_f32_16x16x32_bf16 v[240:243], a[240:243], v[40:43], v[136:139]
 v_exp_f32 v155, v181
 v_mfma_f32_16x16x32_bf16 v[240:243], a[244:247], v[56:59], v[240:243]
 v_add_f32 v150, v150, v153
 v_cvt_pk_bf16_f32 v217, v152, v153
 v_mfma_f32_16x16x32_bf16 v[240:243], a[248:251], v[72:75], v[240:243]
 ds_read_b128 a[216:219], v12 offset:18688
 v_add_f32 v150, v150, v154
 v_mfma_f32_16x16x32_bf16 v[240:243], a[252:255], v[88:91], v[240:243]
 v_exp_f32 v156, v182
 v_mfma_f32_16x16x32_bf16 v[240:243], a[192:195], v[104:107], v[240:243]
 ds_read_b128 a[220:223], v13 offset:18688
 buffer_load_dwordx4 v8, s[40:43], s76 offen offset:1024 lds
 v_mfma_f32_16x16x32_bf16 v[240:243], a[196:199], v[120:123], v[240:243]
 v_add_f32 v150, v150, v155
 v_cvt_pk_bf16_f32 v218, v154, v155
 v_mfma_f32_16x16x32_bf16 v[248:251], a[240:243], v[44:47], v[140:143]
 v_exp_f32 v157, v183
 v_mfma_f32_16x16x32_bf16 v[248:251], a[244:247], v[60:63], v[248:251]
 buffer_load_dwordx4 v9, s[40:43], s76 offen offset:2048 lds
 v_mfma_f32_16x16x32_bf16 v[248:251], a[248:251], v[76:79], v[248:251]
 v_add_f32 v150, v150, v156
 v_add_f32 v150, v150, v157
 v_mfma_f32_16x16x32_bf16 v[248:251], a[252:255], v[92:95], v[248:251]
 v_exp_f32 v152, v184
 v_mfma_f32_16x16x32_bf16 v[248:251], a[192:195], v[108:111], v[248:251]
 s_add_u32 m0, s80, 122880
 s_add_u32 s76, s90, s85
 v_mfma_f32_16x16x32_bf16 v[248:251], a[196:199], v[124:127], v[248:251]
 v_cvt_pk_bf16_f32 v219, v156, v157
 s_waitcnt lgkmcnt(3)
 v_mfma_f32_16x16x32_bf16 v[228:231], a[200:203], v[32:35], v[128:131]
 v_exp_f32 v153, v185
 v_add_f32 v147, v147, v151
 v_mfma_f32_16x16x32_bf16 v[228:231], a[204:207], v[48:51], v[228:231]
 buffer_load_dwordx4 v24, s[40:43], s76 offen offset:0 lds
 v_mfma_f32_16x16x32_bf16 v[228:231], a[208:211], v[64:67], v[228:231]
 v_exp_f32 v154, v186
 s_waitcnt lgkmcnt(0)
 v_mfma_f32_16x16x32_bf16 v[228:231], a[212:215], v[80:83], v[228:231]
 v_add_f32 v151, v152, v153
 v_cvt_pk_bf16_f32 v220, v152, v153
 v_mfma_f32_16x16x32_bf16 v[228:231], a[216:219], v[96:99], v[228:231]
 s_waitcnt vmcnt(13)
 s_barrier
 v_mfma_f32_16x16x32_bf16 v[228:231], a[220:223], v[112:115], v[228:231]
 v_exp_f32 v155, v187
 v_mfma_f32_16x16x32_bf16 v[236:239], a[200:203], v[36:39], v[132:135]
 ds_read_b64_tr_b16 a[224:225], v14 offset:12288
 v_add_f32 v151, v151, v154
 v_mfma_f32_16x16x32_bf16 v[236:239], a[204:207], v[52:55], v[236:239]
 buffer_load_dwordx4 v25, s[40:43], s76 offen offset:1024 lds
 v_mfma_f32_16x16x32_bf16 v[236:239], a[208:211], v[68:71], v[236:239]
 v_exp_f32 v156, v188
 v_mfma_f32_16x16x32_bf16 v[236:239], a[212:215], v[84:87], v[236:239]
 ds_read_b64_tr_b16 a[226:227], v14 offset:18432
 v_add_f32 v151, v151, v155
 v_mfma_f32_16x16x32_bf16 v[236:239], a[216:219], v[100:103], v[236:239]
 v_cvt_pk_bf16_f32 v221, v154, v155
 ds_read_b64_tr_b16 a[228:229], v15 offset:12288
 v_mfma_f32_16x16x32_bf16 v[236:239], a[220:223], v[116:119], v[236:239]
 v_exp_f32 v157, v189
 v_mfma_f32_16x16x32_bf16 v[244:247], a[200:203], v[40:43], v[136:139]
 buffer_load_dwordx4 v26, s[40:43], s76 offen offset:2048 lds
 v_mfma_f32_16x16x32_bf16 v[244:247], a[204:207], v[56:59], v[244:247]
 ds_read_b64_tr_b16 a[230:231], v15 offset:18432
 v_add_f32 v151, v151, v156
 v_mfma_f32_16x16x32_bf16 v[244:247], a[208:211], v[72:75], v[244:247]
 s_add_u32 m0, s80, 24576
 s_add_u32 s76, s90, s84
 s_add_u32 s76, s76, 122880
 v_exp_f32 v152, v190
 v_mfma_f32_16x16x32_bf16 v[244:247], a[212:215], v[88:91], v[244:247]
 ds_read_b64_tr_b16 a[232:233], v16 offset:12288
 v_add_f32 v151, v151, v157
 v_mfma_f32_16x16x32_bf16 v[244:247], a[216:219], v[104:107], v[244:247]
 buffer_load_dwordx4 v7, s[40:43], s76 offen offset:0 lds
 v_mfma_f32_16x16x32_bf16 v[244:247], a[220:223], v[120:123], v[244:247]
 v_cvt_pk_bf16_f32 v222, v156, v157
 v_exp_f32 v153, v191
 v_mfma_f32_16x16x32_bf16 v[252:255], a[200:203], v[44:47], v[140:143]
 ds_read_b64_tr_b16 a[234:235], v16 offset:18432
 v_add_f32 v151, v151, v152
 v_mfma_f32_16x16x32_bf16 v[252:255], a[204:207], v[60:63], v[252:255]
 ds_read_b64_tr_b16 a[236:237], v17 offset:12288
 v_max3_f32 v158, v148, v149, v150
 v_mfma_f32_16x16x32_bf16 v[252:255], a[208:211], v[76:79], v[252:255]
 ds_read_b64_tr_b16 a[238:239], v17 offset:18432
 v_add_f32 v151, v151, v153
 v_mfma_f32_16x16x32_bf16 v[252:255], a[212:215], v[92:95], v[252:255]
 buffer_load_dwordx4 v8, s[40:43], s76 offen offset:1024 lds
 v_mfma_f32_16x16x32_bf16 v[252:255], a[216:219], v[108:111], v[252:255]
 v_cvt_pk_bf16_f32 v223, v152, v153
 v_max_f32 v158, v158, v151
 v_mfma_f32_16x16x32_bf16 v[252:255], a[220:223], v[124:127], v[252:255]
 v_cmp_lt_f32 vcc, s72, v158
 s_cbranch_vccnz L_S_28
L_R_28:
 s_waitcnt lgkmcnt(4)
 v_mfma_f32_16x16x32_bf16 a[0:3], a[224:227], v[208:211], a[0:3]
 v_exp_f32 v152, v224
 v_mfma_f32_16x16x32_bf16 a[4:7], a[224:227], v[212:215], a[4:7]
 ds_read_b64_tr_b16 a[240:241], v14 offset:12416
 v_add_f32 v144, v144, v148
 v_mfma_f32_16x16x32_bf16 a[8:11], a[224:227], v[216:219], a[8:11]
 buffer_load_dwordx4 v9, s[40:43], s76 offen offset:2048 lds
 v_mfma_f32_16x16x32_bf16 a[12:15], a[224:227], v[220:223], a[12:15]
 v_exp_f32 v153, v225
 v_mfma_f32_16x16x32_bf16 a[16:19], a[228:231], v[208:211], a[16:19]
 ds_read_b64_tr_b16 a[242:243], v14 offset:18560
 ds_read_b64_tr_b16 a[244:245], v15 offset:12416
 v_mfma_f32_16x16x32_bf16 a[20:23], a[228:231], v[212:215], a[20:23]
 s_add_u32 m0, s80, 135168
 s_add_u32 s76, s90, s84
 s_add_u32 s76, s76, 123008
 v_mfma_f32_16x16x32_bf16 a[24:27], a[228:231], v[216:219], a[24:27]
 v_exp_f32 v154, v226
 v_mfma_f32_16x16x32_bf16 a[28:31], a[228:231], v[220:223], a[28:31]
 ds_read_b64_tr_b16 a[246:247], v15 offset:18560
 s_waitcnt lgkmcnt(4)
 v_mfma_f32_16x16x32_bf16 a[32:35], a[232:235], v[208:211], a[32:35]
 buffer_load_dwordx4 v7, s[40:43], s76 offen offset:0 lds
 v_mfma_f32_16x16x32_bf16 a[36:39], a[232:235], v[212:215], a[36:39]
 v_add_f32 v148, v152, v153
 v_cvt_pk_bf16_f32 v192, v152, v153
 v_exp_f32 v155, v227
 v_mfma_f32_16x16x32_bf16 a[40:43], a[232:235], v[216:219], a[40:43]
 ds_read_b64_tr_b16 a[248:249], v16 offset:12416
 ds_read_b64_tr_b16 a[250:251], v16 offset:18560
 v_mfma_f32_16x16x32_bf16 a[44:47], a[232:235], v[220:223], a[44:47]
 v_add_f32 v148, v148, v154
 v_add_f32 v148, v148, v155
 v_mfma_f32_16x16x32_bf16 a[48:51], a[236:239], v[208:211], a[48:51]
 v_exp_f32 v156, v228
 v_mfma_f32_16x16x32_bf16 a[52:55], a[236:239], v[212:215], a[52:55]
 buffer_load_dwordx4 v8, s[40:43], s76 offen offset:1024 lds
 v_mfma_f32_16x16x32_bf16 a[56:59], a[236:239], v[216:219], a[56:59]
 ds_read_b64_tr_b16 a[252:253], v17 offset:12416
 v_cvt_pk_bf16_f32 v193, v154, v155
 v_mfma_f32_16x16x32_bf16 a[60:63], a[236:239], v[220:223], a[60:63]
 v_exp_f32 v157, v229
 s_waitcnt lgkmcnt(3)
 v_mfma_f32_16x16x32_bf16 a[64:67], a[240:243], v[208:211], a[64:67]
 ds_read_b64_tr_b16 a[254:255], v17 offset:18560
 v_add_f32 v148, v148, v156
 v_mfma_f32_16x16x32_bf16 a[68:71], a[240:243], v[212:215], a[68:71]
 buffer_load_dwordx4 v9, s[40:43], s76 offen offset:2048 lds
 v_mfma_f32_16x16x32_bf16 a[72:75], a[240:243], v[216:219], a[72:75]
 v_exp_f32 v152, v230
 v_mfma_f32_16x16x32_bf16 a[76:79], a[240:243], v[220:223], a[76:79]
 ds_read_b64_tr_b16 a[192:193], v14 offset:12544
 ds_read_b64_tr_b16 a[194:195], v14 offset:18688
 v_mfma_f32_16x16x32_bf16 a[80:83], a[244:247], v[208:211], a[80:83]
 v_min_u32 v18, 59, v0
 v_lshlrev_b32 v18, 7, v18
 s_sub_u32 s69, s68, 122880
 s_cmp_lt_u32 s60, 4
 s_cselect_b32 s68, s68, s69
 v_exp_f32 v153, v231
 v_mfma_f32_16x16x32_bf16 a[84:87], a[244:247], v[212:215], a[84:87]
 v_add_f32 v148, v148, v157
 v_cvt_pk_bf16_f32 v194, v156, v157
 v_mfma_f32_16x16x32_bf16 a[88:91], a[244:247], v[216:219], a[88:91]
 ds_read_b64_tr_b16 a[196:197], v15 offset:12544
 ds_read_b64_tr_b16 a[198:199], v15 offset:18688
 v_mfma_f32_16x16x32_bf16 a[92:95], a[244:247], v[220:223], a[92:95]
 buffer_load_dword v19, v18, s[40:43], s68 offen
 v_exp_f32 v154, v232
 s_waitcnt lgkmcnt(4)
 v_mfma_f32_16x16x32_bf16 a[96:99], a[248:251], v[208:211], a[96:99]
 v_add_f32 v148, v148, v152
 v_add_f32 v148, v148, v153
 v_mfma_f32_16x16x32_bf16 a[100:103], a[248:251], v[212:215], a[100:103]
 v_cvt_pk_bf16_f32 v195, v152, v153
 v_add_f32 v145, v145, v149
 v_mfma_f32_16x16x32_bf16 a[104:107], a[248:251], v[216:219], a[104:107]
 v_exp_f32 v155, v233
 v_mfma_f32_16x16x32_bf16 a[108:111], a[248:251], v[220:223], a[108:111]
 ds_read_b64_tr_b16 a[200:201], v16 offset:12544
 ds_read_b64_tr_b16 a[202:203], v16 offset:18688
 v_mfma_f32_16x16x32_bf16 a[112:115], a[252:255], v[208:211], a[112:115]
 v_exp_f32 v156, v234
 v_mfma_f32_16x16x32_bf16 a[116:119], a[252:255], v[212:215], a[116:119]
 ds_read_b64_tr_b16 a[204:205], v17 offset:12544
 ds_read_b64_tr_b16 a[206:207], v17 offset:18688
 v_mfma_f32_16x16x32_bf16 a[120:123], a[252:255], v[216:219], a[120:123]
 v_add_f32 v149, v154, v155
 v_cvt_pk_bf16_f32 v196, v154, v155
 v_mfma_f32_16x16x32_bf16 a[124:127], a[252:255], v[220:223], a[124:127]
 ds_read_b128 a[208:211], v12 offset:24576
 s_waitcnt lgkmcnt(5)
 v_mfma_f32_16x16x32_bf16 a[128:131], a[192:195], v[208:211], a[128:131]
 v_exp_f32 v157, v235
 v_mfma_f32_16x16x32_bf16 a[132:135], a[192:195], v[212:215], a[132:135]
 ds_read_b128 a[212:215], v13 offset:24576
 v_add_f32 v149, v149, v156
 v_mfma_f32_16x16x32_bf16 a[136:139], a[192:195], v[216:219], a[136:139]
 v_exp_f32 v152, v236
 v_mfma_f32_16x16x32_bf16 a[140:143], a[192:195], v[220:223], a[140:143]
 ds_read_b128 a[216:219], v12 offset:24704
 v_add_f32 v149, v149, v157
 v_mfma_f32_16x16x32_bf16 a[144:147], a[196:199], v[208:211], a[144:147]
 v_exp_f32 v153, v237
 v_mfma_f32_16x16x32_bf16 a[148:151], a[196:199], v[212:215], a[148:151]
 v_cvt_pk_bf16_f32 v197, v156, v157
 ds_read_b128 a[220:223], v13 offset:24704
 v_mfma_f32_16x16x32_bf16 a[152:155], a[196:199], v[216:219], a[152:155]
 ds_read_b128 a[224:227], v12 offset:24832
 v_add_f32 v149, v149, v152
 v_mfma_f32_16x16x32_bf16 a[156:159], a[196:199], v[220:223], a[156:159]
 v_add_f32 v149, v149, v153
 s_waitcnt lgkmcnt(5)
 v_mfma_f32_16x16x32_bf16 a[160:163], a[200:203], v[208:211], a[160:163]
 v_exp_f32 v154, v238
 v_mfma_f32_16x16x32_bf16 a[164:167], a[200:203], v[212:215], a[164:167]
 ds_read_b128 a[228:231], v13 offset:24832
 v_cvt_pk_bf16_f32 v198, v152, v153
 v_mfma_f32_16x16x32_bf16 a[168:171], a[200:203], v[216:219], a[168:171]
 v_exp_f32 v155, v239
 v_mfma_f32_16x16x32_bf16 a[172:175], a[200:203], v[220:223], a[172:175]
 v_add_f32 v149, v149, v154
 v_add_f32 v149, v149, v155
 v_mfma_f32_16x16x32_bf16 a[176:179], a[204:207], v[208:211], a[176:179]
 v_cvt_pk_bf16_f32 v199, v154, v155
 v_add_f32 v146, v146, v150
 v_mfma_f32_16x16x32_bf16 a[180:183], a[204:207], v[212:215], a[180:183]
 v_exp_f32 v156, v240
 v_mfma_f32_16x16x32_bf16 a[184:187], a[204:207], v[216:219], a[184:187]
 v_add_f32 v147, v147, v151
 v_mfma_f32_16x16x32_bf16 a[188:191], a[204:207], v[220:223], a[188:191]
 s_waitcnt lgkmcnt(3)
 v_mfma_f32_16x16x32_bf16 v[160:163], a[208:211], v[32:35], v[128:131]
 v_exp_f32 v157, v241
 v_mfma_f32_16x16x32_bf16 v[160:163], a[212:215], v[48:51], v[160:163]
 ds_read_b128 a[232:235], v12 offset:30720
 v_add_f32 v150, v156, v157
 v_mfma_f32_16x16x32_bf16 v[160:163], a[216:219], v[64:67], v[160:163]
 ds_read_b128 a[236:239], v13 offset:30720
 s_waitcnt lgkmcnt(2)
 v_mfma_f32_16x16x32_bf16 v[160:163], a[220:223], v[80:83], v[160:163]
 v_exp_f32 v152, v242
 v_mfma_f32_16x16x32_bf16 v[160:163], a[224:227], v[96:99], v[160:163]
 v_cvt_pk_bf16_f32 v200, v156, v157
 v_add_f32 v150, v150, v152
 v_mfma_f32_16x16x32_bf16 v[160:163], a[228:231], v[112:115], v[160:163]
 ds_read_b128 a[240:243], v12 offset:30848
 v_mfma_f32_16x16x32_bf16 v[168:171], a[208:211], v[36:39], v[132:135]
 v_exp_f32 v153, v243
 v_mfma_f32_16x16x32_bf16 v[168:171], a[212:215], v[52:55], v[168:171]
 v_add_f32 v150, v150, v153
 v_cvt_pk_bf16_f32 v201, v152, v153
 v_mfma_f32_16x16x32_bf16 v[168:171], a[216:219], v[68:71], v[168:171]
 v_exp_f32 v154, v244
 v_mfma_f32_16x16x32_bf16 v[168:171], a[220:223], v[84:87], v[168:171]
 ds_read_b128 a[244:247], v13 offset:30848
 v_add_f32 v150, v150, v154
 v_mfma_f32_16x16x32_bf16 v[168:171], a[224:227], v[100:103], v[168:171]
 v_mfma_f32_16x16x32_bf16 v[168:171], a[228:231], v[116:119], v[168:171]
 v_exp_f32 v155, v245
 v_mfma_f32_16x16x32_bf16 v[176:179], a[208:211], v[40:43], v[136:139]
 ds_read_b128 a[248:251], v12 offset:30976
 v_add_f32 v150, v150, v155
 v_mfma_f32_16x16x32_bf16 v[176:179], a[212:215], v[56:59], v[176:179]
 v_cvt_pk_bf16_f32 v202, v154, v155
 v_mfma_f32_16x16x32_bf16 v[176:179], a[216:219], v[72:75], v[176:179]
 v_exp_f32 v156, v246
 v_mfma_f32_16x16x32_bf16 v[176:179], a[220:223], v[88:91], v[176:179]
 ds_read_b128 a[252:255], v13 offset:30976
 v_add_f32 v150, v150, v156
 v_mfma_f32_16x16x32_bf16 v[176:179], a[224:227], v[104:107], v[176:179]
 v_mfma_f32_16x16x32_bf16 v[176:179], a[228:231], v[120:123], v[176:179]
 v_exp_f32 v157, v247
 v_mfma_f32_16x16x32_bf16 v[184:187], a[208:211], v[44:47], v[140:143]
 v_add_f32 v150, v150, v157
 v_cvt_pk_bf16_f32 v203, v156, v157
 v_mfma_f32_16x16x32_bf16 v[184:187], a[212:215], v[60:63], v[184:187]
 v_max3_f32 v158, v148, v149, v150
 v_mfma_f32_16x16x32_bf16 v[184:187], a[216:219], v[76:79], v[184:187]
 v_exp_f32 v152, v248
 v_mfma_f32_16x16x32_bf16 v[184:187], a[220:223], v[92:95], v[184:187]
 v_mfma_f32_16x16x32_bf16 v[184:187], a[224:227], v[108:111], v[184:187]
 v_mfma_f32_16x16x32_bf16 v[184:187], a[228:231], v[124:127], v[184:187]
 s_waitcnt lgkmcnt(3)
 v_mfma_f32_16x16x32_bf16 v[164:167], a[232:235], v[32:35], v[128:131]
 v_exp_f32 v153, v249
 v_mfma_f32_16x16x32_bf16 v[164:167], a[236:239], v[48:51], v[164:167]
 v_exp_f32 v154, v250
 v_mfma_f32_16x16x32_bf16 v[164:167], a[240:243], v[64:67], v[164:167]
 v_add_f32 v151, v152, v153
 s_waitcnt lgkmcnt(0)
 v_mfma_f32_16x16x32_bf16 v[164:167], a[244:247], v[80:83], v[164:167]
 v_cvt_pk_bf16_f32 v204, v152, v153
 v_add_f32 v151, v151, v154
 v_mfma_f32_16x16x32_bf16 v[164:167], a[248:251], v[96:99], v[164:167]
 s_waitcnt vmcnt(16)
 s_barrier
 v_mfma_f32_16x16x32_bf16 v[164:167], a[252:255], v[112:115], v[164:167]
 v_exp_f32 v155, v251
 v_mfma_f32_16x16x32_bf16 v[172:175], a[232:235], v[36:39], v[132:135]
 ds_read_b64_tr_b16 a[192:193], v14 offset:24576
 v_add_f32 v151, v151, v155
 v_mfma_f32_16x16x32_bf16 v[172:175], a[236:239], v[52:55], v[172:175]
 v_exp_f32 v156, v252
 v_mfma_f32_16x16x32_bf16 v[172:175], a[240:243], v[68:71], v[172:175]
 ds_read_b64_tr_b16 a[194:195], v14 offset:30720
 v_cvt_pk_bf16_f32 v205, v154, v155
 v_mfma_f32_16x16x32_bf16 v[172:175], a[244:247], v[84:87], v[172:175]
 ds_read_b64_tr_b16 a[196:197], v15 offset:24576
 v_add_f32 v151, v151, v156
 v_mfma_f32_16x16x32_bf16 v[172:175], a[248:251], v[100:103], v[172:175]
 v_exp_f32 v157, v253
 v_mfma_f32_16x16x32_bf16 v[172:175], a[252:255], v[116:119], v[172:175]
 ds_read_b64_tr_b16 a[198:199], v15 offset:30720
 v_add_f32 v151, v151, v157
 v_mfma_f32_16x16x32_bf16 v[180:183], a[232:235], v[40:43], v[136:139]
 v_cvt_pk_bf16_f32 v206, v156, v157
 v_mfma_f32_16x16x32_bf16 v[180:183], a[236:239], v[56:59], v[180:183]
 v_exp_f32 v152, v254
 v_mfma_f32_16x16x32_bf16 v[180:183], a[240:243], v[72:75], v[180:183]
 ds_read_b64_tr_b16 a[200:201], v16 offset:24576
 v_add_f32 v151, v151, v152
 v_mfma_f32_16x16x32_bf16 v[180:183], a[244:247], v[88:91], v[180:183]
 s_add_u32 m0, s80, 36864
 s_add_u32 s76, s91, s84
 v_mfma_f32_16x16x32_bf16 v[180:183], a[248:251], v[104:107], v[180:183]
 v_exp_f32 v153, v255
 v_mfma_f32_16x16x32_bf16 v[180:183], a[252:255], v[120:123], v[180:183]
 ds_read_b64_tr_b16 a[202:203], v16 offset:30720
 v_add_f32 v151, v151, v153
 v_mfma_f32_16x16x32_bf16 v[188:191], a[232:235], v[44:47], v[140:143]
 ds_read_b64_tr_b16 a[204:205], v17 offset:24576
 v_cvt_pk_bf16_f32 v207, v152, v153
 v_mfma_f32_16x16x32_bf16 v[188:191], a[236:239], v[60:63], v[188:191]
 v_mfma_f32_16x16x32_bf16 v[188:191], a[240:243], v[76:79], v[188:191]
 ds_read_b64_tr_b16 a[206:207], v17 offset:30720
 v_max_f32 v158, v158, v151
 v_mfma_f32_16x16x32_bf16 v[188:191], a[244:247], v[92:95], v[188:191]
 v_cmp_lt_f32 vcc, s72, v158
 v_mfma_f32_16x16x32_bf16 v[188:191], a[248:251], v[108:111], v[188:191]
 v_mfma_f32_16x16x32_bf16 v[188:191], a[252:255], v[124:127], v[188:191]
 buffer_load_dwordx4 v7, s[40:43], s76 offen offset:0 lds
 s_cbranch_vccnz L_S_29
L_R_29:
 s_waitcnt lgkmcnt(4)
 v_mfma_f32_16x16x32_bf16 a[0:3], a[192:195], v[192:195], a[0:3]
 v_exp_f32 v152, v160
 v_mfma_f32_16x16x32_bf16 a[4:7], a[192:195], v[196:199], a[4:7]
 v_exp_f32 v153, v161
 v_mfma_f32_16x16x32_bf16 a[8:11], a[192:195], v[200:203], a[8:11]
 v_add_f32 v144, v144, v148
 ds_read_b64_tr_b16 a[208:209], v14 offset:24704
 v_mfma_f32_16x16x32_bf16 a[12:15], a[192:195], v[204:207], a[12:15]
 v_exp_f32 v154, v162
 v_mfma_f32_16x16x32_bf16 a[16:19], a[196:199], v[192:195], a[16:19]
 ds_read_b64_tr_b16 a[210:211], v14 offset:30848
 ds_read_b64_tr_b16 a[212:213], v15 offset:24704
 v_mfma_f32_16x16x32_bf16 a[20:23], a[196:199], v[196:199], a[20:23]
 v_exp_f32 v155, v163
 v_mfma_f32_16x16x32_bf16 a[24:27], a[196:199], v[200:203], a[24:27]
 v_exp_f32 v156, v164
 v_mfma_f32_16x16x32_bf16 a[28:31], a[196:199], v[204:207], a[28:31]
 buffer_load_dwordx4 v8, s[40:43], s76 offen offset:1024 lds
 v_exp_f32 v157, v165
 s_waitcnt lgkmcnt(3)
 v_mfma_f32_16x16x32_bf16 a[32:35], a[200:203], v[192:195], a[32:35]
 ds_read_b64_tr_b16 a[214:215], v15 offset:30848
 v_add_f32 v148, v152, v153
 v_cvt_pk_bf16_f32 v208, v152, v153
 v_mfma_f32_16x16x32_bf16 a[36:39], a[200:203], v[196:199], a[36:39]
 v_add_f32 v148, v148, v154
 v_exp_f32 v152, v166
 v_mfma_f32_16x16x32_bf16 a[40:43], a[200:203], v[200:203], a[40:43]
 v_exp_f32 v153, v167
 v_mfma_f32_16x16x32_bf16 a[44:47], a[200:203], v[204:207], a[44:47]
 ds_read_b64_tr_b16 a[216:217], v16 offset:24704
 v_add_f32 v148, v148, v155
 v_cvt_pk_bf16_f32 v209, v154, v155
 v_exp_f32 v154, v168
 v_mfma_f32_16x16x32_bf16 a[48:51], a[204:207], v[192:195], a[48:51]
 ds_read_b64_tr_b16 a[218:219], v16 offset:30848
 buffer_load_dwordx4 v9, s[40:43], s76 offen offset:2048 lds
 v_add_f32 v148, v148, v156
 v_mfma_f32_16x16x32_bf16 a[52:55], a[204:207], v[196:199], a[52:55]
 v_add_f32 v148, v148, v157
 v_cvt_pk_bf16_f32 v210, v156, v157
 v_exp_f32 v155, v169
 v_add_f32 v145, v145, v149
 v_mfma_f32_16x16x32_bf16 a[56:59], a[204:207], v[200:203], a[56:59]
 s_add_u32 m0, s80, 147456
 s_add_u32 s76, s91, s84
 s_add_u32 s76, s76, 128
 v_exp_f32 v156, v170
 v_mfma_f32_16x16x32_bf16 a[60:63], a[204:207], v[204:207], a[60:63]
 ds_read_b64_tr_b16 a[220:221], v17 offset:24704
 v_add_f32 v148, v148, v152
 v_exp_f32 v157, v171
 s_waitcnt lgkmcnt(3)
 v_mfma_f32_16x16x32_bf16 a[64:67], a[208:211], v[192:195], a[64:67]
 ds_read_b64_tr_b16 a[222:223], v17 offset:30848
 v_add_f32 v148, v148, v153
 v_cvt_pk_bf16_f32 v211, v152, v153
 v_mfma_f32_16x16x32_bf16 a[68:71], a[208:211], v[196:199], a[68:71]
 buffer_load_dwordx4 v7, s[40:43], s76 offen offset:0 lds
 v_exp_f32 v152, v172
 v_mfma_f32_16x16x32_bf16 a[72:75], a[208:211], v[200:203], a[72:75]
 v_exp_f32 v153, v173
 v_mfma_f32_16x16x32_bf16 a[76:79], a[208:211], v[204:207], a[76:79]
 ds_read_b64_tr_b16 a[224:225], v14 offset:24832
 v_add_f32 v149, v154, v155
 v_cvt_pk_bf16_f32 v212, v154, v155
 v_exp_f32 v154, v174
 v_mfma_f32_16x16x32_bf16 a[80:83], a[212:215], v[192:195], a[80:83]
 ds_read_b64_tr_b16 a[226:227], v14 offset:30976
 v_add_f32 v149, v149, v156
 v_mfma_f32_16x16x32_bf16 a[84:87], a[212:215], v[196:199], a[84:87]
 v_add_f32 v149, v149, v157
 v_cvt_pk_bf16_f32 v213, v156, v157
 v_exp_f32 v155, v175
 v_mfma_f32_16x16x32_bf16 a[88:91], a[212:215], v[200:203], a[88:91]
 buffer_load_dwordx4 v8, s[40:43], s76 offen offset:1024 lds
 v_exp_f32 v156, v176
 v_mfma_f32_16x16x32_bf16 a[92:95], a[212:215], v[204:207], a[92:95]
 ds_read_b64_tr_b16 a[228:229], v15 offset:24832
 v_add_f32 v149, v149, v152
 v_exp_f32 v157, v177
 v_add_f32 v146, v146, v150
 s_waitcnt lgkmcnt(3)
 v_mfma_f32_16x16x32_bf16 a[96:99], a[216:219], v[192:195], a[96:99]
 ds_read_b64_tr_b16 a[230:231], v15 offset:30976
 v_add_f32 v149, v149, v153
 v_cvt_pk_bf16_f32 v214, v152, v153
 v_mfma_f32_16x16x32_bf16 a[100:103], a[216:219], v[196:199], a[100:103]
 v_add_f32 v149, v149, v154
 v_exp_f32 v152, v178
 v_mfma_f32_16x16x32_bf16 a[104:107], a[216:219], v[200:203], a[104:107]
 v_exp_f32 v153, v179
 v_mfma_f32_16x16x32_bf16 a[108:111], a[216:219], v[204:207], a[108:111]
 ds_read_b64_tr_b16 a[232:233], v16 offset:24832
 buffer_load_dwordx4 v9, s[40:43], s76 offen offset:2048 lds
 v_add_f32 v149, v149, v155
 v_cvt_pk_bf16_f32 v215, v154, v155
 v_exp_f32 v154, v180
 v_mfma_f32_16x16x32_bf16 a[112:115], a[220:223], v[192:195], a[112:115]
 ds_read_b64_tr_b16 a[234:235], v16 offset:30976
 v_add_f32 v150, v156, v157
 v_mfma_f32_16x16x32_bf16 a[116:119], a[220:223], v[196:199], a[116:119]
 s_add_u32 m0, s80, 49152
 s_add_u32 s76, s92, s84
 v_cvt_pk_bf16_f32 v216, v156, v157
 v_exp_f32 v155, v181
 v_mfma_f32_16x16x32_bf16 a[120:123], a[220:223], v[200:203], a[120:123]
 v_exp_f32 v156, v182
 v_mfma_f32_16x16x32_bf16 a[124:127], a[220:223], v[204:207], a[124:127]
 ds_read_b64_tr_b16 a[236:237], v17 offset:24832
 v_add_f32 v150, v150, v152
 v_exp_f32 v157, v183
 s_waitcnt lgkmcnt(3)
 v_mfma_f32_16x16x32_bf16 a[128:131], a[224:227], v[192:195], a[128:131]
 ds_read_b64_tr_b16 a[238:239], v17 offset:30976
 buffer_load_dwordx4 v7, s[40:43], s76 offen offset:0 lds
 v_add_f32 v150, v150, v153
 v_cvt_pk_bf16_f32 v217, v152, v153
 v_mfma_f32_16x16x32_bf16 a[132:135], a[224:227], v[196:199], a[132:135]
 v_add_f32 v150, v150, v154
 v_exp_f32 v152, v184
 v_mfma_f32_16x16x32_bf16 a[136:139], a[224:227], v[200:203], a[136:139]
 v_exp_f32 v153, v185
 v_add_f32 v147, v147, v151
 v_mfma_f32_16x16x32_bf16 a[140:143], a[224:227], v[204:207], a[140:143]
 v_add_f32 v150, v150, v155
 v_cvt_pk_bf16_f32 v218, v154, v155
 v_exp_f32 v154, v186
 v_mfma_f32_16x16x32_bf16 a[144:147], a[228:231], v[192:195], a[144:147]
 v_add_f32 v150, v150, v156
 ds_read_b64_tr_b16 a[240:241], v14 offset:36864
 v_mfma_f32_16x16x32_bf16 a[148:151], a[228:231], v[196:199], a[148:151]
 buffer_load_dwordx4 v8, s[40:43], s76 offen offset:1024 lds
 v_add_f32 v150, v150, v157
 v_cvt_pk_bf16_f32 v219, v156, v157
 v_exp_f32 v155, v187
 v_mfma_f32_16x16x32_bf16 a[152:155], a[228:231], v[200:203], a[152:155]
 v_exp_f32 v156, v188
 v_mfma_f32_16x16x32_bf16 a[156:159], a[228:231], v[204:207], a[156:159]
 ds_read_b64_tr_b16 a[242:243], v14 offset:43008
 v_exp_f32 v157, v189
 s_waitcnt lgkmcnt(2)
 v_mfma_f32_16x16x32_bf16 a[160:163], a[232:235], v[192:195], a[160:163]
 ds_read_b64_tr_b16 a[244:245], v15 offset:36864
 v_add_f32 v151, v152, v153
 v_cvt_pk_bf16_f32 v220, v152, v153
 v_lshlrev_b32 v1, 4, v0
 v_mfma_f32_16x16x32_bf16 a[164:167], a[232:235], v[196:199], a[164:167]
 v_add_f32 v151, v151, v154
 v_exp_f32 v152, v190
 v_mfma_f32_16x16x32_bf16 a[168:171], a[232:235], v[200:203], a[168:171]
 ds_read_b64_tr_b16 a[246:247], v15 offset:43008
 buffer_load_dwordx4 v9, s[40:43], s76 offen offset:2048 lds
 v_exp_f32 v153, v191
 v_mfma_f32_16x16x32_bf16 a[172:175], a[232:235], v[204:207], a[172:175]
 ds_read_b64_tr_b16 a[248:249], v16 offset:36864
 v_add_f32 v151, v151, v155
 v_cvt_pk_bf16_f32 v221, v154, v155
 v_mfma_f32_16x16x32_bf16 a[176:179], a[236:239], v[192:195], a[176:179]
 s_add_u32 m0, s80, 73728
 s_add_u32 s76, s92, s84
 s_add_u32 s76, s76, 128
 v_add_f32 v151, v151, v156
 v_mfma_f32_16x16x32_bf16 a[180:183], a[236:239], v[196:199], a[180:183]
 ds_read_b64_tr_b16 a[250:251], v16 offset:43008
 v_add_f32 v151, v151, v157
 v_cvt_pk_bf16_f32 v222, v156, v157
 v_mfma_f32_16x16x32_bf16 a[184:187], a[236:239], v[200:203], a[184:187]
 ds_read_b64_tr_b16 a[252:253], v17 offset:36864
 ds_read_b64_tr_b16 a[254:255], v17 offset:43008
 v_max3_f32 v158, v148, v149, v150
 v_mfma_f32_16x16x32_bf16 a[188:191], a[236:239], v[204:207], a[188:191]
 buffer_load_dwordx4 v7, s[40:43], s76 offen offset:0 lds
 v_add_f32 v151, v151, v152
 v_add_f32 v151, v151, v153
 v_cvt_pk_bf16_f32 v223, v152, v153
 v_max_f32 v158, v158, v151
 v_cmp_lt_f32 vcc, s72, v158
 s_cbranch_vccnz L_S_30
L_R_30:
 s_waitcnt lgkmcnt(4)
 v_mfma_f32_16x16x32_bf16 a[0:3], a[240:243], v[208:211], a[0:3]
 ds_read_b64_tr_b16 a[192:193], v14 offset:36992
 v_add_f32 v144, v144, v148
 v_mfma_f32_16x16x32_bf16 a[4:7], a[240:243], v[212:215], a[4:7]
 ds_read_b64_tr_b16 a[194:195], v14 offset:43136
 v_add_f32 v145, v145, v149
 v_mfma_f32_16x16x32_bf16 a[8:11], a[240:243], v[216:219], a[8:11]
 buffer_load_dwordx4 v8, s[40:43], s76 offen offset:1024 lds
 v_mfma_f32_16x16x32_bf16 a[12:15], a[240:243], v[220:223], a[12:15]
 v_add_f32 v146, v146, v150
 v_add_f32 v147, v147, v151
 v_mfma_f32_16x16x32_bf16 a[16:19], a[244:247], v[208:211], a[16:19]
 ds_read_b64_tr_b16 a[196:197], v15 offset:36992
 v_mov_b32 v152, v144
 v_mfma_f32_16x16x32_bf16 a[20:23], a[244:247], v[212:215], a[20:23]
 ds_read_b64_tr_b16 a[198:199], v15 offset:43136
 v_mov_b32 v153, v145
 v_mfma_f32_16x16x32_bf16 a[24:27], a[244:247], v[216:219], a[24:27]
 buffer_load_dwordx4 v9, s[40:43], s76 offen offset:2048 lds
 v_mfma_f32_16x16x32_bf16 a[28:31], a[244:247], v[220:223], a[28:31]
 v_mov_b32 v154, v146
 s_waitcnt lgkmcnt(4)
 v_mfma_f32_16x16x32_bf16 a[32:35], a[248:251], v[208:211], a[32:35]
 ds_read_b64_tr_b16 a[200:201], v16 offset:36992
 v_mov_b32 v155, v147
 v_mfma_f32_16x16x32_bf16 a[36:39], a[248:251], v[212:215], a[36:39]
 s_add_u32 m0, s80, 61440
 s_add_u32 s76, s93, s84
 v_mfma_f32_16x16x32_bf16 a[40:43], a[248:251], v[216:219], a[40:43]
 ds_read_b64_tr_b16 a[202:203], v16 offset:43136
 v_permlane32_swap_b32 v152, v144
 v_mfma_f32_16x16x32_bf16 a[44:47], a[248:251], v[220:223], a[44:47]
 buffer_load_dwordx4 v7, s[40:43], s76 offen offset:0 lds
 v_mfma_f32_16x16x32_bf16 a[48:51], a[252:255], v[208:211], a[48:51]
 ds_read_b64_tr_b16 a[204:205], v17 offset:36992
 v_permlane32_swap_b32 v153, v145
 v_mfma_f32_16x16x32_bf16 a[52:55], a[252:255], v[212:215], a[52:55]
 ds_read_b64_tr_b16 a[206:207], v17 offset:43136
 v_permlane32_swap_b32 v154, v146
 v_mfma_f32_16x16x32_bf16 a[56:59], a[252:255], v[216:219], a[56:59]
 v_permlane32_swap_b32 v155, v147
 v_add_f32 v144, v144, v152
 v_mfma_f32_16x16x32_bf16 a[60:63], a[252:255], v[220:223], a[60:63]
 v_add_f32 v145, v145, v153
 s_waitcnt lgkmcnt(4)
 v_mfma_f32_16x16x32_bf16 a[64:67], a[192:195], v[208:211], a[64:67]
 ds_read_b64_tr_b16 a[208:209], v14 offset:37120
 v_add_f32 v146, v146, v154
 v_mfma_f32_16x16x32_bf16 a[68:71], a[192:195], v[212:215], a[68:71]
 buffer_load_dwordx4 v8, s[40:43], s76 offen offset:1024 lds
 v_mfma_f32_16x16x32_bf16 a[72:75], a[192:195], v[216:219], a[72:75]
 ds_read_b64_tr_b16 a[210:211], v14 offset:43264
 v_add_f32 v147, v147, v155
 v_mfma_f32_16x16x32_bf16 a[76:79], a[192:195], v[220:223], a[76:79]
 v_mov_b32 v152, v144
 v_mov_b32 v153, v145
 v_mfma_f32_16x16x32_bf16 a[80:83], a[196:199], v[208:211], a[80:83]
 ds_read_b64_tr_b16 a[212:213], v15 offset:37120
 v_mov_b32 v154, v146
 v_mfma_f32_16x16x32_bf16 a[84:87], a[196:199], v[212:215], a[84:87]
 ds_read_b64_tr_b16 a[214:215], v15 offset:43264
 v_mov_b32 v155, v147
 v_mfma_f32_16x16x32_bf16 a[88:91], a[196:199], v[216:219], a[88:91]
 buffer_load_dwordx4 v9, s[40:43], s76 offen offset:2048 lds
 v_mfma_f32_16x16x32_bf16 a[92:95], a[196:199], v[220:223], a[92:95]
 v_permlane16_swap_b32 v152, v144
 s_waitcnt lgkmcnt(4)
 v_mfma_f32_16x16x32_bf16 a[96:99], a[200:203], v[208:211], a[96:99]
 s_add_u32 m0, s80, 86016
 s_add_u32 s76, s93, s84
 v_mfma_f32_16x16x32_bf16 a[100:103], a[200:203], v[212:215], a[100:103]
 s_add_u32 s76, s76, 128
 ds_read_b64_tr_b16 a[216:217], v16 offset:37120
 v_mfma_f32_16x16x32_bf16 a[104:107], a[200:203], v[216:219], a[104:107]
 ds_read_b64_tr_b16 a[218:219], v16 offset:43264
 v_permlane16_swap_b32 v153, v145
 v_mfma_f32_16x16x32_bf16 a[108:111], a[200:203], v[220:223], a[108:111]
 buffer_load_dwordx4 v7, s[40:43], s76 offen offset:0 lds
 v_mfma_f32_16x16x32_bf16 a[112:115], a[204:207], v[208:211], a[112:115]
 ds_read_b64_tr_b16 a[220:221], v17 offset:37120
 v_permlane16_swap_b32 v154, v146
 v_mfma_f32_16x16x32_bf16 a[116:119], a[204:207], v[212:215], a[116:119]
 ds_read_b64_tr_b16 a[222:223], v17 offset:43264
 v_permlane16_swap_b32 v155, v147
 v_mfma_f32_16x16x32_bf16 a[120:123], a[204:207], v[216:219], a[120:123]
 v_add_f32 v144, v144, v152
 v_add_f32 v145, v145, v153
 v_mfma_f32_16x16x32_bf16 a[124:127], a[204:207], v[220:223], a[124:127]
 v_add_f32 v146, v146, v154
 s_waitcnt lgkmcnt(4)
 v_mfma_f32_16x16x32_bf16 a[128:131], a[208:211], v[208:211], a[128:131]
 buffer_load_dwordx4 v8, s[40:43], s76 offen offset:1024 lds
 v_mfma_f32_16x16x32_bf16 a[132:135], a[208:211], v[212:215], a[132:135]
 v_add_f32 v147, v147, v155
 v_mfma_f32_16x16x32_bf16 a[136:139], a[208:211], v[216:219], a[136:139]
 v_rcp_f32 v144, v144
 v_mfma_f32_16x16x32_bf16 a[140:143], a[208:211], v[220:223], a[140:143]
 v_rcp_f32 v145, v145
 v_mfma_f32_16x16x32_bf16 a[144:147], a[212:215], v[208:211], a[144:147]
 buffer_load_dwordx4 v9, s[40:43], s76 offen offset:2048 lds
 v_mfma_f32_16x16x32_bf16 a[148:151], a[212:215], v[212:215], a[148:151]
 v_rcp_f32 v146, v146
 v_mfma_f32_16x16x32_bf16 a[152:155], a[212:215], v[216:219], a[152:155]
 v_rcp_f32 v147, v147
 v_mfma_f32_16x16x32_bf16 a[156:159], a[212:215], v[220:223], a[156:159]
 s_mul_i32 s89, s63, 98304
 s_waitcnt lgkmcnt(0)
 v_mfma_f32_16x16x32_bf16 a[160:163], a[216:219], v[208:211], a[160:163]
 v_accvgpr_read_b32 v160, a0
 v_accvgpr_read_b32 v161, a1
 v_mfma_f32_16x16x32_bf16 a[164:167], a[216:219], v[212:215], a[164:167]
 v_accvgpr_read_b32 v162, a2
 v_accvgpr_read_b32 v163, a3
 v_mfma_f32_16x16x32_bf16 a[168:171], a[216:219], v[216:219], a[168:171]
 v_accvgpr_read_b32 v164, a16
 v_accvgpr_read_b32 v165, a17
 v_mfma_f32_16x16x32_bf16 a[172:175], a[216:219], v[220:223], a[172:175]
 v_accvgpr_read_b32 v166, a18
 v_accvgpr_read_b32 v167, a19
 v_mfma_f32_16x16x32_bf16 a[176:179], a[220:223], v[208:211], a[176:179]
 v_mul_f32 v160, v160, v144
 v_mul_f32 v161, v161, v144
 v_mfma_f32_16x16x32_bf16 a[180:183], a[220:223], v[212:215], a[180:183]
 v_mul_f32 v162, v162, v144
 v_mul_f32 v163, v163, v144
 v_mfma_f32_16x16x32_bf16 a[184:187], a[220:223], v[216:219], a[184:187]
 v_mul_f32 v164, v164, v144
 v_mul_f32 v165, v165, v144
 v_mfma_f32_16x16x32_bf16 a[188:191], a[220:223], v[220:223], a[188:191]
 v_mul_f32 v166, v166, v144
 v_mul_f32 v167, v167, v144
 v_cvt_pk_bf16_f32 v32, v160, v161
 v_cvt_pk_bf16_f32 v33, v162, v163
 v_cvt_pk_bf16_f32 v34, v164, v165
 v_cvt_pk_bf16_f32 v35, v166, v167
 s_add_u32 s75, s89, 0
 buffer_store_dwordx4 v[32:35], v1, s[36:39], s75 offen offset:0 sc1
 v_accvgpr_read_b32 v168, a4
 v_accvgpr_read_b32 v169, a5
 v_accvgpr_read_b32 v170, a6
 v_accvgpr_read_b32 v171, a7
 v_accvgpr_read_b32 v172, a20
 v_accvgpr_read_b32 v173, a21
 v_accvgpr_read_b32 v174, a22
 v_accvgpr_read_b32 v175, a23
 v_mul_f32 v168, v168, v145
 v_mul_f32 v169, v169, v145
 v_mul_f32 v170, v170, v145
 v_mul_f32 v171, v171, v145
 v_mul_f32 v172, v172, v145
 v_mul_f32 v173, v173, v145
 v_mul_f32 v174, v174, v145
 v_mul_f32 v175, v175, v145
 v_cvt_pk_bf16_f32 v36, v168, v169
 v_cvt_pk_bf16_f32 v37, v170, v171
 v_cvt_pk_bf16_f32 v38, v172, v173
 v_cvt_pk_bf16_f32 v39, v174, v175
 buffer_store_dwordx4 v[36:39], v1, s[36:39], s75 offen offset:1024 sc1
 s_waitcnt vmcnt(21)
 s_barrier
 v_add_u32 v14, 0, v27
 v_xor_b32 v15, 32, v14
 v_xor_b32 v16, 64, v14
 v_xor_b32 v17, 96, v14
 ds_read_b64_tr_b16 a[192:193], v14 offset:0
 ds_read_b64_tr_b16 a[194:195], v14 offset:2048
 ds_read_b64_tr_b16 a[196:197], v14 offset:4096
 ds_read_b64_tr_b16 a[198:199], v14 offset:6144
 ds_read_b64_tr_b16 a[200:201], v14 offset:8192
 ds_read_b64_tr_b16 a[202:203], v14 offset:10240
 v_accvgpr_read_b32 v176, a8
 v_accvgpr_read_b32 v177, a9
 v_accvgpr_read_b32 v178, a10
 v_accvgpr_read_b32 v179, a11
 v_accvgpr_read_b32 v180, a24
 v_accvgpr_read_b32 v181, a25
 v_accvgpr_read_b32 v182, a26
 v_accvgpr_read_b32 v183, a27
 v_pk_mul_f32 v[176:177], v[176:177], v[146:147] op_sel_hi:[1,0]
 v_pk_mul_f32 v[178:179], v[178:179], v[146:147] op_sel_hi:[1,0]
 v_pk_mul_f32 v[180:181], v[180:181], v[146:147] op_sel_hi:[1,0]
 v_pk_mul_f32 v[182:183], v[182:183], v[146:147] op_sel_hi:[1,0]
 v_cvt_pk_bf16_f32 v40, v176, v177
 v_cvt_pk_bf16_f32 v41, v178, v179
 v_cvt_pk_bf16_f32 v42, v180, v181
 v_cvt_pk_bf16_f32 v43, v182, v183
 buffer_store_dwordx4 v[40:43], v1, s[36:39], s75 offen offset:2048 sc1
 v_accvgpr_read_b32 v184, a12
 v_accvgpr_read_b32 v185, a13
 v_accvgpr_read_b32 v186, a14
 v_accvgpr_read_b32 v187, a15
 v_accvgpr_read_b32 v188, a28
 v_accvgpr_read_b32 v189, a29
 v_accvgpr_read_b32 v190, a30
 v_accvgpr_read_b32 v191, a31
 v_pk_mul_f32 v[184:185], v[184:185], v[146:147] op_sel:[0,1] op_sel_hi:[1,1]
 v_pk_mul_f32 v[186:187], v[186:187], v[146:147] op_sel:[0,1] op_sel_hi:[1,1]
 v_pk_mul_f32 v[188:189], v[188:189], v[146:147] op_sel:[0,1] op_sel_hi:[1,1]
 v_pk_mul_f32 v[190:191], v[190:191], v[146:147] op_sel:[0,1] op_sel_hi:[1,1]
 v_cvt_pk_bf16_f32 v44, v184, v185
 v_cvt_pk_bf16_f32 v45, v186, v187
 v_cvt_pk_bf16_f32 v46, v188, v189
 v_cvt_pk_bf16_f32 v47, v190, v191
 buffer_store_dwordx4 v[44:47], v1, s[36:39], s75 offen offset:3072 sc1
 v_accvgpr_read_b32 v224, a32
 v_accvgpr_read_b32 v225, a33
 v_accvgpr_read_b32 v226, a34
 v_accvgpr_read_b32 v227, a35
 v_accvgpr_read_b32 v228, a48
 v_accvgpr_read_b32 v229, a49
 v_accvgpr_read_b32 v230, a50
 v_accvgpr_read_b32 v231, a51
 v_pk_mul_f32 v[224:225], v[224:225], v[144:145] op_sel_hi:[1,0]
 v_pk_mul_f32 v[226:227], v[226:227], v[144:145] op_sel_hi:[1,0]
 v_pk_mul_f32 v[228:229], v[228:229], v[144:145] op_sel_hi:[1,0]
 v_pk_mul_f32 v[230:231], v[230:231], v[144:145] op_sel_hi:[1,0]
 v_cvt_pk_bf16_f32 v48, v224, v225
 v_cvt_pk_bf16_f32 v49, v226, v227
 v_cvt_pk_bf16_f32 v50, v228, v229
 v_cvt_pk_bf16_f32 v51, v230, v231
 s_add_u32 s75, s89, 4096
 buffer_store_dwordx4 v[48:51], v1, s[36:39], s75 offen offset:0 sc1
 v_accvgpr_read_b32 v232, a36
 v_accvgpr_read_b32 v233, a37
 v_accvgpr_read_b32 v234, a38
 v_accvgpr_read_b32 v235, a39
 v_accvgpr_read_b32 v236, a52
 v_accvgpr_read_b32 v237, a53
 v_accvgpr_read_b32 v238, a54
 v_accvgpr_read_b32 v239, a55
 v_pk_mul_f32 v[232:233], v[232:233], v[144:145] op_sel:[0,1] op_sel_hi:[1,1]
 v_pk_mul_f32 v[234:235], v[234:235], v[144:145] op_sel:[0,1] op_sel_hi:[1,1]
 v_pk_mul_f32 v[236:237], v[236:237], v[144:145] op_sel:[0,1] op_sel_hi:[1,1]
 v_pk_mul_f32 v[238:239], v[238:239], v[144:145] op_sel:[0,1] op_sel_hi:[1,1]
 v_cvt_pk_bf16_f32 v52, v232, v233
 v_cvt_pk_bf16_f32 v53, v234, v235
 v_cvt_pk_bf16_f32 v54, v236, v237
 v_cvt_pk_bf16_f32 v55, v238, v239
 buffer_store_dwordx4 v[52:55], v1, s[36:39], s75 offen offset:1024 sc1
 v_accvgpr_read_b32 v240, a40
 v_accvgpr_read_b32 v241, a41
 v_accvgpr_read_b32 v242, a42
 v_accvgpr_read_b32 v243, a43
 v_accvgpr_read_b32 v244, a56
 v_accvgpr_read_b32 v245, a57
 v_accvgpr_read_b32 v246, a58
 v_accvgpr_read_b32 v247, a59
 v_pk_mul_f32 v[240:241], v[240:241], v[146:147] op_sel_hi:[1,0]
 v_pk_mul_f32 v[242:243], v[242:243], v[146:147] op_sel_hi:[1,0]
 v_pk_mul_f32 v[244:245], v[244:245], v[146:147] op_sel_hi:[1,0]
 v_pk_mul_f32 v[246:247], v[246:247], v[146:147] op_sel_hi:[1,0]
 v_cvt_pk_bf16_f32 v56, v240, v241
 v_cvt_pk_bf16_f32 v57, v242, v243
 v_cvt_pk_bf16_f32 v58, v244, v245
 v_cvt_pk_bf16_f32 v59, v246, v247
 buffer_store_dwordx4 v[56:59], v1, s[36:39], s75 offen offset:2048 sc1
 v_accvgpr_read_b32 v248, a44
 v_accvgpr_read_b32 v249, a45
 v_accvgpr_read_b32 v250, a46
 v_accvgpr_read_b32 v251, a47
 v_accvgpr_read_b32 v252, a60
 v_accvgpr_read_b32 v253, a61
 v_accvgpr_read_b32 v254, a62
 v_accvgpr_read_b32 v255, a63
 v_pk_mul_f32 v[248:249], v[248:249], v[146:147] op_sel:[0,1] op_sel_hi:[1,1]
 v_pk_mul_f32 v[250:251], v[250:251], v[146:147] op_sel:[0,1] op_sel_hi:[1,1]
 v_pk_mul_f32 v[252:253], v[252:253], v[146:147] op_sel:[0,1] op_sel_hi:[1,1]
 v_pk_mul_f32 v[254:255], v[254:255], v[146:147] op_sel:[0,1] op_sel_hi:[1,1]
 v_cvt_pk_bf16_f32 v60, v248, v249
 v_cvt_pk_bf16_f32 v61, v250, v251
 v_cvt_pk_bf16_f32 v62, v252, v253
 v_cvt_pk_bf16_f32 v63, v254, v255
 buffer_store_dwordx4 v[60:63], v1, s[36:39], s75 offen offset:3072 sc1
 v_accvgpr_read_b32 v160, a64
 v_accvgpr_read_b32 v161, a65
 v_accvgpr_read_b32 v162, a66
 v_accvgpr_read_b32 v163, a67
 v_accvgpr_read_b32 v164, a80
 v_accvgpr_read_b32 v165, a81
 v_accvgpr_read_b32 v166, a82
 v_accvgpr_read_b32 v167, a83
 v_pk_mul_f32 v[160:161], v[160:161], v[144:145] op_sel_hi:[1,0]
 v_pk_mul_f32 v[162:163], v[162:163], v[144:145] op_sel_hi:[1,0]
 v_pk_mul_f32 v[164:165], v[164:165], v[144:145] op_sel_hi:[1,0]
 v_pk_mul_f32 v[166:167], v[166:167], v[144:145] op_sel_hi:[1,0]
 v_cvt_pk_bf16_f32 v64, v160, v161
 v_cvt_pk_bf16_f32 v65, v162, v163
 v_cvt_pk_bf16_f32 v66, v164, v165
 v_cvt_pk_bf16_f32 v67, v166, v167
 s_add_u32 s75, s89, 8192
 buffer_store_dwordx4 v[64:67], v1, s[36:39], s75 offen offset:0 sc1
 v_accvgpr_read_b32 v168, a68
 v_accvgpr_read_b32 v169, a69
 v_accvgpr_read_b32 v170, a70
 v_accvgpr_read_b32 v171, a71
 v_accvgpr_read_b32 v172, a84
 v_accvgpr_read_b32 v173, a85
 v_accvgpr_read_b32 v174, a86
 v_accvgpr_read_b32 v175, a87
 v_pk_mul_f32 v[168:169], v[168:169], v[144:145] op_sel:[0,1] op_sel_hi:[1,1]
 v_pk_mul_f32 v[170:171], v[170:171], v[144:145] op_sel:[0,1] op_sel_hi:[1,1]
 v_pk_mul_f32 v[172:173], v[172:173], v[144:145] op_sel:[0,1] op_sel_hi:[1,1]
 v_pk_mul_f32 v[174:175], v[174:175], v[144:145] op_sel:[0,1] op_sel_hi:[1,1]
 v_cvt_pk_bf16_f32 v68, v168, v169
 v_cvt_pk_bf16_f32 v69, v170, v171
 v_cvt_pk_bf16_f32 v70, v172, v173
 v_cvt_pk_bf16_f32 v71, v174, v175
 buffer_store_dwordx4 v[68:71], v1, s[36:39], s75 offen offset:1024 sc1
 v_accvgpr_read_b32 v176, a72
 v_accvgpr_read_b32 v177, a73
 v_accvgpr_read_b32 v178, a74
 v_accvgpr_read_b32 v179, a75
 v_accvgpr_read_b32 v180, a88
 v_accvgpr_read_b32 v181, a89
 v_accvgpr_read_b32 v182, a90
 v_accvgpr_read_b32 v183, a91
 v_pk_mul_f32 v[176:177], v[176:177], v[146:147] op_sel_hi:[1,0]
 v_pk_mul_f32 v[178:179], v[178:179], v[146:147] op_sel_hi:[1,0]
 v_pk_mul_f32 v[180:181], v[180:181], v[146:147] op_sel_hi:[1,0]
 v_pk_mul_f32 v[182:183], v[182:183], v[146:147] op_sel_hi:[1,0]
 v_cvt_pk_bf16_f32 v72, v176, v177
 v_cvt_pk_bf16_f32 v73, v178, v179
 v_cvt_pk_bf16_f32 v74, v180, v181
 v_cvt_pk_bf16_f32 v75, v182, v183
 buffer_store_dwordx4 v[72:75], v1, s[36:39], s75 offen offset:2048 sc1
 v_accvgpr_read_b32 v184, a76
 v_accvgpr_read_b32 v185, a77
 v_accvgpr_read_b32 v186, a78
 v_accvgpr_read_b32 v187, a79
 v_accvgpr_read_b32 v188, a92
 v_accvgpr_read_b32 v189, a93
 v_accvgpr_read_b32 v190, a94
 v_accvgpr_read_b32 v191, a95
 v_pk_mul_f32 v[184:185], v[184:185], v[146:147] op_sel:[0,1] op_sel_hi:[1,1]
 v_pk_mul_f32 v[186:187], v[186:187], v[146:147] op_sel:[0,1] op_sel_hi:[1,1]
 v_pk_mul_f32 v[188:189], v[188:189], v[146:147] op_sel:[0,1] op_sel_hi:[1,1]
 v_pk_mul_f32 v[190:191], v[190:191], v[146:147] op_sel:[0,1] op_sel_hi:[1,1]
 v_cvt_pk_bf16_f32 v76, v184, v185
 v_cvt_pk_bf16_f32 v77, v186, v187
 v_cvt_pk_bf16_f32 v78, v188, v189
 v_cvt_pk_bf16_f32 v79, v190, v191
 buffer_store_dwordx4 v[76:79], v1, s[36:39], s75 offen offset:3072 sc1
 v_accvgpr_read_b32 v224, a96
 v_accvgpr_read_b32 v225, a97
 v_accvgpr_read_b32 v226, a98
 v_accvgpr_read_b32 v227, a99
 v_accvgpr_read_b32 v228, a112
 v_accvgpr_read_b32 v229, a113
 v_accvgpr_read_b32 v230, a114
 v_accvgpr_read_b32 v231, a115
 v_pk_mul_f32 v[224:225], v[224:225], v[144:145] op_sel_hi:[1,0]
 v_pk_mul_f32 v[226:227], v[226:227], v[144:145] op_sel_hi:[1,0]
 v_pk_mul_f32 v[228:229], v[228:229], v[144:145] op_sel_hi:[1,0]
 v_pk_mul_f32 v[230:231], v[230:231], v[144:145] op_sel_hi:[1,0]
 v_cvt_pk_bf16_f32 v80, v224, v225
 v_cvt_pk_bf16_f32 v81, v226, v227
 v_cvt_pk_bf16_f32 v82, v228, v229
 v_cvt_pk_bf16_f32 v83, v230, v231
 v_accvgpr_read_b32 v232, a100
 v_accvgpr_read_b32 v233, a101
 v_accvgpr_read_b32 v234, a102
 v_accvgpr_read_b32 v235, a103
 v_accvgpr_read_b32 v236, a116
 v_accvgpr_read_b32 v237, a117
 v_accvgpr_read_b32 v238, a118
 v_accvgpr_read_b32 v239, a119
 v_pk_mul_f32 v[232:233], v[232:233], v[144:145] op_sel:[0,1] op_sel_hi:[1,1]
 v_pk_mul_f32 v[234:235], v[234:235], v[144:145] op_sel:[0,1] op_sel_hi:[1,1]
 v_pk_mul_f32 v[236:237], v[236:237], v[144:145] op_sel:[0,1] op_sel_hi:[1,1]
 v_pk_mul_f32 v[238:239], v[238:239], v[144:145] op_sel:[0,1] op_sel_hi:[1,1]
 v_cvt_pk_bf16_f32 v84, v232, v233
 v_cvt_pk_bf16_f32 v85, v234, v235
 v_cvt_pk_bf16_f32 v86, v236, v237
 v_cvt_pk_bf16_f32 v87, v238, v239
 v_accvgpr_read_b32 v240, a104
 v_accvgpr_read_b32 v241, a105
 v_accvgpr_read_b32 v242, a106
 v_accvgpr_read_b32 v243, a107
 v_accvgpr_read_b32 v244, a120
 v_accvgpr_read_b32 v245, a121
 v_accvgpr_read_b32 v246, a122
 v_accvgpr_read_b32 v247, a123
 v_pk_mul_f32 v[240:241], v[240:241], v[146:147] op_sel_hi:[1,0]
 v_pk_mul_f32 v[242:243], v[242:243], v[146:147] op_sel_hi:[1,0]
 v_pk_mul_f32 v[244:245], v[244:245], v[146:147] op_sel_hi:[1,0]
 v_pk_mul_f32 v[246:247], v[246:247], v[146:147] op_sel_hi:[1,0]
 v_cvt_pk_bf16_f32 v88, v240, v241
 v_cvt_pk_bf16_f32 v89, v242, v243
 v_cvt_pk_bf16_f32 v90, v244, v245
 v_cvt_pk_bf16_f32 v91, v246, v247
 v_accvgpr_read_b32 v248, a108
 v_accvgpr_read_b32 v249, a109
 v_accvgpr_read_b32 v250, a110
 v_accvgpr_read_b32 v251, a111
 v_accvgpr_read_b32 v252, a124
 v_accvgpr_read_b32 v253, a125
 v_accvgpr_read_b32 v254, a126
 v_accvgpr_read_b32 v255, a127
 v_pk_mul_f32 v[248:249], v[248:249], v[146:147] op_sel:[0,1] op_sel_hi:[1,1]
 v_pk_mul_f32 v[250:251], v[250:251], v[146:147] op_sel:[0,1] op_sel_hi:[1,1]
 v_pk_mul_f32 v[252:253], v[252:253], v[146:147] op_sel:[0,1] op_sel_hi:[1,1]
 v_pk_mul_f32 v[254:255], v[254:255], v[146:147] op_sel:[0,1] op_sel_hi:[1,1]
 v_cvt_pk_bf16_f32 v92, v248, v249
 v_cvt_pk_bf16_f32 v93, v250, v251
 v_cvt_pk_bf16_f32 v94, v252, v253
 v_cvt_pk_bf16_f32 v95, v254, v255
 v_accvgpr_read_b32 v160, a128
 v_accvgpr_read_b32 v161, a129
 v_accvgpr_read_b32 v162, a130
 v_accvgpr_read_b32 v163, a131
 v_accvgpr_read_b32 v164, a144
 v_accvgpr_read_b32 v165, a145
 v_accvgpr_read_b32 v166, a146
 v_accvgpr_read_b32 v167, a147
 v_pk_mul_f32 v[160:161], v[160:161], v[144:145] op_sel_hi:[1,0]
 v_pk_mul_f32 v[162:163], v[162:163], v[144:145] op_sel_hi:[1,0]
 v_pk_mul_f32 v[164:165], v[164:165], v[144:145] op_sel_hi:[1,0]
 v_pk_mul_f32 v[166:167], v[166:167], v[144:145] op_sel_hi:[1,0]
 v_cvt_pk_bf16_f32 v96, v160, v161
 v_cvt_pk_bf16_f32 v97, v162, v163
 v_cvt_pk_bf16_f32 v98, v164, v165
 v_cvt_pk_bf16_f32 v99, v166, v167
 v_accvgpr_read_b32 v168, a132
 v_accvgpr_read_b32 v169, a133
 v_accvgpr_read_b32 v170, a134
 v_accvgpr_read_b32 v171, a135
 v_accvgpr_read_b32 v172, a148
 v_accvgpr_read_b32 v173, a149
 v_accvgpr_read_b32 v174, a150
 v_accvgpr_read_b32 v175, a151
 v_pk_mul_f32 v[168:169], v[168:169], v[144:145] op_sel:[0,1] op_sel_hi:[1,1]
 v_pk_mul_f32 v[170:171], v[170:171], v[144:145] op_sel:[0,1] op_sel_hi:[1,1]
 v_pk_mul_f32 v[172:173], v[172:173], v[144:145] op_sel:[0,1] op_sel_hi:[1,1]
 v_pk_mul_f32 v[174:175], v[174:175], v[144:145] op_sel:[0,1] op_sel_hi:[1,1]
 v_cvt_pk_bf16_f32 v100, v168, v169
 v_cvt_pk_bf16_f32 v101, v170, v171
 v_cvt_pk_bf16_f32 v102, v172, v173
 v_cvt_pk_bf16_f32 v103, v174, v175
 v_accvgpr_read_b32 v176, a136
 v_accvgpr_read_b32 v177, a137
 v_accvgpr_read_b32 v178, a138
 v_accvgpr_read_b32 v179, a139
 v_accvgpr_read_b32 v180, a152
 v_accvgpr_read_b32 v181, a153
 v_accvgpr_read_b32 v182, a154
 v_accvgpr_read_b32 v183, a155
 v_pk_mul_f32 v[176:177], v[176:177], v[146:147] op_sel_hi:[1,0]
 v_pk_mul_f32 v[178:179], v[178:179], v[146:147] op_sel_hi:[1,0]
 v_pk_mul_f32 v[180:181], v[180:181], v[146:147] op_sel_hi:[1,0]
 v_pk_mul_f32 v[182:183], v[182:183], v[146:147] op_sel_hi:[1,0]
 v_cvt_pk_bf16_f32 v104, v176, v177
 v_cvt_pk_bf16_f32 v105, v178, v179
 v_cvt_pk_bf16_f32 v106, v180, v181
 v_cvt_pk_bf16_f32 v107, v182, v183
 v_accvgpr_read_b32 v184, a140
 v_accvgpr_read_b32 v185, a141
 v_accvgpr_read_b32 v186, a142
 v_accvgpr_read_b32 v187, a143
 v_accvgpr_read_b32 v188, a156
 v_accvgpr_read_b32 v189, a157
 v_accvgpr_read_b32 v190, a158
 v_accvgpr_read_b32 v191, a159
 v_pk_mul_f32 v[184:185], v[184:185], v[146:147] op_sel:[0,1] op_sel_hi:[1,1]
 v_pk_mul_f32 v[186:187], v[186:187], v[146:147] op_sel:[0,1] op_sel_hi:[1,1]
 v_pk_mul_f32 v[188:189], v[188:189], v[146:147] op_sel:[0,1] op_sel_hi:[1,1]
 v_pk_mul_f32 v[190:191], v[190:191], v[146:147] op_sel:[0,1] op_sel_hi:[1,1]
 v_cvt_pk_bf16_f32 v108, v184, v185
 v_cvt_pk_bf16_f32 v109, v186, v187
 v_cvt_pk_bf16_f32 v110, v188, v189
 v_cvt_pk_bf16_f32 v111, v190, v191
 v_accvgpr_read_b32 v224, a160
 v_accvgpr_read_b32 v225, a161
 v_accvgpr_read_b32 v226, a162
 v_accvgpr_read_b32 v227, a163
 v_accvgpr_read_b32 v228, a176
 v_accvgpr_read_b32 v229, a177
 v_accvgpr_read_b32 v230, a178
 v_accvgpr_read_b32 v231, a179
 v_pk_mul_f32 v[224:225], v[224:225], v[144:145] op_sel_hi:[1,0]
 v_pk_mul_f32 v[226:227], v[226:227], v[144:145] op_sel_hi:[1,0]
 v_pk_mul_f32 v[228:229], v[228:229], v[144:145] op_sel_hi:[1,0]
 v_pk_mul_f32 v[230:231], v[230:231], v[144:145] op_sel_hi:[1,0]
 v_cvt_pk_bf16_f32 v112, v224, v225
 v_cvt_pk_bf16_f32 v113, v226, v227
 v_cvt_pk_bf16_f32 v114, v228, v229
 v_cvt_pk_bf16_f32 v115, v230, v231
 v_accvgpr_read_b32 v232, a164
 v_accvgpr_read_b32 v233, a165
 v_accvgpr_read_b32 v234, a166
 v_accvgpr_read_b32 v235, a167
 v_accvgpr_read_b32 v236, a180
 v_accvgpr_read_b32 v237, a181
 v_accvgpr_read_b32 v238, a182
 v_accvgpr_read_b32 v239, a183
 v_pk_mul_f32 v[232:233], v[232:233], v[144:145] op_sel:[0,1] op_sel_hi:[1,1]
 v_pk_mul_f32 v[234:235], v[234:235], v[144:145] op_sel:[0,1] op_sel_hi:[1,1]
 v_pk_mul_f32 v[236:237], v[236:237], v[144:145] op_sel:[0,1] op_sel_hi:[1,1]
 v_pk_mul_f32 v[238:239], v[238:239], v[144:145] op_sel:[0,1] op_sel_hi:[1,1]
 v_cvt_pk_bf16_f32 v116, v232, v233
 v_cvt_pk_bf16_f32 v117, v234, v235
 v_cvt_pk_bf16_f32 v118, v236, v237
 v_cvt_pk_bf16_f32 v119, v238, v239
 v_accvgpr_read_b32 v240, a168
 v_accvgpr_read_b32 v241, a169
 v_accvgpr_read_b32 v242, a170
 v_accvgpr_read_b32 v243, a171
 v_accvgpr_read_b32 v244, a184
 v_accvgpr_read_b32 v245, a185
 v_accvgpr_read_b32 v246, a186
 v_accvgpr_read_b32 v247, a187
 v_pk_mul_f32 v[240:241], v[240:241], v[146:147] op_sel_hi:[1,0]
 v_pk_mul_f32 v[242:243], v[242:243], v[146:147] op_sel_hi:[1,0]
 v_pk_mul_f32 v[244:245], v[244:245], v[146:147] op_sel_hi:[1,0]
 v_pk_mul_f32 v[246:247], v[246:247], v[146:147] op_sel_hi:[1,0]
 v_cvt_pk_bf16_f32 v120, v240, v241
 v_cvt_pk_bf16_f32 v121, v242, v243
 v_cvt_pk_bf16_f32 v122, v244, v245
 v_cvt_pk_bf16_f32 v123, v246, v247
 v_accvgpr_read_b32 v248, a172
 v_accvgpr_read_b32 v249, a173
 v_accvgpr_read_b32 v250, a174
 v_accvgpr_read_b32 v251, a175
 v_accvgpr_read_b32 v252, a188
 v_accvgpr_read_b32 v253, a189
 v_accvgpr_read_b32 v254, a190
 v_accvgpr_read_b32 v255, a191
 v_pk_mul_f32 v[248:249], v[248:249], v[146:147] op_sel:[0,1] op_sel_hi:[1,1]
 v_pk_mul_f32 v[250:251], v[250:251], v[146:147] op_sel:[0,1] op_sel_hi:[1,1]
 v_pk_mul_f32 v[252:253], v[252:253], v[146:147] op_sel:[0,1] op_sel_hi:[1,1]
 v_pk_mul_f32 v[254:255], v[254:255], v[146:147] op_sel:[0,1] op_sel_hi:[1,1]
 v_cvt_pk_bf16_f32 v124, v248, v249
 v_cvt_pk_bf16_f32 v125, v250, v251
 v_cvt_pk_bf16_f32 v126, v252, v253
 v_cvt_pk_bf16_f32 v127, v254, v255
 s_waitcnt vmcnt(0)
 s_lshl_b32 s75, s63, 3
 s_add_u32 s75, s75, s87
 s_add_u32 s76, s83, 1
 v_mov_b32 v4, s82
 v_mov_b32 v5, s76
 v_mov_b32 v6, 0
 buffer_store_dwordx2 v[4:5], v6, s[48:51], s75 offen sc0 sc1
 s_waitcnt lgkmcnt(0)
 v_mfma_f32_16x16x32_bf16 a[0:3], a[192:195], v[32:35], 0
 ds_read_b64_tr_b16 a[204:205], v15 offset:0
 ds_read_b64_tr_b16 a[206:207], v15 offset:2048
 v_mfma_f32_16x16x32_bf16 a[0:3], a[196:199], v[48:51], a[0:3]
 ds_read_b64_tr_b16 a[208:209], v15 offset:4096
 ds_read_b64_tr_b16 a[210:211], v15 offset:6144
 v_mfma_f32_16x16x32_bf16 a[0:3], a[200:203], v[64:67], a[0:3]
 ds_read_b64_tr_b16 a[212:213], v15 offset:8192
 ds_read_b64_tr_b16 a[214:215], v15 offset:10240
 v_mfma_f32_16x16x32_bf16 a[4:7], a[192:195], v[36:39], 0
 s_add_u32 s75, s89, 12288
 buffer_store_dwordx4 v[80:83], v1, s[36:39], s75 offen offset:0 sc1
 v_mfma_f32_16x16x32_bf16 a[4:7], a[196:199], v[52:55], a[4:7]
 buffer_store_dwordx4 v[84:87], v1, s[36:39], s75 offen offset:1024 sc1
 v_mfma_f32_16x16x32_bf16 a[4:7], a[200:203], v[68:71], a[4:7]
 v_mfma_f32_16x16x32_bf16 a[8:11], a[192:195], v[40:43], 0
 v_mfma_f32_16x16x32_bf16 a[8:11], a[196:199], v[56:59], a[8:11]
 buffer_store_dwordx4 v[88:91], v1, s[36:39], s75 offen offset:2048 sc1
 v_mfma_f32_16x16x32_bf16 a[8:11], a[200:203], v[72:75], a[8:11]
 v_mfma_f32_16x16x32_bf16 a[12:15], a[192:195], v[44:47], 0
 v_mfma_f32_16x16x32_bf16 a[12:15], a[196:199], v[60:63], a[12:15]
 v_mfma_f32_16x16x32_bf16 a[12:15], a[200:203], v[76:79], a[12:15]
 s_waitcnt lgkmcnt(0)
 v_mfma_f32_16x16x32_bf16 a[16:19], a[204:207], v[32:35], 0
 ds_read_b64_tr_b16 a[216:217], v16 offset:0
 ds_read_b64_tr_b16 a[218:219], v16 offset:2048
 v_mfma_f32_16x16x32_bf16 a[16:19], a[208:211], v[48:51], a[16:19]
 ds_read_b64_tr_b16 a[220:221], v16 offset:4096
 ds_read_b64_tr_b16 a[222:223], v16 offset:6144
 v_mfma_f32_16x16x32_bf16 a[16:19], a[212:215], v[64:67], a[16:19]
 ds_read_b64_tr_b16 a[192:193], v16 offset:8192
 ds_read_b64_tr_b16 a[194:195], v16 offset:10240
 v_mfma_f32_16x16x32_bf16 a[20:23], a[204:207], v[36:39], 0
 buffer_store_dwordx4 v[92:95], v1, s[36:39], s75 offen offset:3072 sc1
 v_mfma_f32_16x16x32_bf16 a[20:23], a[208:211], v[52:55], a[20:23]
 s_add_u32 s75, s89, 16384
 buffer_store_dwordx4 v[96:99], v1, s[36:39], s75 offen offset:0 sc1
 v_mfma_f32_16x16x32_bf16 a[20:23], a[212:215], v[68:71], a[20:23]
 v_mfma_f32_16x16x32_bf16 a[24:27], a[204:207], v[40:43], 0
 v_mfma_f32_16x16x32_bf16 a[24:27], a[208:211], v[56:59], a[24:27]
 buffer_store_dwordx4 v[100:103], v1, s[36:39], s75 offen offset:1024 sc1
 v_mfma_f32_16x16x32_bf16 a[24:27], a[212:215], v[72:75], a[24:27]
 v_mfma_f32_16x16x32_bf16 a[28:31], a[204:207], v[44:47], 0
 v_mfma_f32_16x16x32_bf16 a[28:31], a[208:211], v[60:63], a[28:31]
 v_mfma_f32_16x16x32_bf16 a[28:31], a[212:215], v[76:79], a[28:31]
 s_waitcnt lgkmcnt(0)
 v_mfma_f32_16x16x32_bf16 a[32:35], a[216:219], v[32:35], 0
 ds_read_b64_tr_b16 a[196:197], v17 offset:0
 ds_read_b64_tr_b16 a[198:199], v17 offset:2048
 v_mfma_f32_16x16x32_bf16 a[32:35], a[220:223], v[48:51], a[32:35]
 ds_read_b64_tr_b16 a[200:201], v17 offset:4096
 ds_read_b64_tr_b16 a[202:203], v17 offset:6144
 v_mfma_f32_16x16x32_bf16 a[32:35], a[192:195], v[64:67], a[32:35]
 ds_read_b64_tr_b16 a[204:205], v17 offset:8192
 ds_read_b64_tr_b16 a[206:207], v17 offset:10240
 v_mfma_f32_16x16x32_bf16 a[36:39], a[216:219], v[36:39], 0
 buffer_store_dwordx4 v[104:107], v1, s[36:39], s75 offen offset:2048 sc1
 v_mfma_f32_16x16x32_bf16 a[36:39], a[220:223], v[52:55], a[36:39]
 buffer_store_dwordx4 v[108:111], v1, s[36:39], s75 offen offset:3072 sc1
 v_mfma_f32_16x16x32_bf16 a[36:39], a[192:195], v[68:71], a[36:39]
 v_mfma_f32_16x16x32_bf16 a[40:43], a[216:219], v[40:43], 0
 v_mfma_f32_16x16x32_bf16 a[40:43], a[220:223], v[56:59], a[40:43]
 s_add_u32 s75, s89, 20480
 buffer_store_dwordx4 v[112:115], v1, s[36:39], s75 offen offset:0 sc1
 v_mfma_f32_16x16x32_bf16 a[40:43], a[192:195], v[72:75], a[40:43]
 v_mfma_f32_16x16x32_bf16 a[44:47], a[216:219], v[44:47], 0
 v_mfma_f32_16x16x32_bf16 a[44:47], a[220:223], v[60:63], a[44:47]
 v_mfma_f32_16x16x32_bf16 a[44:47], a[192:195], v[76:79], a[44:47]
 s_waitcnt lgkmcnt(0)
 v_mfma_f32_16x16x32_bf16 a[48:51], a[196:199], v[32:35], 0
 v_add_u32 v14, 12288, v27
 v_xor_b32 v15, 32, v14
 v_mfma_f32_16x16x32_bf16 a[48:51], a[200:203], v[48:51], a[48:51]
 v_xor_b32 v16, 64, v14
 v_xor_b32 v17, 96, v14
 v_mfma_f32_16x16x32_bf16 a[48:51], a[204:207], v[64:67], a[48:51]
 ds_read_b64_tr_b16 a[208:209], v14 offset:0
 ds_read_b64_tr_b16 a[210:211], v14 offset:2048
 v_mfma_f32_16x16x32_bf16 a[52:55], a[196:199], v[36:39], 0
 ds_read_b64_tr_b16 a[212:213], v14 offset:4096
 ds_read_b64_tr_b16 a[214:215], v14 offset:6144
 v_mfma_f32_16x16x32_bf16 a[52:55], a[200:203], v[52:55], a[52:55]
 ds_read_b64_tr_b16 a[216:217], v14 offset:8192
 ds_read_b64_tr_b16 a[218:219], v14 offset:10240
 buffer_store_dwordx4 v[116:119], v1, s[36:39], s75 offen offset:1024 sc1
 v_mfma_f32_16x16x32_bf16 a[52:55], a[204:207], v[68:71], a[52:55]
 buffer_store_dwordx4 v[120:123], v1, s[36:39], s75 offen offset:2048 sc1
 v_mfma_f32_16x16x32_bf16 a[56:59], a[196:199], v[40:43], 0
 v_mfma_f32_16x16x32_bf16 a[56:59], a[200:203], v[56:59], a[56:59]
 buffer_store_dwordx4 v[124:127], v1, s[36:39], s75 offen offset:3072 sc1
 v_mfma_f32_16x16x32_bf16 a[56:59], a[204:207], v[72:75], a[56:59]
 v_mfma_f32_16x16x32_bf16 a[60:63], a[196:199], v[44:47], 0
 v_mfma_f32_16x16x32_bf16 a[60:63], a[200:203], v[60:63], a[60:63]
 v_mfma_f32_16x16x32_bf16 a[60:63], a[204:207], v[76:79], a[60:63]
 s_waitcnt lgkmcnt(0)
 v_mfma_f32_16x16x32_bf16 a[64:67], a[208:211], v[32:35], 0
 ds_read_b64_tr_b16 a[220:221], v15 offset:0
 ds_read_b64_tr_b16 a[222:223], v15 offset:2048
 v_mfma_f32_16x16x32_bf16 a[64:67], a[212:215], v[48:51], a[64:67]
 ds_read_b64_tr_b16 a[192:193], v15 offset:4096
 ds_read_b64_tr_b16 a[194:195], v15 offset:6144
 v_mfma_f32_16x16x32_bf16 a[64:67], a[216:219], v[64:67], a[64:67]
 ds_read_b64_tr_b16 a[196:197], v15 offset:8192
 ds_read_b64_tr_b16 a[198:199], v15 offset:10240
 v_mfma_f32_16x16x32_bf16 a[68:71], a[208:211], v[36:39], 0
 v_mfma_f32_16x16x32_bf16 a[68:71], a[212:215], v[52:55], a[68:71]
 s_add_u32 m0, s80, 98304
 s_add_u32 s76, s91, s84
 v_mfma_f32_16x16x32_bf16 a[68:71], a[216:219], v[68:71], a[68:71]
 v_mfma_f32_16x16x32_bf16 a[72:75], a[208:211], v[40:43], 0
 v_mfma_f32_16x16x32_bf16 a[72:75], a[212:215], v[56:59], a[72:75]
 v_mfma_f32_16x16x32_bf16 a[72:75], a[216:219], v[72:75], a[72:75]
 v_mfma_f32_16x16x32_bf16 a[76:79], a[208:211], v[44:47], 0
 v_mfma_f32_16x16x32_bf16 a[76:79], a[212:215], v[60:63], a[76:79]
 v_mfma_f32_16x16x32_bf16 a[76:79], a[216:219], v[76:79], a[76:79]
 s_waitcnt lgkmcnt(0)
 v_mfma_f32_16x16x32_bf16 a[80:83], a[220:223], v[32:35], 0
 ds_read_b64_tr_b16 a[200:201], v16 offset:0
 ds_read_b64_tr_b16 a[202:203], v16 offset:2048
 v_mfma_f32_16x16x32_bf16 a[80:83], a[192:195], v[48:51], a[80:83]
 ds_read_b64_tr_b16 a[204:205], v16 offset:4096
 ds_read_b64_tr_b16 a[206:207], v16 offset:6144
 v_mfma_f32_16x16x32_bf16 a[80:83], a[196:199], v[64:67], a[80:83]
 ds_read_b64_tr_b16 a[208:209], v16 offset:8192
 ds_read_b64_tr_b16 a[210:211], v16 offset:10240
 v_mfma_f32_16x16x32_bf16 a[84:87], a[220:223], v[36:39], 0
 s_add_u32 s76, s76, 122880
 v_mfma_f32_16x16x32_bf16 a[84:87], a[192:195], v[52:55], a[84:87]
 v_mfma_f32_16x16x32_bf16 a[84:87], a[196:199], v[68:71], a[84:87]
 v_mfma_f32_16x16x32_bf16 a[88:91], a[220:223], v[40:43], 0
 v_mfma_f32_16x16x32_bf16 a[88:91], a[192:195], v[56:59], a[88:91]
 v_mfma_f32_16x16x32_bf16 a[88:91], a[196:199], v[72:75], a[88:91]
 v_mfma_f32_16x16x32_bf16 a[92:95], a[220:223], v[44:47], 0
 buffer_load_dwordx4 v7, s[40:43], s76 offen offset:0 lds
 v_mfma_f32_16x16x32_bf16 a[92:95], a[192:195], v[60:63], a[92:95]
 v_mfma_f32_16x16x32_bf16 a[92:95], a[196:199], v[76:79], a[92:95]
 s_waitcnt lgkmcnt(0)
 v_mfma_f32_16x16x32_bf16 a[96:99], a[200:203], v[32:35], 0
 ds_read_b64_tr_b16 a[212:213], v17 offset:0
 ds_read_b64_tr_b16 a[214:215], v17 offset:2048
 v_mfma_f32_16x16x32_bf16 a[96:99], a[204:207], v[48:51], a[96:99]
 ds_read_b64_tr_b16 a[216:217], v17 offset:4096
 ds_read_b64_tr_b16 a[218:219], v17 offset:6144
 v_mfma_f32_16x16x32_bf16 a[96:99], a[208:211], v[64:67], a[96:99]
 ds_read_b64_tr_b16 a[220:221], v17 offset:8192
 ds_read_b64_tr_b16 a[222:223], v17 offset:10240
 v_mfma_f32_16x16x32_bf16 a[100:103], a[200:203], v[36:39], 0
 v_mfma_f32_16x16x32_bf16 a[100:103], a[204:207], v[52:55], a[100:103]
 v_mfma_f32_16x16x32_bf16 a[100:103], a[208:211], v[68:71], a[100:103]
 v_mfma_f32_16x16x32_bf16 a[104:107], a[200:203], v[40:43], 0
 buffer_load_dwordx4 v8, s[40:43], s76 offen offset:1024 lds
 v_mfma_f32_16x16x32_bf16 a[104:107], a[204:207], v[56:59], a[104:107]
 v_mfma_f32_16x16x32_bf16 a[104:107], a[208:211], v[72:75], a[104:107]
 v_mfma_f32_16x16x32_bf16 a[108:111], a[200:203], v[44:47], 0
 v_mfma_f32_16x16x32_bf16 a[108:111], a[204:207], v[60:63], a[108:111]
 v_mfma_f32_16x16x32_bf16 a[108:111], a[208:211], v[76:79], a[108:111]
 s_waitcnt lgkmcnt(0)
 v_mfma_f32_16x16x32_bf16 a[112:115], a[212:215], v[32:35], 0
 v_add_u32 v14, 122880, v28
 v_xor_b32 v15, 32, v14
 v_mfma_f32_16x16x32_bf16 a[112:115], a[216:219], v[48:51], a[112:115]
 ds_read_b64_tr_b16 a[192:193], v14 offset:0
 ds_read_b64_tr_b16 a[194:195], v14 offset:1024
 v_mfma_f32_16x16x32_bf16 a[112:115], a[220:223], v[64:67], a[112:115]
 ds_read_b64_tr_b16 a[196:197], v14 offset:2048
 ds_read_b64_tr_b16 a[198:199], v14 offset:3072
 v_mfma_f32_16x16x32_bf16 a[116:119], a[212:215], v[36:39], 0
 ds_read_b64_tr_b16 a[200:201], v14 offset:4096
 ds_read_b64_tr_b16 a[202:203], v14 offset:5120
 v_mfma_f32_16x16x32_bf16 a[116:119], a[216:219], v[52:55], a[116:119]
 buffer_load_dwordx4 v9, s[40:43], s76 offen offset:2048 lds
 v_mfma_f32_16x16x32_bf16 a[116:119], a[220:223], v[68:71], a[116:119]
 v_mfma_f32_16x16x32_bf16 a[120:123], a[212:215], v[40:43], 0
 v_mfma_f32_16x16x32_bf16 a[120:123], a[216:219], v[56:59], a[120:123]
 v_mfma_f32_16x16x32_bf16 a[120:123], a[220:223], v[72:75], a[120:123]
 v_mfma_f32_16x16x32_bf16 a[124:127], a[212:215], v[44:47], 0
 v_mfma_f32_16x16x32_bf16 a[124:127], a[216:219], v[60:63], a[124:127]
 v_mfma_f32_16x16x32_bf16 a[124:127], a[220:223], v[76:79], a[124:127]
 s_waitcnt lgkmcnt(0)
 v_mfma_f32_16x16x32_bf16 a[128:131], a[192:195], v[32:35], 0
 ds_read_b64_tr_b16 a[204:205], v14 offset:6144
 ds_read_b64_tr_b16 a[206:207], v14 offset:7168
 v_mfma_f32_16x16x32_bf16 a[128:131], a[196:199], v[48:51], a[128:131]
 ds_read_b64_tr_b16 a[208:209], v14 offset:8192
 ds_read_b64_tr_b16 a[210:211], v14 offset:9216
 v_mfma_f32_16x16x32_bf16 a[128:131], a[200:203], v[64:67], a[128:131]
 ds_read_b64_tr_b16 a[212:213], v14 offset:10240
 ds_read_b64_tr_b16 a[214:215], v14 offset:11264
 v_mfma_f32_16x16x32_bf16 a[132:135], a[192:195], v[36:39], 0
 s_add_u32 m0, s80, 110592
 s_add_u32 s76, s92, s84
 v_mfma_f32_16x16x32_bf16 a[132:135], a[196:199], v[52:55], a[132:135]
 v_mfma_f32_16x16x32_bf16 a[132:135], a[200:203], v[68:71], a[132:135]
 v_mfma_f32_16x16x32_bf16 a[136:139], a[192:195], v[40:43], 0
 v_mfma_f32_16x16x32_bf16 a[136:139], a[196:199], v[56:59], a[136:139]
 s_add_u32 s76, s76, 122880
 v_mfma_f32_16x16x32_bf16 a[136:139], a[200:203], v[72:75], a[136:139]
 v_mfma_f32_16x16x32_bf16 a[140:143], a[192:195], v[44:47], 0
 v_mfma_f32_16x16x32_bf16 a[140:143], a[196:199], v[60:63], a[140:143]
 v_mfma_f32_16x16x32_bf16 a[140:143], a[200:203], v[76:79], a[140:143]
 s_waitcnt lgkmcnt(0)
 v_mfma_f32_16x16x32_bf16 a[128:131], a[204:207], v[80:83], a[128:131]
 ds_read_b64_tr_b16 a[216:217], v15 offset:0
 ds_read_b64_tr_b16 a[218:219], v15 offset:1024
 v_mfma_f32_16x16x32_bf16 a[128:131], a[208:211], v[96:99], a[128:131]
 ds_read_b64_tr_b16 a[220:221], v15 offset:2048
 ds_read_b64_tr_b16 a[222:223], v15 offset:3072
 v_mfma_f32_16x16x32_bf16 a[128:131], a[212:215], v[112:115], a[128:131]
 ds_read_b64_tr_b16 a[192:193], v15 offset:4096
 ds_read_b64_tr_b16 a[194:195], v15 offset:5120
 v_mfma_f32_16x16x32_bf16 a[132:135], a[204:207], v[84:87], a[132:135]
 buffer_load_dwordx4 v7, s[40:43], s76 offen offset:0 lds
 v_mfma_f32_16x16x32_bf16 a[132:135], a[208:211], v[100:103], a[132:135]
 v_mfma_f32_16x16x32_bf16 a[132:135], a[212:215], v[116:119], a[132:135]
 v_mfma_f32_16x16x32_bf16 a[136:139], a[204:207], v[88:91], a[136:139]
 v_mfma_f32_16x16x32_bf16 a[136:139], a[208:211], v[104:107], a[136:139]
 v_mfma_f32_16x16x32_bf16 a[136:139], a[212:215], v[120:123], a[136:139]
 v_mfma_f32_16x16x32_bf16 a[140:143], a[204:207], v[92:95], a[140:143]
 v_mfma_f32_16x16x32_bf16 a[140:143], a[208:211], v[108:111], a[140:143]
 buffer_load_dwordx4 v8, s[40:43], s76 offen offset:1024 lds
 v_mfma_f32_16x16x32_bf16 a[140:143], a[212:215], v[124:127], a[140:143]
 s_waitcnt lgkmcnt(0)
 v_mfma_f32_16x16x32_bf16 a[144:147], a[216:219], v[32:35], 0
 ds_read_b64_tr_b16 a[196:197], v15 offset:6144
 ds_read_b64_tr_b16 a[198:199], v15 offset:7168
 v_mfma_f32_16x16x32_bf16 a[144:147], a[220:223], v[48:51], a[144:147]
 ds_read_b64_tr_b16 a[200:201], v15 offset:8192
 ds_read_b64_tr_b16 a[202:203], v15 offset:9216
 v_mfma_f32_16x16x32_bf16 a[144:147], a[192:195], v[64:67], a[144:147]
 ds_read_b64_tr_b16 a[204:205], v15 offset:10240
 ds_read_b64_tr_b16 a[206:207], v15 offset:11264
 v_mfma_f32_16x16x32_bf16 a[148:151], a[216:219], v[36:39], 0
 v_mfma_f32_16x16x32_bf16 a[148:151], a[220:223], v[52:55], a[148:151]
 v_mfma_f32_16x16x32_bf16 a[148:151], a[192:195], v[68:71], a[148:151]
 v_mfma_f32_16x16x32_bf16 a[152:155], a[216:219], v[40:43], 0
 buffer_load_dwordx4 v9, s[40:43], s76 offen offset:2048 lds
 v_mfma_f32_16x16x32_bf16 a[152:155], a[220:223], v[56:59], a[152:155]
 v_mfma_f32_16x16x32_bf16 a[152:155], a[192:195], v[72:75], a[152:155]
 v_mfma_f32_16x16x32_bf16 a[156:159], a[216:219], v[44:47], 0
 v_mfma_f32_16x16x32_bf16 a[156:159], a[220:223], v[60:63], a[156:159]
 v_mfma_f32_16x16x32_bf16 a[156:159], a[192:195], v[76:79], a[156:159]
 s_waitcnt lgkmcnt(0)
 v_mfma_f32_16x16x32_bf16 a[144:147], a[196:199], v[80:83], a[144:147]
 v_add_u32 v14, 24576, v27
 v_xor_b32 v15, 32, v14
 v_mfma_f32_16x16x32_bf16 a[144:147], a[200:203], v[96:99], a[144:147]
 v_xor_b32 v16, 64, v14
 v_xor_b32 v17, 96, v14
 v_mfma_f32_16x16x32_bf16 a[144:147], a[204:207], v[112:115], a[144:147]
 ds_read_b64_tr_b16 a[208:209], v14 offset:0
 ds_read_b64_tr_b16 a[210:211], v14 offset:2048
 v_mfma_f32_16x16x32_bf16 a[148:151], a[196:199], v[84:87], a[148:151]
 ds_read_b64_tr_b16 a[212:213], v14 offset:4096
 ds_read_b64_tr_b16 a[214:215], v14 offset:6144
 v_mfma_f32_16x16x32_bf16 a[148:151], a[200:203], v[100:103], a[148:151]
 ds_read_b64_tr_b16 a[216:217], v14 offset:8192
 ds_read_b64_tr_b16 a[218:219], v14 offset:10240
 v_mfma_f32_16x16x32_bf16 a[148:151], a[204:207], v[116:119], a[148:151]
 v_and_b32 v22, 24, v29
 buffer_load_dwordx2 v[2:3], v22, s[48:51], s87 offen sc0 sc1
 v_mfma_f32_16x16x32_bf16 a[152:155], a[196:199], v[88:91], a[152:155]
 v_mfma_f32_16x16x32_bf16 a[152:155], a[200:203], v[104:107], a[152:155]
 v_mfma_f32_16x16x32_bf16 a[152:155], a[204:207], v[120:123], a[152:155]
 v_mfma_f32_16x16x32_bf16 a[156:159], a[196:199], v[92:95], a[156:159]
 v_mfma_f32_16x16x32_bf16 a[156:159], a[200:203], v[108:111], a[156:159]
 v_mfma_f32_16x16x32_bf16 a[156:159], a[204:207], v[124:127], a[156:159]
 s_waitcnt lgkmcnt(0)
 v_mfma_f32_16x16x32_bf16 a[0:3], a[208:211], v[80:83], a[0:3]
 ds_read_b64_tr_b16 a[220:221], v15 offset:0
 ds_read_b64_tr_b16 a[222:223], v15 offset:2048
 v_mfma_f32_16x16x32_bf16 a[0:3], a[212:215], v[96:99], a[0:3]
 ds_read_b64_tr_b16 a[192:193], v15 offset:4096
 ds_read_b64_tr_b16 a[194:195], v15 offset:6144
 v_mfma_f32_16x16x32_bf16 a[0:3], a[216:219], v[112:115], a[0:3]
 ds_read_b64_tr_b16 a[196:197], v15 offset:8192
 ds_read_b64_tr_b16 a[198:199], v15 offset:10240
 v_mfma_f32_16x16x32_bf16 a[4:7], a[208:211], v[84:87], a[4:7]
 v_mfma_f32_16x16x32_bf16 a[4:7], a[212:215], v[100:103], a[4:7]
 v_mfma_f32_16x16x32_bf16 a[4:7], a[216:219], v[116:119], a[4:7]
 v_mfma_f32_16x16x32_bf16 a[8:11], a[208:211], v[88:91], a[8:11]
 v_mfma_f32_16x16x32_bf16 a[8:11], a[212:215], v[104:107], a[8:11]
 v_mfma_f32_16x16x32_bf16 a[8:11], a[216:219], v[120:123], a[8:11]
 v_mfma_f32_16x16x32_bf16 a[12:15], a[208:211], v[92:95], a[12:15]
 v_mfma_f32_16x16x32_bf16 a[12:15], a[212:215], v[108:111], a[12:15]
 v_mfma_f32_16x16x32_bf16 a[12:15], a[216:219], v[124:127], a[12:15]
 s_waitcnt lgkmcnt(0)
 v_mfma_f32_16x16x32_bf16 a[16:19], a[220:223], v[80:83], a[16:19]
 ds_read_b64_tr_b16 a[200:201], v16 offset:0
 ds_read_b64_tr_b16 a[202:203], v16 offset:2048
 v_mfma_f32_16x16x32_bf16 a[16:19], a[192:195], v[96:99], a[16:19]
 ds_read_b64_tr_b16 a[204:205], v16 offset:4096
 ds_read_b64_tr_b16 a[206:207], v16 offset:6144
 v_mfma_f32_16x16x32_bf16 a[16:19], a[196:199], v[112:115], a[16:19]
 ds_read_b64_tr_b16 a[208:209], v16 offset:8192
 ds_read_b64_tr_b16 a[210:211], v16 offset:10240
 v_mfma_f32_16x16x32_bf16 a[20:23], a[220:223], v[84:87], a[20:23]
 v_mfma_f32_16x16x32_bf16 a[20:23], a[192:195], v[100:103], a[20:23]
 v_mfma_f32_16x16x32_bf16 a[20:23], a[196:199], v[116:119], a[20:23]
 v_mfma_f32_16x16x32_bf16 a[24:27], a[220:223], v[88:91], a[24:27]
 v_mfma_f32_16x16x32_bf16 a[24:27], a[192:195], v[104:107], a[24:27]
 v_mfma_f32_16x16x32_bf16 a[24:27], a[196:199], v[120:123], a[24:27]
 v_mfma_f32_16x16x32_bf16 a[28:31], a[220:223], v[92:95], a[28:31]
 v_mfma_f32_16x16x32_bf16 a[28:31], a[192:195], v[108:111], a[28:31]
 v_mfma_f32_16x16x32_bf16 a[28:31], a[196:199], v[124:127], a[28:31]
 s_waitcnt lgkmcnt(0)
 v_mfma_f32_16x16x32_bf16 a[32:35], a[200:203], v[80:83], a[32:35]
 ds_read_b64_tr_b16 a[212:213], v17 offset:0
 ds_read_b64_tr_b16 a[214:215], v17 offset:2048
 v_mfma_f32_16x16x32_bf16 a[32:35], a[204:207], v[96:99], a[32:35]
 ds_read_b64_tr_b16 a[216:217], v17 offset:4096
 ds_read_b64_tr_b16 a[218:219], v17 offset:6144
 v_mfma_f32_16x16x32_bf16 a[32:35], a[208:211], v[112:115], a[32:35]
 ds_read_b64_tr_b16 a[220:221], v17 offset:8192
 ds_read_b64_tr_b16 a[222:223], v17 offset:10240
 v_mfma_f32_16x16x32_bf16 a[36:39], a[200:203], v[84:87], a[36:39]
 v_mfma_f32_16x16x32_bf16 a[36:39], a[204:207], v[100:103], a[36:39]
 v_mfma_f32_16x16x32_bf16 a[36:39], a[208:211], v[116:119], a[36:39]
 v_mfma_f32_16x16x32_bf16 a[40:43], a[200:203], v[88:91], a[40:43]
 v_mfma_f32_16x16x32_bf16 a[40:43], a[204:207], v[104:107], a[40:43]
 v_mfma_f32_16x16x32_bf16 a[40:43], a[208:211], v[120:123], a[40:43]
 v_mfma_f32_16x16x32_bf16 a[44:47], a[200:203], v[92:95], a[44:47]
 v_mfma_f32_16x16x32_bf16 a[44:47], a[204:207], v[108:111], a[44:47]
 v_mfma_f32_16x16x32_bf16 a[44:47], a[208:211], v[124:127], a[44:47]
 s_waitcnt lgkmcnt(0)
 v_mfma_f32_16x16x32_bf16 a[48:51], a[212:215], v[80:83], a[48:51]
 v_add_u32 v14, 135168, v27
 v_xor_b32 v15, 32, v14
 v_mfma_f32_16x16x32_bf16 a[48:51], a[216:219], v[96:99], a[48:51]
 v_xor_b32 v16, 64, v14
 v_xor_b32 v17, 96, v14
 v_mfma_f32_16x16x32_bf16 a[48:51], a[220:223], v[112:115], a[48:51]
 ds_read_b64_tr_b16 a[192:193], v14 offset:0
 ds_read_b64_tr_b16 a[194:195], v14 offset:2048
 v_mfma_f32_16x16x32_bf16 a[52:55], a[212:215], v[84:87], a[52:55]
 ds_read_b64_tr_b16 a[196:197], v14 offset:4096
 ds_read_b64_tr_b16 a[198:199], v14 offset:6144
 v_mfma_f32_16x16x32_bf16 a[52:55], a[216:219], v[100:103], a[52:55]
 ds_read_b64_tr_b16 a[200:201], v14 offset:8192
 ds_read_b64_tr_b16 a[202:203], v14 offset:10240
 v_mfma_f32_16x16x32_bf16 a[52:55], a[220:223], v[116:119], a[52:55]
 v_mfma_f32_16x16x32_bf16 a[56:59], a[212:215], v[88:91], a[56:59]
 v_mfma_f32_16x16x32_bf16 a[56:59], a[216:219], v[104:107], a[56:59]
 v_mfma_f32_16x16x32_bf16 a[56:59], a[220:223], v[120:123], a[56:59]
 v_mfma_f32_16x16x32_bf16 a[60:63], a[212:215], v[92:95], a[60:63]
 v_mfma_f32_16x16x32_bf16 a[60:63], a[216:219], v[108:111], a[60:63]
 v_mfma_f32_16x16x32_bf16 a[60:63], a[220:223], v[124:127], a[60:63]
 s_waitcnt vmcnt(0)
 s_lshl_b32 s75, s63, 3
 s_add_u32 s75, s75, s87
 s_add_u32 s76, s83, 2
 v_mov_b32 v4, s82
 v_mov_b32 v5, s76
 v_mov_b32 v6, 0
 buffer_store_dwordx2 v[4:5], v6, s[48:51], s75 offen sc0 sc1
 s_add_u32 s76, s83, 1
 s_mov_b32 s86, 0
 s_branch L_POLLC_O1
L_POLL_O1:
 buffer_load_dwordx2 v[2:3], v22, s[48:51], s87 offen sc0 sc1
 s_waitcnt vmcnt(0)
L_POLLC_O1:
 v_cmp_ne_u32 vcc, s82, v2
 v_subrev_u32 v23, s76, v3
 v_cmp_lt_u32 s[96:97], 3, v23
 s_add_u32 s86, s86, 1
 s_cmp_gt_u32 s86, 30000
 s_cbranch_scc1 L_POLLX_O1
 s_or_b64 vcc, vcc, s[96:97]
 s_cbranch_scc1 L_POLL_O1
L_POLLX_O1:
 s_add_u32 s74, s63, 1
 s_and_b32 s74, s74, 3
 s_mul_i32 s74, s74, 98304
 s_add_u32 s75, s74, 0
 buffer_load_dwordx4 v[128:131], v1, s[36:39], s75 offen offset:0 sc1
 buffer_load_dwordx4 v[132:135], v1, s[36:39], s75 offen offset:1024 sc1
 buffer_load_dwordx4 v[136:139], v1, s[36:39], s75 offen offset:2048 sc1
 buffer_load_dwordx4 v[140:143], v1, s[36:39], s75 offen offset:3072 sc1
 s_add_u32 s75, s74, 4096
 buffer_load_dwordx4 v[144:147], v1, s[36:39], s75 offen offset:0 sc1
 buffer_load_dwordx4 v[148:151], v1, s[36:39], s75 offen offset:1024 sc1
 buffer_load_dwordx4 v[152:155], v1, s[36:39], s75 offen offset:2048 sc1
 buffer_load_dwordx4 v[156:159], v1, s[36:39], s75 offen offset:3072 sc1
 s_add_u32 s75, s74, 8192
 buffer_load_dwordx4 v[160:163], v1, s[36:39], s75 offen offset:0 sc1
 buffer_load_dwordx4 v[164:167], v1, s[36:39], s75 offen offset:1024 sc1
 buffer_load_dwordx4 v[168:171], v1, s[36:39], s75 offen offset:2048 sc1
 buffer_load_dwordx4 v[172:175], v1, s[36:39], s75 offen offset:3072 sc1
 s_barrier
 s_waitcnt lgkmcnt(0)
 v_mfma_f32_16x16x32_bf16 a[64:67], a[192:195], v[80:83], a[64:67]
 s_add_u32 s74, s63, 2
 s_and_b32 s74, s74, 3
 v_mfma_f32_16x16x32_bf16 a[64:67], a[196:199], v[96:99], a[64:67]
 ds_read_b64_tr_b16 a[204:205], v15 offset:0
 ds_read_b64_tr_b16 a[206:207], v15 offset:2048
 v_mfma_f32_16x16x32_bf16 a[64:67], a[200:203], v[112:115], a[64:67]
 ds_read_b64_tr_b16 a[208:209], v15 offset:4096
 ds_read_b64_tr_b16 a[210:211], v15 offset:6144
 v_mfma_f32_16x16x32_bf16 a[68:71], a[192:195], v[84:87], a[68:71]
 ds_read_b64_tr_b16 a[212:213], v15 offset:8192
 ds_read_b64_tr_b16 a[214:215], v15 offset:10240
 v_mfma_f32_16x16x32_bf16 a[68:71], a[196:199], v[100:103], a[68:71]
 s_mul_i32 s74, s74, 98304
 v_mfma_f32_16x16x32_bf16 a[68:71], a[200:203], v[116:119], a[68:71]
 s_add_u32 s75, s74, 0
 v_mfma_f32_16x16x32_bf16 a[72:75], a[192:195], v[88:91], a[72:75]
 v_mfma_f32_16x16x32_bf16 a[72:75], a[196:199], v[104:107], a[72:75]
 v_mfma_f32_16x16x32_bf16 a[72:75], a[200:203], v[120:123], a[72:75]
 buffer_load_dwordx4 v[224:227], v1, s[36:39], s75 offen offset:0 sc1
 v_mfma_f32_16x16x32_bf16 a[76:79], a[192:195], v[92:95], a[76:79]
 v_mfma_f32_16x16x32_bf16 a[76:79], a[196:199], v[108:111], a[76:79]
 v_mfma_f32_16x16x32_bf16 a[76:79], a[200:203], v[124:127], a[76:79]
 s_waitcnt lgkmcnt(0)
 v_mfma_f32_16x16x32_bf16 a[80:83], a[204:207], v[80:83], a[80:83]
 buffer_load_dwordx4 v[228:231], v1, s[36:39], s75 offen offset:1024 sc1
 v_mfma_f32_16x16x32_bf16 a[80:83], a[208:211], v[96:99], a[80:83]
 ds_read_b64_tr_b16 a[216:217], v16 offset:0
 ds_read_b64_tr_b16 a[218:219], v16 offset:2048
 v_mfma_f32_16x16x32_bf16 a[80:83], a[212:215], v[112:115], a[80:83]
 ds_read_b64_tr_b16 a[220:221], v16 offset:4096
 ds_read_b64_tr_b16 a[222:223], v16 offset:6144
 v_mfma_f32_16x16x32_bf16 a[84:87], a[204:207], v[84:87], a[84:87]
 ds_read_b64_tr_b16 a[192:193], v16 offset:8192
 ds_read_b64_tr_b16 a[194:195], v16 offset:10240
 v_mfma_f32_16x16x32_bf16 a[84:87], a[208:211], v[100:103], a[84:87]
 buffer_load_dwordx4 v[232:235], v1, s[36:39], s75 offen offset:2048 sc1
 v_mfma_f32_16x16x32_bf16 a[84:87], a[212:215], v[116:119], a[84:87]
 buffer_load_dwordx4 v[236:239], v1, s[36:39], s75 offen offset:3072 sc1
 v_mfma_f32_16x16x32_bf16 a[88:91], a[204:207], v[88:91], a[88:91]
 v_mfma_f32_16x16x32_bf16 a[88:91], a[208:211], v[104:107], a[88:91]
 s_add_u32 s75, s74, 4096
 v_mfma_f32_16x16x32_bf16 a[88:91], a[212:215], v[120:123], a[88:91]
 v_mfma_f32_16x16x32_bf16 a[92:95], a[204:207], v[92:95], a[92:95]
 v_mfma_f32_16x16x32_bf16 a[92:95], a[208:211], v[108:111], a[92:95]
 buffer_load_dwordx4 v[240:243], v1, s[36:39], s75 offen offset:0 sc1
 v_mfma_f32_16x16x32_bf16 a[92:95], a[212:215], v[124:127], a[92:95]
 s_waitcnt lgkmcnt(0)
 v_mfma_f32_16x16x32_bf16 a[96:99], a[216:219], v[80:83], a[96:99]
 ds_read_b64_tr_b16 a[196:197], v17 offset:0
 ds_read_b64_tr_b16 a[198:199], v17 offset:2048
 v_mfma_f32_16x16x32_bf16 a[96:99], a[220:223], v[96:99], a[96:99]
 ds_read_b64_tr_b16 a[200:201], v17 offset:4096
 ds_read_b64_tr_b16 a[202:203], v17 offset:6144
 v_mfma_f32_16x16x32_bf16 a[96:99], a[192:195], v[112:115], a[96:99]
 ds_read_b64_tr_b16 a[204:205], v17 offset:8192
 ds_read_b64_tr_b16 a[206:207], v17 offset:10240
 v_mfma_f32_16x16x32_bf16 a[100:103], a[216:219], v[84:87], a[100:103]
 buffer_load_dwordx4 v[244:247], v1, s[36:39], s75 offen offset:1024 sc1
 v_mfma_f32_16x16x32_bf16 a[100:103], a[220:223], v[100:103], a[100:103]
 buffer_load_dwordx4 v[248:251], v1, s[36:39], s75 offen offset:2048 sc1
 v_mfma_f32_16x16x32_bf16 a[100:103], a[192:195], v[116:119], a[100:103]
 v_mfma_f32_16x16x32_bf16 a[104:107], a[216:219], v[88:91], a[104:107]
 v_mfma_f32_16x16x32_bf16 a[104:107], a[220:223], v[104:107], a[104:107]
 buffer_load_dwordx4 v[252:255], v1, s[36:39], s75 offen offset:3072 sc1
 v_mfma_f32_16x16x32_bf16 a[104:107], a[192:195], v[120:123], a[104:107]
 v_mfma_f32_16x16x32_bf16 a[108:111], a[216:219], v[92:95], a[108:111]
 s_add_u32 s75, s74, 8192
 v_mfma_f32_16x16x32_bf16 a[108:111], a[220:223], v[108:111], a[108:111]
 v_mfma_f32_16x16x32_bf16 a[108:111], a[192:195], v[124:127], a[108:111]
 s_waitcnt lgkmcnt(0)
 v_mfma_f32_16x16x32_bf16 a[112:115], a[196:199], v[80:83], a[112:115]
 v_add_u32 v14, 36864, v27
 v_xor_b32 v15, 32, v14
 v_mfma_f32_16x16x32_bf16 a[112:115], a[200:203], v[96:99], a[112:115]
 v_xor_b32 v16, 64, v14
 v_xor_b32 v17, 96, v14
 v_mfma_f32_16x16x32_bf16 a[112:115], a[204:207], v[112:115], a[112:115]
 ds_read_b64_tr_b16 a[208:209], v14 offset:0
 ds_read_b64_tr_b16 a[210:211], v14 offset:2048
 v_mfma_f32_16x16x32_bf16 a[116:119], a[196:199], v[84:87], a[116:119]
 ds_read_b64_tr_b16 a[212:213], v14 offset:4096
 ds_read_b64_tr_b16 a[214:215], v14 offset:6144
 v_mfma_f32_16x16x32_bf16 a[116:119], a[200:203], v[100:103], a[116:119]
 ds_read_b64_tr_b16 a[216:217], v14 offset:8192
 ds_read_b64_tr_b16 a[218:219], v14 offset:10240
 buffer_load_dwordx4 a[160:163], v1, s[36:39], s75 offen offset:0 sc1
 v_mfma_f32_16x16x32_bf16 a[116:119], a[204:207], v[116:119], a[116:119]
 buffer_load_dwordx4 a[164:167], v1, s[36:39], s75 offen offset:1024 sc1
 v_mfma_f32_16x16x32_bf16 a[120:123], a[196:199], v[88:91], a[120:123]
 buffer_load_dwordx4 a[168:171], v1, s[36:39], s75 offen offset:2048 sc1
 v_mfma_f32_16x16x32_bf16 a[120:123], a[200:203], v[104:107], a[120:123]
 v_mfma_f32_16x16x32_bf16 a[120:123], a[204:207], v[120:123], a[120:123]
 v_mfma_f32_16x16x32_bf16 a[124:127], a[196:199], v[92:95], a[124:127]
 buffer_load_dwordx4 a[172:175], v1, s[36:39], s75 offen offset:3072 sc1
 v_mfma_f32_16x16x32_bf16 a[124:127], a[200:203], v[108:111], a[124:127]
 v_mfma_f32_16x16x32_bf16 a[124:127], a[204:207], v[124:127], a[124:127]
 s_waitcnt lgkmcnt(0)
 s_waitcnt vmcnt(23)
 v_mfma_f32_16x16x32_bf16 a[0:3], a[208:211], v[128:131], a[0:3]
 ds_read_b64_tr_b16 a[220:221], v15 offset:0
 ds_read_b64_tr_b16 a[222:223], v15 offset:2048
 s_waitcnt vmcnt(19)
 v_mfma_f32_16x16x32_bf16 a[0:3], a[212:215], v[144:147], a[0:3]
 ds_read_b64_tr_b16 a[192:193], v15 offset:4096
 ds_read_b64_tr_b16 a[194:195], v15 offset:6144
 s_waitcnt vmcnt(15)
 v_mfma_f32_16x16x32_bf16 a[0:3], a[216:219], v[160:163], a[0:3]
 ds_read_b64_tr_b16 a[196:197], v15 offset:8192
 ds_read_b64_tr_b16 a[198:199], v15 offset:10240
 v_mfma_f32_16x16x32_bf16 a[4:7], a[208:211], v[132:135], a[4:7]
 v_mfma_f32_16x16x32_bf16 a[4:7], a[212:215], v[148:151], a[4:7]
 s_waitcnt vmcnt(14)
 v_mfma_f32_16x16x32_bf16 a[4:7], a[216:219], v[164:167], a[4:7]
 v_mfma_f32_16x16x32_bf16 a[8:11], a[208:211], v[136:139], a[8:11]
 v_mfma_f32_16x16x32_bf16 a[8:11], a[212:215], v[152:155], a[8:11]
 s_waitcnt vmcnt(13)
 v_mfma_f32_16x16x32_bf16 a[8:11], a[216:219], v[168:171], a[8:11]
 v_mfma_f32_16x16x32_bf16 a[12:15], a[208:211], v[140:143], a[12:15]
 v_mfma_f32_16x16x32_bf16 a[12:15], a[212:215], v[156:159], a[12:15]
 s_waitcnt vmcnt(12)
 v_mfma_f32_16x16x32_bf16 a[12:15], a[216:219], v[172:175], a[12:15]
 s_waitcnt lgkmcnt(0)
 v_mfma_f32_16x16x32_bf16 a[16:19], a[220:223], v[128:131], a[16:19]
 s_add_u32 s74, s63, 3
 s_and_b32 s74, s74, 3
 v_mfma_f32_16x16x32_bf16 a[16:19], a[192:195], v[144:147], a[16:19]
 ds_read_b64_tr_b16 a[200:201], v16 offset:0
 ds_read_b64_tr_b16 a[202:203], v16 offset:2048
 v_mfma_f32_16x16x32_bf16 a[16:19], a[196:199], v[160:163], a[16:19]
 ds_read_b64_tr_b16 a[204:205], v16 offset:4096
 ds_read_b64_tr_b16 a[206:207], v16 offset:6144
 v_mfma_f32_16x16x32_bf16 a[20:23], a[220:223], v[132:135], a[20:23]
 ds_read_b64_tr_b16 a[208:209], v16 offset:8192
 ds_read_b64_tr_b16 a[210:211], v16 offset:10240
 v_mfma_f32_16x16x32_bf16 a[20:23], a[192:195], v[148:151], a[20:23]
 s_mul_i32 s74, s74, 98304
 s_add_u32 s75, s74, 0
 v_mfma_f32_16x16x32_bf16 a[20:23], a[196:199], v[164:167], a[20:23]
 v_mfma_f32_16x16x32_bf16 a[24:27], a[220:223], v[136:139], a[24:27]
 buffer_load_dwordx4 v[32:35], v1, s[36:39], s75 offen offset:0 sc1
 v_mfma_f32_16x16x32_bf16 a[24:27], a[192:195], v[152:155], a[24:27]
 v_mfma_f32_16x16x32_bf16 a[24:27], a[196:199], v[168:171], a[24:27]
 buffer_load_dwordx4 v[36:39], v1, s[36:39], s75 offen offset:1024 sc1
 v_mfma_f32_16x16x32_bf16 a[28:31], a[220:223], v[140:143], a[28:31]
 v_mfma_f32_16x16x32_bf16 a[28:31], a[192:195], v[156:159], a[28:31]
 buffer_load_dwordx4 v[40:43], v1, s[36:39], s75 offen offset:2048 sc1
 v_mfma_f32_16x16x32_bf16 a[28:31], a[196:199], v[172:175], a[28:31]
 s_waitcnt lgkmcnt(0)
 v_mfma_f32_16x16x32_bf16 a[32:35], a[200:203], v[128:131], a[32:35]
 buffer_load_dwordx4 v[44:47], v1, s[36:39], s75 offen offset:3072 sc1
 v_mfma_f32_16x16x32_bf16 a[32:35], a[204:207], v[144:147], a[32:35]
 ds_read_b64_tr_b16 a[212:213], v17 offset:0
 ds_read_b64_tr_b16 a[214:215], v17 offset:2048
 v_mfma_f32_16x16x32_bf16 a[32:35], a[208:211], v[160:163], a[32:35]
 ds_read_b64_tr_b16 a[216:217], v17 offset:4096
 ds_read_b64_tr_b16 a[218:219], v17 offset:6144
 v_mfma_f32_16x16x32_bf16 a[36:39], a[200:203], v[132:135], a[36:39]
 ds_read_b64_tr_b16 a[220:221], v17 offset:8192
 ds_read_b64_tr_b16 a[222:223], v17 offset:10240
 v_mfma_f32_16x16x32_bf16 a[36:39], a[204:207], v[148:151], a[36:39]
 s_add_u32 s75, s74, 4096
 v_mfma_f32_16x16x32_bf16 a[36:39], a[208:211], v[164:167], a[36:39]
 buffer_load_dwordx4 v[48:51], v1, s[36:39], s75 offen offset:0 sc1
 v_mfma_f32_16x16x32_bf16 a[40:43], a[200:203], v[136:139], a[40:43]
 buffer_load_dwordx4 v[52:55], v1, s[36:39], s75 offen offset:1024 sc1
 v_mfma_f32_16x16x32_bf16 a[40:43], a[204:207], v[152:155], a[40:43]
 v_mfma_f32_16x16x32_bf16 a[40:43], a[208:211], v[168:171], a[40:43]
 buffer_load_dwordx4 v[56:59], v1, s[36:39], s75 offen offset:2048 sc1
 v_mfma_f32_16x16x32_bf16 a[44:47], a[200:203], v[140:143], a[44:47]
 v_mfma_f32_16x16x32_bf16 a[44:47], a[204:207], v[156:159], a[44:47]
 buffer_load_dwordx4 v[60:63], v1, s[36:39], s75 offen offset:3072 sc1
 v_mfma_f32_16x16x32_bf16 a[44:47], a[208:211], v[172:175], a[44:47]
 s_waitcnt lgkmcnt(0)
 v_mfma_f32_16x16x32_bf16 a[48:51], a[212:215], v[128:131], a[48:51]
 s_add_u32 s75, s74, 8192
 v_add_u32 v14, 147456, v27
 v_mfma_f32_16x16x32_bf16 a[48:51], a[216:219], v[144:147], a[48:51]
 v_xor_b32 v15, 32, v14
 v_xor_b32 v16, 64, v14
 v_mfma_f32_16x16x32_bf16 a[48:51], a[220:223], v[160:163], a[48:51]
 v_xor_b32 v17, 96, v14
 ds_read_b64_tr_b16 a[192:193], v14 offset:0
 v_mfma_f32_16x16x32_bf16 a[52:55], a[212:215], v[132:135], a[52:55]
 ds_read_b64_tr_b16 a[194:195], v14 offset:2048
 ds_read_b64_tr_b16 a[196:197], v14 offset:4096
 v_mfma_f32_16x16x32_bf16 a[52:55], a[216:219], v[148:151], a[52:55]
 ds_read_b64_tr_b16 a[198:199], v14 offset:6144
 ds_read_b64_tr_b16 a[200:201], v14 offset:8192
 ds_read_b64_tr_b16 a[202:203], v14 offset:10240
 v_mfma_f32_16x16x32_bf16 a[52:55], a[220:223], v[164:167], a[52:55]
 buffer_load_dwordx4 v[64:67], v1, s[36:39], s75 offen offset:0 sc1
 v_mfma_f32_16x16x32_bf16 a[56:59], a[212:215], v[136:139], a[56:59]
 buffer_load_dwordx4 v[68:71], v1, s[36:39], s75 offen offset:1024 sc1
 v_mfma_f32_16x16x32_bf16 a[56:59], a[216:219], v[152:155], a[56:59]
 buffer_load_dwordx4 v[72:75], v1, s[36:39], s75 offen offset:2048 sc1
 v_mfma_f32_16x16x32_bf16 a[56:59], a[220:223], v[168:171], a[56:59]
 buffer_load_dwordx4 v[76:79], v1, s[36:39], s75 offen offset:3072 sc1
 v_mfma_f32_16x16x32_bf16 a[60:63], a[212:215], v[140:143], a[60:63]
 v_mfma_f32_16x16x32_bf16 a[60:63], a[216:219], v[156:159], a[60:63]
 v_and_b32 v22, 24, v29
 buffer_load_dwordx2 v[2:3], v22, s[48:51], s87 offen sc0 sc1
 v_mfma_f32_16x16x32_bf16 a[60:63], a[220:223], v[172:175], a[60:63]
 s_waitcnt lgkmcnt(0)
 v_mfma_f32_16x16x32_bf16 a[64:67], a[192:195], v[128:131], a[64:67]
 ds_read_b64_tr_b16 a[204:205], v15 offset:0
 ds_read_b64_tr_b16 a[206:207], v15 offset:2048
 v_mfma_f32_16x16x32_bf16 a[64:67], a[196:199], v[144:147], a[64:67]
 ds_read_b64_tr_b16 a[208:209], v15 offset:4096
 ds_read_b64_tr_b16 a[210:211], v15 offset:6144
 v_mfma_f32_16x16x32_bf16 a[64:67], a[200:203], v[160:163], a[64:67]
 ds_read_b64_tr_b16 a[212:213], v15 offset:8192
 ds_read_b64_tr_b16 a[214:215], v15 offset:10240
 v_mfma_f32_16x16x32_bf16 a[68:71], a[192:195], v[132:135], a[68:71]
 v_mfma_f32_16x16x32_bf16 a[68:71], a[196:199], v[148:151], a[68:71]
 v_mfma_f32_16x16x32_bf16 a[68:71], a[200:203], v[164:167], a[68:71]
 v_mfma_f32_16x16x32_bf16 a[72:75], a[192:195], v[136:139], a[72:75]
 v_mfma_f32_16x16x32_bf16 a[72:75], a[196:199], v[152:155], a[72:75]
 v_mfma_f32_16x16x32_bf16 a[72:75], a[200:203], v[168:171], a[72:75]
 v_mfma_f32_16x16x32_bf16 a[76:79], a[192:195], v[140:143], a[76:79]
 v_mfma_f32_16x16x32_bf16 a[76:79], a[196:199], v[156:159], a[76:79]
 v_mfma_f32_16x16x32_bf16 a[76:79], a[200:203], v[172:175], a[76:79]
 s_waitcnt lgkmcnt(0)
 v_mfma_f32_16x16x32_bf16 a[80:83], a[204:207], v[128:131], a[80:83]
 ds_read_b64_tr_b16 a[216:217], v16 offset:0
 ds_read_b64_tr_b16 a[218:219], v16 offset:2048
 v_mfma_f32_16x16x32_bf16 a[80:83], a[208:211], v[144:147], a[80:83]
 ds_read_b64_tr_b16 a[220:221], v16 offset:4096
 ds_read_b64_tr_b16 a[222:223], v16 offset:6144
 v_mfma_f32_16x16x32_bf16 a[80:83], a[212:215], v[160:163], a[80:83]
 ds_read_b64_tr_b16 a[192:193], v16 offset:8192
 ds_read_b64_tr_b16 a[194:195], v16 offset:10240
 v_mfma_f32_16x16x32_bf16 a[84:87], a[204:207], v[132:135], a[84:87]
 v_mfma_f32_16x16x32_bf16 a[84:87], a[208:211], v[148:151], a[84:87]
 v_mfma_f32_16x16x32_bf16 a[84:87], a[212:215], v[164:167], a[84:87]
 v_mfma_f32_16x16x32_bf16 a[88:91], a[204:207], v[136:139], a[88:91]
 v_mfma_f32_16x16x32_bf16 a[88:91], a[208:211], v[152:155], a[88:91]
 v_mfma_f32_16x16x32_bf16 a[88:91], a[212:215], v[168:171], a[88:91]
 v_mfma_f32_16x16x32_bf16 a[92:95], a[204:207], v[140:143], a[92:95]
 v_mfma_f32_16x16x32_bf16 a[92:95], a[208:211], v[156:159], a[92:95]
 v_mfma_f32_16x16x32_bf16 a[92:95], a[212:215], v[172:175], a[92:95]
 s_waitcnt lgkmcnt(0)
 v_mfma_f32_16x16x32_bf16 a[96:99], a[216:219], v[128:131], a[96:99]
 ds_read_b64_tr_b16 a[196:197], v17 offset:0
 ds_read_b64_tr_b16 a[198:199], v17 offset:2048
 v_mfma_f32_16x16x32_bf16 a[96:99], a[220:223], v[144:147], a[96:99]
 ds_read_b64_tr_b16 a[200:201], v17 offset:4096
 ds_read_b64_tr_b16 a[202:203], v17 offset:6144
 v_mfma_f32_16x16x32_bf16 a[96:99], a[192:195], v[160:163], a[96:99]
 ds_read_b64_tr_b16 a[204:205], v17 offset:8192
 ds_read_b64_tr_b16 a[206:207], v17 offset:10240
 v_mfma_f32_16x16x32_bf16 a[100:103], a[216:219], v[132:135], a[100:103]
 v_mfma_f32_16x16x32_bf16 a[100:103], a[220:223], v[148:151], a[100:103]
 v_mfma_f32_16x16x32_bf16 a[100:103], a[192:195], v[164:167], a[100:103]
 v_mfma_f32_16x16x32_bf16 a[104:107], a[216:219], v[136:139], a[104:107]
 v_mfma_f32_16x16x32_bf16 a[104:107], a[220:223], v[152:155], a[104:107]
 v_mfma_f32_16x16x32_bf16 a[104:107], a[192:195], v[168:171], a[104:107]
 v_mfma_f32_16x16x32_bf16 a[108:111], a[216:219], v[140:143], a[108:111]
 v_mfma_f32_16x16x32_bf16 a[108:111], a[220:223], v[156:159], a[108:111]
 v_mfma_f32_16x16x32_bf16 a[108:111], a[192:195], v[172:175], a[108:111]
 s_waitcnt lgkmcnt(0)
 v_mfma_f32_16x16x32_bf16 a[112:115], a[196:199], v[128:131], a[112:115]
 v_add_u32 v14, 49152, v27
 v_xor_b32 v15, 32, v14
 v_mfma_f32_16x16x32_bf16 a[112:115], a[200:203], v[144:147], a[112:115]
 v_xor_b32 v16, 64, v14
 v_xor_b32 v17, 96, v14
 v_mfma_f32_16x16x32_bf16 a[112:115], a[204:207], v[160:163], a[112:115]
 ds_read_b64_tr_b16 a[208:209], v14 offset:0
 ds_read_b64_tr_b16 a[210:211], v14 offset:2048
 v_mfma_f32_16x16x32_bf16 a[116:119], a[196:199], v[132:135], a[116:119]
 ds_read_b64_tr_b16 a[212:213], v14 offset:4096
 ds_read_b64_tr_b16 a[214:215], v14 offset:6144
 v_mfma_f32_16x16x32_bf16 a[116:119], a[200:203], v[148:151], a[116:119]
 ds_read_b64_tr_b16 a[216:217], v14 offset:8192
 ds_read_b64_tr_b16 a[218:219], v14 offset:10240
 v_mfma_f32_16x16x32_bf16 a[116:119], a[204:207], v[164:167], a[116:119]
 v_mfma_f32_16x16x32_bf16 a[120:123], a[196:199], v[136:139], a[120:123]
 v_mfma_f32_16x16x32_bf16 a[120:123], a[200:203], v[152:155], a[120:123]
 v_mfma_f32_16x16x32_bf16 a[120:123], a[204:207], v[168:171], a[120:123]
 v_mfma_f32_16x16x32_bf16 a[124:127], a[196:199], v[140:143], a[124:127]
 v_mfma_f32_16x16x32_bf16 a[124:127], a[200:203], v[156:159], a[124:127]
 v_mfma_f32_16x16x32_bf16 a[124:127], a[204:207], v[172:175], a[124:127]
 s_waitcnt vmcnt(0)
 s_add_u32 s76, s83, 2
 s_mov_b32 s86, 0
 s_branch L_POLLC_O2
L_POLL_O2:
 buffer_load_dwordx2 v[2:3], v22, s[48:51], s87 offen sc0 sc1
 s_waitcnt vmcnt(0)
L_POLLC_O2:
 v_cmp_ne_u32 vcc, s82, v2
 v_subrev_u32 v23, s76, v3
 v_cmp_lt_u32 s[96:97], 3, v23
 s_add_u32 s86, s86, 1
 s_cmp_gt_u32 s86, 30000
 s_cbranch_scc1 L_POLLX_O2
 s_or_b64 vcc, vcc, s[96:97]
 s_cbranch_scc1 L_POLL_O2
L_POLLX_O2:
 s_waitcnt lgkmcnt(0)
 v_mfma_f32_16x16x32_bf16 a[0:3], a[208:211], v[224:227], a[0:3]
 s_add_u32 s74, s63, 1
 s_and_b32 s74, s74, 3
 v_mfma_f32_16x16x32_bf16 a[0:3], a[212:215], v[240:243], a[0:3]
 ds_read_b64_tr_b16 a[220:221], v15 offset:0
 ds_read_b64_tr_b16 a[222:223], v15 offset:2048
 v_mfma_f32_16x16x32_bf16 a[0:3], a[216:219], a[160:163], a[0:3]
 ds_read_b64_tr_b16 a[192:193], v15 offset:4096
 ds_read_b64_tr_b16 a[194:195], v15 offset:6144
 v_mfma_f32_16x16x32_bf16 a[4:7], a[208:211], v[228:231], a[4:7]
 ds_read_b64_tr_b16 a[196:197], v15 offset:8192
 ds_read_b64_tr_b16 a[198:199], v15 offset:10240
 v_mfma_f32_16x16x32_bf16 a[4:7], a[212:215], v[244:247], a[4:7]
 s_mul_i32 s74, s74, 98304
 s_add_u32 s75, s74, 12288
 v_mfma_f32_16x16x32_bf16 a[4:7], a[216:219], a[164:167], a[4:7]
 v_mfma_f32_16x16x32_bf16 a[8:11], a[208:211], v[232:235], a[8:11]
 buffer_load_dwordx4 v[176:179], v1, s[36:39], s75 offen offset:0 sc1
 v_mfma_f32_16x16x32_bf16 a[8:11], a[212:215], v[248:251], a[8:11]
 v_mfma_f32_16x16x32_bf16 a[8:11], a[216:219], a[168:171], a[8:11]
 buffer_load_dwordx4 v[180:183], v1, s[36:39], s75 offen offset:1024 sc1
 v_mfma_f32_16x16x32_bf16 a[12:15], a[208:211], v[236:239], a[12:15]
 v_mfma_f32_16x16x32_bf16 a[12:15], a[212:215], v[252:255], a[12:15]
 buffer_load_dwordx4 v[184:187], v1, s[36:39], s75 offen offset:2048 sc1
 v_mfma_f32_16x16x32_bf16 a[12:15], a[216:219], a[172:175], a[12:15]
 s_waitcnt lgkmcnt(0)
 v_mfma_f32_16x16x32_bf16 a[16:19], a[220:223], v[224:227], a[16:19]
 ds_read_b64_tr_b16 a[200:201], v16 offset:0
 ds_read_b64_tr_b16 a[202:203], v16 offset:2048
 v_mfma_f32_16x16x32_bf16 a[16:19], a[192:195], v[240:243], a[16:19]
 ds_read_b64_tr_b16 a[204:205], v16 offset:4096
 ds_read_b64_tr_b16 a[206:207], v16 offset:6144
 v_mfma_f32_16x16x32_bf16 a[16:19], a[196:199], a[160:163], a[16:19]
 ds_read_b64_tr_b16 a[208:209], v16 offset:8192
 ds_read_b64_tr_b16 a[210:211], v16 offset:10240
 v_mfma_f32_16x16x32_bf16 a[20:23], a[220:223], v[228:231], a[20:23]
 buffer_load_dwordx4 v[188:191], v1, s[36:39], s75 offen offset:3072 sc1
 v_mfma_f32_16x16x32_bf16 a[20:23], a[192:195], v[244:247], a[20:23]
 s_add_u32 s75, s74, 16384
 v_mfma_f32_16x16x32_bf16 a[20:23], a[196:199], a[164:167], a[20:23]
 buffer_load_dwordx4 v[192:195], v1, s[36:39], s75 offen offset:0 sc1
 v_mfma_f32_16x16x32_bf16 a[24:27], a[220:223], v[232:235], a[24:27]
 v_mfma_f32_16x16x32_bf16 a[24:27], a[192:195], v[248:251], a[24:27]
 buffer_load_dwordx4 v[196:199], v1, s[36:39], s75 offen offset:1024 sc1
 v_mfma_f32_16x16x32_bf16 a[24:27], a[196:199], a[168:171], a[24:27]
 v_mfma_f32_16x16x32_bf16 a[28:31], a[220:223], v[236:239], a[28:31]
 buffer_load_dwordx4 v[200:203], v1, s[36:39], s75 offen offset:2048 sc1
 v_mfma_f32_16x16x32_bf16 a[28:31], a[192:195], v[252:255], a[28:31]
 v_mfma_f32_16x16x32_bf16 a[28:31], a[196:199], a[172:175], a[28:31]
 s_waitcnt lgkmcnt(0)
 v_mfma_f32_16x16x32_bf16 a[32:35], a[200:203], v[224:227], a[32:35]
 buffer_load_dwordx4 v[204:207], v1, s[36:39], s75 offen offset:3072 sc1
 v_mfma_f32_16x16x32_bf16 a[32:35], a[204:207], v[240:243], a[32:35]
 ds_read_b64_tr_b16 a[212:213], v17 offset:0
 ds_read_b64_tr_b16 a[214:215], v17 offset:2048
 v_mfma_f32_16x16x32_bf16 a[32:35], a[208:211], a[160:163], a[32:35]
 ds_read_b64_tr_b16 a[216:217], v17 offset:4096
 ds_read_b64_tr_b16 a[218:219], v17 offset:6144
 v_mfma_f32_16x16x32_bf16 a[36:39], a[200:203], v[228:231], a[36:39]
 ds_read_b64_tr_b16 a[220:221], v17 offset:8192
 ds_read_b64_tr_b16 a[222:223], v17 offset:10240
 v_mfma_f32_16x16x32_bf16 a[36:39], a[204:207], v[244:247], a[36:39]
 s_add_u32 s75, s74, 20480
 v_mfma_f32_16x16x32_bf16 a[36:39], a[208:211], a[164:167], a[36:39]
 buffer_load_dwordx4 v[208:211], v1, s[36:39], s75 offen offset:0 sc1
 v_mfma_f32_16x16x32_bf16 a[40:43], a[200:203], v[232:235], a[40:43]
 buffer_load_dwordx4 v[212:215], v1, s[36:39], s75 offen offset:1024 sc1
 v_mfma_f32_16x16x32_bf16 a[40:43], a[204:207], v[248:251], a[40:43]
 v_mfma_f32_16x16x32_bf16 a[40:43], a[208:211], a[168:171], a[40:43]
 buffer_load_dwordx4 v[216:219], v1, s[36:39], s75 offen offset:2048 sc1
 v_mfma_f32_16x16x32_bf16 a[44:47], a[200:203], v[236:239], a[44:47]
 v_mfma_f32_16x16x32_bf16 a[44:47], a[204:207], v[252:255], a[44:47]
 buffer_load_dwordx4 v[220:223], v1, s[36:39], s75 offen offset:3072 sc1
 v_mfma_f32_16x16x32_bf16 a[44:47], a[208:211], a[172:175], a[44:47]
 s_waitcnt lgkmcnt(0)
 v_mfma_f32_16x16x32_bf16 a[48:51], a[212:215], v[224:227], a[48:51]
 v_add_u32 v14, 73728, v27
 v_xor_b32 v15, 32, v14
 v_mfma_f32_16x16x32_bf16 a[48:51], a[216:219], v[240:243], a[48:51]
 v_xor_b32 v16, 64, v14
 v_xor_b32 v17, 96, v14
 v_mfma_f32_16x16x32_bf16 a[48:51], a[220:223], a[160:163], a[48:51]
 ds_read_b64_tr_b16 a[192:193], v14 offset:0
 ds_read_b64_tr_b16 a[194:195], v14 offset:2048
 v_mfma_f32_16x16x32_bf16 a[52:55], a[212:215], v[228:231], a[52:55]
 ds_read_b64_tr_b16 a[196:197], v14 offset:4096
 ds_read_b64_tr_b16 a[198:199], v14 offset:6144
 v_mfma_f32_16x16x32_bf16 a[52:55], a[216:219], v[244:247], a[52:55]
 ds_read_b64_tr_b16 a[200:201], v14 offset:8192
 ds_read_b64_tr_b16 a[202:203], v14 offset:10240
 s_add_u32 m0, s80, 0
 s_add_u32 s76, s93, s84
 v_mfma_f32_16x16x32_bf16 a[52:55], a[220:223], a[164:167], a[52:55]
 s_add_u32 s76, s76, 122880
 v_mfma_f32_16x16x32_bf16 a[56:59], a[212:215], v[232:235], a[56:59]
 buffer_load_dwordx4 v7, s[40:43], s76 offen offset:0 lds
 v_mfma_f32_16x16x32_bf16 a[56:59], a[216:219], v[248:251], a[56:59]
 buffer_load_dwordx4 v8, s[40:43], s76 offen offset:1024 lds
 v_mfma_f32_16x16x32_bf16 a[56:59], a[220:223], a[168:171], a[56:59]
 v_mfma_f32_16x16x32_bf16 a[60:63], a[212:215], v[236:239], a[60:63]
 buffer_load_dwordx4 v9, s[40:43], s76 offen offset:2048 lds
 v_mfma_f32_16x16x32_bf16 a[60:63], a[216:219], v[252:255], a[60:63]
 v_mfma_f32_16x16x32_bf16 a[60:63], a[220:223], a[172:175], a[60:63]
 s_waitcnt lgkmcnt(0)
 v_mfma_f32_16x16x32_bf16 a[64:67], a[192:195], v[224:227], a[64:67]
 s_add_u32 s74, s63, 2
 s_and_b32 s74, s74, 3
 v_mfma_f32_16x16x32_bf16 a[64:67], a[196:199], v[240:243], a[64:67]
 ds_read_b64_tr_b16 a[204:205], v15 offset:0
 ds_read_b64_tr_b16 a[206:207], v15 offset:2048
 v_mfma_f32_16x16x32_bf16 a[64:67], a[200:203], a[160:163], a[64:67]
 ds_read_b64_tr_b16 a[208:209], v15 offset:4096
 ds_read_b64_tr_b16 a[210:211], v15 offset:6144
 v_mfma_f32_16x16x32_bf16 a[68:71], a[192:195], v[228:231], a[68:71]
 ds_read_b64_tr_b16 a[212:213], v15 offset:8192
 ds_read_b64_tr_b16 a[214:215], v15 offset:10240
 v_mfma_f32_16x16x32_bf16 a[68:71], a[196:199], v[244:247], a[68:71]
 s_mul_i32 s74, s74, 98304
 s_add_u32 s75, s74, 12288
 v_mfma_f32_16x16x32_bf16 a[68:71], a[200:203], a[164:167], a[68:71]
 v_mfma_f32_16x16x32_bf16 a[72:75], a[192:195], v[232:235], a[72:75]
 buffer_load_dwordx4 a[176:179], v1, s[36:39], s75 offen offset:0 sc1
 v_mfma_f32_16x16x32_bf16 a[72:75], a[196:199], v[248:251], a[72:75]
 v_mfma_f32_16x16x32_bf16 a[72:75], a[200:203], a[168:171], a[72:75]
 buffer_load_dwordx4 a[180:183], v1, s[36:39], s75 offen offset:1024 sc1
 v_mfma_f32_16x16x32_bf16 a[76:79], a[192:195], v[236:239], a[76:79]
 v_mfma_f32_16x16x32_bf16 a[76:79], a[196:199], v[252:255], a[76:79]
 buffer_load_dwordx4 a[184:187], v1, s[36:39], s75 offen offset:2048 sc1
 v_mfma_f32_16x16x32_bf16 a[76:79], a[200:203], a[172:175], a[76:79]
 s_waitcnt lgkmcnt(0)
 v_mfma_f32_16x16x32_bf16 a[80:83], a[204:207], v[224:227], a[80:83]
 ds_read_b64_tr_b16 a[216:217], v16 offset:0
 ds_read_b64_tr_b16 a[218:219], v16 offset:2048
 v_mfma_f32_16x16x32_bf16 a[80:83], a[208:211], v[240:243], a[80:83]
 ds_read_b64_tr_b16 a[220:221], v16 offset:4096
 ds_read_b64_tr_b16 a[222:223], v16 offset:6144
 v_mfma_f32_16x16x32_bf16 a[80:83], a[212:215], a[160:163], a[80:83]
 ds_read_b64_tr_b16 a[192:193], v16 offset:8192
 ds_read_b64_tr_b16 a[194:195], v16 offset:10240
 v_mfma_f32_16x16x32_bf16 a[84:87], a[204:207], v[228:231], a[84:87]
 buffer_load_dwordx4 a[188:191], v1, s[36:39], s75 offen offset:3072 sc1
 v_mfma_f32_16x16x32_bf16 a[84:87], a[208:211], v[244:247], a[84:87]
 s_add_u32 s75, s74, 16384
 v_mfma_f32_16x16x32_bf16 a[84:87], a[212:215], a[164:167], a[84:87]
 buffer_load_dwordx4 a[224:227], v1, s[36:39], s75 offen offset:0 sc1
 v_mfma_f32_16x16x32_bf16 a[88:91], a[204:207], v[232:235], a[88:91]
 v_mfma_f32_16x16x32_bf16 a[88:91], a[208:211], v[248:251], a[88:91]
 buffer_load_dwordx4 a[228:231], v1, s[36:39], s75 offen offset:1024 sc1
 v_mfma_f32_16x16x32_bf16 a[88:91], a[212:215], a[168:171], a[88:91]
 v_mfma_f32_16x16x32_bf16 a[92:95], a[204:207], v[236:239], a[92:95]
 buffer_load_dwordx4 a[232:235], v1, s[36:39], s75 offen offset:2048 sc1
 v_mfma_f32_16x16x32_bf16 a[92:95], a[208:211], v[252:255], a[92:95]
 v_mfma_f32_16x16x32_bf16 a[92:95], a[212:215], a[172:175], a[92:95]
 s_waitcnt lgkmcnt(0)
 v_mfma_f32_16x16x32_bf16 a[96:99], a[216:219], v[224:227], a[96:99]
 buffer_load_dwordx4 a[236:239], v1, s[36:39], s75 offen offset:3072 sc1
 v_mfma_f32_16x16x32_bf16 a[96:99], a[220:223], v[240:243], a[96:99]
 ds_read_b64_tr_b16 a[196:197], v17 offset:0
 ds_read_b64_tr_b16 a[198:199], v17 offset:2048
 v_mfma_f32_16x16x32_bf16 a[96:99], a[192:195], a[160:163], a[96:99]
 ds_read_b64_tr_b16 a[200:201], v17 offset:4096
 ds_read_b64_tr_b16 a[202:203], v17 offset:6144
 v_mfma_f32_16x16x32_bf16 a[100:103], a[216:219], v[228:231], a[100:103]
 ds_read_b64_tr_b16 a[204:205], v17 offset:8192
 ds_read_b64_tr_b16 a[206:207], v17 offset:10240
 v_mfma_f32_16x16x32_bf16 a[100:103], a[220:223], v[244:247], a[100:103]
 s_add_u32 s75, s74, 20480
 v_mfma_f32_16x16x32_bf16 a[100:103], a[192:195], a[164:167], a[100:103]
 buffer_load_dwordx4 a[240:243], v1, s[36:39], s75 offen offset:0 sc1
 v_mfma_f32_16x16x32_bf16 a[104:107], a[216:219], v[232:235], a[104:107]
 buffer_load_dwordx4 a[244:247], v1, s[36:39], s75 offen offset:1024 sc1
 v_mfma_f32_16x16x32_bf16 a[104:107], a[220:223], v[248:251], a[104:107]
 v_mfma_f32_16x16x32_bf16 a[104:107], a[192:195], a[168:171], a[104:107]
 buffer_load_dwordx4 a[248:251], v1, s[36:39], s75 offen offset:2048 sc1
 v_mfma_f32_16x16x32_bf16 a[108:111], a[216:219], v[236:239], a[108:111]
 v_mfma_f32_16x16x32_bf16 a[108:111], a[220:223], v[252:255], a[108:111]
 buffer_load_dwordx4 a[252:255], v1, s[36:39], s75 offen offset:3072 sc1
 v_mfma_f32_16x16x32_bf16 a[108:111], a[192:195], a[172:175], a[108:111]
 s_waitcnt lgkmcnt(0)
 v_mfma_f32_16x16x32_bf16 a[112:115], a[196:199], v[224:227], a[112:115]
 v_add_u32 v14, 61440, v27
 v_xor_b32 v15, 32, v14
 v_mfma_f32_16x16x32_bf16 a[112:115], a[200:203], v[240:243], a[112:115]
 v_xor_b32 v16, 64, v14
 v_xor_b32 v17, 96, v14
 v_mfma_f32_16x16x32_bf16 a[112:115], a[204:207], a[160:163], a[112:115]
 ds_read_b64_tr_b16 a[208:209], v14 offset:0
 ds_read_b64_tr_b16 a[210:211], v14 offset:2048
 v_mfma_f32_16x16x32_bf16 a[116:119], a[196:199], v[228:231], a[116:119]
 ds_read_b64_tr_b16 a[212:213], v14 offset:4096
 ds_read_b64_tr_b16 a[214:215], v14 offset:6144
 v_mfma_f32_16x16x32_bf16 a[116:119], a[200:203], v[244:247], a[116:119]
 ds_read_b64_tr_b16 a[216:217], v14 offset:8192
 ds_read_b64_tr_b16 a[218:219], v14 offset:10240
 s_add_u32 m0, s80, 12288
 s_add_u32 s76, s91, s84
 v_mfma_f32_16x16x32_bf16 a[116:119], a[204:207], a[164:167], a[116:119]
 s_add_u32 s76, s76, 123008
 v_mfma_f32_16x16x32_bf16 a[120:123], a[196:199], v[232:235], a[120:123]
 buffer_load_dwordx4 v7, s[40:43], s76 offen offset:0 lds
 v_mfma_f32_16x16x32_bf16 a[120:123], a[200:203], v[248:251], a[120:123]
 buffer_load_dwordx4 v8, s[40:43], s76 offen offset:1024 lds
 v_mfma_f32_16x16x32_bf16 a[120:123], a[204:207], a[168:171], a[120:123]
 v_mfma_f32_16x16x32_bf16 a[124:127], a[196:199], v[236:239], a[124:127]
 buffer_load_dwordx4 v9, s[40:43], s76 offen offset:2048 lds
 v_mfma_f32_16x16x32_bf16 a[124:127], a[200:203], v[252:255], a[124:127]
 v_mfma_f32_16x16x32_bf16 a[124:127], a[204:207], a[172:175], a[124:127]
 s_waitcnt lgkmcnt(0)
 v_mfma_f32_16x16x32_bf16 a[0:3], a[208:211], v[32:35], a[0:3]
 s_add_u32 s74, s63, 3
 s_and_b32 s74, s74, 3
 v_mfma_f32_16x16x32_bf16 a[0:3], a[212:215], v[48:51], a[0:3]
 ds_read_b64_tr_b16 a[220:221], v15 offset:0
 ds_read_b64_tr_b16 a[222:223], v15 offset:2048
 v_mfma_f32_16x16x32_bf16 a[0:3], a[216:219], v[64:67], a[0:3]
 ds_read_b64_tr_b16 a[192:193], v15 offset:4096
 ds_read_b64_tr_b16 a[194:195], v15 offset:6144
 v_mfma_f32_16x16x32_bf16 a[4:7], a[208:211], v[36:39], a[4:7]
 ds_read_b64_tr_b16 a[196:197], v15 offset:8192
 ds_read_b64_tr_b16 a[198:199], v15 offset:10240
 v_mfma_f32_16x16x32_bf16 a[4:7], a[212:215], v[52:55], a[4:7]
 s_mul_i32 s74, s74, 98304
 v_mfma_f32_16x16x32_bf16 a[4:7], a[216:219], v[68:71], a[4:7]
 s_add_u32 s75, s74, 12288
 v_mfma_f32_16x16x32_bf16 a[8:11], a[208:211], v[40:43], a[8:11]
 v_mfma_f32_16x16x32_bf16 a[8:11], a[212:215], v[56:59], a[8:11]
 v_mfma_f32_16x16x32_bf16 a[8:11], a[216:219], v[72:75], a[8:11]
 buffer_load_dwordx4 v[80:83], v1, s[36:39], s75 offen offset:0 sc1
 v_mfma_f32_16x16x32_bf16 a[12:15], a[208:211], v[44:47], a[12:15]
 v_mfma_f32_16x16x32_bf16 a[12:15], a[212:215], v[60:63], a[12:15]
 v_mfma_f32_16x16x32_bf16 a[12:15], a[216:219], v[76:79], a[12:15]
 s_waitcnt lgkmcnt(0)
 v_mfma_f32_16x16x32_bf16 a[16:19], a[220:223], v[32:35], a[16:19]
 buffer_load_dwordx4 v[84:87], v1, s[36:39], s75 offen offset:1024 sc1
 v_mfma_f32_16x16x32_bf16 a[16:19], a[192:195], v[48:51], a[16:19]
 ds_read_b64_tr_b16 a[200:201], v16 offset:0
 ds_read_b64_tr_b16 a[202:203], v16 offset:2048
 v_mfma_f32_16x16x32_bf16 a[16:19], a[196:199], v[64:67], a[16:19]
 ds_read_b64_tr_b16 a[204:205], v16 offset:4096
 ds_read_b64_tr_b16 a[206:207], v16 offset:6144
 v_mfma_f32_16x16x32_bf16 a[20:23], a[220:223], v[36:39], a[20:23]
 ds_read_b64_tr_b16 a[208:209], v16 offset:8192
 ds_read_b64_tr_b16 a[210:211], v16 offset:10240
 v_mfma_f32_16x16x32_bf16 a[20:23], a[192:195], v[52:55], a[20:23]
 buffer_load_dwordx4 v[88:91], v1, s[36:39], s75 offen offset:2048 sc1
 v_mfma_f32_16x16x32_bf16 a[20:23], a[196:199], v[68:71], a[20:23]
 buffer_load_dwordx4 v[92:95], v1, s[36:39], s75 offen offset:3072 sc1
 v_mfma_f32_16x16x32_bf16 a[24:27], a[220:223], v[40:43], a[24:27]
 v_mfma_f32_16x16x32_bf16 a[24:27], a[192:195], v[56:59], a[24:27]
 s_add_u32 s75, s74, 16384
 v_mfma_f32_16x16x32_bf16 a[24:27], a[196:199], v[72:75], a[24:27]
 v_mfma_f32_16x16x32_bf16 a[28:31], a[220:223], v[44:47], a[28:31]
 v_mfma_f32_16x16x32_bf16 a[28:31], a[192:195], v[60:63], a[28:31]
 buffer_load_dwordx4 v[96:99], v1, s[36:39], s75 offen offset:0 sc1
 v_mfma_f32_16x16x32_bf16 a[28:31], a[196:199], v[76:79], a[28:31]
 s_waitcnt lgkmcnt(0)
 v_mfma_f32_16x16x32_bf16 a[32:35], a[200:203], v[32:35], a[32:35]
 ds_read_b64_tr_b16 a[212:213], v17 offset:0
 ds_read_b64_tr_b16 a[214:215], v17 offset:2048
 v_mfma_f32_16x16x32_bf16 a[32:35], a[204:207], v[48:51], a[32:35]
 ds_read_b64_tr_b16 a[216:217], v17 offset:4096
 ds_read_b64_tr_b16 a[218:219], v17 offset:6144
 v_mfma_f32_16x16x32_bf16 a[32:35], a[208:211], v[64:67], a[32:35]
 ds_read_b64_tr_b16 a[220:221], v17 offset:8192
 ds_read_b64_tr_b16 a[222:223], v17 offset:10240
 v_mfma_f32_16x16x32_bf16 a[36:39], a[200:203], v[36:39], a[36:39]
 buffer_load_dwordx4 v[100:103], v1, s[36:39], s75 offen offset:1024 sc1
 v_mfma_f32_16x16x32_bf16 a[36:39], a[204:207], v[52:55], a[36:39]
 buffer_load_dwordx4 v[104:107], v1, s[36:39], s75 offen offset:2048 sc1
 v_mfma_f32_16x16x32_bf16 a[36:39], a[208:211], v[68:71], a[36:39]
 v_mfma_f32_16x16x32_bf16 a[40:43], a[200:203], v[40:43], a[40:43]
 v_mfma_f32_16x16x32_bf16 a[40:43], a[204:207], v[56:59], a[40:43]
 buffer_load_dwordx4 v[108:111], v1, s[36:39], s75 offen offset:3072 sc1
 v_mfma_f32_16x16x32_bf16 a[40:43], a[208:211], v[72:75], a[40:43]
 v_mfma_f32_16x16x32_bf16 a[44:47], a[200:203], v[44:47], a[44:47]
 s_add_u32 s75, s74, 20480
 v_mfma_f32_16x16x32_bf16 a[44:47], a[204:207], v[60:63], a[44:47]
 v_mfma_f32_16x16x32_bf16 a[44:47], a[208:211], v[76:79], a[44:47]
 s_waitcnt lgkmcnt(0)
 v_mfma_f32_16x16x32_bf16 a[48:51], a[212:215], v[32:35], a[48:51]
 v_add_u32 v14, 86016, v27
 v_xor_b32 v15, 32, v14
 v_mfma_f32_16x16x32_bf16 a[48:51], a[216:219], v[48:51], a[48:51]
 v_xor_b32 v16, 64, v14
 v_xor_b32 v17, 96, v14
 v_mfma_f32_16x16x32_bf16 a[48:51], a[220:223], v[64:67], a[48:51]
 ds_read_b64_tr_b16 a[192:193], v14 offset:0
 ds_read_b64_tr_b16 a[194:195], v14 offset:2048
 v_mfma_f32_16x16x32_bf16 a[52:55], a[212:215], v[36:39], a[52:55]
 ds_read_b64_tr_b16 a[196:197], v14 offset:4096
 ds_read_b64_tr_b16 a[198:199], v14 offset:6144
 v_mfma_f32_16x16x32_bf16 a[52:55], a[216:219], v[52:55], a[52:55]
 ds_read_b64_tr_b16 a[200:201], v14 offset:8192
 ds_read_b64_tr_b16 a[202:203], v14 offset:10240
 buffer_load_dwordx4 v[112:115], v1, s[36:39], s75 offen offset:0 sc1
 v_mfma_f32_16x16x32_bf16 a[52:55], a[220:223], v[68:71], a[52:55]
 buffer_load_dwordx4 v[116:119], v1, s[36:39], s75 offen offset:1024 sc1
 v_mfma_f32_16x16x32_bf16 a[56:59], a[212:215], v[40:43], a[56:59]
 buffer_load_dwordx4 v[120:123], v1, s[36:39], s75 offen offset:2048 sc1
 v_mfma_f32_16x16x32_bf16 a[56:59], a[216:219], v[56:59], a[56:59]
 v_mfma_f32_16x16x32_bf16 a[56:59], a[220:223], v[72:75], a[56:59]
 v_mfma_f32_16x16x32_bf16 a[60:63], a[212:215], v[44:47], a[60:63]
 buffer_load_dwordx4 v[124:127], v1, s[36:39], s75 offen offset:3072 sc1
 v_mfma_f32_16x16x32_bf16 a[60:63], a[216:219], v[60:63], a[60:63]
 v_mfma_f32_16x16x32_bf16 a[60:63], a[220:223], v[76:79], a[60:63]
 s_waitcnt lgkmcnt(0)
 v_mfma_f32_16x16x32_bf16 a[64:67], a[192:195], v[32:35], a[64:67]
 ds_read_b64_tr_b16 a[204:205], v15 offset:0
 ds_read_b64_tr_b16 a[206:207], v15 offset:2048
 v_mfma_f32_16x16x32_bf16 a[64:67], a[196:199], v[48:51], a[64:67]
 ds_read_b64_tr_b16 a[208:209], v15 offset:4096
 ds_read_b64_tr_b16 a[210:211], v15 offset:6144
 v_mfma_f32_16x16x32_bf16 a[64:67], a[200:203], v[64:67], a[64:67]
 ds_read_b64_tr_b16 a[212:213], v15 offset:8192
 ds_read_b64_tr_b16 a[214:215], v15 offset:10240
 v_mfma_f32_16x16x32_bf16 a[68:71], a[192:195], v[36:39], a[68:71]
 s_add_u32 m0, s80, 122880
 s_add_u32 s76, s92, s84
 v_mfma_f32_16x16x32_bf16 a[68:71], a[196:199], v[52:55], a[68:71]
 s_add_u32 s76, s76, 123008
 v_mfma_f32_16x16x32_bf16 a[68:71], a[200:203], v[68:71], a[68:71]
 v_mfma_f32_16x16x32_bf16 a[72:75], a[192:195], v[40:43], a[72:75]
 v_mfma_f32_16x16x32_bf16 a[72:75], a[196:199], v[56:59], a[72:75]
 v_mfma_f32_16x16x32_bf16 a[72:75], a[200:203], v[72:75], a[72:75]
 v_mfma_f32_16x16x32_bf16 a[76:79], a[192:195], v[44:47], a[76:79]
 buffer_load_dwordx4 v7, s[40:43], s76 offen offset:0 lds
 v_mfma_f32_16x16x32_bf16 a[76:79], a[196:199], v[60:63], a[76:79]
 v_mfma_f32_16x16x32_bf16 a[76:79], a[200:203], v[76:79], a[76:79]
 s_waitcnt lgkmcnt(0)
 v_mfma_f32_16x16x32_bf16 a[80:83], a[204:207], v[32:35], a[80:83]
 ds_read_b64_tr_b16 a[216:217], v16 offset:0
 ds_read_b64_tr_b16 a[218:219], v16 offset:2048
 v_mfma_f32_16x16x32_bf16 a[80:83], a[208:211], v[48:51], a[80:83]
 ds_read_b64_tr_b16 a[220:221], v16 offset:4096
 ds_read_b64_tr_b16 a[222:223], v16 offset:6144
 v_mfma_f32_16x16x32_bf16 a[80:83], a[212:215], v[64:67], a[80:83]
 ds_read_b64_tr_b16 a[192:193], v16 offset:8192
 ds_read_b64_tr_b16 a[194:195], v16 offset:10240
 v_mfma_f32_16x16x32_bf16 a[84:87], a[204:207], v[36:39], a[84:87]
 buffer_load_dwordx4 v8, s[40:43], s76 offen offset:1024 lds
 v_mfma_f32_16x16x32_bf16 a[84:87], a[208:211], v[52:55], a[84:87]
 v_mfma_f32_16x16x32_bf16 a[84:87], a[212:215], v[68:71], a[84:87]
 v_mfma_f32_16x16x32_bf16 a[88:91], a[204:207], v[40:43], a[88:91]
 v_mfma_f32_16x16x32_bf16 a[88:91], a[208:211], v[56:59], a[88:91]
 buffer_load_dwordx4 v9, s[40:43], s76 offen offset:2048 lds
 v_mfma_f32_16x16x32_bf16 a[88:91], a[212:215], v[72:75], a[88:91]
 v_mfma_f32_16x16x32_bf16 a[92:95], a[204:207], v[44:47], a[92:95]
 v_mfma_f32_16x16x32_bf16 a[92:95], a[208:211], v[60:63], a[92:95]
 v_mfma_f32_16x16x32_bf16 a[92:95], a[212:215], v[76:79], a[92:95]
 s_waitcnt lgkmcnt(0)
 v_mfma_f32_16x16x32_bf16 a[96:99], a[216:219], v[32:35], a[96:99]
 ds_read_b64_tr_b16 a[196:197], v17 offset:0
 ds_read_b64_tr_b16 a[198:199], v17 offset:2048
 v_mfma_f32_16x16x32_bf16 a[96:99], a[220:223], v[48:51], a[96:99]
 ds_read_b64_tr_b16 a[200:201], v17 offset:4096
 ds_read_b64_tr_b16 a[202:203], v17 offset:6144
 v_mfma_f32_16x16x32_bf16 a[96:99], a[192:195], v[64:67], a[96:99]
 ds_read_b64_tr_b16 a[204:205], v17 offset:8192
 ds_read_b64_tr_b16 a[206:207], v17 offset:10240
 v_mfma_f32_16x16x32_bf16 a[100:103], a[216:219], v[36:39], a[100:103]
 s_add_u32 m0, s80, 24576
 s_add_u32 s76, s93, s84
 v_mfma_f32_16x16x32_bf16 a[100:103], a[220:223], v[52:55], a[100:103]
 s_add_u32 s76, s76, 123008
 v_mfma_f32_16x16x32_bf16 a[100:103], a[192:195], v[68:71], a[100:103]
 v_mfma_f32_16x16x32_bf16 a[104:107], a[216:219], v[40:43], a[104:107]
 v_mfma_f32_16x16x32_bf16 a[104:107], a[220:223], v[56:59], a[104:107]
 v_mfma_f32_16x16x32_bf16 a[104:107], a[192:195], v[72:75], a[104:107]
 v_mfma_f32_16x16x32_bf16 a[108:111], a[216:219], v[44:47], a[108:111]
 buffer_load_dwordx4 v7, s[40:43], s76 offen offset:0 lds
 v_mfma_f32_16x16x32_bf16 a[108:111], a[220:223], v[60:63], a[108:111]
 v_mfma_f32_16x16x32_bf16 a[108:111], a[192:195], v[76:79], a[108:111]
 s_waitcnt lgkmcnt(0)
 v_mfma_f32_16x16x32_bf16 a[112:115], a[196:199], v[32:35], a[112:115]
 v_add_u32 v14, 98304, v27
 v_xor_b32 v15, 32, v14
 v_mfma_f32_16x16x32_bf16 a[112:115], a[200:203], v[48:51], a[112:115]
 v_xor_b32 v16, 64, v14
 v_xor_b32 v17, 96, v14
 v_mfma_f32_16x16x32_bf16 a[112:115], a[204:207], v[64:67], a[112:115]
 ds_read_b64_tr_b16 a[208:209], v14 offset:0
 ds_read_b64_tr_b16 a[210:211], v14 offset:2048
 v_mfma_f32_16x16x32_bf16 a[116:119], a[196:199], v[36:39], a[116:119]
 ds_read_b64_tr_b16 a[212:213], v14 offset:4096
 ds_read_b64_tr_b16 a[214:215], v14 offset:6144
 v_mfma_f32_16x16x32_bf16 a[116:119], a[200:203], v[52:55], a[116:119]
 ds_read_b64_tr_b16 a[216:217], v14 offset:8192
 ds_read_b64_tr_b16 a[218:219], v14 offset:10240
 v_mfma_f32_16x16x32_bf16 a[116:119], a[204:207], v[68:71], a[116:119]
 buffer_load_dwordx4 v8, s[40:43], s76 offen offset:1024 lds
 v_mfma_f32_16x16x32_bf16 a[120:123], a[196:199], v[40:43], a[120:123]
 v_mfma_f32_16x16x32_bf16 a[120:123], a[200:203], v[56:59], a[120:123]
 buffer_load_dwordx4 v9, s[40:43], s76 offen offset:2048 lds
 v_mfma_f32_16x16x32_bf16 a[120:123], a[204:207], v[72:75], a[120:123]
 v_mfma_f32_16x16x32_bf16 a[124:127], a[196:199], v[44:47], a[124:127]
 v_mfma_f32_16x16x32_bf16 a[124:127], a[200:203], v[60:63], a[124:127]
 v_mfma_f32_16x16x32_bf16 a[124:127], a[204:207], v[76:79], a[124:127]
 s_waitcnt lgkmcnt(0)
 s_waitcnt vmcnt(47)
 v_mfma_f32_16x16x32_bf16 a[0:3], a[208:211], v[176:179], a[0:3]
 ds_read_b64_tr_b16 a[220:221], v15 offset:0
 ds_read_b64_tr_b16 a[222:223], v15 offset:2048
 s_waitcnt vmcnt(43)
 v_mfma_f32_16x16x32_bf16 a[0:3], a[212:215], v[192:195], a[0:3]
 ds_read_b64_tr_b16 a[192:193], v15 offset:4096
 ds_read_b64_tr_b16 a[194:195], v15 offset:6144
 s_waitcnt vmcnt(39)
 v_mfma_f32_16x16x32_bf16 a[0:3], a[216:219], v[208:211], a[0:3]
 ds_read_b64_tr_b16 a[196:197], v15 offset:8192
 ds_read_b64_tr_b16 a[198:199], v15 offset:10240
 v_mfma_f32_16x16x32_bf16 a[4:7], a[208:211], v[180:183], a[4:7]
 v_mfma_f32_16x16x32_bf16 a[4:7], a[212:215], v[196:199], a[4:7]
 s_waitcnt vmcnt(38)
 v_mfma_f32_16x16x32_bf16 a[4:7], a[216:219], v[212:215], a[4:7]
 v_mfma_f32_16x16x32_bf16 a[8:11], a[208:211], v[184:187], a[8:11]
 v_mfma_f32_16x16x32_bf16 a[8:11], a[212:215], v[200:203], a[8:11]
 s_waitcnt vmcnt(37)
 v_mfma_f32_16x16x32_bf16 a[8:11], a[216:219], v[216:219], a[8:11]
 v_mfma_f32_16x16x32_bf16 a[12:15], a[208:211], v[188:191], a[12:15]
 v_mfma_f32_16x16x32_bf16 a[12:15], a[212:215], v[204:207], a[12:15]
 s_waitcnt vmcnt(36)
 v_mfma_f32_16x16x32_bf16 a[12:15], a[216:219], v[220:223], a[12:15]
 s_waitcnt lgkmcnt(0)
 v_mfma_f32_16x16x32_bf16 a[16:19], a[220:223], v[176:179], a[16:19]
 ds_read_b64_tr_b16 a[200:201], v16 offset:0
 ds_read_b64_tr_b16 a[202:203], v16 offset:2048
 v_mfma_f32_16x16x32_bf16 a[16:19], a[192:195], v[192:195], a[16:19]
 ds_read_b64_tr_b16 a[204:205], v16 offset:4096
 ds_read_b64_tr_b16 a[206:207], v16 offset:6144
 v_mfma_f32_16x16x32_bf16 a[16:19], a[196:199], v[208:211], a[16:19]
 ds_read_b64_tr_b16 a[208:209], v16 offset:8192
 ds_read_b64_tr_b16 a[210:211], v16 offset:10240
 v_mfma_f32_16x16x32_bf16 a[20:23], a[220:223], v[180:183], a[20:23]
 v_mfma_f32_16x16x32_bf16 a[20:23], a[192:195], v[196:199], a[20:23]
 v_mfma_f32_16x16x32_bf16 a[20:23], a[196:199], v[212:215], a[20:23]
 v_mfma_f32_16x16x32_bf16 a[24:27], a[220:223], v[184:187], a[24:27]
 v_mfma_f32_16x16x32_bf16 a[24:27], a[192:195], v[200:203], a[24:27]
 v_mfma_f32_16x16x32_bf16 a[24:27], a[196:199], v[216:219], a[24:27]
 v_mfma_f32_16x16x32_bf16 a[28:31], a[220:223], v[188:191], a[28:31]
 v_mfma_f32_16x16x32_bf16 a[28:31], a[192:195], v[204:207], a[28:31]
 v_mfma_f32_16x16x32_bf16 a[28:31], a[196:199], v[220:223], a[28:31]
 s_waitcnt lgkmcnt(0)
 v_mfma_f32_16x16x32_bf16 a[32:35], a[200:203], v[176:179], a[32:35]
 ds_read_b64_tr_b16 a[212:213], v17 offset:0
 ds_read_b64_tr_b16 a[214:215], v17 offset:2048
 v_mfma_f32_16x16x32_bf16 a[32:35], a[204:207], v[192:195], a[32:35]
 ds_read_b64_tr_b16 a[216:217], v17 offset:4096
 ds_read_b64_tr_b16 a[218:219], v17 offset:6144
 v_mfma_f32_16x16x32_bf16 a[32:35], a[208:211], v[208:211], a[32:35]
 ds_read_b64_tr_b16 a[220:221], v17 offset:8192
 ds_read_b64_tr_b16 a[222:223], v17 offset:10240
 v_mfma_f32_16x16x32_bf16 a[36:39], a[200:203], v[180:183], a[36:39]
 v_mfma_f32_16x16x32_bf16 a[36:39], a[204:207], v[196:199], a[36:39]
 v_mfma_f32_16x16x32_bf16 a[36:39], a[208:211], v[212:215], a[36:39]
 v_mfma_f32_16x16x32_bf16 a[40:43], a[200:203], v[184:187], a[40:43]
 v_mfma_f32_16x16x32_bf16 a[40:43], a[204:207], v[200:203], a[40:43]
 v_mfma_f32_16x16x32_bf16 a[40:43], a[208:211], v[216:219], a[40:43]
 v_mfma_f32_16x16x32_bf16 a[44:47], a[200:203], v[188:191], a[44:47]
 v_mfma_f32_16x16x32_bf16 a[44:47], a[204:207], v[204:207], a[44:47]
 v_mfma_f32_16x16x32_bf16 a[44:47], a[208:211], v[220:223], a[44:47]
 s_waitcnt lgkmcnt(0)
 v_mfma_f32_16x16x32_bf16 a[48:51], a[212:215], v[176:179], a[48:51]
 v_add_u32 v14, 110592, v27
 v_xor_b32 v15, 32, v14
 v_mfma_f32_16x16x32_bf16 a[48:51], a[216:219], v[192:195], a[48:51]
 v_xor_b32 v16, 64, v14
 v_xor_b32 v17, 96, v14
 v_mfma_f32_16x16x32_bf16 a[48:51], a[220:223], v[208:211], a[48:51]
 ds_read_b64_tr_b16 a[192:193], v14 offset:0
 ds_read_b64_tr_b16 a[194:195], v14 offset:2048
 v_mfma_f32_16x16x32_bf16 a[52:55], a[212:215], v[180:183], a[52:55]
 ds_read_b64_tr_b16 a[196:197], v14 offset:4096
 ds_read_b64_tr_b16 a[198:199], v14 offset:6144
 v_mfma_f32_16x16x32_bf16 a[52:55], a[216:219], v[196:199], a[52:55]
 ds_read_b64_tr_b16 a[200:201], v14 offset:8192
 ds_read_b64_tr_b16 a[202:203], v14 offset:10240
 v_mfma_f32_16x16x32_bf16 a[52:55], a[220:223], v[212:215], a[52:55]
 v_mfma_f32_16x16x32_bf16 a[56:59], a[212:215], v[184:187], a[56:59]
 v_mfma_f32_16x16x32_bf16 a[56:59], a[216:219], v[200:203], a[56:59]
 v_mfma_f32_16x16x32_bf16 a[56:59], a[220:223], v[216:219], a[56:59]
 v_mfma_f32_16x16x32_bf16 a[60:63], a[212:215], v[188:191], a[60:63]
 v_mfma_f32_16x16x32_bf16 a[60:63], a[216:219], v[204:207], a[60:63]
 v_mfma_f32_16x16x32_bf16 a[60:63], a[220:223], v[220:223], a[60:63]
 s_waitcnt vmcnt(18)
 s_barrier
 s_waitcnt lgkmcnt(0)
 v_mfma_f32_16x16x32_bf16 a[0:3], a[192:195], a[176:179], a[0:3]
 ds_read_b64_tr_b16 a[204:205], v15 offset:0
 ds_read_b64_tr_b16 a[206:207], v15 offset:2048
 v_mfma_f32_16x16x32_bf16 a[0:3], a[196:199], a[224:227], a[0:3]
 ds_read_b64_tr_b16 a[208:209], v15 offset:4096
 ds_read_b64_tr_b16 a[210:211], v15 offset:6144
 v_mfma_f32_16x16x32_bf16 a[0:3], a[200:203], a[240:243], a[0:3]
 ds_read_b64_tr_b16 a[212:213], v15 offset:8192
 ds_read_b64_tr_b16 a[214:215], v15 offset:10240
 v_mfma_f32_16x16x32_bf16 a[4:7], a[192:195], a[180:183], a[4:7]
 s_add_u32 m0, s80, 135168
 s_add_u32 s76, s91, s85
 v_mfma_f32_16x16x32_bf16 a[4:7], a[196:199], a[228:231], a[4:7]
 buffer_load_dwordx4 v24, s[40:43], s76 offen offset:0 lds
 v_mfma_f32_16x16x32_bf16 a[4:7], a[200:203], a[244:247], a[4:7]
 v_mfma_f32_16x16x32_bf16 a[8:11], a[192:195], a[184:187], a[8:11]
 v_mfma_f32_16x16x32_bf16 a[8:11], a[196:199], a[232:235], a[8:11]
 v_mfma_f32_16x16x32_bf16 a[8:11], a[200:203], a[248:251], a[8:11]
 buffer_load_dwordx4 v25, s[40:43], s76 offen offset:1024 lds
 v_mfma_f32_16x16x32_bf16 a[12:15], a[192:195], a[188:191], a[12:15]
 v_mfma_f32_16x16x32_bf16 a[12:15], a[196:199], a[236:239], a[12:15]
 v_mfma_f32_16x16x32_bf16 a[12:15], a[200:203], a[252:255], a[12:15]
 s_waitcnt lgkmcnt(0)
 v_mfma_f32_16x16x32_bf16 a[16:19], a[204:207], a[176:179], a[16:19]
 ds_read_b64_tr_b16 a[216:217], v16 offset:0
 ds_read_b64_tr_b16 a[218:219], v16 offset:2048
 v_mfma_f32_16x16x32_bf16 a[16:19], a[208:211], a[224:227], a[16:19]
 ds_read_b64_tr_b16 a[220:221], v16 offset:4096
 ds_read_b64_tr_b16 a[222:223], v16 offset:6144
 v_mfma_f32_16x16x32_bf16 a[16:19], a[212:215], a[240:243], a[16:19]
 ds_read_b64_tr_b16 a[192:193], v16 offset:8192
 ds_read_b64_tr_b16 a[194:195], v16 offset:10240
 v_mfma_f32_16x16x32_bf16 a[20:23], a[204:207], a[180:183], a[20:23]
 buffer_load_dwordx4 v26, s[40:43], s76 offen offset:2048 lds
 v_mfma_f32_16x16x32_bf16 a[20:23], a[208:211], a[228:231], a[20:23]
 s_add_u32 m0, s80, 36864
 s_add_u32 s76, s92, s85
 v_mfma_f32_16x16x32_bf16 a[20:23], a[212:215], a[244:247], a[20:23]
 v_mfma_f32_16x16x32_bf16 a[24:27], a[204:207], a[184:187], a[24:27]
 v_mfma_f32_16x16x32_bf16 a[24:27], a[208:211], a[232:235], a[24:27]
 v_mfma_f32_16x16x32_bf16 a[24:27], a[212:215], a[248:251], a[24:27]
 buffer_load_dwordx4 v24, s[40:43], s76 offen offset:0 lds
 v_mfma_f32_16x16x32_bf16 a[28:31], a[204:207], a[188:191], a[28:31]
 v_mfma_f32_16x16x32_bf16 a[28:31], a[208:211], a[236:239], a[28:31]
 v_mfma_f32_16x16x32_bf16 a[28:31], a[212:215], a[252:255], a[28:31]
 s_waitcnt lgkmcnt(0)
 v_mfma_f32_16x16x32_bf16 a[32:35], a[216:219], a[176:179], a[32:35]
 ds_read_b64_tr_b16 a[196:197], v17 offset:0
 ds_read_b64_tr_b16 a[198:199], v17 offset:2048
 v_mfma_f32_16x16x32_bf16 a[32:35], a[220:223], a[224:227], a[32:35]
 ds_read_b64_tr_b16 a[200:201], v17 offset:4096
 ds_read_b64_tr_b16 a[202:203], v17 offset:6144
 v_mfma_f32_16x16x32_bf16 a[32:35], a[192:195], a[240:243], a[32:35]
 ds_read_b64_tr_b16 a[204:205], v17 offset:8192
 ds_read_b64_tr_b16 a[206:207], v17 offset:10240
 v_mfma_f32_16x16x32_bf16 a[36:39], a[216:219], a[180:183], a[36:39]
 buffer_load_dwordx4 v25, s[40:43], s76 offen offset:1024 lds
 v_mfma_f32_16x16x32_bf16 a[36:39], a[220:223], a[228:231], a[36:39]
 buffer_load_dwordx4 v26, s[40:43], s76 offen offset:2048 lds
 v_mfma_f32_16x16x32_bf16 a[36:39], a[192:195], a[244:247], a[36:39]
 v_mfma_f32_16x16x32_bf16 a[40:43], a[216:219], a[184:187], a[40:43]
 v_mfma_f32_16x16x32_bf16 a[40:43], a[220:223], a[232:235], a[40:43]
 v_mfma_f32_16x16x32_bf16 a[40:43], a[192:195], a[248:251], a[40:43]
 s_add_u32 m0, s80, 147456
 s_add_u32 s76, s93, s85
 v_mfma_f32_16x16x32_bf16 a[44:47], a[216:219], a[188:191], a[44:47]
 v_mfma_f32_16x16x32_bf16 a[44:47], a[220:223], a[236:239], a[44:47]
 v_mfma_f32_16x16x32_bf16 a[44:47], a[192:195], a[252:255], a[44:47]
 s_waitcnt lgkmcnt(0)
 v_mfma_f32_16x16x32_bf16 a[48:51], a[196:199], a[176:179], a[48:51]
 v_add_u32 v14, 0, v27
 v_xor_b32 v15, 32, v14
 v_mfma_f32_16x16x32_bf16 a[48:51], a[200:203], a[224:227], a[48:51]
 v_xor_b32 v16, 64, v14
 v_xor_b32 v17, 96, v14
 v_mfma_f32_16x16x32_bf16 a[48:51], a[204:207], a[240:243], a[48:51]
 ds_read_b64_tr_b16 a[208:209], v14 offset:0
 ds_read_b64_tr_b16 a[210:211], v14 offset:2048
 v_mfma_f32_16x16x32_bf16 a[52:55], a[196:199], a[180:183], a[52:55]
 ds_read_b64_tr_b16 a[212:213], v14 offset:4096
 ds_read_b64_tr_b16 a[214:215], v14 offset:6144
 v_mfma_f32_16x16x32_bf16 a[52:55], a[200:203], a[228:231], a[52:55]
 ds_read_b64_tr_b16 a[216:217], v14 offset:8192
 ds_read_b64_tr_b16 a[218:219], v14 offset:10240
 v_mfma_f32_16x16x32_bf16 a[52:55], a[204:207], a[244:247], a[52:55]
 buffer_load_dwordx4 v24, s[40:43], s76 offen offset:0 lds
 v_mfma_f32_16x16x32_bf16 a[56:59], a[196:199], a[184:187], a[56:59]
 buffer_load_dwordx4 v25, s[40:43], s76 offen offset:1024 lds
 v_mfma_f32_16x16x32_bf16 a[56:59], a[200:203], a[232:235], a[56:59]
 v_mfma_f32_16x16x32_bf16 a[56:59], a[204:207], a[248:251], a[56:59]
 buffer_load_dwordx4 v26, s[40:43], s76 offen offset:2048 lds
 v_mfma_f32_16x16x32_bf16 a[60:63], a[196:199], a[188:191], a[60:63]
 v_mfma_f32_16x16x32_bf16 a[60:63], a[200:203], a[236:239], a[60:63]
 v_mfma_f32_16x16x32_bf16 a[60:63], a[204:207], a[252:255], a[60:63]
 s_waitcnt lgkmcnt(0)
 s_waitcnt vmcnt(26)
 v_mfma_f32_16x16x32_bf16 a[0:3], a[208:211], v[80:83], a[0:3]
 ds_read_b64_tr_b16 a[220:221], v15 offset:0
 ds_read_b64_tr_b16 a[222:223], v15 offset:2048
 s_waitcnt vmcnt(22)
 v_mfma_f32_16x16x32_bf16 a[0:3], a[212:215], v[96:99], a[0:3]
 ds_read_b64_tr_b16 a[192:193], v15 offset:4096
 ds_read_b64_tr_b16 a[194:195], v15 offset:6144
 s_waitcnt vmcnt(18)
 v_mfma_f32_16x16x32_bf16 a[0:3], a[216:219], v[112:115], a[0:3]
 ds_read_b64_tr_b16 a[196:197], v15 offset:8192
 ds_read_b64_tr_b16 a[198:199], v15 offset:10240
 v_mfma_f32_16x16x32_bf16 a[4:7], a[208:211], v[84:87], a[4:7]
 v_mfma_f32_16x16x32_bf16 a[4:7], a[212:215], v[100:103], a[4:7]
 s_waitcnt vmcnt(17)
 v_mfma_f32_16x16x32_bf16 a[4:7], a[216:219], v[116:119], a[4:7]
 v_mfma_f32_16x16x32_bf16 a[8:11], a[208:211], v[88:91], a[8:11]
 v_mfma_f32_16x16x32_bf16 a[8:11], a[212:215], v[104:107], a[8:11]
 s_waitcnt vmcnt(16)
 v_mfma_f32_16x16x32_bf16 a[8:11], a[216:219], v[120:123], a[8:11]
 v_mfma_f32_16x16x32_bf16 a[12:15], a[208:211], v[92:95], a[12:15]
 v_mfma_f32_16x16x32_bf16 a[12:15], a[212:215], v[108:111], a[12:15]
 s_waitcnt vmcnt(15)
 v_mfma_f32_16x16x32_bf16 a[12:15], a[216:219], v[124:127], a[12:15]
 s_waitcnt lgkmcnt(0)
 v_mfma_f32_16x16x32_bf16 a[16:19], a[220:223], v[80:83], a[16:19]
 ds_read_b64_tr_b16 a[200:201], v16 offset:0
 ds_read_b64_tr_b16 a[202:203], v16 offset:2048
 v_mfma_f32_16x16x32_bf16 a[16:19], a[192:195], v[96:99], a[16:19]
 ds_read_b64_tr_b16 a[204:205], v16 offset:4096
 ds_read_b64_tr_b16 a[206:207], v16 offset:6144
 v_mfma_f32_16x16x32_bf16 a[16:19], a[196:199], v[112:115], a[16:19]
 ds_read_b64_tr_b16 a[208:209], v16 offset:8192
 ds_read_b64_tr_b16 a[210:211], v16 offset:10240
 v_mfma_f32_16x16x32_bf16 a[20:23], a[220:223], v[84:87], a[20:23]
 v_mfma_f32_16x16x32_bf16 a[20:23], a[192:195], v[100:103], a[20:23]
 v_mfma_f32_16x16x32_bf16 a[20:23], a[196:199], v[116:119], a[20:23]
 v_mfma_f32_16x16x32_bf16 a[24:27], a[220:223], v[88:91], a[24:27]
 v_mfma_f32_16x16x32_bf16 a[24:27], a[192:195], v[104:107], a[24:27]
 v_mfma_f32_16x16x32_bf16 a[24:27], a[196:199], v[120:123], a[24:27]
 v_mfma_f32_16x16x32_bf16 a[28:31], a[220:223], v[92:95], a[28:31]
 v_mfma_f32_16x16x32_bf16 a[28:31], a[192:195], v[108:111], a[28:31]
 v_mfma_f32_16x16x32_bf16 a[28:31], a[196:199], v[124:127], a[28:31]
 s_waitcnt lgkmcnt(0)
 v_mfma_f32_16x16x32_bf16 a[32:35], a[200:203], v[80:83], a[32:35]
 ds_read_b64_tr_b16 a[212:213], v17 offset:0
 ds_read_b64_tr_b16 a[214:215], v17 offset:2048
 v_mfma_f32_16x16x32_bf16 a[32:35], a[204:207], v[96:99], a[32:35]
 ds_read_b64_tr_b16 a[216:217], v17 offset:4096
 ds_read_b64_tr_b16 a[218:219], v17 offset:6144
 v_mfma_f32_16x16x32_bf16 a[32:35], a[208:211], v[112:115], a[32:35]
 ds_read_b64_tr_b16 a[220:221], v17 offset:8192
 ds_read_b64_tr_b16 a[222:223], v17 offset:10240
 v_mfma_f32_16x16x32_bf16 a[36:39], a[200:203], v[84:87], a[36:39]
 v_mfma_f32_16x16x32_bf16 a[36:39], a[204:207], v[100:103], a[36:39]
 v_mfma_f32_16x16x32_bf16 a[36:39], a[208:211], v[116:119], a[36:39]
 v_mfma_f32_16x16x32_bf16 a[40:43], a[200:203], v[88:91], a[40:43]
 v_mfma_f32_16x16x32_bf16 a[40:43], a[204:207], v[104:107], a[40:43]
 v_mfma_f32_16x16x32_bf16 a[40:43], a[208:211], v[120:123], a[40:43]
 v_mfma_f32_16x16x32_bf16 a[44:47], a[200:203], v[92:95], a[44:47]
 v_mfma_f32_16x16x32_bf16 a[44:47], a[204:207], v[108:111], a[44:47]
 v_mfma_f32_16x16x32_bf16 a[44:47], a[208:211], v[124:127], a[44:47]
 s_waitcnt lgkmcnt(0)
 v_mfma_f32_16x16x32_bf16 a[48:51], a[212:215], v[80:83], a[48:51]
 v_add_u32 v14, 12288, v27
 v_xor_b32 v15, 32, v14
 v_mfma_f32_16x16x32_bf16 a[48:51], a[216:219], v[96:99], a[48:51]
 v_xor_b32 v16, 64, v14
 v_xor_b32 v17, 96, v14
 v_mfma_f32_16x16x32_bf16 a[48:51], a[220:223], v[112:115], a[48:51]
 ds_read_b64_tr_b16 a[192:193], v14 offset:0
 ds_read_b64_tr_b16 a[194:195], v14 offset:2048
 v_mfma_f32_16x16x32_bf16 a[52:55], a[212:215], v[84:87], a[52:55]
 ds_read_b64_tr_b16 a[196:197], v14 offset:4096
 ds_read_b64_tr_b16 a[198:199], v14 offset:6144
 v_mfma_f32_16x16x32_bf16 a[52:55], a[216:219], v[100:103], a[52:55]
 ds_read_b64_tr_b16 a[200:201], v14 offset:8192
 ds_read_b64_tr_b16 a[202:203], v14 offset:10240
 v_mfma_f32_16x16x32_bf16 a[52:55], a[220:223], v[116:119], a[52:55]
 v_mfma_f32_16x16x32_bf16 a[56:59], a[212:215], v[88:91], a[56:59]
 v_mfma_f32_16x16x32_bf16 a[56:59], a[216:219], v[104:107], a[56:59]
 v_mfma_f32_16x16x32_bf16 a[56:59], a[220:223], v[120:123], a[56:59]
 v_mfma_f32_16x16x32_bf16 a[60:63], a[212:215], v[92:95], a[60:63]
 v_mfma_f32_16x16x32_bf16 a[60:63], a[216:219], v[108:111], a[60:63]
 v_mfma_f32_16x16x32_bf16 a[60:63], a[220:223], v[124:127], a[60:63]
 s_waitcnt vmcnt(6)
 s_barrier
 s_waitcnt lgkmcnt(0)
 v_mfma_f32_16x16x32_bf16 a[64:67], a[192:195], v[176:179], a[64:67]
 ds_read_b64_tr_b16 a[204:205], v15 offset:0
 ds_read_b64_tr_b16 a[206:207], v15 offset:2048
 v_mfma_f32_16x16x32_bf16 a[64:67], a[196:199], v[192:195], a[64:67]
 ds_read_b64_tr_b16 a[208:209], v15 offset:4096
 ds_read_b64_tr_b16 a[210:211], v15 offset:6144
 v_mfma_f32_16x16x32_bf16 a[64:67], a[200:203], v[208:211], a[64:67]
 ds_read_b64_tr_b16 a[212:213], v15 offset:8192
 ds_read_b64_tr_b16 a[214:215], v15 offset:10240
 v_mfma_f32_16x16x32_bf16 a[68:71], a[192:195], v[180:183], a[68:71]
 s_mul_i32 s89, s62, 10240
 v_accvgpr_read_b32 v18, a0
 v_mfma_f32_16x16x32_bf16 a[68:71], a[196:199], v[196:199], a[68:71]
 v_accvgpr_read_b32 v19, a1
 v_mfma_f32_16x16x32_bf16 a[68:71], a[200:203], v[212:215], a[68:71]
 v_accvgpr_read_b32 v20, a2
 v_mfma_f32_16x16x32_bf16 a[72:75], a[192:195], v[184:187], a[72:75]
 v_accvgpr_read_b32 v21, a3
 v_cvt_pk_bf16_f32 v10, v18, v19
 v_mfma_f32_16x16x32_bf16 a[72:75], a[196:199], v[200:203], a[72:75]
 v_cvt_pk_bf16_f32 v11, v20, v21
 v_mfma_f32_16x16x32_bf16 a[72:75], a[200:203], v[216:219], a[72:75]
 v_accvgpr_read_b32 v18, a16
 v_mfma_f32_16x16x32_bf16 a[76:79], a[192:195], v[188:191], a[76:79]
 v_accvgpr_read_b32 v19, a17
 v_mfma_f32_16x16x32_bf16 a[76:79], a[196:199], v[204:207], a[76:79]
 v_accvgpr_read_b32 v20, a18
 v_accvgpr_read_b32 v21, a19
 v_mfma_f32_16x16x32_bf16 a[76:79], a[200:203], v[220:223], a[76:79]
 v_cvt_pk_bf16_f32 v12, v18, v19
 s_waitcnt lgkmcnt(0)
 v_mfma_f32_16x16x32_bf16 a[80:83], a[204:207], v[176:179], a[80:83]
 v_cvt_pk_bf16_f32 v13, v20, v21
 ds_read_b64_tr_b16 a[216:217], v16 offset:0
 v_mfma_f32_16x16x32_bf16 a[80:83], a[208:211], v[192:195], a[80:83]
 s_add_u32 s75, s89, 0
 ds_read_b64_tr_b16 a[218:219], v16 offset:2048
 v_mfma_f32_16x16x32_bf16 a[80:83], a[212:215], v[208:211], a[80:83]
 buffer_store_dwordx4 v[10:13], v1, s[44:47], s75 offen offset:0 sc1
 v_mfma_f32_16x16x32_bf16 a[84:87], a[204:207], v[180:183], a[84:87]
 ds_read_b64_tr_b16 a[220:221], v16 offset:4096
 ds_read_b64_tr_b16 a[222:223], v16 offset:6144
 v_mfma_f32_16x16x32_bf16 a[84:87], a[208:211], v[196:199], a[84:87]
 ds_read_b64_tr_b16 a[192:193], v16 offset:8192
 ds_read_b64_tr_b16 a[194:195], v16 offset:10240
 v_accvgpr_read_b32 v18, a32
 v_mfma_f32_16x16x32_bf16 a[84:87], a[212:215], v[212:215], a[84:87]
 v_accvgpr_read_b32 v19, a33
 v_accvgpr_read_b32 v20, a34
 v_mfma_f32_16x16x32_bf16 a[88:91], a[204:207], v[184:187], a[88:91]
 v_accvgpr_read_b32 v21, a35
 v_cvt_pk_bf16_f32 v4, v18, v19
 v_mfma_f32_16x16x32_bf16 a[88:91], a[208:211], v[200:203], a[88:91]
 v_cvt_pk_bf16_f32 v5, v20, v21
 v_accvgpr_read_b32 v18, a48
 v_mfma_f32_16x16x32_bf16 a[88:91], a[212:215], v[216:219], a[88:91]
 v_accvgpr_read_b32 v19, a49
 v_mfma_f32_16x16x32_bf16 a[92:95], a[204:207], v[188:191], a[92:95]
 v_accvgpr_read_b32 v20, a50
 v_accvgpr_read_b32 v21, a51
 v_mfma_f32_16x16x32_bf16 a[92:95], a[208:211], v[204:207], a[92:95]
 v_cvt_pk_bf16_f32 v6, v18, v19
 v_mfma_f32_16x16x32_bf16 a[92:95], a[212:215], v[220:223], a[92:95]
 v_cvt_pk_bf16_f32 v7, v20, v21
 s_waitcnt lgkmcnt(0)
 v_mfma_f32_16x16x32_bf16 a[96:99], a[216:219], v[176:179], a[96:99]
 s_add_u32 s75, s89, 81920
 ds_read_b64_tr_b16 a[196:197], v17 offset:0
 v_mfma_f32_16x16x32_bf16 a[96:99], a[220:223], v[192:195], a[96:99]
 buffer_store_dwordx4 v[4:7], v1, s[44:47], s75 offen offset:0 sc1
 v_mfma_f32_16x16x32_bf16 a[96:99], a[192:195], v[208:211], a[96:99]
 v_accvgpr_read_b32 v18, a4
 ds_read_b64_tr_b16 a[198:199], v17 offset:2048
 v_mfma_f32_16x16x32_bf16 a[100:103], a[216:219], v[180:183], a[100:103]
 ds_read_b64_tr_b16 a[200:201], v17 offset:4096
 ds_read_b64_tr_b16 a[202:203], v17 offset:6144
 v_mfma_f32_16x16x32_bf16 a[100:103], a[220:223], v[196:199], a[100:103]
 ds_read_b64_tr_b16 a[204:205], v17 offset:8192
 ds_read_b64_tr_b16 a[206:207], v17 offset:10240
 v_accvgpr_read_b32 v19, a5
 v_mfma_f32_16x16x32_bf16 a[100:103], a[192:195], v[212:215], a[100:103]
 v_accvgpr_read_b32 v20, a6
 v_accvgpr_read_b32 v21, a7
 v_mfma_f32_16x16x32_bf16 a[104:107], a[216:219], v[184:187], a[104:107]
 v_cvt_pk_bf16_f32 v10, v18, v19
 v_cvt_pk_bf16_f32 v11, v20, v21
 v_mfma_f32_16x16x32_bf16 a[104:107], a[220:223], v[200:203], a[104:107]
 v_accvgpr_read_b32 v18, a20
 v_accvgpr_read_b32 v19, a21
 v_mfma_f32_16x16x32_bf16 a[104:107], a[192:195], v[216:219], a[104:107]
 v_accvgpr_read_b32 v20, a22
 v_mfma_f32_16x16x32_bf16 a[108:111], a[216:219], v[188:191], a[108:111]
 v_accvgpr_read_b32 v21, a23
 v_cvt_pk_bf16_f32 v12, v18, v19
 v_mfma_f32_16x16x32_bf16 a[108:111], a[220:223], v[204:207], a[108:111]
 v_cvt_pk_bf16_f32 v13, v20, v21
 v_mfma_f32_16x16x32_bf16 a[108:111], a[192:195], v[220:223], a[108:111]
 s_add_u32 s75, s89, 163840
 s_waitcnt lgkmcnt(0)
 v_mfma_f32_16x16x32_bf16 a[112:115], a[196:199], v[176:179], a[112:115]
 buffer_store_dwordx4 v[10:13], v1, s[44:47], s75 offen offset:0 sc1
 v_mfma_f32_16x16x32_bf16 a[112:115], a[200:203], v[192:195], a[112:115]
 v_accvgpr_read_b32 v18, a36
 v_accvgpr_read_b32 v19, a37
 v_mfma_f32_16x16x32_bf16 a[112:115], a[204:207], v[208:211], a[112:115]
 v_add_u32 v14, 122880, v27
 v_xor_b32 v15, 32, v14
 v_mfma_f32_16x16x32_bf16 a[116:119], a[196:199], v[180:183], a[116:119]
 v_xor_b32 v16, 64, v14
 v_xor_b32 v17, 96, v14
 v_mfma_f32_16x16x32_bf16 a[116:119], a[200:203], v[196:199], a[116:119]
 ds_read_b64_tr_b16 a[208:209], v14 offset:0
 ds_read_b64_tr_b16 a[210:211], v14 offset:2048
 ds_read_b64_tr_b16 a[212:213], v14 offset:4096
 ds_read_b64_tr_b16 a[214:215], v14 offset:6144
 ds_read_b64_tr_b16 a[216:217], v14 offset:8192
 ds_read_b64_tr_b16 a[218:219], v14 offset:10240
 v_accvgpr_read_b32 v20, a38
 v_mfma_f32_16x16x32_bf16 a[116:119], a[204:207], v[212:215], a[116:119]
 v_accvgpr_read_b32 v21, a39
 v_cvt_pk_bf16_f32 v4, v18, v19
 v_mfma_f32_16x16x32_bf16 a[120:123], a[196:199], v[184:187], a[120:123]
 v_cvt_pk_bf16_f32 v5, v20, v21
 v_accvgpr_read_b32 v18, a52
 v_mfma_f32_16x16x32_bf16 a[120:123], a[200:203], v[200:203], a[120:123]
 v_accvgpr_read_b32 v19, a53
 v_accvgpr_read_b32 v20, a54
 v_mfma_f32_16x16x32_bf16 a[120:123], a[204:207], v[216:219], a[120:123]
 v_accvgpr_read_b32 v21, a55
 v_cvt_pk_bf16_f32 v6, v18, v19
 v_mfma_f32_16x16x32_bf16 a[124:127], a[196:199], v[188:191], a[124:127]
 v_cvt_pk_bf16_f32 v7, v20, v21
 v_mfma_f32_16x16x32_bf16 a[124:127], a[200:203], v[204:207], a[124:127]
 s_add_u32 s75, s89, 245760
 v_mfma_f32_16x16x32_bf16 a[124:127], a[204:207], v[220:223], a[124:127]
 buffer_store_dwordx4 v[4:7], v1, s[44:47], s75 offen offset:0 sc1
 s_waitcnt lgkmcnt(0)
 v_mfma_f32_16x16x32_bf16 a[64:67], a[208:211], a[176:179], a[64:67]
 v_accvgpr_read_b32 v18, a8
 v_accvgpr_read_b32 v19, a9
 v_mfma_f32_16x16x32_bf16 a[64:67], a[212:215], a[224:227], a[64:67]
 v_accvgpr_read_b32 v20, a10
 ds_read_b64_tr_b16 a[220:221], v15 offset:0
 v_mfma_f32_16x16x32_bf16 a[64:67], a[216:219], a[240:243], a[64:67]
 ds_read_b64_tr_b16 a[222:223], v15 offset:2048
 ds_read_b64_tr_b16 a[192:193], v15 offset:4096
 v_mfma_f32_16x16x32_bf16 a[68:71], a[208:211], a[180:183], a[68:71]
 ds_read_b64_tr_b16 a[194:195], v15 offset:6144
 ds_read_b64_tr_b16 a[196:197], v15 offset:8192
 v_mfma_f32_16x16x32_bf16 a[68:71], a[212:215], a[228:231], a[68:71]
 ds_read_b64_tr_b16 a[198:199], v15 offset:10240
 v_accvgpr_read_b32 v21, a11
 v_mfma_f32_16x16x32_bf16 a[68:71], a[216:219], a[244:247], a[68:71]
 v_cvt_pk_bf16_f32 v10, v18, v19
 v_cvt_pk_bf16_f32 v11, v20, v21
 v_mfma_f32_16x16x32_bf16 a[72:75], a[208:211], a[184:187], a[72:75]
 v_accvgpr_read_b32 v18, a24
 v_accvgpr_read_b32 v19, a25
 v_mfma_f32_16x16x32_bf16 a[72:75], a[212:215], a[232:235], a[72:75]
 v_accvgpr_read_b32 v20, a26
 v_accvgpr_read_b32 v21, a27
 v_mfma_f32_16x16x32_bf16 a[72:75], a[216:219], a[248:251], a[72:75]
 v_cvt_pk_bf16_f32 v12, v18, v19
 v_mfma_f32_16x16x32_bf16 a[76:79], a[208:211], a[188:191], a[76:79]
 v_cvt_pk_bf16_f32 v13, v20, v21
 v_mfma_f32_16x16x32_bf16 a[76:79], a[212:215], a[236:239], a[76:79]
 s_add_u32 s75, s89, 327680
 v_mfma_f32_16x16x32_bf16 a[76:79], a[216:219], a[252:255], a[76:79]
 s_waitcnt lgkmcnt(0)
 v_mfma_f32_16x16x32_bf16 a[80:83], a[220:223], a[176:179], a[80:83]
 buffer_store_dwordx4 v[10:13], v1, s[44:47], s75 offen offset:0 sc1
 v_mfma_f32_16x16x32_bf16 a[80:83], a[192:195], a[224:227], a[80:83]
 v_accvgpr_read_b32 v18, a40
 v_accvgpr_read_b32 v19, a41
 v_mfma_f32_16x16x32_bf16 a[80:83], a[196:199], a[240:243], a[80:83]
 v_accvgpr_read_b32 v20, a42
 ds_read_b64_tr_b16 a[200:201], v16 offset:0
 v_mfma_f32_16x16x32_bf16 a[84:87], a[220:223], a[180:183], a[84:87]
 ds_read_b64_tr_b16 a[202:203], v16 offset:2048
 ds_read_b64_tr_b16 a[204:205], v16 offset:4096
 v_mfma_f32_16x16x32_bf16 a[84:87], a[192:195], a[228:231], a[84:87]
 ds_read_b64_tr_b16 a[206:207], v16 offset:6144
 ds_read_b64_tr_b16 a[208:209], v16 offset:8192
 ds_read_b64_tr_b16 a[210:211], v16 offset:10240
 v_accvgpr_read_b32 v21, a43
 v_mfma_f32_16x16x32_bf16 a[84:87], a[196:199], a[244:247], a[84:87]
 v_cvt_pk_bf16_f32 v4, v18, v19
 v_cvt_pk_bf16_f32 v5, v20, v21
 v_mfma_f32_16x16x32_bf16 a[88:91], a[220:223], a[184:187], a[88:91]
 v_accvgpr_read_b32 v18, a56
 v_accvgpr_read_b32 v19, a57
 v_mfma_f32_16x16x32_bf16 a[88:91], a[192:195], a[232:235], a[88:91]
 v_accvgpr_read_b32 v20, a58
 v_accvgpr_read_b32 v21, a59
 v_mfma_f32_16x16x32_bf16 a[88:91], a[196:199], a[248:251], a[88:91]
 v_cvt_pk_bf16_f32 v6, v18, v19
 v_mfma_f32_16x16x32_bf16 a[92:95], a[220:223], a[188:191], a[92:95]
 v_cvt_pk_bf16_f32 v7, v20, v21
 v_mfma_f32_16x16x32_bf16 a[92:95], a[192:195], a[236:239], a[92:95]
 s_add_u32 s75, s89, 409600
 v_mfma_f32_16x16x32_bf16 a[92:95], a[196:199], a[252:255], a[92:95]
 s_waitcnt lgkmcnt(0)
 v_mfma_f32_16x16x32_bf16 a[96:99], a[200:203], a[176:179], a[96:99]
 buffer_store_dwordx4 v[4:7], v1, s[44:47], s75 offen offset:0 sc1
 v_mfma_f32_16x16x32_bf16 a[96:99], a[204:207], a[224:227], a[96:99]
 v_accvgpr_read_b32 v18, a12
 v_accvgpr_read_b32 v19, a13
 v_mfma_f32_16x16x32_bf16 a[96:99], a[208:211], a[240:243], a[96:99]
 v_accvgpr_read_b32 v20, a14
 ds_read_b64_tr_b16 a[212:213], v17 offset:0
 v_mfma_f32_16x16x32_bf16 a[100:103], a[200:203], a[180:183], a[100:103]
 ds_read_b64_tr_b16 a[214:215], v17 offset:2048
 ds_read_b64_tr_b16 a[216:217], v17 offset:4096
 v_mfma_f32_16x16x32_bf16 a[100:103], a[204:207], a[228:231], a[100:103]
 ds_read_b64_tr_b16 a[218:219], v17 offset:6144
 ds_read_b64_tr_b16 a[220:221], v17 offset:8192
 ds_read_b64_tr_b16 a[222:223], v17 offset:10240
 v_accvgpr_read_b32 v21, a15
 v_mfma_f32_16x16x32_bf16 a[100:103], a[208:211], a[244:247], a[100:103]
 v_cvt_pk_bf16_f32 v10, v18, v19
 v_cvt_pk_bf16_f32 v11, v20, v21
 v_mfma_f32_16x16x32_bf16 a[104:107], a[200:203], a[184:187], a[104:107]
 v_accvgpr_read_b32 v18, a28
 v_accvgpr_read_b32 v19, a29
 v_mfma_f32_16x16x32_bf16 a[104:107], a[204:207], a[232:235], a[104:107]
 v_accvgpr_read_b32 v20, a30
 v_accvgpr_read_b32 v21, a31
 v_mfma_f32_16x16x32_bf16 a[104:107], a[208:211], a[248:251], a[104:107]
 v_cvt_pk_bf16_f32 v12, v18, v19
 v_mfma_f32_16x16x32_bf16 a[108:111], a[200:203], a[188:191], a[108:111]
 v_cvt_pk_bf16_f32 v13, v20, v21
 v_mfma_f32_16x16x32_bf16 a[108:111], a[204:207], a[236:239], a[108:111]
 s_add_u32 s75, s89, 491520
 v_mfma_f32_16x16x32_bf16 a[108:111], a[208:211], a[252:255], a[108:111]
 s_waitcnt lgkmcnt(0)
 v_mfma_f32_16x16x32_bf16 a[112:115], a[212:215], a[176:179], a[112:115]
 buffer_store_dwordx4 v[10:13], v1, s[44:47], s75 offen offset:0 sc1
 v_mfma_f32_16x16x32_bf16 a[112:115], a[216:219], a[224:227], a[112:115]
 v_accvgpr_read_b32 v18, a44
 v_accvgpr_read_b32 v19, a45
 v_mfma_f32_16x16x32_bf16 a[112:115], a[220:223], a[240:243], a[112:115]
 v_accvgpr_read_b32 v20, a46
 v_add_u32 v14, 24576, v27
 v_mfma_f32_16x16x32_bf16 a[116:119], a[212:215], a[180:183], a[116:119]
 v_xor_b32 v15, 32, v14
 v_xor_b32 v16, 64, v14
 v_mfma_f32_16x16x32_bf16 a[116:119], a[216:219], a[228:231], a[116:119]
 v_xor_b32 v17, 96, v14
 ds_read_b64_tr_b16 a[192:193], v14 offset:0
 ds_read_b64_tr_b16 a[194:195], v14 offset:2048
 ds_read_b64_tr_b16 a[196:197], v14 offset:4096
 ds_read_b64_tr_b16 a[198:199], v14 offset:6144
 ds_read_b64_tr_b16 a[200:201], v14 offset:8192
 ds_read_b64_tr_b16 a[202:203], v14 offset:10240
 v_accvgpr_read_b32 v21, a47
 v_mfma_f32_16x16x32_bf16 a[116:119], a[220:223], a[244:247], a[116:119]
 v_cvt_pk_bf16_f32 v4, v18, v19
 v_cvt_pk_bf16_f32 v5, v20, v21
 v_mfma_f32_16x16x32_bf16 a[120:123], a[212:215], a[184:187], a[120:123]
 v_accvgpr_read_b32 v18, a60
 v_accvgpr_read_b32 v19, a61
 v_mfma_f32_16x16x32_bf16 a[120:123], a[216:219], a[232:235], a[120:123]
 v_accvgpr_read_b32 v20, a62
 v_accvgpr_read_b32 v21, a63
 v_mfma_f32_16x16x32_bf16 a[120:123], a[220:223], a[248:251], a[120:123]
 v_cvt_pk_bf16_f32 v6, v18, v19
 v_mfma_f32_16x16x32_bf16 a[124:127], a[212:215], a[188:191], a[124:127]
 v_cvt_pk_bf16_f32 v7, v20, v21
 v_mfma_f32_16x16x32_bf16 a[124:127], a[216:219], a[236:239], a[124:127]
 s_add_u32 s75, s89, 573440
 v_mfma_f32_16x16x32_bf16 a[124:127], a[220:223], a[252:255], a[124:127]
 buffer_store_dwordx4 v[4:7], v1, s[44:47], s75 offen offset:0 sc1
 s_waitcnt lgkmcnt(0)
 v_mfma_f32_16x16x32_bf16 a[64:67], a[192:195], v[80:83], a[64:67]
 ds_read_b64_tr_b16 a[204:205], v15 offset:0
 ds_read_b64_tr_b16 a[206:207], v15 offset:2048
 v_mfma_f32_16x16x32_bf16 a[64:67], a[196:199], v[96:99], a[64:67]
 ds_read_b64_tr_b16 a[208:209], v15 offset:4096
 ds_read_b64_tr_b16 a[210:211], v15 offset:6144
 v_mfma_f32_16x16x32_bf16 a[64:67], a[200:203], v[112:115], a[64:67]
 ds_read_b64_tr_b16 a[212:213], v15 offset:8192
 ds_read_b64_tr_b16 a[214:215], v15 offset:10240
 v_mfma_f32_16x16x32_bf16 a[68:71], a[192:195], v[84:87], a[68:71]
 v_mfma_f32_16x16x32_bf16 a[68:71], a[196:199], v[100:103], a[68:71]
 v_mfma_f32_16x16x32_bf16 a[68:71], a[200:203], v[116:119], a[68:71]
 v_mfma_f32_16x16x32_bf16 a[72:75], a[192:195], v[88:91], a[72:75]
 v_mfma_f32_16x16x32_bf16 a[72:75], a[196:199], v[104:107], a[72:75]
 v_mfma_f32_16x16x32_bf16 a[72:75], a[200:203], v[120:123], a[72:75]
 v_mfma_f32_16x16x32_bf16 a[76:79], a[192:195], v[92:95], a[76:79]
 v_mfma_f32_16x16x32_bf16 a[76:79], a[196:199], v[108:111], a[76:79]
 v_mfma_f32_16x16x32_bf16 a[76:79], a[200:203], v[124:127], a[76:79]
 s_waitcnt lgkmcnt(0)
 v_mfma_f32_16x16x32_bf16 a[80:83], a[204:207], v[80:83], a[80:83]
 ds_read_b64_tr_b16 a[216:217], v16 offset:0
 ds_read_b64_tr_b16 a[218:219], v16 offset:2048
 v_mfma_f32_16x16x32_bf16 a[80:83], a[208:211], v[96:99], a[80:83]
 ds_read_b64_tr_b16 a[220:221], v16 offset:4096
 ds_read_b64_tr_b16 a[222:223], v16 offset:6144
 v_mfma_f32_16x16x32_bf16 a[80:83], a[212:215], v[112:115], a[80:83]
 ds_read_b64_tr_b16 a[192:193], v16 offset:8192
 ds_read_b64_tr_b16 a[194:195], v16 offset:10240
 v_mfma_f32_16x16x32_bf16 a[84:87], a[204:207], v[84:87], a[84:87]
 v_mfma_f32_16x16x32_bf16 a[84:87], a[208:211], v[100:103], a[84:87]
 v_mfma_f32_16x16x32_bf16 a[84:87], a[212:215], v[116:119], a[84:87]
 v_mfma_f32_16x16x32_bf16 a[88:91], a[204:207], v[88:91], a[88:91]
 v_mfma_f32_16x16x32_bf16 a[88:91], a[208:211], v[104:107], a[88:91]
 v_mfma_f32_16x16x32_bf16 a[88:91], a[212:215], v[120:123], a[88:91]
 v_mfma_f32_16x16x32_bf16 a[92:95], a[204:207], v[92:95], a[92:95]
 v_mfma_f32_16x16x32_bf16 a[92:95], a[208:211], v[108:111], a[92:95]
 v_mfma_f32_16x16x32_bf16 a[92:95], a[212:215], v[124:127], a[92:95]
 s_waitcnt lgkmcnt(0)
 v_mfma_f32_16x16x32_bf16 a[96:99], a[216:219], v[80:83], a[96:99]
 ds_read_b64_tr_b16 a[196:197], v17 offset:0
 ds_read_b64_tr_b16 a[198:199], v17 offset:2048
 v_mfma_f32_16x16x32_bf16 a[96:99], a[220:223], v[96:99], a[96:99]
 ds_read_b64_tr_b16 a[200:201], v17 offset:4096
 ds_read_b64_tr_b16 a[202:203], v17 offset:6144
 v_mfma_f32_16x16x32_bf16 a[96:99], a[192:195], v[112:115], a[96:99]
 ds_read_b64_tr_b16 a[204:205], v17 offset:8192
 ds_read_b64_tr_b16 a[206:207], v17 offset:10240
 v_mfma_f32_16x16x32_bf16 a[100:103], a[216:219], v[84:87], a[100:103]
 v_mfma_f32_16x16x32_bf16 a[100:103], a[220:223], v[100:103], a[100:103]
 v_mfma_f32_16x16x32_bf16 a[100:103], a[192:195], v[116:119], a[100:103]
 v_mfma_f32_16x16x32_bf16 a[104:107], a[216:219], v[88:91], a[104:107]
 v_mfma_f32_16x16x32_bf16 a[104:107], a[220:223], v[104:107], a[104:107]
 v_mfma_f32_16x16x32_bf16 a[104:107], a[192:195], v[120:123], a[104:107]
 v_mfma_f32_16x16x32_bf16 a[108:111], a[216:219], v[92:95], a[108:111]
 v_mfma_f32_16x16x32_bf16 a[108:111], a[220:223], v[108:111], a[108:111]
 v_mfma_f32_16x16x32_bf16 a[108:111], a[192:195], v[124:127], a[108:111]
 s_waitcnt lgkmcnt(0)
 v_mfma_f32_16x16x32_bf16 a[112:115], a[196:199], v[80:83], a[112:115]
 v_add_u32 v14, 135168, v28
 v_xor_b32 v15, 32, v14
 v_mfma_f32_16x16x32_bf16 a[112:115], a[200:203], v[96:99], a[112:115]
 ds_read_b64_tr_b16 a[208:209], v14 offset:0
 ds_read_b64_tr_b16 a[210:211], v14 offset:1024
 v_mfma_f32_16x16x32_bf16 a[112:115], a[204:207], v[112:115], a[112:115]
 ds_read_b64_tr_b16 a[212:213], v14 offset:2048
 ds_read_b64_tr_b16 a[214:215], v14 offset:3072
 v_mfma_f32_16x16x32_bf16 a[116:119], a[196:199], v[84:87], a[116:119]
 ds_read_b64_tr_b16 a[216:217], v14 offset:4096
 ds_read_b64_tr_b16 a[218:219], v14 offset:5120
 v_mfma_f32_16x16x32_bf16 a[116:119], a[200:203], v[100:103], a[116:119]
 v_mfma_f32_16x16x32_bf16 a[116:119], a[204:207], v[116:119], a[116:119]
 v_mfma_f32_16x16x32_bf16 a[120:123], a[196:199], v[88:91], a[120:123]
 v_mfma_f32_16x16x32_bf16 a[120:123], a[200:203], v[104:107], a[120:123]
 v_mfma_f32_16x16x32_bf16 a[120:123], a[204:207], v[120:123], a[120:123]
 v_mfma_f32_16x16x32_bf16 a[124:127], a[196:199], v[92:95], a[124:127]
 v_mfma_f32_16x16x32_bf16 a[124:127], a[200:203], v[108:111], a[124:127]
 v_mfma_f32_16x16x32_bf16 a[124:127], a[204:207], v[124:127], a[124:127]
 s_waitcnt vmcnt(0)
 s_lshl_b32 s75, s62, 3
 s_add_u32 s75, s75, s88
 s_add_u32 s76, s83, 1
 v_mov_b32 v4, s82
 v_mov_b32 v5, s76
 v_mov_b32 v6, 0
 buffer_store_dwordx2 v[4:5], v6, s[48:51], s75 offen sc0 sc1
 s_barrier
 s_waitcnt lgkmcnt(0)
 v_mfma_f32_16x16x32_bf16 a[128:131], a[208:211], v[128:131], a[128:131]
 ds_read_b64_tr_b16 a[220:221], v14 offset:6144
 ds_read_b64_tr_b16 a[222:223], v14 offset:7168
 v_mfma_f32_16x16x32_bf16 a[128:131], a[212:215], v[144:147], a[128:131]
 ds_read_b64_tr_b16 a[192:193], v14 offset:8192
 ds_read_b64_tr_b16 a[194:195], v14 offset:9216
 v_mfma_f32_16x16x32_bf16 a[128:131], a[216:219], v[160:163], a[128:131]
 ds_read_b64_tr_b16 a[196:197], v14 offset:10240
 ds_read_b64_tr_b16 a[198:199], v14 offset:11264
 v_mfma_f32_16x16x32_bf16 a[132:135], a[208:211], v[132:135], a[132:135]
 s_mul_i32 s89, s62, 10240
 v_accvgpr_read_b32 v18, a64
 v_mfma_f32_16x16x32_bf16 a[132:135], a[212:215], v[148:151], a[132:135]
 v_accvgpr_read_b32 v19, a65
 v_mfma_f32_16x16x32_bf16 a[132:135], a[216:219], v[164:167], a[132:135]
 v_accvgpr_read_b32 v20, a66
 v_mfma_f32_16x16x32_bf16 a[136:139], a[208:211], v[136:139], a[136:139]
 v_accvgpr_read_b32 v21, a67
 v_cvt_pk_bf16_f32 v10, v18, v19
 v_mfma_f32_16x16x32_bf16 a[136:139], a[212:215], v[152:155], a[136:139]
 v_cvt_pk_bf16_f32 v11, v20, v21
 v_mfma_f32_16x16x32_bf16 a[136:139], a[216:219], v[168:171], a[136:139]
 v_accvgpr_read_b32 v18, a80
 v_mfma_f32_16x16x32_bf16 a[140:143], a[208:211], v[140:143], a[140:143]
 v_accvgpr_read_b32 v19, a81
 v_mfma_f32_16x16x32_bf16 a[140:143], a[212:215], v[156:159], a[140:143]
 v_accvgpr_read_b32 v20, a82
 v_accvgpr_read_b32 v21, a83
 v_mfma_f32_16x16x32_bf16 a[140:143], a[216:219], v[172:175], a[140:143]
 v_cvt_pk_bf16_f32 v12, v18, v19
 s_waitcnt lgkmcnt(0)
 v_mfma_f32_16x16x32_bf16 a[128:131], a[220:223], v[176:179], a[128:131]
 v_cvt_pk_bf16_f32 v13, v20, v21
 ds_read_b64_tr_b16 a[200:201], v15 offset:0
 v_mfma_f32_16x16x32_bf16 a[128:131], a[192:195], v[192:195], a[128:131]
 s_add_u32 s75, s89, 0
 ds_read_b64_tr_b16 a[202:203], v15 offset:1024
 v_mfma_f32_16x16x32_bf16 a[128:131], a[196:199], v[208:211], a[128:131]
 buffer_store_dwordx4 v[10:13], v1, s[44:47], s75 offen offset:1024 sc1
 v_mfma_f32_16x16x32_bf16 a[132:135], a[220:223], v[180:183], a[132:135]
 ds_read_b64_tr_b16 a[204:205], v15 offset:2048
 ds_read_b64_tr_b16 a[206:207], v15 offset:3072
 v_mfma_f32_16x16x32_bf16 a[132:135], a[192:195], v[196:199], a[132:135]
 ds_read_b64_tr_b16 a[208:209], v15 offset:4096
 ds_read_b64_tr_b16 a[210:211], v15 offset:5120
 v_accvgpr_read_b32 v18, a96
 v_mfma_f32_16x16x32_bf16 a[132:135], a[196:199], v[212:215], a[132:135]
 v_accvgpr_read_b32 v19, a97
 v_accvgpr_read_b32 v20, a98
 v_mfma_f32_16x16x32_bf16 a[136:139], a[220:223], v[184:187], a[136:139]
 v_accvgpr_read_b32 v21, a99
 v_cvt_pk_bf16_f32 v4, v18, v19
 v_mfma_f32_16x16x32_bf16 a[136:139], a[192:195], v[200:203], a[136:139]
 v_cvt_pk_bf16_f32 v5, v20, v21
 v_accvgpr_read_b32 v18, a112
 v_mfma_f32_16x16x32_bf16 a[136:139], a[196:199], v[216:219], a[136:139]
 v_accvgpr_read_b32 v19, a113
 v_mfma_f32_16x16x32_bf16 a[140:143], a[220:223], v[188:191], a[140:143]
 v_accvgpr_read_b32 v20, a114
 v_accvgpr_read_b32 v21, a115
 v_mfma_f32_16x16x32_bf16 a[140:143], a[192:195], v[204:207], a[140:143]
 v_cvt_pk_bf16_f32 v6, v18, v19
 v_mfma_f32_16x16x32_bf16 a[140:143], a[196:199], v[220:223], a[140:143]
 v_cvt_pk_bf16_f32 v7, v20, v21
 s_waitcnt lgkmcnt(0)
 v_mfma_f32_16x16x32_bf16 a[144:147], a[200:203], v[128:131], a[144:147]
 s_add_u32 s75, s89, 81920
 ds_read_b64_tr_b16 a[212:213], v15 offset:6144
 v_mfma_f32_16x16x32_bf16 a[144:147], a[204:207], v[144:147], a[144:147]
 buffer_store_dwordx4 v[4:7], v1, s[44:47], s75 offen offset:1024 sc1
 v_mfma_f32_16x16x32_bf16 a[144:147], a[208:211], v[160:163], a[144:147]
 v_accvgpr_read_b32 v18, a68
 ds_read_b64_tr_b16 a[214:215], v15 offset:7168
 v_mfma_f32_16x16x32_bf16 a[148:151], a[200:203], v[132:135], a[148:151]
 ds_read_b64_tr_b16 a[216:217], v15 offset:8192
 ds_read_b64_tr_b16 a[218:219], v15 offset:9216
 v_mfma_f32_16x16x32_bf16 a[148:151], a[204:207], v[148:151], a[148:151]
 ds_read_b64_tr_b16 a[220:221], v15 offset:10240
 ds_read_b64_tr_b16 a[222:223], v15 offset:11264
 v_accvgpr_read_b32 v19, a69
 v_mfma_f32_16x16x32_bf16 a[148:151], a[208:211], v[164:167], a[148:151]
 v_accvgpr_read_b32 v20, a70
 v_accvgpr_read_b32 v21, a71
 v_mfma_f32_16x16x32_bf16 a[152:155], a[200:203], v[136:139], a[152:155]
 v_cvt_pk_bf16_f32 v10, v18, v19
 v_cvt_pk_bf16_f32 v11, v20, v21
 v_mfma_f32_16x16x32_bf16 a[152:155], a[204:207], v[152:155], a[152:155]
 v_accvgpr_read_b32 v18, a84
 v_accvgpr_read_b32 v19, a85
 v_mfma_f32_16x16x32_bf16 a[152:155], a[208:211], v[168:171], a[152:155]
 v_accvgpr_read_b32 v20, a86
 v_mfma_f32_16x16x32_bf16 a[156:159], a[200:203], v[140:143], a[156:159]
 v_accvgpr_read_b32 v21, a87
 v_cvt_pk_bf16_f32 v12, v18, v19
 v_mfma_f32_16x16x32_bf16 a[156:159], a[204:207], v[156:159], a[156:159]
 v_cvt_pk_bf16_f32 v13, v20, v21
 v_mfma_f32_16x16x32_bf16 a[156:159], a[208:211], v[172:175], a[156:159]
 s_add_u32 s75, s89, 163840
 s_waitcnt lgkmcnt(0)
 v_mfma_f32_16x16x32_bf16 a[144:147], a[212:215], v[176:179], a[144:147]
 buffer_store_dwordx4 v[10:13], v1, s[44:47], s75 offen offset:1024 sc1
 v_mfma_f32_16x16x32_bf16 a[144:147], a[216:219], v[192:195], a[144:147]
 v_accvgpr_read_b32 v18, a100
 v_accvgpr_read_b32 v19, a101
 v_mfma_f32_16x16x32_bf16 a[144:147], a[220:223], v[208:211], a[144:147]
 v_add_u32 v14, 36864, v28
 v_xor_b32 v15, 32, v14
 v_mfma_f32_16x16x32_bf16 a[148:151], a[212:215], v[180:183], a[148:151]
 ds_read_b64_tr_b16 a[192:193], v14 offset:0
 ds_read_b64_tr_b16 a[194:195], v14 offset:1024
 v_mfma_f32_16x16x32_bf16 a[148:151], a[216:219], v[196:199], a[148:151]
 ds_read_b64_tr_b16 a[196:197], v14 offset:2048
 ds_read_b64_tr_b16 a[198:199], v14 offset:3072
 ds_read_b64_tr_b16 a[200:201], v14 offset:4096
 ds_read_b64_tr_b16 a[202:203], v14 offset:5120
 v_accvgpr_read_b32 v20, a102
 v_mfma_f32_16x16x32_bf16 a[148:151], a[220:223], v[212:215], a[148:151]
 v_accvgpr_read_b32 v21, a103
 v_cvt_pk_bf16_f32 v4, v18, v19
 v_mfma_f32_16x16x32_bf16 a[152:155], a[212:215], v[184:187], a[152:155]
 v_cvt_pk_bf16_f32 v5, v20, v21
 v_accvgpr_read_b32 v18, a116
 v_mfma_f32_16x16x32_bf16 a[152:155], a[216:219], v[200:203], a[152:155]
 v_accvgpr_read_b32 v19, a117
 v_accvgpr_read_b32 v20, a118
 v_mfma_f32_16x16x32_bf16 a[152:155], a[220:223], v[216:219], a[152:155]
 v_accvgpr_read_b32 v21, a119
 v_cvt_pk_bf16_f32 v6, v18, v19
 v_mfma_f32_16x16x32_bf16 a[156:159], a[212:215], v[188:191], a[156:159]
 v_cvt_pk_bf16_f32 v7, v20, v21
 v_mfma_f32_16x16x32_bf16 a[156:159], a[216:219], v[204:207], a[156:159]
 s_add_u32 s75, s89, 245760
 v_mfma_f32_16x16x32_bf16 a[156:159], a[220:223], v[220:223], a[156:159]
 buffer_store_dwordx4 v[4:7], v1, s[44:47], s75 offen offset:1024 sc1
 s_waitcnt lgkmcnt(0)
 v_mfma_f32_16x16x32_bf16 a[128:131], a[192:195], v[224:227], a[128:131]
 v_accvgpr_read_b32 v18, a72
 v_accvgpr_read_b32 v19, a73
 v_mfma_f32_16x16x32_bf16 a[128:131], a[196:199], v[240:243], a[128:131]
 v_accvgpr_read_b32 v20, a74
 ds_read_b64_tr_b16 a[204:205], v14 offset:6144
 v_mfma_f32_16x16x32_bf16 a[128:131], a[200:203], a[160:163], a[128:131]
 ds_read_b64_tr_b16 a[206:207], v14 offset:7168
 ds_read_b64_tr_b16 a[208:209], v14 offset:8192
 v_mfma_f32_16x16x32_bf16 a[132:135], a[192:195], v[228:231], a[132:135]
 ds_read_b64_tr_b16 a[210:211], v14 offset:9216
 ds_read_b64_tr_b16 a[212:213], v14 offset:10240
 v_mfma_f32_16x16x32_bf16 a[132:135], a[196:199], v[244:247], a[132:135]
 ds_read_b64_tr_b16 a[214:215], v14 offset:11264
 v_accvgpr_read_b32 v21, a75
 v_mfma_f32_16x16x32_bf16 a[132:135], a[200:203], a[164:167], a[132:135]
 v_cvt_pk_bf16_f32 v10, v18, v19
 v_cvt_pk_bf16_f32 v11, v20, v21
 v_mfma_f32_16x16x32_bf16 a[136:139], a[192:195], v[232:235], a[136:139]
 v_accvgpr_read_b32 v18, a88
 v_accvgpr_read_b32 v19, a89
 v_mfma_f32_16x16x32_bf16 a[136:139], a[196:199], v[248:251], a[136:139]
 v_accvgpr_read_b32 v20, a90
 v_accvgpr_read_b32 v21, a91
 v_mfma_f32_16x16x32_bf16 a[136:139], a[200:203], a[168:171], a[136:139]
 v_cvt_pk_bf16_f32 v12, v18, v19
 v_mfma_f32_16x16x32_bf16 a[140:143], a[192:195], v[236:239], a[140:143]
 v_cvt_pk_bf16_f32 v13, v20, v21
 v_mfma_f32_16x16x32_bf16 a[140:143], a[196:199], v[252:255], a[140:143]
 s_add_u32 s75, s89, 327680
 v_mfma_f32_16x16x32_bf16 a[140:143], a[200:203], a[172:175], a[140:143]
 s_waitcnt lgkmcnt(0)
 v_mfma_f32_16x16x32_bf16 a[128:131], a[204:207], a[176:179], a[128:131]
 buffer_store_dwordx4 v[10:13], v1, s[44:47], s75 offen offset:1024 sc1
 v_mfma_f32_16x16x32_bf16 a[128:131], a[208:211], a[224:227], a[128:131]
 v_accvgpr_read_b32 v18, a104
 v_accvgpr_read_b32 v19, a105
 v_mfma_f32_16x16x32_bf16 a[128:131], a[212:215], a[240:243], a[128:131]
 v_accvgpr_read_b32 v20, a106
 ds_read_b64_tr_b16 a[216:217], v15 offset:0
 v_mfma_f32_16x16x32_bf16 a[132:135], a[204:207], a[180:183], a[132:135]
 ds_read_b64_tr_b16 a[218:219], v15 offset:1024
 ds_read_b64_tr_b16 a[220:221], v15 offset:2048
 v_mfma_f32_16x16x32_bf16 a[132:135], a[208:211], a[228:231], a[132:135]
 ds_read_b64_tr_b16 a[222:223], v15 offset:3072
 ds_read_b64_tr_b16 a[192:193], v15 offset:4096
 ds_read_b64_tr_b16 a[194:195], v15 offset:5120
 v_accvgpr_read_b32 v21, a107
 v_mfma_f32_16x16x32_bf16 a[132:135], a[212:215], a[244:247], a[132:135]
 v_cvt_pk_bf16_f32 v4, v18, v19
 v_cvt_pk_bf16_f32 v5, v20, v21
 v_mfma_f32_16x16x32_bf16 a[136:139], a[204:207], a[184:187], a[136:139]
 v_accvgpr_read_b32 v18, a120
 v_accvgpr_read_b32 v19, a121
 v_mfma_f32_16x16x32_bf16 a[136:139], a[208:211], a[232:235], a[136:139]
 v_accvgpr_read_b32 v20, a122
 v_accvgpr_read_b32 v21, a123
 v_mfma_f32_16x16x32_bf16 a[136:139], a[212:215], a[248:251], a[136:139]
 v_cvt_pk_bf16_f32 v6, v18, v19
 v_mfma_f32_16x16x32_bf16 a[140:143], a[204:207], a[188:191], a[140:143]
 v_cvt_pk_bf16_f32 v7, v20, v21
 v_mfma_f32_16x16x32_bf16 a[140:143], a[208:211], a[236:239], a[140:143]
 s_add_u32 s75, s89, 409600
 v_mfma_f32_16x16x32_bf16 a[140:143], a[212:215], a[252:255], a[140:143]
 s_waitcnt lgkmcnt(0)
 v_mfma_f32_16x16x32_bf16 a[144:147], a[216:219], v[224:227], a[144:147]
 buffer_store_dwordx4 v[4:7], v1, s[44:47], s75 offen offset:1024 sc1
 v_mfma_f32_16x16x32_bf16 a[144:147], a[220:223], v[240:243], a[144:147]
 v_accvgpr_read_b32 v18, a76
 v_accvgpr_read_b32 v19, a77
 v_mfma_f32_16x16x32_bf16 a[144:147], a[192:195], a[160:163], a[144:147]
 v_accvgpr_read_b32 v20, a78
 ds_read_b64_tr_b16 a[196:197], v15 offset:6144
 v_mfma_f32_16x16x32_bf16 a[148:151], a[216:219], v[228:231], a[148:151]
 ds_read_b64_tr_b16 a[198:199], v15 offset:7168
 ds_read_b64_tr_b16 a[200:201], v15 offset:8192
 v_mfma_f32_16x16x32_bf16 a[148:151], a[220:223], v[244:247], a[148:151]
 ds_read_b64_tr_b16 a[202:203], v15 offset:9216
 ds_read_b64_tr_b16 a[204:205], v15 offset:10240
 ds_read_b64_tr_b16 a[206:207], v15 offset:11264
 v_accvgpr_read_b32 v21, a79
 v_mfma_f32_16x16x32_bf16 a[148:151], a[192:195], a[164:167], a[148:151]
 v_cvt_pk_bf16_f32 v10, v18, v19
 v_cvt_pk_bf16_f32 v11, v20, v21
 v_mfma_f32_16x16x32_bf16 a[152:155], a[216:219], v[232:235], a[152:155]
 v_accvgpr_read_b32 v18, a92
 v_accvgpr_read_b32 v19, a93
 v_mfma_f32_16x16x32_bf16 a[152:155], a[220:223], v[248:251], a[152:155]
 v_accvgpr_read_b32 v20, a94
 v_accvgpr_read_b32 v21, a95
 v_mfma_f32_16x16x32_bf16 a[152:155], a[192:195], a[168:171], a[152:155]
 v_cvt_pk_bf16_f32 v12, v18, v19
 v_mfma_f32_16x16x32_bf16 a[156:159], a[216:219], v[236:239], a[156:159]
 v_cvt_pk_bf16_f32 v13, v20, v21
 v_mfma_f32_16x16x32_bf16 a[156:159], a[220:223], v[252:255], a[156:159]
 s_add_u32 s75, s89, 491520
 v_mfma_f32_16x16x32_bf16 a[156:159], a[192:195], a[172:175], a[156:159]
 s_waitcnt lgkmcnt(0)
 v_mfma_f32_16x16x32_bf16 a[144:147], a[196:199], a[176:179], a[144:147]
 buffer_store_dwordx4 v[10:13], v1, s[44:47], s75 offen offset:1024 sc1
 v_mfma_f32_16x16x32_bf16 a[144:147], a[200:203], a[224:227], a[144:147]
 v_accvgpr_read_b32 v18, a108
 v_accvgpr_read_b32 v19, a109
 v_mfma_f32_16x16x32_bf16 a[144:147], a[204:207], a[240:243], a[144:147]
 v_accvgpr_read_b32 v20, a110
 v_add_u32 v14, 147456, v28
 v_mfma_f32_16x16x32_bf16 a[148:151], a[196:199], a[180:183], a[148:151]
 v_xor_b32 v15, 32, v14
 ds_read_b64_tr_b16 a[208:209], v14 offset:0
 v_mfma_f32_16x16x32_bf16 a[148:151], a[200:203], a[228:231], a[148:151]
 ds_read_b64_tr_b16 a[210:211], v14 offset:1024
 ds_read_b64_tr_b16 a[212:213], v14 offset:2048
 ds_read_b64_tr_b16 a[214:215], v14 offset:3072
 ds_read_b64_tr_b16 a[216:217], v14 offset:4096
 ds_read_b64_tr_b16 a[218:219], v14 offset:5120
 v_accvgpr_read_b32 v21, a111
 v_mfma_f32_16x16x32_bf16 a[148:151], a[204:207], a[244:247], a[148:151]
 v_cvt_pk_bf16_f32 v4, v18, v19
 v_cvt_pk_bf16_f32 v5, v20, v21
 v_mfma_f32_16x16x32_bf16 a[152:155], a[196:199], a[184:187], a[152:155]
 v_accvgpr_read_b32 v18, a124
 v_accvgpr_read_b32 v19, a125
 v_mfma_f32_16x16x32_bf16 a[152:155], a[200:203], a[232:235], a[152:155]
 v_accvgpr_read_b32 v20, a126
 v_accvgpr_read_b32 v21, a127
 v_mfma_f32_16x16x32_bf16 a[152:155], a[204:207], a[248:251], a[152:155]
 v_cvt_pk_bf16_f32 v6, v18, v19
 v_mfma_f32_16x16x32_bf16 a[156:159], a[196:199], a[188:191], a[156:159]
 v_cvt_pk_bf16_f32 v7, v20, v21
 v_mfma_f32_16x16x32_bf16 a[156:159], a[200:203], a[236:239], a[156:159]
 s_add_u32 s75, s89, 573440
 v_mfma_f32_16x16x32_bf16 a[156:159], a[204:207], a[252:255], a[156:159]
 buffer_store_dwordx4 v[4:7], v1, s[44:47], s75 offen offset:1024 sc1
 s_waitcnt lgkmcnt(0)
 v_mfma_f32_16x16x32_bf16 a[128:131], a[208:211], v[32:35], a[128:131]
 ds_read_b64_tr_b16 a[220:221], v14 offset:6144
 ds_read_b64_tr_b16 a[222:223], v14 offset:7168
 v_mfma_f32_16x16x32_bf16 a[128:131], a[212:215], v[48:51], a[128:131]
 ds_read_b64_tr_b16 a[192:193], v14 offset:8192
 ds_read_b64_tr_b16 a[194:195], v14 offset:9216
 v_mfma_f32_16x16x32_bf16 a[128:131], a[216:219], v[64:67], a[128:131]
 ds_read_b64_tr_b16 a[196:197], v14 offset:10240
 ds_read_b64_tr_b16 a[198:199], v14 offset:11264
 v_mfma_f32_16x16x32_bf16 a[132:135], a[208:211], v[36:39], a[132:135]
 v_mfma_f32_16x16x32_bf16 a[132:135], a[212:215], v[52:55], a[132:135]
 v_mfma_f32_16x16x32_bf16 a[132:135], a[216:219], v[68:71], a[132:135]
 v_mfma_f32_16x16x32_bf16 a[136:139], a[208:211], v[40:43], a[136:139]
 v_and_b32 v22, 56, v29
 buffer_load_dwordx2 v[2:3], v22, s[48:51], s88 offen sc0 sc1
 v_mfma_f32_16x16x32_bf16 a[136:139], a[212:215], v[56:59], a[136:139]
 v_mfma_f32_16x16x32_bf16 a[136:139], a[216:219], v[72:75], a[136:139]
 v_mfma_f32_16x16x32_bf16 a[140:143], a[208:211], v[44:47], a[140:143]
 v_mfma_f32_16x16x32_bf16 a[140:143], a[212:215], v[60:63], a[140:143]
 v_mfma_f32_16x16x32_bf16 a[140:143], a[216:219], v[76:79], a[140:143]
 s_waitcnt lgkmcnt(0)
 v_mfma_f32_16x16x32_bf16 a[128:131], a[220:223], v[80:83], a[128:131]
 ds_read_b64_tr_b16 a[200:201], v15 offset:0
 ds_read_b64_tr_b16 a[202:203], v15 offset:1024
 v_mfma_f32_16x16x32_bf16 a[128:131], a[192:195], v[96:99], a[128:131]
 ds_read_b64_tr_b16 a[204:205], v15 offset:2048
 ds_read_b64_tr_b16 a[206:207], v15 offset:3072
 v_mfma_f32_16x16x32_bf16 a[128:131], a[196:199], v[112:115], a[128:131]
 ds_read_b64_tr_b16 a[208:209], v15 offset:4096
 ds_read_b64_tr_b16 a[210:211], v15 offset:5120
 v_mfma_f32_16x16x32_bf16 a[132:135], a[220:223], v[84:87], a[132:135]
 v_mfma_f32_16x16x32_bf16 a[132:135], a[192:195], v[100:103], a[132:135]
 v_mfma_f32_16x16x32_bf16 a[132:135], a[196:199], v[116:119], a[132:135]
 v_mfma_f32_16x16x32_bf16 a[136:139], a[220:223], v[88:91], a[136:139]
 v_mfma_f32_16x16x32_bf16 a[136:139], a[192:195], v[104:107], a[136:139]
 v_mfma_f32_16x16x32_bf16 a[136:139], a[196:199], v[120:123], a[136:139]
 v_mfma_f32_16x16x32_bf16 a[140:143], a[220:223], v[92:95], a[140:143]
 v_mfma_f32_16x16x32_bf16 a[140:143], a[192:195], v[108:111], a[140:143]
 v_mfma_f32_16x16x32_bf16 a[140:143], a[196:199], v[124:127], a[140:143]
 s_waitcnt lgkmcnt(0)
 v_mfma_f32_16x16x32_bf16 a[144:147], a[200:203], v[32:35], a[144:147]
 ds_read_b64_tr_b16 a[212:213], v15 offset:6144
 ds_read_b64_tr_b16 a[214:215], v15 offset:7168
 v_mfma_f32_16x16x32_bf16 a[144:147], a[204:207], v[48:51], a[144:147]
 ds_read_b64_tr_b16 a[216:217], v15 offset:8192
 ds_read_b64_tr_b16 a[218:219], v15 offset:9216
 v_mfma_f32_16x16x32_bf16 a[144:147], a[208:211], v[64:67], a[144:147]
 ds_read_b64_tr_b16 a[220:221], v15 offset:10240
 ds_read_b64_tr_b16 a[222:223], v15 offset:11264
 v_mfma_f32_16x16x32_bf16 a[148:151], a[200:203], v[36:39], a[148:151]
 v_mfma_f32_16x16x32_bf16 a[148:151], a[204:207], v[52:55], a[148:151]
 v_mfma_f32_16x16x32_bf16 a[148:151], a[208:211], v[68:71], a[148:151]
 v_mfma_f32_16x16x32_bf16 a[152:155], a[200:203], v[40:43], a[152:155]
 v_mfma_f32_16x16x32_bf16 a[152:155], a[204:207], v[56:59], a[152:155]
 v_mfma_f32_16x16x32_bf16 a[152:155], a[208:211], v[72:75], a[152:155]
 v_mfma_f32_16x16x32_bf16 a[156:159], a[200:203], v[44:47], a[156:159]
 v_mfma_f32_16x16x32_bf16 a[156:159], a[204:207], v[60:63], a[156:159]
 v_mfma_f32_16x16x32_bf16 a[156:159], a[208:211], v[76:79], a[156:159]
 s_waitcnt lgkmcnt(0)
 v_mfma_f32_16x16x32_bf16 a[144:147], a[212:215], v[80:83], a[144:147]
 v_mfma_f32_16x16x32_bf16 a[144:147], a[216:219], v[96:99], a[144:147]
 v_mfma_f32_16x16x32_bf16 a[144:147], a[220:223], v[112:115], a[144:147]
 v_mfma_f32_16x16x32_bf16 a[148:151], a[212:215], v[84:87], a[148:151]
 v_mfma_f32_16x16x32_bf16 a[148:151], a[216:219], v[100:103], a[148:151]
 v_mfma_f32_16x16x32_bf16 a[148:151], a[220:223], v[116:119], a[148:151]
 v_mfma_f32_16x16x32_bf16 a[152:155], a[212:215], v[88:91], a[152:155]
 v_mfma_f32_16x16x32_bf16 a[152:155], a[216:219], v[104:107], a[152:155]
 v_mfma_f32_16x16x32_bf16 a[152:155], a[220:223], v[120:123], a[152:155]
 v_mfma_f32_16x16x32_bf16 a[156:159], a[212:215], v[92:95], a[156:159]
 v_mfma_f32_16x16x32_bf16 a[156:159], a[216:219], v[108:111], a[156:159]
 v_mfma_f32_16x16x32_bf16 a[156:159], a[220:223], v[124:127], a[156:159]
 s_waitcnt vmcnt(0)
 s_lshl_b32 s75, s62, 3
 s_add_u32 s75, s75, s88
 s_add_u32 s76, s83, 2
 v_mov_b32 v4, s82
 v_mov_b32 v5, s76
 v_mov_b32 v6, 0
 buffer_store_dwordx2 v[4:5], v6, s[48:51], s75 offen sc0 sc1
 s_add_u32 s76, s83, 1
 s_mov_b32 s86, 0
 s_branch L_POLLC_A
L_POLL_A:
 buffer_load_dwordx2 v[2:3], v22, s[48:51], s88 offen sc0 sc1
 s_waitcnt vmcnt(0)
L_POLLC_A:
 v_cmp_ne_u32 vcc, s82, v2
 v_subrev_u32 v23, s76, v3
 v_cmp_lt_u32 s[96:97], 3, v23
 s_add_u32 s86, s86, 1
 s_cmp_gt_u32 s86, 30000
 s_cbranch_scc1 L_POLLX_A
 s_or_b64 vcc, vcc, s[96:97]
 s_cbranch_scc1 L_POLL_A
L_POLLX_A:
 s_mul_i32 s89, s62, 81920
 s_add_u32 s75, s89, 0
 buffer_load_dwordx4 v[32:35], v1, s[44:47], s75 offen offset:0 sc1
 s_add_u32 s75, s89, 10240
 buffer_load_dwordx4 v[36:39], v1, s[44:47], s75 offen offset:0 sc1
 s_add_u32 s75, s89, 20480
 buffer_load_dwordx4 v[40:43], v1, s[44:47], s75 offen offset:0 sc1
 s_add_u32 s75, s89, 30720
 buffer_load_dwordx4 v[44:47], v1, s[44:47], s75 offen offset:0 sc1
 s_add_u32 s75, s89, 40960
 buffer_load_dwordx4 v[48:51], v1, s[44:47], s75 offen offset:0 sc1
 s_add_u32 s75, s89, 51200
 buffer_load_dwordx4 v[52:55], v1, s[44:47], s75 offen offset:0 sc1
 s_add_u32 s75, s89, 61440
 buffer_load_dwordx4 v[56:59], v1, s[44:47], s75 offen offset:0 sc1
 s_add_u32 s75, s89, 71680
 buffer_load_dwordx4 v[60:63], v1, s[44:47], s75 offen offset:0 sc1
 s_mul_i32 s89, s62, 10240
 v_accvgpr_read_b32 v18, a128
 v_accvgpr_read_b32 v19, a129
 v_accvgpr_read_b32 v20, a130
 v_accvgpr_read_b32 v21, a131
 v_cvt_pk_bf16_f32 v10, v18, v19
 v_cvt_pk_bf16_f32 v11, v20, v21
 s_add_u32 s75, s89, 0
 buffer_store_dwordx2 v[10:11], v29, s[44:47], s75 offen offset:2048 sc1
 v_accvgpr_read_b32 v18, a144
 v_accvgpr_read_b32 v19, a145
 v_accvgpr_read_b32 v20, a146
 v_accvgpr_read_b32 v21, a147
 v_cvt_pk_bf16_f32 v4, v18, v19
 v_cvt_pk_bf16_f32 v5, v20, v21
 s_add_u32 s75, s89, 81920
 buffer_store_dwordx2 v[4:5], v29, s[44:47], s75 offen offset:2048 sc1
 v_accvgpr_read_b32 v18, a132
 v_accvgpr_read_b32 v19, a133
 v_accvgpr_read_b32 v20, a134
 v_accvgpr_read_b32 v21, a135
 v_cvt_pk_bf16_f32 v10, v18, v19
 v_cvt_pk_bf16_f32 v11, v20, v21
 s_add_u32 s75, s89, 163840
 buffer_store_dwordx2 v[10:11], v29, s[44:47], s75 offen offset:2048 sc1
 v_accvgpr_read_b32 v18, a148
 v_accvgpr_read_b32 v19, a149
 v_accvgpr_read_b32 v20, a150
 v_accvgpr_read_b32 v21, a151
 v_cvt_pk_bf16_f32 v4, v18, v19
 v_cvt_pk_bf16_f32 v5, v20, v21
 s_add_u32 s75, s89, 245760
 buffer_store_dwordx2 v[4:5], v29, s[44:47], s75 offen offset:2048 sc1
 v_accvgpr_read_b32 v18, a136
 v_accvgpr_read_b32 v19, a137
 v_accvgpr_read_b32 v20, a138
 v_accvgpr_read_b32 v21, a139
 v_cvt_pk_bf16_f32 v10, v18, v19
 v_cvt_pk_bf16_f32 v11, v20, v21
 s_add_u32 s75, s89, 327680
 buffer_store_dwordx2 v[10:11], v29, s[44:47], s75 offen offset:2048 sc1
 v_accvgpr_read_b32 v18, a152
 v_accvgpr_read_b32 v19, a153
 v_accvgpr_read_b32 v20, a154
 v_accvgpr_read_b32 v21, a155
 v_cvt_pk_bf16_f32 v4, v18, v19
 v_cvt_pk_bf16_f32 v5, v20, v21
 s_add_u32 s75, s89, 409600
 buffer_store_dwordx2 v[4:5], v29, s[44:47], s75 offen offset:2048 sc1
 v_accvgpr_read_b32 v18, a140
 v_accvgpr_read_b32 v19, a141
 v_accvgpr_read_b32 v20, a142
 v_accvgpr_read_b32 v21, a143
 v_cvt_pk_bf16_f32 v10, v18, v19
 v_cvt_pk_bf16_f32 v11, v20, v21
 s_add_u32 s75, s89, 491520
 buffer_store_dwordx2 v[10:11], v29, s[44:47], s75 offen offset:2048 sc1
 v_accvgpr_read_b32 v18, a156
 v_accvgpr_read_b32 v19, a157
 v_accvgpr_read_b32 v20, a158
 v_accvgpr_read_b32 v21, a159
 v_cvt_pk_bf16_f32 v4, v18, v19
 v_cvt_pk_bf16_f32 v5, v20, v21
 s_add_u32 s75, s89, 573440
 buffer_store_dwordx2 v[4:5], v29, s[44:47], s75 offen offset:2048 sc1
 v_and_b32 v8, 15, v0
 v_mul_u32_u24 v8, 1280, v8
 v_lshrrev_b32 v9, 4, v0
 v_lshl_add_u32 v8, v9, 3, v8
 s_lshl_b32 s75, s60, 2
 s_add_u32 s75, s75, s3
 s_lshl_b32 s75, s75, 2
 s_lshr_b32 s76, s62, 1
 s_add_u32 s75, s75, s76
 s_mul_i32 s64, s75, 20480
 s_and_b32 s75, s62, 1
 s_lshl_b32 s76, s75, 6
 s_add_u32 s65, s64, s76
 s_add_u32 s65, s65, s84
 s_lshl_b32 s76, s75, 5
 s_add_u32 s64, s64, s76
 s_add_u32 s64, s64, s85
 s_mov_b32 s72, 0xffff0000
 s_waitcnt vmcnt(0)
 s_lshl_b32 s75, s62, 3
 s_add_u32 s75, s75, s88
 s_add_u32 s76, s83, 3
 v_mov_b32 v4, s82
 v_mov_b32 v5, s76
 v_mov_b32 v6, 0
 buffer_store_dwordx2 v[4:5], v6, s[48:51], s75 offen sc0 sc1
 v_and_b32 v22, 56, v29
 buffer_load_dwordx2 v[2:3], v22, s[48:51], s88 offen sc0 sc1
 v_lshlrev_b32 v160, 16, v32
 v_and_b32 v161, s72, v32
 v_lshlrev_b32 v162, 16, v33
 v_and_b32 v163, s72, v33
 v_lshlrev_b32 v164, 16, v34
 v_and_b32 v165, s72, v34
 v_lshlrev_b32 v166, 16, v35
 v_and_b32 v167, s72, v35
 v_lshlrev_b32 v168, 16, v36
 v_and_b32 v169, s72, v36
 v_pk_add_f32 v[160:161], v[160:161], v[168:169]
 v_lshlrev_b32 v170, 16, v37
 v_and_b32 v171, s72, v37
 v_pk_add_f32 v[162:163], v[162:163], v[170:171]
 v_lshlrev_b32 v172, 16, v38
 v_and_b32 v173, s72, v38
 v_pk_add_f32 v[164:165], v[164:165], v[172:173]
 v_lshlrev_b32 v174, 16, v39
 v_and_b32 v175, s72, v39
 v_pk_add_f32 v[166:167], v[166:167], v[174:175]
 v_lshlrev_b32 v168, 16, v40
 v_and_b32 v169, s72, v40
 v_pk_add_f32 v[160:161], v[160:161], v[168:169]
 v_lshlrev_b32 v170, 16, v41
 v_and_b32 v171, s72, v41
 v_pk_add_f32 v[162:163], v[162:163], v[170:171]
 v_lshlrev_b32 v172, 16, v42
 v_and_b32 v173, s72, v42
 v_pk_add_f32 v[164:165], v[164:165], v[172:173]
 v_lshlrev_b32 v174, 16, v43
 v_and_b32 v175, s72, v43
 v_pk_add_f32 v[166:167], v[166:167], v[174:175]
 v_lshlrev_b32 v168, 16, v44
 v_and_b32 v169, s72, v44
 v_pk_add_f32 v[160:161], v[160:161], v[168:169]
 v_lshlrev_b32 v170, 16, v45
 v_and_b32 v171, s72, v45
 v_pk_add_f32 v[162:163], v[162:163], v[170:171]
 v_lshlrev_b32 v172, 16, v46
 v_and_b32 v173, s72, v46
 v_pk_add_f32 v[164:165], v[164:165], v[172:173]
 v_lshlrev_b32 v174, 16, v47
 v_and_b32 v175, s72, v47
 v_pk_add_f32 v[166:167], v[166:167], v[174:175]
 v_lshlrev_b32 v168, 16, v48
 v_and_b32 v169, s72, v48
 v_pk_add_f32 v[160:161], v[160:161], v[168:169]
 v_lshlrev_b32 v170, 16, v49
 v_and_b32 v171, s72, v49
 v_pk_add_f32 v[162:163], v[162:163], v[170:171]
 v_lshlrev_b32 v172, 16, v50
 v_and_b32 v173, s72, v50
 v_pk_add_f32 v[164:165], v[164:165], v[172:173]
 v_lshlrev_b32 v174, 16, v51
 v_and_b32 v175, s72, v51
 v_pk_add_f32 v[166:167], v[166:167], v[174:175]
 v_lshlrev_b32 v168, 16, v52
 v_and_b32 v169, s72, v52
 v_pk_add_f32 v[160:161], v[160:161], v[168:169]
 v_lshlrev_b32 v170, 16, v53
 v_and_b32 v171, s72, v53
 v_pk_add_f32 v[162:163], v[162:163], v[170:171]
 v_lshlrev_b32 v172, 16, v54
 v_and_b32 v173, s72, v54
 v_pk_add_f32 v[164:165], v[164:165], v[172:173]
 v_lshlrev_b32 v174, 16, v55
 v_and_b32 v175, s72, v55
 v_pk_add_f32 v[166:167], v[166:167], v[174:175]
 v_lshlrev_b32 v168, 16, v56
 v_and_b32 v169, s72, v56
 v_pk_add_f32 v[160:161], v[160:161], v[168:169]
 v_lshlrev_b32 v170, 16, v57
 v_and_b32 v171, s72, v57
 v_pk_add_f32 v[162:163], v[162:163], v[170:171]
 v_lshlrev_b32 v172, 16, v58
 v_and_b32 v173, s72, v58
 v_pk_add_f32 v[164:165], v[164:165], v[172:173]
 v_lshlrev_b32 v174, 16, v59
 v_and_b32 v175, s72, v59
 v_pk_add_f32 v[166:167], v[166:167], v[174:175]
 v_lshlrev_b32 v168, 16, v60
 v_and_b32 v169, s72, v60
 v_pk_add_f32 v[160:161], v[160:161], v[168:169]
 v_lshlrev_b32 v170, 16, v61
 v_and_b32 v171, s72, v61
 v_pk_add_f32 v[162:163], v[162:163], v[170:171]
 v_lshlrev_b32 v172, 16, v62
 v_and_b32 v173, s72, v62
 v_pk_add_f32 v[164:165], v[164:165], v[172:173]
 v_lshlrev_b32 v174, 16, v63
 v_and_b32 v175, s72, v63
 v_pk_add_f32 v[166:167], v[166:167], v[174:175]
 v_cvt_pk_bf16_f32 v160, v160, v161
 v_cvt_pk_bf16_f32 v161, v162, v163
 v_cvt_pk_bf16_f32 v162, v164, v165
 v_cvt_pk_bf16_f32 v163, v166, v167
 buffer_store_dwordx2 v[160:161], v8, s[52:55], s65 offen offset:0
 buffer_store_dwordx2 v[162:163], v8, s[52:55], s65 offen offset:32
 s_waitcnt vmcnt(2)
 s_add_u32 s76, s83, 2
 s_mov_b32 s86, 0
 s_branch L_POLLC_B
L_POLL_B:
 buffer_load_dwordx2 v[2:3], v22, s[48:51], s88 offen sc0 sc1
 s_waitcnt vmcnt(0)
L_POLLC_B:
 v_cmp_ne_u32 vcc, s82, v2
 v_subrev_u32 v23, s76, v3
 v_cmp_lt_u32 s[96:97], 3, v23
 s_add_u32 s86, s86, 1
 s_cmp_gt_u32 s86, 30000
 s_cbranch_scc1 L_POLLX_B
 s_or_b64 vcc, vcc, s[96:97]
 s_cbranch_scc1 L_POLL_B
L_POLLX_B:
 s_mul_i32 s89, s62, 81920
 s_add_u32 s75, s89, 0
 buffer_load_dwordx4 v[64:67], v1, s[44:47], s75 offen offset:1024 sc1
 s_add_u32 s75, s89, 10240
 buffer_load_dwordx4 v[68:71], v1, s[44:47], s75 offen offset:1024 sc1
 s_add_u32 s75, s89, 20480
 buffer_load_dwordx4 v[72:75], v1, s[44:47], s75 offen offset:1024 sc1
 s_add_u32 s75, s89, 30720
 buffer_load_dwordx4 v[76:79], v1, s[44:47], s75 offen offset:1024 sc1
 s_add_u32 s75, s89, 40960
 buffer_load_dwordx4 v[80:83], v1, s[44:47], s75 offen offset:1024 sc1
 s_add_u32 s75, s89, 51200
 buffer_load_dwordx4 v[84:87], v1, s[44:47], s75 offen offset:1024 sc1
 s_add_u32 s75, s89, 61440
 buffer_load_dwordx4 v[88:91], v1, s[44:47], s75 offen offset:1024 sc1
 s_add_u32 s75, s89, 71680
 buffer_load_dwordx4 v[92:95], v1, s[44:47], s75 offen offset:1024 sc1
 s_add_u32 s76, s83, 3
 s_mov_b32 s86, 0
 s_branch L_POLLC_C
L_POLL_C:
 buffer_load_dwordx2 v[2:3], v22, s[48:51], s88 offen sc0 sc1
 s_waitcnt vmcnt(0)
L_POLLC_C:
 v_cmp_ne_u32 vcc, s82, v2
 v_subrev_u32 v23, s76, v3
 v_cmp_lt_u32 s[96:97], 3, v23
 s_add_u32 s86, s86, 1
 s_cmp_gt_u32 s86, 30000
 s_cbranch_scc1 L_POLLX_C
 s_or_b64 vcc, vcc, s[96:97]
 s_cbranch_scc1 L_POLL_C
L_POLLX_C:
 s_mul_i32 s89, s62, 81920
 s_add_u32 s75, s89, 0
 buffer_load_dwordx2 v[96:97], v29, s[44:47], s75 offen offset:2048 sc1
 s_add_u32 s75, s89, 10240
 buffer_load_dwordx2 v[98:99], v29, s[44:47], s75 offen offset:2048 sc1
 s_add_u32 s75, s89, 20480
 buffer_load_dwordx2 v[100:101], v29, s[44:47], s75 offen offset:2048 sc1
 s_add_u32 s75, s89, 30720
 buffer_load_dwordx2 v[102:103], v29, s[44:47], s75 offen offset:2048 sc1
 s_add_u32 s75, s89, 40960
 buffer_load_dwordx2 v[104:105], v29, s[44:47], s75 offen offset:2048 sc1
 s_add_u32 s75, s89, 51200
 buffer_load_dwordx2 v[106:107], v29, s[44:47], s75 offen offset:2048 sc1
 s_add_u32 s75, s89, 61440
 buffer_load_dwordx2 v[108:109], v29, s[44:47], s75 offen offset:2048 sc1
 s_add_u32 s75, s89, 71680
 buffer_load_dwordx2 v[110:111], v29, s[44:47], s75 offen offset:2048 sc1
 s_waitcnt vmcnt(8)
 v_lshlrev_b32 v176, 16, v64
 v_and_b32 v177, s72, v64
 v_lshlrev_b32 v178, 16, v65
 v_and_b32 v179, s72, v65
 v_lshlrev_b32 v180, 16, v66
 v_and_b32 v181, s72, v66
 v_lshlrev_b32 v182, 16, v67
 v_and_b32 v183, s72, v67
 v_lshlrev_b32 v184, 16, v68
 v_and_b32 v185, s72, v68
 v_pk_add_f32 v[176:177], v[176:177], v[184:185]
 v_lshlrev_b32 v186, 16, v69
 v_and_b32 v187, s72, v69
 v_pk_add_f32 v[178:179], v[178:179], v[186:187]
 v_lshlrev_b32 v188, 16, v70
 v_and_b32 v189, s72, v70
 v_pk_add_f32 v[180:181], v[180:181], v[188:189]
 v_lshlrev_b32 v190, 16, v71
 v_and_b32 v191, s72, v71
 v_pk_add_f32 v[182:183], v[182:183], v[190:191]
 v_lshlrev_b32 v184, 16, v72
 v_and_b32 v185, s72, v72
 v_pk_add_f32 v[176:177], v[176:177], v[184:185]
 v_lshlrev_b32 v186, 16, v73
 v_and_b32 v187, s72, v73
 v_pk_add_f32 v[178:179], v[178:179], v[186:187]
 v_lshlrev_b32 v188, 16, v74
 v_and_b32 v189, s72, v74
 v_pk_add_f32 v[180:181], v[180:181], v[188:189]
 v_lshlrev_b32 v190, 16, v75
 v_and_b32 v191, s72, v75
 v_pk_add_f32 v[182:183], v[182:183], v[190:191]
 v_lshlrev_b32 v184, 16, v76
 v_and_b32 v185, s72, v76
 v_pk_add_f32 v[176:177], v[176:177], v[184:185]
 v_lshlrev_b32 v186, 16, v77
 v_and_b32 v187, s72, v77
 v_pk_add_f32 v[178:179], v[178:179], v[186:187]
 v_lshlrev_b32 v188, 16, v78
 v_and_b32 v189, s72, v78
 v_pk_add_f32 v[180:181], v[180:181], v[188:189]
 v_lshlrev_b32 v190, 16, v79
 v_and_b32 v191, s72, v79
 v_pk_add_f32 v[182:183], v[182:183], v[190:191]
 v_lshlrev_b32 v184, 16, v80
 v_and_b32 v185, s72, v80
 v_pk_add_f32 v[176:177], v[176:177], v[184:185]
 v_lshlrev_b32 v186, 16, v81
 v_and_b32 v187, s72, v81
 v_pk_add_f32 v[178:179], v[178:179], v[186:187]
 v_lshlrev_b32 v188, 16, v82
 v_and_b32 v189, s72, v82
 v_pk_add_f32 v[180:181], v[180:181], v[188:189]
 v_lshlrev_b32 v190, 16, v83
 v_and_b32 v191, s72, v83
 v_pk_add_f32 v[182:183], v[182:183], v[190:191]
 v_lshlrev_b32 v184, 16, v84
 v_and_b32 v185, s72, v84
 v_pk_add_f32 v[176:177], v[176:177], v[184:185]
 v_lshlrev_b32 v186, 16, v85
 v_and_b32 v187, s72, v85
 v_pk_add_f32 v[178:179], v[178:179], v[186:187]
 v_lshlrev_b32 v188, 16, v86
 v_and_b32 v189, s72, v86
 v_pk_add_f32 v[180:181], v[180:181], v[188:189]
 v_lshlrev_b32 v190, 16, v87
 v_and_b32 v191, s72, v87
 v_pk_add_f32 v[182:183], v[182:183], v[190:191]
 v_lshlrev_b32 v184, 16, v88
 v_and_b32 v185, s72, v88
 v_pk_add_f32 v[176:177], v[176:177], v[184:185]
 v_lshlrev_b32 v186, 16, v89
 v_and_b32 v187, s72, v89
 v_pk_add_f32 v[178:179], v[178:179], v[186:187]
 v_lshlrev_b32 v188, 16, v90
 v_and_b32 v189, s72, v90
 v_pk_add_f32 v[180:181], v[180:181], v[188:189]
 v_lshlrev_b32 v190, 16, v91
 v_and_b32 v191, s72, v91
 v_pk_add_f32 v[182:183], v[182:183], v[190:191]
 v_lshlrev_b32 v184, 16, v92
 v_and_b32 v185, s72, v92
 v_pk_add_f32 v[176:177], v[176:177], v[184:185]
 v_lshlrev_b32 v186, 16, v93
 v_and_b32 v187, s72, v93
 v_pk_add_f32 v[178:179], v[178:179], v[186:187]
 v_lshlrev_b32 v188, 16, v94
 v_and_b32 v189, s72, v94
 v_pk_add_f32 v[180:181], v[180:181], v[188:189]
 v_lshlrev_b32 v190, 16, v95
 v_and_b32 v191, s72, v95
 v_pk_add_f32 v[182:183], v[182:183], v[190:191]
 v_cvt_pk_bf16_f32 v176, v176, v177
 v_cvt_pk_bf16_f32 v177, v178, v179
 v_cvt_pk_bf16_f32 v178, v180, v181
 v_cvt_pk_bf16_f32 v179, v182, v183
 buffer_store_dwordx2 v[176:177], v8, s[52:55], s65 offen offset:128
 buffer_store_dwordx2 v[178:179], v8, s[52:55], s65 offen offset:160
 s_waitcnt vmcnt(2)
 v_lshlrev_b32 v192, 16, v96
 v_and_b32 v193, s72, v96
 v_lshlrev_b32 v194, 16, v97
 v_and_b32 v195, s72, v97
 v_lshlrev_b32 v204, 16, v98
 v_and_b32 v205, s72, v98
 v_pk_add_f32 v[192:193], v[192:193], v[204:205]
 v_lshlrev_b32 v206, 16, v99
 v_and_b32 v207, s72, v99
 v_pk_add_f32 v[194:195], v[194:195], v[206:207]
 v_lshlrev_b32 v200, 16, v100
 v_and_b32 v201, s72, v100
 v_pk_add_f32 v[192:193], v[192:193], v[200:201]
 v_lshlrev_b32 v202, 16, v101
 v_and_b32 v203, s72, v101
 v_pk_add_f32 v[194:195], v[194:195], v[202:203]
 v_lshlrev_b32 v204, 16, v102
 v_and_b32 v205, s72, v102
 v_pk_add_f32 v[192:193], v[192:193], v[204:205]
 v_lshlrev_b32 v206, 16, v103
 v_and_b32 v207, s72, v103
 v_pk_add_f32 v[194:195], v[194:195], v[206:207]
 v_lshlrev_b32 v200, 16, v104
 v_and_b32 v201, s72, v104
 v_pk_add_f32 v[192:193], v[192:193], v[200:201]
 v_lshlrev_b32 v202, 16, v105
 v_and_b32 v203, s72, v105
 v_pk_add_f32 v[194:195], v[194:195], v[202:203]
 v_lshlrev_b32 v204, 16, v106
 v_and_b32 v205, s72, v106
 v_pk_add_f32 v[192:193], v[192:193], v[204:205]
 v_lshlrev_b32 v206, 16, v107
 v_and_b32 v207, s72, v107
 v_pk_add_f32 v[194:195], v[194:195], v[206:207]
 v_lshlrev_b32 v200, 16, v108
 v_and_b32 v201, s72, v108
 v_pk_add_f32 v[192:193], v[192:193], v[200:201]
 v_lshlrev_b32 v202, 16, v109
 v_and_b32 v203, s72, v109
 v_pk_add_f32 v[194:195], v[194:195], v[202:203]
 v_lshlrev_b32 v204, 16, v110
 v_and_b32 v205, s72, v110
 v_pk_add_f32 v[192:193], v[192:193], v[204:205]
 v_lshlrev_b32 v206, 16, v111
 v_and_b32 v207, s72, v111
 v_pk_add_f32 v[194:195], v[194:195], v[206:207]
 v_cvt_pk_bf16_f32 v192, v192, v193
 v_cvt_pk_bf16_f32 v193, v194, v195
 buffer_store_dwordx2 v[192:193], v8, s[52:55], s64 offen offset:0
L_END:
 s_endpgm
L_S_0:
 s_call_b64 s[94:95], L_SLOW1
 s_branch L_R_0
L_S_1:
 s_call_b64 s[94:95], L_SLOW0
 s_branch L_R_1
L_S_2:
 s_call_b64 s[94:95], L_SLOW1
 s_branch L_R_2
L_S_3:
 s_call_b64 s[94:95], L_SLOW0
 s_branch L_R_3
L_S_4:
 s_call_b64 s[94:95], L_SLOW1
 s_branch L_R_4
L_S_5:
 s_call_b64 s[94:95], L_SLOW0
 s_branch L_R_5
L_S_6:
 s_call_b64 s[94:95], L_SLOW1
 s_branch L_R_6
L_S_7:
 s_call_b64 s[94:95], L_SLOW0
 s_branch L_R_7
L_S_8:
 s_call_b64 s[94:95], L_SLOW1
 s_branch L_R_8
L_S_9:
 s_call_b64 s[94:95], L_SLOW0
 s_branch L_R_9
L_S_10:
 s_call_b64 s[94:95], L_SLOW1
 s_branch L_R_10
L_S_11:
 s_call_b64 s[94:95], L_SLOW0
 s_branch L_R_11
L_S_12:
 s_call_b64 s[94:95], L_SLOW1
 s_branch L_R_12
L_S_13:
 s_call_b64 s[94:95], L_SLOW0
 s_branch L_R_13
L_S_14:
 s_call_b64 s[94:95], L_SLOW1
 s_branch L_R_14
L_S_15:
 s_call_b64 s[94:95], L_SLOW0
 s_branch L_R_15
L_S_16:
 s_call_b64 s[94:95], L_SLOW1
 s_branch L_R_16
L_S_17:
 s_call_b64 s[94:95], L_SLOW0
 s_branch L_R_17
L_S_18:
 s_call_b64 s[94:95], L_SLOW1
 s_branch L_R_18
L_S_19:
 s_call_b64 s[94:95], L_SLOW0
 s_branch L_R_19
L_S_20:
 s_call_b64 s[94:95], L_SLOW1
 s_branch L_R_20
L_S_21:
 s_call_b64 s[94:95], L_SLOW0
 s_branch L_R_21
L_S_22:
 s_call_b64 s[94:95], L_SLOW1
 s_branch L_R_22
L_S_23:
 s_call_b64 s[94:95], L_SLOW0
 s_branch L_R_23
L_S_24:
 s_call_b64 s[94:95], L_SLOW1
 s_branch L_R_24
L_S_25:
 s_call_b64 s[94:95], L_SLOW0
 s_branch L_R_25
L_S_26:
 s_call_b64 s[94:95], L_SLOW1
 s_branch L_R_26
L_S_27:
 s_call_b64 s[94:95], L_SLOW0
 s_branch L_R_27
L_S_28:
 s_call_b64 s[94:95], L_SLOW1
 s_branch L_R_28
L_S_29:
 s_call_b64 s[94:95], L_SLOW0
 s_branch L_R_29
L_S_30:
 s_call_b64 s[94:95], L_SLOW1
 s_branch L_R_30
L_SLOW0:
 s_nop 15
 v_max3_f32 v158, v224, v225, v226
 v_max3_f32 v158, v158, v227, v228
 v_max3_f32 v158, v158, v229, v230
 v_max_f32 v158, v158, v231
 v_mov_b32 v159, v158
 s_nop 1
 v_permlane32_swap_b32 v159, v158
 v_max_f32 v158, v158, v159
 v_mov_b32 v159, v158
 s_nop 1
 v_permlane16_swap_b32 v159, v158
 v_max_f32 v158, v158, v159
 v_max_f32 v158, 0, v158
 v_sub_f32 v224, v224, v158
 v_sub_f32 v160, v160, v158
 v_sub_f32 v225, v225, v158
 v_sub_f32 v161, v161, v158
 v_sub_f32 v226, v226, v158
 v_sub_f32 v162, v162, v158
 v_sub_f32 v227, v227, v158
 v_sub_f32 v163, v163, v158
 v_sub_f32 v228, v228, v158
 v_sub_f32 v164, v164, v158
 v_sub_f32 v229, v229, v158
 v_sub_f32 v165, v165, v158
 v_sub_f32 v230, v230, v158
 v_sub_f32 v166, v166, v158
 v_sub_f32 v231, v231, v158
 v_sub_f32 v167, v167, v158
 v_sub_f32 v128, v128, v158
 v_sub_f32 v129, v129, v158
 v_sub_f32 v130, v130, v158
 v_sub_f32 v131, v131, v158
 v_sub_f32 v159, 0, v158
 v_exp_f32 v159, v159
 s_nop 0
 v_mul_f32 v144, v144, v159
 v_accvgpr_read_b32 v152, a0
 v_accvgpr_read_b32 v153, a1
 v_accvgpr_read_b32 v154, a2
 v_accvgpr_read_b32 v155, a3
 v_mul_f32 v152, v152, v159
 v_mul_f32 v153, v153, v159
 v_mul_f32 v154, v154, v159
 v_mul_f32 v155, v155, v159
 v_accvgpr_write_b32 a0, v152
 v_accvgpr_write_b32 a1, v153
 v_accvgpr_write_b32 a2, v154
 v_accvgpr_write_b32 a3, v155
 v_accvgpr_read_b32 v152, a16
 v_accvgpr_read_b32 v153, a17
 v_accvgpr_read_b32 v154, a18
 v_accvgpr_read_b32 v155, a19
 v_mul_f32 v152, v152, v159
 v_mul_f32 v153, v153, v159
 v_mul_f32 v154, v154, v159
 v_mul_f32 v155, v155, v159
 v_accvgpr_write_b32 a16, v152
 v_accvgpr_write_b32 a17, v153
 v_accvgpr_write_b32 a18, v154
 v_accvgpr_write_b32 a19, v155
 v_accvgpr_read_b32 v152, a32
 v_accvgpr_read_b32 v153, a33
 v_accvgpr_read_b32 v154, a34
 v_accvgpr_read_b32 v155, a35
 v_mul_f32 v152, v152, v159
 v_mul_f32 v153, v153, v159
 v_mul_f32 v154, v154, v159
 v_mul_f32 v155, v155, v159
 v_accvgpr_write_b32 a32, v152
 v_accvgpr_write_b32 a33, v153
 v_accvgpr_write_b32 a34, v154
 v_accvgpr_write_b32 a35, v155
 v_accvgpr_read_b32 v152, a48
 v_accvgpr_read_b32 v153, a49
 v_accvgpr_read_b32 v154, a50
 v_accvgpr_read_b32 v155, a51
 v_mul_f32 v152, v152, v159
 v_mul_f32 v153, v153, v159
 v_mul_f32 v154, v154, v159
 v_mul_f32 v155, v155, v159
 v_accvgpr_write_b32 a48, v152
 v_accvgpr_write_b32 a49, v153
 v_accvgpr_write_b32 a50, v154
 v_accvgpr_write_b32 a51, v155
 v_accvgpr_read_b32 v152, a64
 v_accvgpr_read_b32 v153, a65
 v_accvgpr_read_b32 v154, a66
 v_accvgpr_read_b32 v155, a67
 v_mul_f32 v152, v152, v159
 v_mul_f32 v153, v153, v159
 v_mul_f32 v154, v154, v159
 v_mul_f32 v155, v155, v159
 v_accvgpr_write_b32 a64, v152
 v_accvgpr_write_b32 a65, v153
 v_accvgpr_write_b32 a66, v154
 v_accvgpr_write_b32 a67, v155
 v_accvgpr_read_b32 v152, a80
 v_accvgpr_read_b32 v153, a81
 v_accvgpr_read_b32 v154, a82
 v_accvgpr_read_b32 v155, a83
 v_mul_f32 v152, v152, v159
 v_mul_f32 v153, v153, v159
 v_mul_f32 v154, v154, v159
 v_mul_f32 v155, v155, v159
 v_accvgpr_write_b32 a80, v152
 v_accvgpr_write_b32 a81, v153
 v_accvgpr_write_b32 a82, v154
 v_accvgpr_write_b32 a83, v155
 v_accvgpr_read_b32 v152, a96
 v_accvgpr_read_b32 v153, a97
 v_accvgpr_read_b32 v154, a98
 v_accvgpr_read_b32 v155, a99
 v_mul_f32 v152, v152, v159
 v_mul_f32 v153, v153, v159
 v_mul_f32 v154, v154, v159
 v_mul_f32 v155, v155, v159
 v_accvgpr_write_b32 a96, v152
 v_accvgpr_write_b32 a97, v153
 v_accvgpr_write_b32 a98, v154
 v_accvgpr_write_b32 a99, v155
 v_accvgpr_read_b32 v152, a112
 v_accvgpr_read_b32 v153, a113
 v_accvgpr_read_b32 v154, a114
 v_accvgpr_read_b32 v155, a115
 v_mul_f32 v152, v152, v159
 v_mul_f32 v153, v153, v159
 v_mul_f32 v154, v154, v159
 v_mul_f32 v155, v155, v159
 v_accvgpr_write_b32 a112, v152
 v_accvgpr_write_b32 a113, v153
 v_accvgpr_write_b32 a114, v154
 v_accvgpr_write_b32 a115, v155
 v_accvgpr_read_b32 v152, a128
 v_accvgpr_read_b32 v153, a129
 v_accvgpr_read_b32 v154, a130
 v_accvgpr_read_b32 v155, a131
 v_mul_f32 v152, v152, v159
 v_mul_f32 v153, v153, v159
 v_mul_f32 v154, v154, v159
 v_mul_f32 v155, v155, v159
 v_accvgpr_write_b32 a128, v152
 v_accvgpr_write_b32 a129, v153
 v_accvgpr_write_b32 a130, v154
 v_accvgpr_write_b32 a131, v155
 v_accvgpr_read_b32 v152, a144
 v_accvgpr_read_b32 v153, a145
 v_accvgpr_read_b32 v154, a146
 v_accvgpr_read_b32 v155, a147
 v_mul_f32 v152, v152, v159
 v_mul_f32 v153, v153, v159
 v_mul_f32 v154, v154, v159
 v_mul_f32 v155, v155, v159
 v_accvgpr_write_b32 a144, v152
 v_accvgpr_write_b32 a145, v153
 v_accvgpr_write_b32 a146, v154
 v_accvgpr_write_b32 a147, v155
 v_accvgpr_read_b32 v152, a160
 v_accvgpr_read_b32 v153, a161
 v_accvgpr_read_b32 v154, a162
 v_accvgpr_read_b32 v155, a163
 v_mul_f32 v152, v152, v159
 v_mul_f32 v153, v153, v159
 v_mul_f32 v154, v154, v159
 v_mul_f32 v155, v155, v159
 v_accvgpr_write_b32 a160, v152
 v_accvgpr_write_b32 a161, v153
 v_accvgpr_write_b32 a162, v154
 v_accvgpr_write_b32 a163, v155
 v_accvgpr_read_b32 v152, a176
 v_accvgpr_read_b32 v153, a177
 v_accvgpr_read_b32 v154, a178
 v_accvgpr_read_b32 v155, a179
 v_mul_f32 v152, v152, v159
 v_mul_f32 v153, v153, v159
 v_mul_f32 v154, v154, v159
 v_mul_f32 v155, v155, v159
 v_accvgpr_write_b32 a176, v152
 v_accvgpr_write_b32 a177, v153
 v_accvgpr_write_b32 a178, v154
 v_accvgpr_write_b32 a179, v155
 v_mov_b32 v148, 0
 v_exp_f32 v152, v224
 v_exp_f32 v153, v225
 v_add_f32 v148, v148, v152
 v_add_f32 v148, v148, v153
 v_cvt_pk_bf16_f32 v192, v152, v153
 v_exp_f32 v152, v226
 v_exp_f32 v153, v227
 v_add_f32 v148, v148, v152
 v_add_f32 v148, v148, v153
 v_cvt_pk_bf16_f32 v193, v152, v153
 v_exp_f32 v152, v228
 v_exp_f32 v153, v229
 v_add_f32 v148, v148, v152
 v_add_f32 v148, v148, v153
 v_cvt_pk_bf16_f32 v194, v152, v153
 v_exp_f32 v152, v230
 v_exp_f32 v153, v231
 v_add_f32 v148, v148, v152
 v_add_f32 v148, v148, v153
 v_cvt_pk_bf16_f32 v195, v152, v153
 v_max3_f32 v158, v232, v233, v234
 v_max3_f32 v158, v158, v235, v236
 v_max3_f32 v158, v158, v237, v238
 v_max_f32 v158, v158, v239
 v_mov_b32 v159, v158
 s_nop 1
 v_permlane32_swap_b32 v159, v158
 v_max_f32 v158, v158, v159
 v_mov_b32 v159, v158
 s_nop 1
 v_permlane16_swap_b32 v159, v158
 v_max_f32 v158, v158, v159
 v_max_f32 v158, 0, v158
 v_sub_f32 v232, v232, v158
 v_sub_f32 v168, v168, v158
 v_sub_f32 v233, v233, v158
 v_sub_f32 v169, v169, v158
 v_sub_f32 v234, v234, v158
 v_sub_f32 v170, v170, v158
 v_sub_f32 v235, v235, v158
 v_sub_f32 v171, v171, v158
 v_sub_f32 v236, v236, v158
 v_sub_f32 v172, v172, v158
 v_sub_f32 v237, v237, v158
 v_sub_f32 v173, v173, v158
 v_sub_f32 v238, v238, v158
 v_sub_f32 v174, v174, v158
 v_sub_f32 v239, v239, v158
 v_sub_f32 v175, v175, v158
 v_sub_f32 v132, v132, v158
 v_sub_f32 v133, v133, v158
 v_sub_f32 v134, v134, v158
 v_sub_f32 v135, v135, v158
 v_sub_f32 v159, 0, v158
 v_exp_f32 v159, v159
 s_nop 0
 v_mul_f32 v145, v145, v159
 v_accvgpr_read_b32 v152, a4
 v_accvgpr_read_b32 v153, a5
 v_accvgpr_read_b32 v154, a6
 v_accvgpr_read_b32 v155, a7
 v_mul_f32 v152, v152, v159
 v_mul_f32 v153, v153, v159
 v_mul_f32 v154, v154, v159
 v_mul_f32 v155, v155, v159
 v_accvgpr_write_b32 a4, v152
 v_accvgpr_write_b32 a5, v153
 v_accvgpr_write_b32 a6, v154
 v_accvgpr_write_b32 a7, v155
 v_accvgpr_read_b32 v152, a20
 v_accvgpr_read_b32 v153, a21
 v_accvgpr_read_b32 v154, a22
 v_accvgpr_read_b32 v155, a23
 v_mul_f32 v152, v152, v159
 v_mul_f32 v153, v153, v159
 v_mul_f32 v154, v154, v159
 v_mul_f32 v155, v155, v159
 v_accvgpr_write_b32 a20, v152
 v_accvgpr_write_b32 a21, v153
 v_accvgpr_write_b32 a22, v154
 v_accvgpr_write_b32 a23, v155
 v_accvgpr_read_b32 v152, a36
 v_accvgpr_read_b32 v153, a37
 v_accvgpr_read_b32 v154, a38
 v_accvgpr_read_b32 v155, a39
 v_mul_f32 v152, v152, v159
 v_mul_f32 v153, v153, v159
 v_mul_f32 v154, v154, v159
 v_mul_f32 v155, v155, v159
 v_accvgpr_write_b32 a36, v152
 v_accvgpr_write_b32 a37, v153
 v_accvgpr_write_b32 a38, v154
 v_accvgpr_write_b32 a39, v155
 v_accvgpr_read_b32 v152, a52
 v_accvgpr_read_b32 v153, a53
 v_accvgpr_read_b32 v154, a54
 v_accvgpr_read_b32 v155, a55
 v_mul_f32 v152, v152, v159
 v_mul_f32 v153, v153, v159
 v_mul_f32 v154, v154, v159
 v_mul_f32 v155, v155, v159
 v_accvgpr_write_b32 a52, v152
 v_accvgpr_write_b32 a53, v153
 v_accvgpr_write_b32 a54, v154
 v_accvgpr_write_b32 a55, v155
 v_accvgpr_read_b32 v152, a68
 v_accvgpr_read_b32 v153, a69
 v_accvgpr_read_b32 v154, a70
 v_accvgpr_read_b32 v155, a71
 v_mul_f32 v152, v152, v159
 v_mul_f32 v153, v153, v159
 v_mul_f32 v154, v154, v159
 v_mul_f32 v155, v155, v159
 v_accvgpr_write_b32 a68, v152
 v_accvgpr_write_b32 a69, v153
 v_accvgpr_write_b32 a70, v154
 v_accvgpr_write_b32 a71, v155
 v_accvgpr_read_b32 v152, a84
 v_accvgpr_read_b32 v153, a85
 v_accvgpr_read_b32 v154, a86
 v_accvgpr_read_b32 v155, a87
 v_mul_f32 v152, v152, v159
 v_mul_f32 v153, v153, v159
 v_mul_f32 v154, v154, v159
 v_mul_f32 v155, v155, v159
 v_accvgpr_write_b32 a84, v152
 v_accvgpr_write_b32 a85, v153
 v_accvgpr_write_b32 a86, v154
 v_accvgpr_write_b32 a87, v155
 v_accvgpr_read_b32 v152, a100
 v_accvgpr_read_b32 v153, a101
 v_accvgpr_read_b32 v154, a102
 v_accvgpr_read_b32 v155, a103
 v_mul_f32 v152, v152, v159
 v_mul_f32 v153, v153, v159
 v_mul_f32 v154, v154, v159
 v_mul_f32 v155, v155, v159
 v_accvgpr_write_b32 a100, v152
 v_accvgpr_write_b32 a101, v153
 v_accvgpr_write_b32 a102, v154
 v_accvgpr_write_b32 a103, v155
 v_accvgpr_read_b32 v152, a116
 v_accvgpr_read_b32 v153, a117
 v_accvgpr_read_b32 v154, a118
 v_accvgpr_read_b32 v155, a119
 v_mul_f32 v152, v152, v159
 v_mul_f32 v153, v153, v159
 v_mul_f32 v154, v154, v159
 v_mul_f32 v155, v155, v159
 v_accvgpr_write_b32 a116, v152
 v_accvgpr_write_b32 a117, v153
 v_accvgpr_write_b32 a118, v154
 v_accvgpr_write_b32 a119, v155
 v_accvgpr_read_b32 v152, a132
 v_accvgpr_read_b32 v153, a133
 v_accvgpr_read_b32 v154, a134
 v_accvgpr_read_b32 v155, a135
 v_mul_f32 v152, v152, v159
 v_mul_f32 v153, v153, v159
 v_mul_f32 v154, v154, v159
 v_mul_f32 v155, v155, v159
 v_accvgpr_write_b32 a132, v152
 v_accvgpr_write_b32 a133, v153
 v_accvgpr_write_b32 a134, v154
 v_accvgpr_write_b32 a135, v155
 v_accvgpr_read_b32 v152, a148
 v_accvgpr_read_b32 v153, a149
 v_accvgpr_read_b32 v154, a150
 v_accvgpr_read_b32 v155, a151
 v_mul_f32 v152, v152, v159
 v_mul_f32 v153, v153, v159
 v_mul_f32 v154, v154, v159
 v_mul_f32 v155, v155, v159
 v_accvgpr_write_b32 a148, v152
 v_accvgpr_write_b32 a149, v153
 v_accvgpr_write_b32 a150, v154
 v_accvgpr_write_b32 a151, v155
 v_accvgpr_read_b32 v152, a164
 v_accvgpr_read_b32 v153, a165
 v_accvgpr_read_b32 v154, a166
 v_accvgpr_read_b32 v155, a167
 v_mul_f32 v152, v152, v159
 v_mul_f32 v153, v153, v159
 v_mul_f32 v154, v154, v159
 v_mul_f32 v155, v155, v159
 v_accvgpr_write_b32 a164, v152
 v_accvgpr_write_b32 a165, v153
 v_accvgpr_write_b32 a166, v154
 v_accvgpr_write_b32 a167, v155
 v_accvgpr_read_b32 v152, a180
 v_accvgpr_read_b32 v153, a181
 v_accvgpr_read_b32 v154, a182
 v_accvgpr_read_b32 v155, a183
 v_mul_f32 v152, v152, v159
 v_mul_f32 v153, v153, v159
 v_mul_f32 v154, v154, v159
 v_mul_f32 v155, v155, v159
 v_accvgpr_write_b32 a180, v152
 v_accvgpr_write_b32 a181, v153
 v_accvgpr_write_b32 a182, v154
 v_accvgpr_write_b32 a183, v155
 v_mov_b32 v149, 0
 v_exp_f32 v152, v232
 v_exp_f32 v153, v233
 v_add_f32 v149, v149, v152
 v_add_f32 v149, v149, v153
 v_cvt_pk_bf16_f32 v196, v152, v153
 v_exp_f32 v152, v234
 v_exp_f32 v153, v235
 v_add_f32 v149, v149, v152
 v_add_f32 v149, v149, v153
 v_cvt_pk_bf16_f32 v197, v152, v153
 v_exp_f32 v152, v236
 v_exp_f32 v153, v237
 v_add_f32 v149, v149, v152
 v_add_f32 v149, v149, v153
 v_cvt_pk_bf16_f32 v198, v152, v153
 v_exp_f32 v152, v238
 v_exp_f32 v153, v239
 v_add_f32 v149, v149, v152
 v_add_f32 v149, v149, v153
 v_cvt_pk_bf16_f32 v199, v152, v153
 v_max3_f32 v158, v240, v241, v242
 v_max3_f32 v158, v158, v243, v244
 v_max3_f32 v158, v158, v245, v246
 v_max_f32 v158, v158, v247
 v_mov_b32 v159, v158
 s_nop 1
 v_permlane32_swap_b32 v159, v158
 v_max_f32 v158, v158, v159
 v_mov_b32 v159, v158
 s_nop 1
 v_permlane16_swap_b32 v159, v158
 v_max_f32 v158, v158, v159
 v_max_f32 v158, 0, v158
 v_sub_f32 v240, v240, v158
 v_sub_f32 v176, v176, v158
 v_sub_f32 v241, v241, v158
 v_sub_f32 v177, v177, v158
 v_sub_f32 v242, v242, v158
 v_sub_f32 v178, v178, v158
 v_sub_f32 v243, v243, v158
 v_sub_f32 v179, v179, v158
 v_sub_f32 v244, v244, v158
 v_sub_f32 v180, v180, v158
 v_sub_f32 v245, v245, v158
 v_sub_f32 v181, v181, v158
 v_sub_f32 v246, v246, v158
 v_sub_f32 v182, v182, v158
 v_sub_f32 v247, v247, v158
 v_sub_f32 v183, v183, v158
 v_sub_f32 v136, v136, v158
 v_sub_f32 v137, v137, v158
 v_sub_f32 v138, v138, v158
 v_sub_f32 v139, v139, v158
 v_sub_f32 v159, 0, v158
 v_exp_f32 v159, v159
 s_nop 0
 v_mul_f32 v146, v146, v159
 v_accvgpr_read_b32 v152, a8
 v_accvgpr_read_b32 v153, a9
 v_accvgpr_read_b32 v154, a10
 v_accvgpr_read_b32 v155, a11
 v_mul_f32 v152, v152, v159
 v_mul_f32 v153, v153, v159
 v_mul_f32 v154, v154, v159
 v_mul_f32 v155, v155, v159
 v_accvgpr_write_b32 a8, v152
 v_accvgpr_write_b32 a9, v153
 v_accvgpr_write_b32 a10, v154
 v_accvgpr_write_b32 a11, v155
 v_accvgpr_read_b32 v152, a24
 v_accvgpr_read_b32 v153, a25
 v_accvgpr_read_b32 v154, a26
 v_accvgpr_read_b32 v155, a27
 v_mul_f32 v152, v152, v159
 v_mul_f32 v153, v153, v159
 v_mul_f32 v154, v154, v159
 v_mul_f32 v155, v155, v159
 v_accvgpr_write_b32 a24, v152
 v_accvgpr_write_b32 a25, v153
 v_accvgpr_write_b32 a26, v154
 v_accvgpr_write_b32 a27, v155
 v_accvgpr_read_b32 v152, a40
 v_accvgpr_read_b32 v153, a41
 v_accvgpr_read_b32 v154, a42
 v_accvgpr_read_b32 v155, a43
 v_mul_f32 v152, v152, v159
 v_mul_f32 v153, v153, v159
 v_mul_f32 v154, v154, v159
 v_mul_f32 v155, v155, v159
 v_accvgpr_write_b32 a40, v152
 v_accvgpr_write_b32 a41, v153
 v_accvgpr_write_b32 a42, v154
 v_accvgpr_write_b32 a43, v155
 v_accvgpr_read_b32 v152, a56
 v_accvgpr_read_b32 v153, a57
 v_accvgpr_read_b32 v154, a58
 v_accvgpr_read_b32 v155, a59
 v_mul_f32 v152, v152, v159
 v_mul_f32 v153, v153, v159
 v_mul_f32 v154, v154, v159
 v_mul_f32 v155, v155, v159
 v_accvgpr_write_b32 a56, v152
 v_accvgpr_write_b32 a57, v153
 v_accvgpr_write_b32 a58, v154
 v_accvgpr_write_b32 a59, v155
 v_accvgpr_read_b32 v152, a72
 v_accvgpr_read_b32 v153, a73
 v_accvgpr_read_b32 v154, a74
 v_accvgpr_read_b32 v155, a75
 v_mul_f32 v152, v152, v159
 v_mul_f32 v153, v153, v159
 v_mul_f32 v154, v154, v159
 v_mul_f32 v155, v155, v159
 v_accvgpr_write_b32 a72, v152
 v_accvgpr_write_b32 a73, v153
 v_accvgpr_write_b32 a74, v154
 v_accvgpr_write_b32 a75, v155
 v_accvgpr_read_b32 v152, a88
 v_accvgpr_read_b32 v153, a89
 v_accvgpr_read_b32 v154, a90
 v_accvgpr_read_b32 v155, a91
 v_mul_f32 v152, v152, v159
 v_mul_f32 v153, v153, v159
 v_mul_f32 v154, v154, v159
 v_mul_f32 v155, v155, v159
 v_accvgpr_write_b32 a88, v152
 v_accvgpr_write_b32 a89, v153
 v_accvgpr_write_b32 a90, v154
 v_accvgpr_write_b32 a91, v155
 v_accvgpr_read_b32 v152, a104
 v_accvgpr_read_b32 v153, a105
 v_accvgpr_read_b32 v154, a106
 v_accvgpr_read_b32 v155, a107
 v_mul_f32 v152, v152, v159
 v_mul_f32 v153, v153, v159
 v_mul_f32 v154, v154, v159
 v_mul_f32 v155, v155, v159
 v_accvgpr_write_b32 a104, v152
 v_accvgpr_write_b32 a105, v153
 v_accvgpr_write_b32 a106, v154
 v_accvgpr_write_b32 a107, v155
 v_accvgpr_read_b32 v152, a120
 v_accvgpr_read_b32 v153, a121
 v_accvgpr_read_b32 v154, a122
 v_accvgpr_read_b32 v155, a123
 v_mul_f32 v152, v152, v159
 v_mul_f32 v153, v153, v159
 v_mul_f32 v154, v154, v159
 v_mul_f32 v155, v155, v159
 v_accvgpr_write_b32 a120, v152
 v_accvgpr_write_b32 a121, v153
 v_accvgpr_write_b32 a122, v154
 v_accvgpr_write_b32 a123, v155
 v_accvgpr_read_b32 v152, a136
 v_accvgpr_read_b32 v153, a137
 v_accvgpr_read_b32 v154, a138
 v_accvgpr_read_b32 v155, a139
 v_mul_f32 v152, v152, v159
 v_mul_f32 v153, v153, v159
 v_mul_f32 v154, v154, v159
 v_mul_f32 v155, v155, v159
 v_accvgpr_write_b32 a136, v152
 v_accvgpr_write_b32 a137, v153
 v_accvgpr_write_b32 a138, v154
 v_accvgpr_write_b32 a139, v155
 v_accvgpr_read_b32 v152, a152
 v_accvgpr_read_b32 v153, a153
 v_accvgpr_read_b32 v154, a154
 v_accvgpr_read_b32 v155, a155
 v_mul_f32 v152, v152, v159
 v_mul_f32 v153, v153, v159
 v_mul_f32 v154, v154, v159
 v_mul_f32 v155, v155, v159
 v_accvgpr_write_b32 a152, v152
 v_accvgpr_write_b32 a153, v153
 v_accvgpr_write_b32 a154, v154
 v_accvgpr_write_b32 a155, v155
 v_accvgpr_read_b32 v152, a168
 v_accvgpr_read_b32 v153, a169
 v_accvgpr_read_b32 v154, a170
 v_accvgpr_read_b32 v155, a171
 v_mul_f32 v152, v152, v159
 v_mul_f32 v153, v153, v159
 v_mul_f32 v154, v154, v159
 v_mul_f32 v155, v155, v159
 v_accvgpr_write_b32 a168, v152
 v_accvgpr_write_b32 a169, v153
 v_accvgpr_write_b32 a170, v154
 v_accvgpr_write_b32 a171, v155
 v_accvgpr_read_b32 v152, a184
 v_accvgpr_read_b32 v153, a185
 v_accvgpr_read_b32 v154, a186
 v_accvgpr_read_b32 v155, a187
 v_mul_f32 v152, v152, v159
 v_mul_f32 v153, v153, v159
 v_mul_f32 v154, v154, v159
 v_mul_f32 v155, v155, v159
 v_accvgpr_write_b32 a184, v152
 v_accvgpr_write_b32 a185, v153
 v_accvgpr_write_b32 a186, v154
 v_accvgpr_write_b32 a187, v155
 v_mov_b32 v150, 0
 v_exp_f32 v152, v240
 v_exp_f32 v153, v241
 v_add_f32 v150, v150, v152
 v_add_f32 v150, v150, v153
 v_cvt_pk_bf16_f32 v200, v152, v153
 v_exp_f32 v152, v242
 v_exp_f32 v153, v243
 v_add_f32 v150, v150, v152
 v_add_f32 v150, v150, v153
 v_cvt_pk_bf16_f32 v201, v152, v153
 v_exp_f32 v152, v244
 v_exp_f32 v153, v245
 v_add_f32 v150, v150, v152
 v_add_f32 v150, v150, v153
 v_cvt_pk_bf16_f32 v202, v152, v153
 v_exp_f32 v152, v246
 v_exp_f32 v153, v247
 v_add_f32 v150, v150, v152
 v_add_f32 v150, v150, v153
 v_cvt_pk_bf16_f32 v203, v152, v153
 v_max3_f32 v158, v248, v249, v250
 v_max3_f32 v158, v158, v251, v252
 v_max3_f32 v158, v158, v253, v254
 v_max_f32 v158, v158, v255
 v_mov_b32 v159, v158
 s_nop 1
 v_permlane32_swap_b32 v159, v158
 v_max_f32 v158, v158, v159
 v_mov_b32 v159, v158
 s_nop 1
 v_permlane16_swap_b32 v159, v158
 v_max_f32 v158, v158, v159
 v_max_f32 v158, 0, v158
 v_sub_f32 v248, v248, v158
 v_sub_f32 v184, v184, v158
 v_sub_f32 v249, v249, v158
 v_sub_f32 v185, v185, v158
 v_sub_f32 v250, v250, v158
 v_sub_f32 v186, v186, v158
 v_sub_f32 v251, v251, v158
 v_sub_f32 v187, v187, v158
 v_sub_f32 v252, v252, v158
 v_sub_f32 v188, v188, v158
 v_sub_f32 v253, v253, v158
 v_sub_f32 v189, v189, v158
 v_sub_f32 v254, v254, v158
 v_sub_f32 v190, v190, v158
 v_sub_f32 v255, v255, v158
 v_sub_f32 v191, v191, v158
 v_sub_f32 v140, v140, v158
 v_sub_f32 v141, v141, v158
 v_sub_f32 v142, v142, v158
 v_sub_f32 v143, v143, v158
 v_sub_f32 v159, 0, v158
 v_exp_f32 v159, v159
 s_nop 0
 v_mul_f32 v147, v147, v159
 v_accvgpr_read_b32 v152, a12
 v_accvgpr_read_b32 v153, a13
 v_accvgpr_read_b32 v154, a14
 v_accvgpr_read_b32 v155, a15
 v_mul_f32 v152, v152, v159
 v_mul_f32 v153, v153, v159
 v_mul_f32 v154, v154, v159
 v_mul_f32 v155, v155, v159
 v_accvgpr_write_b32 a12, v152
 v_accvgpr_write_b32 a13, v153
 v_accvgpr_write_b32 a14, v154
 v_accvgpr_write_b32 a15, v155
 v_accvgpr_read_b32 v152, a28
 v_accvgpr_read_b32 v153, a29
 v_accvgpr_read_b32 v154, a30
 v_accvgpr_read_b32 v155, a31
 v_mul_f32 v152, v152, v159
 v_mul_f32 v153, v153, v159
 v_mul_f32 v154, v154, v159
 v_mul_f32 v155, v155, v159
 v_accvgpr_write_b32 a28, v152
 v_accvgpr_write_b32 a29, v153
 v_accvgpr_write_b32 a30, v154
 v_accvgpr_write_b32 a31, v155
 v_accvgpr_read_b32 v152, a44
 v_accvgpr_read_b32 v153, a45
 v_accvgpr_read_b32 v154, a46
 v_accvgpr_read_b32 v155, a47
 v_mul_f32 v152, v152, v159
 v_mul_f32 v153, v153, v159
 v_mul_f32 v154, v154, v159
 v_mul_f32 v155, v155, v159
 v_accvgpr_write_b32 a44, v152
 v_accvgpr_write_b32 a45, v153
 v_accvgpr_write_b32 a46, v154
 v_accvgpr_write_b32 a47, v155
 v_accvgpr_read_b32 v152, a60
 v_accvgpr_read_b32 v153, a61
 v_accvgpr_read_b32 v154, a62
 v_accvgpr_read_b32 v155, a63
 v_mul_f32 v152, v152, v159
 v_mul_f32 v153, v153, v159
 v_mul_f32 v154, v154, v159
 v_mul_f32 v155, v155, v159
 v_accvgpr_write_b32 a60, v152
 v_accvgpr_write_b32 a61, v153
 v_accvgpr_write_b32 a62, v154
 v_accvgpr_write_b32 a63, v155
 v_accvgpr_read_b32 v152, a76
 v_accvgpr_read_b32 v153, a77
 v_accvgpr_read_b32 v154, a78
 v_accvgpr_read_b32 v155, a79
 v_mul_f32 v152, v152, v159
 v_mul_f32 v153, v153, v159
 v_mul_f32 v154, v154, v159
 v_mul_f32 v155, v155, v159
 v_accvgpr_write_b32 a76, v152
 v_accvgpr_write_b32 a77, v153
 v_accvgpr_write_b32 a78, v154
 v_accvgpr_write_b32 a79, v155
 v_accvgpr_read_b32 v152, a92
 v_accvgpr_read_b32 v153, a93
 v_accvgpr_read_b32 v154, a94
 v_accvgpr_read_b32 v155, a95
 v_mul_f32 v152, v152, v159
 v_mul_f32 v153, v153, v159
 v_mul_f32 v154, v154, v159
 v_mul_f32 v155, v155, v159
 v_accvgpr_write_b32 a92, v152
 v_accvgpr_write_b32 a93, v153
 v_accvgpr_write_b32 a94, v154
 v_accvgpr_write_b32 a95, v155
 v_accvgpr_read_b32 v152, a108
 v_accvgpr_read_b32 v153, a109
 v_accvgpr_read_b32 v154, a110
 v_accvgpr_read_b32 v155, a111
 v_mul_f32 v152, v152, v159
 v_mul_f32 v153, v153, v159
 v_mul_f32 v154, v154, v159
 v_mul_f32 v155, v155, v159
 v_accvgpr_write_b32 a108, v152
 v_accvgpr_write_b32 a109, v153
 v_accvgpr_write_b32 a110, v154
 v_accvgpr_write_b32 a111, v155
 v_accvgpr_read_b32 v152, a124
 v_accvgpr_read_b32 v153, a125
 v_accvgpr_read_b32 v154, a126
 v_accvgpr_read_b32 v155, a127
 v_mul_f32 v152, v152, v159
 v_mul_f32 v153, v153, v159
 v_mul_f32 v154, v154, v159
 v_mul_f32 v155, v155, v159
 v_accvgpr_write_b32 a124, v152
 v_accvgpr_write_b32 a125, v153
 v_accvgpr_write_b32 a126, v154
 v_accvgpr_write_b32 a127, v155
 v_accvgpr_read_b32 v152, a140
 v_accvgpr_read_b32 v153, a141
 v_accvgpr_read_b32 v154, a142
 v_accvgpr_read_b32 v155, a143
 v_mul_f32 v152, v152, v159
 v_mul_f32 v153, v153, v159
 v_mul_f32 v154, v154, v159
 v_mul_f32 v155, v155, v159
 v_accvgpr_write_b32 a140, v152
 v_accvgpr_write_b32 a141, v153
 v_accvgpr_write_b32 a142, v154
 v_accvgpr_write_b32 a143, v155
 v_accvgpr_read_b32 v152, a156
 v_accvgpr_read_b32 v153, a157
 v_accvgpr_read_b32 v154, a158
 v_accvgpr_read_b32 v155, a159
 v_mul_f32 v152, v152, v159
 v_mul_f32 v153, v153, v159
 v_mul_f32 v154, v154, v159
 v_mul_f32 v155, v155, v159
 v_accvgpr_write_b32 a156, v152
 v_accvgpr_write_b32 a157, v153
 v_accvgpr_write_b32 a158, v154
 v_accvgpr_write_b32 a159, v155
 v_accvgpr_read_b32 v152, a172
 v_accvgpr_read_b32 v153, a173
 v_accvgpr_read_b32 v154, a174
 v_accvgpr_read_b32 v155, a175
 v_mul_f32 v152, v152, v159
 v_mul_f32 v153, v153, v159
 v_mul_f32 v154, v154, v159
 v_mul_f32 v155, v155, v159
 v_accvgpr_write_b32 a172, v152
 v_accvgpr_write_b32 a173, v153
 v_accvgpr_write_b32 a174, v154
 v_accvgpr_write_b32 a175, v155
 v_accvgpr_read_b32 v152, a188
 v_accvgpr_read_b32 v153, a189
 v_accvgpr_read_b32 v154, a190
 v_accvgpr_read_b32 v155, a191
 v_mul_f32 v152, v152, v159
 v_mul_f32 v153, v153, v159
 v_mul_f32 v154, v154, v159
 v_mul_f32 v155, v155, v159
 v_accvgpr_write_b32 a188, v152
 v_accvgpr_write_b32 a189, v153
 v_accvgpr_write_b32 a190, v154
 v_accvgpr_write_b32 a191, v155
 v_mov_b32 v151, 0
 v_exp_f32 v152, v248
 v_exp_f32 v153, v249
 v_add_f32 v151, v151, v152
 v_add_f32 v151, v151, v153
 v_cvt_pk_bf16_f32 v204, v152, v153
 v_exp_f32 v152, v250
 v_exp_f32 v153, v251
 v_add_f32 v151, v151, v152
 v_add_f32 v151, v151, v153
 v_cvt_pk_bf16_f32 v205, v152, v153
 v_exp_f32 v152, v252
 v_exp_f32 v153, v253
 v_add_f32 v151, v151, v152
 v_add_f32 v151, v151, v153
 v_cvt_pk_bf16_f32 v206, v152, v153
 v_exp_f32 v152, v254
 v_exp_f32 v153, v255
 v_add_f32 v151, v151, v152
 v_add_f32 v151, v151, v153
 v_cvt_pk_bf16_f32 v207, v152, v153
 s_nop 2
 s_setpc_b64 s[94:95]
L_SLOW1:
 s_nop 15
 v_max3_f32 v158, v160, v161, v162
 v_max3_f32 v158, v158, v163, v164
 v_max3_f32 v158, v158, v165, v166
 v_max_f32 v158, v158, v167
 v_mov_b32 v159, v158
 s_nop 1
 v_permlane32_swap_b32 v159, v158
 v_max_f32 v158, v158, v159
 v_mov_b32 v159, v158
 s_nop 1
 v_permlane16_swap_b32 v159, v158
 v_max_f32 v158, v158, v159
 v_max_f32 v158, 0, v158
 v_sub_f32 v160, v160, v158
 v_sub_f32 v224, v224, v158
 v_sub_f32 v161, v161, v158
 v_sub_f32 v225, v225, v158
 v_sub_f32 v162, v162, v158
 v_sub_f32 v226, v226, v158
 v_sub_f32 v163, v163, v158
 v_sub_f32 v227, v227, v158
 v_sub_f32 v164, v164, v158
 v_sub_f32 v228, v228, v158
 v_sub_f32 v165, v165, v158
 v_sub_f32 v229, v229, v158
 v_sub_f32 v166, v166, v158
 v_sub_f32 v230, v230, v158
 v_sub_f32 v167, v167, v158
 v_sub_f32 v231, v231, v158
 v_sub_f32 v128, v128, v158
 v_sub_f32 v129, v129, v158
 v_sub_f32 v130, v130, v158
 v_sub_f32 v131, v131, v158
 v_sub_f32 v159, 0, v158
 v_exp_f32 v159, v159
 s_nop 0
 v_mul_f32 v144, v144, v159
 v_accvgpr_read_b32 v152, a0
 v_accvgpr_read_b32 v153, a1
 v_accvgpr_read_b32 v154, a2
 v_accvgpr_read_b32 v155, a3
 v_mul_f32 v152, v152, v159
 v_mul_f32 v153, v153, v159
 v_mul_f32 v154, v154, v159
 v_mul_f32 v155, v155, v159
 v_accvgpr_write_b32 a0, v152
 v_accvgpr_write_b32 a1, v153
 v_accvgpr_write_b32 a2, v154
 v_accvgpr_write_b32 a3, v155
 v_accvgpr_read_b32 v152, a16
 v_accvgpr_read_b32 v153, a17
 v_accvgpr_read_b32 v154, a18
 v_accvgpr_read_b32 v155, a19
 v_mul_f32 v152, v152, v159
 v_mul_f32 v153, v153, v159
 v_mul_f32 v154, v154, v159
 v_mul_f32 v155, v155, v159
 v_accvgpr_write_b32 a16, v152
 v_accvgpr_write_b32 a17, v153
 v_accvgpr_write_b32 a18, v154
 v_accvgpr_write_b32 a19, v155
 v_accvgpr_read_b32 v152, a32
 v_accvgpr_read_b32 v153, a33
 v_accvgpr_read_b32 v154, a34
 v_accvgpr_read_b32 v155, a35
 v_mul_f32 v152, v152, v159
 v_mul_f32 v153, v153, v159
 v_mul_f32 v154, v154, v159
 v_mul_f32 v155, v155, v159
 v_accvgpr_write_b32 a32, v152
 v_accvgpr_write_b32 a33, v153
 v_accvgpr_write_b32 a34, v154
 v_accvgpr_write_b32 a35, v155
 v_accvgpr_read_b32 v152, a48
 v_accvgpr_read_b32 v153, a49
 v_accvgpr_read_b32 v154, a50
 v_accvgpr_read_b32 v155, a51
 v_mul_f32 v152, v152, v159
 v_mul_f32 v153, v153, v159
 v_mul_f32 v154, v154, v159
 v_mul_f32 v155, v155, v159
 v_accvgpr_write_b32 a48, v152
 v_accvgpr_write_b32 a49, v153
 v_accvgpr_write_b32 a50, v154
 v_accvgpr_write_b32 a51, v155
 v_accvgpr_read_b32 v152, a64
 v_accvgpr_read_b32 v153, a65
 v_accvgpr_read_b32 v154, a66
 v_accvgpr_read_b32 v155, a67
 v_mul_f32 v152, v152, v159
 v_mul_f32 v153, v153, v159
 v_mul_f32 v154, v154, v159
 v_mul_f32 v155, v155, v159
 v_accvgpr_write_b32 a64, v152
 v_accvgpr_write_b32 a65, v153
 v_accvgpr_write_b32 a66, v154
 v_accvgpr_write_b32 a67, v155
 v_accvgpr_read_b32 v152, a80
 v_accvgpr_read_b32 v153, a81
 v_accvgpr_read_b32 v154, a82
 v_accvgpr_read_b32 v155, a83
 v_mul_f32 v152, v152, v159
 v_mul_f32 v153, v153, v159
 v_mul_f32 v154, v154, v159
 v_mul_f32 v155, v155, v159
 v_accvgpr_write_b32 a80, v152
 v_accvgpr_write_b32 a81, v153
 v_accvgpr_write_b32 a82, v154
 v_accvgpr_write_b32 a83, v155
 v_accvgpr_read_b32 v152, a96
 v_accvgpr_read_b32 v153, a97
 v_accvgpr_read_b32 v154, a98
 v_accvgpr_read_b32 v155, a99
 v_mul_f32 v152, v152, v159
 v_mul_f32 v153, v153, v159
 v_mul_f32 v154, v154, v159
 v_mul_f32 v155, v155, v159
 v_accvgpr_write_b32 a96, v152
 v_accvgpr_write_b32 a97, v153
 v_accvgpr_write_b32 a98, v154
 v_accvgpr_write_b32 a99, v155
 v_accvgpr_read_b32 v152, a112
 v_accvgpr_read_b32 v153, a113
 v_accvgpr_read_b32 v154, a114
 v_accvgpr_read_b32 v155, a115
 v_mul_f32 v152, v152, v159
 v_mul_f32 v153, v153, v159
 v_mul_f32 v154, v154, v159
 v_mul_f32 v155, v155, v159
 v_accvgpr_write_b32 a112, v152
 v_accvgpr_write_b32 a113, v153
 v_accvgpr_write_b32 a114, v154
 v_accvgpr_write_b32 a115, v155
 v_accvgpr_read_b32 v152, a128
 v_accvgpr_read_b32 v153, a129
 v_accvgpr_read_b32 v154, a130
 v_accvgpr_read_b32 v155, a131
 v_mul_f32 v152, v152, v159
 v_mul_f32 v153, v153, v159
 v_mul_f32 v154, v154, v159
 v_mul_f32 v155, v155, v159
 v_accvgpr_write_b32 a128, v152
 v_accvgpr_write_b32 a129, v153
 v_accvgpr_write_b32 a130, v154
 v_accvgpr_write_b32 a131, v155
 v_accvgpr_read_b32 v152, a144
 v_accvgpr_read_b32 v153, a145
 v_accvgpr_read_b32 v154, a146
 v_accvgpr_read_b32 v155, a147
 v_mul_f32 v152, v152, v159
 v_mul_f32 v153, v153, v159
 v_mul_f32 v154, v154, v159
 v_mul_f32 v155, v155, v159
 v_accvgpr_write_b32 a144, v152
 v_accvgpr_write_b32 a145, v153
 v_accvgpr_write_b32 a146, v154
 v_accvgpr_write_b32 a147, v155
 v_accvgpr_read_b32 v152, a160
 v_accvgpr_read_b32 v153, a161
 v_accvgpr_read_b32 v154, a162
 v_accvgpr_read_b32 v155, a163
 v_mul_f32 v152, v152, v159
 v_mul_f32 v153, v153, v159
 v_mul_f32 v154, v154, v159
 v_mul_f32 v155, v155, v159
 v_accvgpr_write_b32 a160, v152
 v_accvgpr_write_b32 a161, v153
 v_accvgpr_write_b32 a162, v154
 v_accvgpr_write_b32 a163, v155
 v_accvgpr_read_b32 v152, a176
 v_accvgpr_read_b32 v153, a177
 v_accvgpr_read_b32 v154, a178
 v_accvgpr_read_b32 v155, a179
 v_mul_f32 v152, v152, v159
 v_mul_f32 v153, v153, v159
 v_mul_f32 v154, v154, v159
 v_mul_f32 v155, v155, v159
 v_accvgpr_write_b32 a176, v152
 v_accvgpr_write_b32 a177, v153
 v_accvgpr_write_b32 a178, v154
 v_accvgpr_write_b32 a179, v155
 v_mov_b32 v148, 0
 v_exp_f32 v152, v160
 v_exp_f32 v153, v161
 v_add_f32 v148, v148, v152
 v_add_f32 v148, v148, v153
 v_cvt_pk_bf16_f32 v208, v152, v153
 v_exp_f32 v152, v162
 v_exp_f32 v153, v163
 v_add_f32 v148, v148, v152
 v_add_f32 v148, v148, v153
 v_cvt_pk_bf16_f32 v209, v152, v153
 v_exp_f32 v152, v164
 v_exp_f32 v153, v165
 v_add_f32 v148, v148, v152
 v_add_f32 v148, v148, v153
 v_cvt_pk_bf16_f32 v210, v152, v153
 v_exp_f32 v152, v166
 v_exp_f32 v153, v167
 v_add_f32 v148, v148, v152
 v_add_f32 v148, v148, v153
 v_cvt_pk_bf16_f32 v211, v152, v153
 v_max3_f32 v158, v168, v169, v170
 v_max3_f32 v158, v158, v171, v172
 v_max3_f32 v158, v158, v173, v174
 v_max_f32 v158, v158, v175
 v_mov_b32 v159, v158
 s_nop 1
 v_permlane32_swap_b32 v159, v158
 v_max_f32 v158, v158, v159
 v_mov_b32 v159, v158
 s_nop 1
 v_permlane16_swap_b32 v159, v158
 v_max_f32 v158, v158, v159
 v_max_f32 v158, 0, v158
 v_sub_f32 v168, v168, v158
 v_sub_f32 v232, v232, v158
 v_sub_f32 v169, v169, v158
 v_sub_f32 v233, v233, v158
 v_sub_f32 v170, v170, v158
 v_sub_f32 v234, v234, v158
 v_sub_f32 v171, v171, v158
 v_sub_f32 v235, v235, v158
 v_sub_f32 v172, v172, v158
 v_sub_f32 v236, v236, v158
 v_sub_f32 v173, v173, v158
 v_sub_f32 v237, v237, v158
 v_sub_f32 v174, v174, v158
 v_sub_f32 v238, v238, v158
 v_sub_f32 v175, v175, v158
 v_sub_f32 v239, v239, v158
 v_sub_f32 v132, v132, v158
 v_sub_f32 v133, v133, v158
 v_sub_f32 v134, v134, v158
 v_sub_f32 v135, v135, v158
 v_sub_f32 v159, 0, v158
 v_exp_f32 v159, v159
 s_nop 0
 v_mul_f32 v145, v145, v159
 v_accvgpr_read_b32 v152, a4
 v_accvgpr_read_b32 v153, a5
 v_accvgpr_read_b32 v154, a6
 v_accvgpr_read_b32 v155, a7
 v_mul_f32 v152, v152, v159
 v_mul_f32 v153, v153, v159
 v_mul_f32 v154, v154, v159
 v_mul_f32 v155, v155, v159
 v_accvgpr_write_b32 a4, v152
 v_accvgpr_write_b32 a5, v153
 v_accvgpr_write_b32 a6, v154
 v_accvgpr_write_b32 a7, v155
 v_accvgpr_read_b32 v152, a20
 v_accvgpr_read_b32 v153, a21
 v_accvgpr_read_b32 v154, a22
 v_accvgpr_read_b32 v155, a23
 v_mul_f32 v152, v152, v159
 v_mul_f32 v153, v153, v159
 v_mul_f32 v154, v154, v159
 v_mul_f32 v155, v155, v159
 v_accvgpr_write_b32 a20, v152
 v_accvgpr_write_b32 a21, v153
 v_accvgpr_write_b32 a22, v154
 v_accvgpr_write_b32 a23, v155
 v_accvgpr_read_b32 v152, a36
 v_accvgpr_read_b32 v153, a37
 v_accvgpr_read_b32 v154, a38
 v_accvgpr_read_b32 v155, a39
 v_mul_f32 v152, v152, v159
 v_mul_f32 v153, v153, v159
 v_mul_f32 v154, v154, v159
 v_mul_f32 v155, v155, v159
 v_accvgpr_write_b32 a36, v152
 v_accvgpr_write_b32 a37, v153
 v_accvgpr_write_b32 a38, v154
 v_accvgpr_write_b32 a39, v155
 v_accvgpr_read_b32 v152, a52
 v_accvgpr_read_b32 v153, a53
 v_accvgpr_read_b32 v154, a54
 v_accvgpr_read_b32 v155, a55
 v_mul_f32 v152, v152, v159
 v_mul_f32 v153, v153, v159
 v_mul_f32 v154, v154, v159
 v_mul_f32 v155, v155, v159
 v_accvgpr_write_b32 a52, v152
 v_accvgpr_write_b32 a53, v153
 v_accvgpr_write_b32 a54, v154
 v_accvgpr_write_b32 a55, v155
 v_accvgpr_read_b32 v152, a68
 v_accvgpr_read_b32 v153, a69
 v_accvgpr_read_b32 v154, a70
 v_accvgpr_read_b32 v155, a71
 v_mul_f32 v152, v152, v159
 v_mul_f32 v153, v153, v159
 v_mul_f32 v154, v154, v159
 v_mul_f32 v155, v155, v159
 v_accvgpr_write_b32 a68, v152
 v_accvgpr_write_b32 a69, v153
 v_accvgpr_write_b32 a70, v154
 v_accvgpr_write_b32 a71, v155
 v_accvgpr_read_b32 v152, a84
 v_accvgpr_read_b32 v153, a85
 v_accvgpr_read_b32 v154, a86
 v_accvgpr_read_b32 v155, a87
 v_mul_f32 v152, v152, v159
 v_mul_f32 v153, v153, v159
 v_mul_f32 v154, v154, v159
 v_mul_f32 v155, v155, v159
 v_accvgpr_write_b32 a84, v152
 v_accvgpr_write_b32 a85, v153
 v_accvgpr_write_b32 a86, v154
 v_accvgpr_write_b32 a87, v155
 v_accvgpr_read_b32 v152, a100
 v_accvgpr_read_b32 v153, a101
 v_accvgpr_read_b32 v154, a102
 v_accvgpr_read_b32 v155, a103
 v_mul_f32 v152, v152, v159
 v_mul_f32 v153, v153, v159
 v_mul_f32 v154, v154, v159
 v_mul_f32 v155, v155, v159
 v_accvgpr_write_b32 a100, v152
 v_accvgpr_write_b32 a101, v153
 v_accvgpr_write_b32 a102, v154
 v_accvgpr_write_b32 a103, v155
 v_accvgpr_read_b32 v152, a116
 v_accvgpr_read_b32 v153, a117
 v_accvgpr_read_b32 v154, a118
 v_accvgpr_read_b32 v155, a119
 v_mul_f32 v152, v152, v159
 v_mul_f32 v153, v153, v159
 v_mul_f32 v154, v154, v159
 v_mul_f32 v155, v155, v159
 v_accvgpr_write_b32 a116, v152
 v_accvgpr_write_b32 a117, v153
 v_accvgpr_write_b32 a118, v154
 v_accvgpr_write_b32 a119, v155
 v_accvgpr_read_b32 v152, a132
 v_accvgpr_read_b32 v153, a133
 v_accvgpr_read_b32 v154, a134
 v_accvgpr_read_b32 v155, a135
 v_mul_f32 v152, v152, v159
 v_mul_f32 v153, v153, v159
 v_mul_f32 v154, v154, v159
 v_mul_f32 v155, v155, v159
 v_accvgpr_write_b32 a132, v152
 v_accvgpr_write_b32 a133, v153
 v_accvgpr_write_b32 a134, v154
 v_accvgpr_write_b32 a135, v155
 v_accvgpr_read_b32 v152, a148
 v_accvgpr_read_b32 v153, a149
 v_accvgpr_read_b32 v154, a150
 v_accvgpr_read_b32 v155, a151
 v_mul_f32 v152, v152, v159
 v_mul_f32 v153, v153, v159
 v_mul_f32 v154, v154, v159
 v_mul_f32 v155, v155, v159
 v_accvgpr_write_b32 a148, v152
 v_accvgpr_write_b32 a149, v153
 v_accvgpr_write_b32 a150, v154
 v_accvgpr_write_b32 a151, v155
 v_accvgpr_read_b32 v152, a164
 v_accvgpr_read_b32 v153, a165
 v_accvgpr_read_b32 v154, a166
 v_accvgpr_read_b32 v155, a167
 v_mul_f32 v152, v152, v159
 v_mul_f32 v153, v153, v159
 v_mul_f32 v154, v154, v159
 v_mul_f32 v155, v155, v159
 v_accvgpr_write_b32 a164, v152
 v_accvgpr_write_b32 a165, v153
 v_accvgpr_write_b32 a166, v154
 v_accvgpr_write_b32 a167, v155
 v_accvgpr_read_b32 v152, a180
 v_accvgpr_read_b32 v153, a181
 v_accvgpr_read_b32 v154, a182
 v_accvgpr_read_b32 v155, a183
 v_mul_f32 v152, v152, v159
 v_mul_f32 v153, v153, v159
 v_mul_f32 v154, v154, v159
 v_mul_f32 v155, v155, v159
 v_accvgpr_write_b32 a180, v152
 v_accvgpr_write_b32 a181, v153
 v_accvgpr_write_b32 a182, v154
 v_accvgpr_write_b32 a183, v155
 v_mov_b32 v149, 0
 v_exp_f32 v152, v168
 v_exp_f32 v153, v169
 v_add_f32 v149, v149, v152
 v_add_f32 v149, v149, v153
 v_cvt_pk_bf16_f32 v212, v152, v153
 v_exp_f32 v152, v170
 v_exp_f32 v153, v171
 v_add_f32 v149, v149, v152
 v_add_f32 v149, v149, v153
 v_cvt_pk_bf16_f32 v213, v152, v153
 v_exp_f32 v152, v172
 v_exp_f32 v153, v173
 v_add_f32 v149, v149, v152
 v_add_f32 v149, v149, v153
 v_cvt_pk_bf16_f32 v214, v152, v153
 v_exp_f32 v152, v174
 v_exp_f32 v153, v175
 v_add_f32 v149, v149, v152
 v_add_f32 v149, v149, v153
 v_cvt_pk_bf16_f32 v215, v152, v153
 v_max3_f32 v158, v176, v177, v178
 v_max3_f32 v158, v158, v179, v180
 v_max3_f32 v158, v158, v181, v182
 v_max_f32 v158, v158, v183
 v_mov_b32 v159, v158
 s_nop 1
 v_permlane32_swap_b32 v159, v158
 v_max_f32 v158, v158, v159
 v_mov_b32 v159, v158
 s_nop 1
 v_permlane16_swap_b32 v159, v158
 v_max_f32 v158, v158, v159
 v_max_f32 v158, 0, v158
 v_sub_f32 v176, v176, v158
 v_sub_f32 v240, v240, v158
 v_sub_f32 v177, v177, v158
 v_sub_f32 v241, v241, v158
 v_sub_f32 v178, v178, v158
 v_sub_f32 v242, v242, v158
 v_sub_f32 v179, v179, v158
 v_sub_f32 v243, v243, v158
 v_sub_f32 v180, v180, v158
 v_sub_f32 v244, v244, v158
 v_sub_f32 v181, v181, v158
 v_sub_f32 v245, v245, v158
 v_sub_f32 v182, v182, v158
 v_sub_f32 v246, v246, v158
 v_sub_f32 v183, v183, v158
 v_sub_f32 v247, v247, v158
 v_sub_f32 v136, v136, v158
 v_sub_f32 v137, v137, v158
 v_sub_f32 v138, v138, v158
 v_sub_f32 v139, v139, v158
 v_sub_f32 v159, 0, v158
 v_exp_f32 v159, v159
 s_nop 0
 v_mul_f32 v146, v146, v159
 v_accvgpr_read_b32 v152, a8
 v_accvgpr_read_b32 v153, a9
 v_accvgpr_read_b32 v154, a10
 v_accvgpr_read_b32 v155, a11
 v_mul_f32 v152, v152, v159
 v_mul_f32 v153, v153, v159
 v_mul_f32 v154, v154, v159
 v_mul_f32 v155, v155, v159
 v_accvgpr_write_b32 a8, v152
 v_accvgpr_write_b32 a9, v153
 v_accvgpr_write_b32 a10, v154
 v_accvgpr_write_b32 a11, v155
 v_accvgpr_read_b32 v152, a24
 v_accvgpr_read_b32 v153, a25
 v_accvgpr_read_b32 v154, a26
 v_accvgpr_read_b32 v155, a27
 v_mul_f32 v152, v152, v159
 v_mul_f32 v153, v153, v159
 v_mul_f32 v154, v154, v159
 v_mul_f32 v155, v155, v159
 v_accvgpr_write_b32 a24, v152
 v_accvgpr_write_b32 a25, v153
 v_accvgpr_write_b32 a26, v154
 v_accvgpr_write_b32 a27, v155
 v_accvgpr_read_b32 v152, a40
 v_accvgpr_read_b32 v153, a41
 v_accvgpr_read_b32 v154, a42
 v_accvgpr_read_b32 v155, a43
 v_mul_f32 v152, v152, v159
 v_mul_f32 v153, v153, v159
 v_mul_f32 v154, v154, v159
 v_mul_f32 v155, v155, v159
 v_accvgpr_write_b32 a40, v152
 v_accvgpr_write_b32 a41, v153
 v_accvgpr_write_b32 a42, v154
 v_accvgpr_write_b32 a43, v155
 v_accvgpr_read_b32 v152, a56
 v_accvgpr_read_b32 v153, a57
 v_accvgpr_read_b32 v154, a58
 v_accvgpr_read_b32 v155, a59
 v_mul_f32 v152, v152, v159
 v_mul_f32 v153, v153, v159
 v_mul_f32 v154, v154, v159
 v_mul_f32 v155, v155, v159
 v_accvgpr_write_b32 a56, v152
 v_accvgpr_write_b32 a57, v153
 v_accvgpr_write_b32 a58, v154
 v_accvgpr_write_b32 a59, v155
 v_accvgpr_read_b32 v152, a72
 v_accvgpr_read_b32 v153, a73
 v_accvgpr_read_b32 v154, a74
 v_accvgpr_read_b32 v155, a75
 v_mul_f32 v152, v152, v159
 v_mul_f32 v153, v153, v159
 v_mul_f32 v154, v154, v159
 v_mul_f32 v155, v155, v159
 v_accvgpr_write_b32 a72, v152
 v_accvgpr_write_b32 a73, v153
 v_accvgpr_write_b32 a74, v154
 v_accvgpr_write_b32 a75, v155
 v_accvgpr_read_b32 v152, a88
 v_accvgpr_read_b32 v153, a89
 v_accvgpr_read_b32 v154, a90
 v_accvgpr_read_b32 v155, a91
 v_mul_f32 v152, v152, v159
 v_mul_f32 v153, v153, v159
 v_mul_f32 v154, v154, v159
 v_mul_f32 v155, v155, v159
 v_accvgpr_write_b32 a88, v152
 v_accvgpr_write_b32 a89, v153
 v_accvgpr_write_b32 a90, v154
 v_accvgpr_write_b32 a91, v155
 v_accvgpr_read_b32 v152, a104
 v_accvgpr_read_b32 v153, a105
 v_accvgpr_read_b32 v154, a106
 v_accvgpr_read_b32 v155, a107
 v_mul_f32 v152, v152, v159
 v_mul_f32 v153, v153, v159
 v_mul_f32 v154, v154, v159
 v_mul_f32 v155, v155, v159
 v_accvgpr_write_b32 a104, v152
 v_accvgpr_write_b32 a105, v153
 v_accvgpr_write_b32 a106, v154
 v_accvgpr_write_b32 a107, v155
 v_accvgpr_read_b32 v152, a120
 v_accvgpr_read_b32 v153, a121
 v_accvgpr_read_b32 v154, a122
 v_accvgpr_read_b32 v155, a123
 v_mul_f32 v152, v152, v159
 v_mul_f32 v153, v153, v159
 v_mul_f32 v154, v154, v159
 v_mul_f32 v155, v155, v159
 v_accvgpr_write_b32 a120, v152
 v_accvgpr_write_b32 a121, v153
 v_accvgpr_write_b32 a122, v154
 v_accvgpr_write_b32 a123, v155
 v_accvgpr_read_b32 v152, a136
 v_accvgpr_read_b32 v153, a137
 v_accvgpr_read_b32 v154, a138
 v_accvgpr_read_b32 v155, a139
 v_mul_f32 v152, v152, v159
 v_mul_f32 v153, v153, v159
 v_mul_f32 v154, v154, v159
 v_mul_f32 v155, v155, v159
 v_accvgpr_write_b32 a136, v152
 v_accvgpr_write_b32 a137, v153
 v_accvgpr_write_b32 a138, v154
 v_accvgpr_write_b32 a139, v155
 v_accvgpr_read_b32 v152, a152
 v_accvgpr_read_b32 v153, a153
 v_accvgpr_read_b32 v154, a154
 v_accvgpr_read_b32 v155, a155
 v_mul_f32 v152, v152, v159
 v_mul_f32 v153, v153, v159
 v_mul_f32 v154, v154, v159
 v_mul_f32 v155, v155, v159
 v_accvgpr_write_b32 a152, v152
 v_accvgpr_write_b32 a153, v153
 v_accvgpr_write_b32 a154, v154
 v_accvgpr_write_b32 a155, v155
 v_accvgpr_read_b32 v152, a168
 v_accvgpr_read_b32 v153, a169
 v_accvgpr_read_b32 v154, a170
 v_accvgpr_read_b32 v155, a171
 v_mul_f32 v152, v152, v159
 v_mul_f32 v153, v153, v159
 v_mul_f32 v154, v154, v159
 v_mul_f32 v155, v155, v159
 v_accvgpr_write_b32 a168, v152
 v_accvgpr_write_b32 a169, v153
 v_accvgpr_write_b32 a170, v154
 v_accvgpr_write_b32 a171, v155
 v_accvgpr_read_b32 v152, a184
 v_accvgpr_read_b32 v153, a185
 v_accvgpr_read_b32 v154, a186
 v_accvgpr_read_b32 v155, a187
 v_mul_f32 v152, v152, v159
 v_mul_f32 v153, v153, v159
 v_mul_f32 v154, v154, v159
 v_mul_f32 v155, v155, v159
 v_accvgpr_write_b32 a184, v152
 v_accvgpr_write_b32 a185, v153
 v_accvgpr_write_b32 a186, v154
 v_accvgpr_write_b32 a187, v155
 v_mov_b32 v150, 0
 v_exp_f32 v152, v176
 v_exp_f32 v153, v177
 v_add_f32 v150, v150, v152
 v_add_f32 v150, v150, v153
 v_cvt_pk_bf16_f32 v216, v152, v153
 v_exp_f32 v152, v178
 v_exp_f32 v153, v179
 v_add_f32 v150, v150, v152
 v_add_f32 v150, v150, v153
 v_cvt_pk_bf16_f32 v217, v152, v153
 v_exp_f32 v152, v180
 v_exp_f32 v153, v181
 v_add_f32 v150, v150, v152
 v_add_f32 v150, v150, v153
 v_cvt_pk_bf16_f32 v218, v152, v153
 v_exp_f32 v152, v182
 v_exp_f32 v153, v183
 v_add_f32 v150, v150, v152
 v_add_f32 v150, v150, v153
 v_cvt_pk_bf16_f32 v219, v152, v153
 v_max3_f32 v158, v184, v185, v186
 v_max3_f32 v158, v158, v187, v188
 v_max3_f32 v158, v158, v189, v190
 v_max_f32 v158, v158, v191
 v_mov_b32 v159, v158
 s_nop 1
 v_permlane32_swap_b32 v159, v158
 v_max_f32 v158, v158, v159
 v_mov_b32 v159, v158
 s_nop 1
 v_permlane16_swap_b32 v159, v158
 v_max_f32 v158, v158, v159
 v_max_f32 v158, 0, v158
 v_sub_f32 v184, v184, v158
 v_sub_f32 v248, v248, v158
 v_sub_f32 v185, v185, v158
 v_sub_f32 v249, v249, v158
 v_sub_f32 v186, v186, v158
 v_sub_f32 v250, v250, v158
 v_sub_f32 v187, v187, v158
 v_sub_f32 v251, v251, v158
 v_sub_f32 v188, v188, v158
 v_sub_f32 v252, v252, v158
 v_sub_f32 v189, v189, v158
 v_sub_f32 v253, v253, v158
 v_sub_f32 v190, v190, v158
 v_sub_f32 v254, v254, v158
 v_sub_f32 v191, v191, v158
 v_sub_f32 v255, v255, v158
 v_sub_f32 v140, v140, v158
 v_sub_f32 v141, v141, v158
 v_sub_f32 v142, v142, v158
 v_sub_f32 v143, v143, v158
 v_sub_f32 v159, 0, v158
 v_exp_f32 v159, v159
 s_nop 0
 v_mul_f32 v147, v147, v159
 v_accvgpr_read_b32 v152, a12
 v_accvgpr_read_b32 v153, a13
 v_accvgpr_read_b32 v154, a14
 v_accvgpr_read_b32 v155, a15
 v_mul_f32 v152, v152, v159
 v_mul_f32 v153, v153, v159
 v_mul_f32 v154, v154, v159
 v_mul_f32 v155, v155, v159
 v_accvgpr_write_b32 a12, v152
 v_accvgpr_write_b32 a13, v153
 v_accvgpr_write_b32 a14, v154
 v_accvgpr_write_b32 a15, v155
 v_accvgpr_read_b32 v152, a28
 v_accvgpr_read_b32 v153, a29
 v_accvgpr_read_b32 v154, a30
 v_accvgpr_read_b32 v155, a31
 v_mul_f32 v152, v152, v159
 v_mul_f32 v153, v153, v159
 v_mul_f32 v154, v154, v159
 v_mul_f32 v155, v155, v159
 v_accvgpr_write_b32 a28, v152
 v_accvgpr_write_b32 a29, v153
 v_accvgpr_write_b32 a30, v154
 v_accvgpr_write_b32 a31, v155
 v_accvgpr_read_b32 v152, a44
 v_accvgpr_read_b32 v153, a45
 v_accvgpr_read_b32 v154, a46
 v_accvgpr_read_b32 v155, a47
 v_mul_f32 v152, v152, v159
 v_mul_f32 v153, v153, v159
 v_mul_f32 v154, v154, v159
 v_mul_f32 v155, v155, v159
 v_accvgpr_write_b32 a44, v152
 v_accvgpr_write_b32 a45, v153
 v_accvgpr_write_b32 a46, v154
 v_accvgpr_write_b32 a47, v155
 v_accvgpr_read_b32 v152, a60
 v_accvgpr_read_b32 v153, a61
 v_accvgpr_read_b32 v154, a62
 v_accvgpr_read_b32 v155, a63
 v_mul_f32 v152, v152, v159
 v_mul_f32 v153, v153, v159
 v_mul_f32 v154, v154, v159
 v_mul_f32 v155, v155, v159
 v_accvgpr_write_b32 a60, v152
 v_accvgpr_write_b32 a61, v153
 v_accvgpr_write_b32 a62, v154
 v_accvgpr_write_b32 a63, v155
 v_accvgpr_read_b32 v152, a76
 v_accvgpr_read_b32 v153, a77
 v_accvgpr_read_b32 v154, a78
 v_accvgpr_read_b32 v155, a79
 v_mul_f32 v152, v152, v159
 v_mul_f32 v153, v153, v159
 v_mul_f32 v154, v154, v159
 v_mul_f32 v155, v155, v159
 v_accvgpr_write_b32 a76, v152
 v_accvgpr_write_b32 a77, v153
 v_accvgpr_write_b32 a78, v154
 v_accvgpr_write_b32 a79, v155
 v_accvgpr_read_b32 v152, a92
 v_accvgpr_read_b32 v153, a93
 v_accvgpr_read_b32 v154, a94
 v_accvgpr_read_b32 v155, a95
 v_mul_f32 v152, v152, v159
 v_mul_f32 v153, v153, v159
 v_mul_f32 v154, v154, v159
 v_mul_f32 v155, v155, v159
 v_accvgpr_write_b32 a92, v152
 v_accvgpr_write_b32 a93, v153
 v_accvgpr_write_b32 a94, v154
 v_accvgpr_write_b32 a95, v155
 v_accvgpr_read_b32 v152, a108
 v_accvgpr_read_b32 v153, a109
 v_accvgpr_read_b32 v154, a110
 v_accvgpr_read_b32 v155, a111
 v_mul_f32 v152, v152, v159
 v_mul_f32 v153, v153, v159
 v_mul_f32 v154, v154, v159
 v_mul_f32 v155, v155, v159
 v_accvgpr_write_b32 a108, v152
 v_accvgpr_write_b32 a109, v153
 v_accvgpr_write_b32 a110, v154
 v_accvgpr_write_b32 a111, v155
 v_accvgpr_read_b32 v152, a124
 v_accvgpr_read_b32 v153, a125
 v_accvgpr_read_b32 v154, a126
 v_accvgpr_read_b32 v155, a127
 v_mul_f32 v152, v152, v159
 v_mul_f32 v153, v153, v159
 v_mul_f32 v154, v154, v159
 v_mul_f32 v155, v155, v159
 v_accvgpr_write_b32 a124, v152
 v_accvgpr_write_b32 a125, v153
 v_accvgpr_write_b32 a126, v154
 v_accvgpr_write_b32 a127, v155
 v_accvgpr_read_b32 v152, a140
 v_accvgpr_read_b32 v153, a141
 v_accvgpr_read_b32 v154, a142
 v_accvgpr_read_b32 v155, a143
 v_mul_f32 v152, v152, v159
 v_mul_f32 v153, v153, v159
 v_mul_f32 v154, v154, v159
 v_mul_f32 v155, v155, v159
 v_accvgpr_write_b32 a140, v152
 v_accvgpr_write_b32 a141, v153
 v_accvgpr_write_b32 a142, v154
 v_accvgpr_write_b32 a143, v155
 v_accvgpr_read_b32 v152, a156
 v_accvgpr_read_b32 v153, a157
 v_accvgpr_read_b32 v154, a158
 v_accvgpr_read_b32 v155, a159
 v_mul_f32 v152, v152, v159
 v_mul_f32 v153, v153, v159
 v_mul_f32 v154, v154, v159
 v_mul_f32 v155, v155, v159
 v_accvgpr_write_b32 a156, v152
 v_accvgpr_write_b32 a157, v153
 v_accvgpr_write_b32 a158, v154
 v_accvgpr_write_b32 a159, v155
 v_accvgpr_read_b32 v152, a172
 v_accvgpr_read_b32 v153, a173
 v_accvgpr_read_b32 v154, a174
 v_accvgpr_read_b32 v155, a175
 v_mul_f32 v152, v152, v159
 v_mul_f32 v153, v153, v159
 v_mul_f32 v154, v154, v159
 v_mul_f32 v155, v155, v159
 v_accvgpr_write_b32 a172, v152
 v_accvgpr_write_b32 a173, v153
 v_accvgpr_write_b32 a174, v154
 v_accvgpr_write_b32 a175, v155
 v_accvgpr_read_b32 v152, a188
 v_accvgpr_read_b32 v153, a189
 v_accvgpr_read_b32 v154, a190
 v_accvgpr_read_b32 v155, a191
 v_mul_f32 v152, v152, v159
 v_mul_f32 v153, v153, v159
 v_mul_f32 v154, v154, v159
 v_mul_f32 v155, v155, v159
 v_accvgpr_write_b32 a188, v152
 v_accvgpr_write_b32 a189, v153
 v_accvgpr_write_b32 a190, v154
 v_accvgpr_write_b32 a191, v155
 v_mov_b32 v151, 0
 v_exp_f32 v152, v184
 v_exp_f32 v153, v185
 v_add_f32 v151, v151, v152
 v_add_f32 v151, v151, v153
 v_cvt_pk_bf16_f32 v220, v152, v153
 v_exp_f32 v152, v186
 v_exp_f32 v153, v187
 v_add_f32 v151, v151, v152
 v_add_f32 v151, v151, v153
 v_cvt_pk_bf16_f32 v221, v152, v153
 v_exp_f32 v152, v188
 v_exp_f32 v153, v189
 v_add_f32 v151, v151, v152
 v_add_f32 v151, v151, v153
 v_cvt_pk_bf16_f32 v222, v152, v153
 v_exp_f32 v152, v190
 v_exp_f32 v153, v191
 v_add_f32 v151, v151, v152
 v_add_f32 v151, v151, v153
 v_cvt_pk_bf16_f32 v223, v152, v153
 s_nop 2
 s_setpc_b64 s[94:95]
.section .rodata,"a"
.p2align 6
.amdhsa_kernel standalone__gqa_block_cached__near_ridge_kernel
  .amdhsa_next_free_vgpr 512
  .amdhsa_next_free_sgpr 102
  .amdhsa_accum_offset 256
  .amdhsa_group_segment_fixed_size 0
  .amdhsa_kernarg_size 64
  .amdhsa_user_sgpr_count 2
  .amdhsa_user_sgpr_kernarg_segment_ptr 1
  .amdhsa_system_sgpr_workgroup_id_x 1
.end_amdhsa_kernel
```
